```python
import torch

def _softmax(x, axis=-1):
    return torch.softmax(x, dim=axis)
def _gelu(x):
    return torch.nn.functional.gelu(x, approximate="tanh")
def _silu(x):
    return torch.nn.functional.silu(x)
def _sigmoid(x):
    return torch.sigmoid(x)
def _layernorm(x, axis=-1, eps=1e-5):
    m = x.mean(dim=axis, keepdim=True)
    v = x.var(dim=axis, keepdim=True, unbiased=False)
    return (x - m) / torch.sqrt(v + eps)
def _scatter_add(tgt, idx, src, axis=0):
    return tgt.clone().index_add_(axis, idx, src)
def _segment_sum(src, seg, n):
    out = torch.zeros((n,) + src.shape[1:], dtype=src.dtype)
    return out.index_add_(0, seg, src)
def _pad(x, pw):
    flat = tuple(v for pair in reversed(pw) for v in pair)
    return torch.nn.functional.pad(x, flat)

kernel_name = 'concat_heads__compressed_kv_cla__grouped_kv_mqa__prompt'

def setup_inputs():

    _w = (lambda a: (lambda t: t.to(torch.bfloat16) if t.is_floating_point() else t)(torch.as_tensor(a)))
    def _A_setup():
        B, H, Sq, Sk, D, M = 1, 32, 2048, 2048, 128, 640
        Dc = 4 * D
        return {
            "x": _w((lambda *s: torch.randn(*s, dtype=torch.bfloat16) * 0.4)(B, Sq, M)),
            "c_kv": _w((lambda *s: torch.randn(*s, dtype=torch.bfloat16) * 1.6)(B, Sk, Dc)),
            "w_q": _w((lambda *s: torch.randn(*s, dtype=torch.bfloat16) * 3.2)(M, H, D) * (M ** -0.5)),
            "w_uk": _w((lambda *s: torch.randn(*s, dtype=torch.bfloat16) * 3.2)(Dc, H, D) * (Dc ** -0.5)),
            "w_uv": _w((lambda *s: torch.randn(*s, dtype=torch.bfloat16) * 1.6)(Dc, H, D) * (Dc ** -0.5)),
            "w_o": _w((lambda *s: torch.randn(*s, dtype=torch.bfloat16) * 1.6)(H, D, M) * ((H * D) ** -0.5)),
        }
    _A_in = _A_setup()

    def _B_setup():
        B, S, D, H = 1, 2048, 640, 32
        Dh = D // H
        return {
            "x": _w((lambda *s: torch.randn(*s, dtype=torch.bfloat16) * 0.1)(B, S, D)),
            "wq": _w((lambda *s: torch.randn(*s, dtype=torch.bfloat16) * 0.8)(D, H * Dh)),
            "wk": _w((lambda *s: torch.randn(*s, dtype=torch.bfloat16) * 0.8)(D, Dh)),
            "wv": _w((lambda *s: torch.randn(*s, dtype=torch.bfloat16) * 0.4)(D, Dh)),
            "wo": _w((lambda *s: torch.randn(*s, dtype=torch.bfloat16) * 0.4)(H * Dh, D)),
        }
    _B_in = _B_setup()

    return {
        "A_x": _A_in["x"],
        "A_c_kv": _A_in["c_kv"],
        "A_w_q": _A_in["w_q"],
        "A_w_uk": _A_in["w_uk"],
        "A_w_uv": _A_in["w_uv"],
        "A_w_o": _A_in["w_o"],
        "B_x": _B_in["x"],
        "B_wq": _B_in["wq"],
        "B_wk": _B_in["wk"],
        "B_wv": _B_in["wv"],
        "B_wo": _B_in["wo"],
    }

def reference(A_x, A_c_kv, A_w_q, A_w_uk, A_w_uv, A_w_o, B_x, B_wq, B_wk, B_wv, B_wo):
    def _A_ref(x, c_kv, w_q, w_uk, w_uv, w_o):
        B, Sq, M = x.shape[0], x.shape[1], x.shape[2]
        Sk = c_kv.shape[1]
        H, D = w_q.shape[1], w_q.shape[2]
        q = torch.einsum("bqm,mhd->bhqd", x, w_q)
        k = torch.einsum("bkc,chd->bhkd", c_kv, w_uk)
        v = torch.einsum("bkc,chd->bhkd", c_kv, w_uv)
        scores = torch.einsum("bhqd,bhkd->bhqk", q, k) * (D ** -0.5)
        off = Sk - Sq
        qi = torch.arange(Sq)[:, None]
        kj = torch.arange(Sk)[None, :]
        cmask = kj <= (qi + off)
        scores = torch.where(cmask[None, None], scores, -1e9)
        p = _softmax(scores, axis=-1)
        ctx = torch.einsum("bhqk,bhkd->bhqd", p, v)
        return torch.einsum("bhqd,hdm->bqm", ctx, w_o)

    def _B_ref(x, wq, wk, wv, wo):
        B, S, D = x.shape
        H = 32
        Dh = D // H
        q = (lambda x, *d: x.permute(*d))((x @ wq).reshape(B, S, H, Dh), 0, 2, 1, 3)
        k = x @ wk
        v = x @ wv
        scores = torch.einsum("bhqd,bkd->bhqk", q, k) * (Dh ** -0.5)
        p = _softmax(scores, axis=-1)
        o = torch.einsum("bhqk,bkd->bhqd", p, v)
        return (lambda x, *d: x.permute(*d))(o, 0, 2, 1, 3).reshape(B, S, H * Dh) @ wo

    a = _A_ref(A_x, A_c_kv, A_w_q, A_w_uk, A_w_uv, A_w_o)
    b = _B_ref(B_x, B_wq, B_wk, B_wv, B_wo)
    return torch.concatenate([a, b], axis=-1)
```

```asm
; @launch kernel=concat_heads__compressed_kv_cla__grouped_kv_mqa__prompt_kernel grid=(256,1,1) block=(256,1,1) lds=163840
.amdgcn_target "amdgcn-amd-amdhsa--gfx950"
.macro M16 x:vararg
v_mfma_f32_16x16x32_bf16 \x
.endm
.macro M32 x:vararg
v_mfma_f32_32x32x16_bf16 \x
.endm
.macro M8 x:vararg
v_mfma_f32_32x32x8bf16_1k \x
.endm
.macro CVT x:vararg
v_cvt_pk_bf16_f32 \x
.endm
.macro DTR x:vararg
ds_read_b64_tr_b16 \x
.endm
.macro DR x:vararg
ds_read_b128 \x
.endm
.macro BL4 x:vararg
buffer_load_dwordx4 \x
.endm
.macro BS4 x:vararg
buffer_store_dwordx4 \x
.endm
.macro AW x:vararg
v_accvgpr_write_b32 \x
.endm
.macro AR x:vararg
v_accvgpr_read_b32 \x
.endm
.macro EXP x:vararg
v_exp_f32 \x
.endm
.text
.globl concat_heads__compressed_kv_cla__grouped_kv_mqa__prompt_kernel
.p2align 8
.type concat_heads__compressed_kv_cla__grouped_kv_mqa__prompt_kernel,@function
concat_heads__compressed_kv_cla__grouped_kv_mqa__prompt_kernel:
s_cmp_lt_u32 s2, 256
s_cbranch_scc1 L_p1_go
s_endpgm
L_p1_go:
s_load_dwordx16 s[64:79], s[0:1], 0
s_load_dwordx8 s[80:87], s[0:1], 64
s_load_dwordx4 s[88:91], s[0:1], 96
v_and_b32 v1, 63, v0
v_lshrrev_b32 v12, 6, v0
s_nop 0
v_readfirstlane_b32 s20, v12
s_and_b32 s40, s2, 1
s_lshl_b32 s40, s40, 2
s_bfe_u32 s41, s2, 0x20003
s_add_u32 s21, s40, s41
s_bfe_u32 s40, s2, 0x20001
s_lshl_b32 s40, s40, 3
s_lshr_b32 s41, s2, 5
s_add_u32 s22, s40, s41
s_lshl_b32 s34, s20, 12
s_lshl_b32 s35, s20, 10
s_mov_b32 s46, 1073741824
s_waitcnt lgkmcnt(0)
s_mov_b32 s16, s90
s_mov_b32 s17, s91
s_mov_b32 s18, 268435456
s_mov_b32 s19, 0x00020000
s_lshr_b32 s40, s2, 3
s_lshl_b32 s40, s40, 2
s_add_u32 s40, s40, s20
s_getpc_b64 s[56:57]
L_pc_1:
s_add_u32 s56, s56, concat_heads__compressed_kv_cla__grouped_kv_mqa__prompt_kernel-L_pc_1
s_addc_u32 s57, s57, 0-(((concat_heads__compressed_kv_cla__grouped_kv_mqa__prompt_kernel-L_pc_1)>>63)&1)
s_mul_i32 s58, s40, (((L_p3_end-concat_heads__compressed_kv_cla__grouped_kv_mqa__prompt_kernel)/128+128)/128)
v_min_u32 v212, (((L_p3_end-concat_heads__compressed_kv_cla__grouped_kv_mqa__prompt_kernel)/128+128)/128)-1, v1
v_add_u32 v212, s58, v212
v_min_u32 v212, (L_p3_end-concat_heads__compressed_kv_cla__grouped_kv_mqa__prompt_kernel)/128, v212
v_lshlrev_b32 v212, 7, v212
global_load_dword v6, v212, s[56:57]
s_mov_b32 s3, 200000
s_and_b32 s40, s2, 3
s_lshl_b32 s40, s40, 3
s_bfe_u32 s41, s2, 0x30003
s_add_u32 s42, s40, s41
s_bfe_u32 s40, s2, 0x10002
s_lshl_b32 s40, s40, 2
s_lshr_b32 s41, s2, 6
s_add_u32 s43, s40, s41
s_lshl_b32 s42, s42, 7
s_lshl_b32 s43, s43, 2
s_add_u32 s43, s43, s42
s_add_u32 s43, s43, 125894656
s_lshr_b32 s42, s2, 5
s_lshl_b32 s42, s42, 3
s_and_b32 s40, s2, 7
s_add_u32 s42, s42, s40
s_lshl_b32 s42, s42, 7
s_bfe_u32 s40, s2, 0x20003
s_lshl_b32 s40, s40, 2
s_add_u32 s42, s42, s40
s_add_u32 s42, s42, 125829120
v_mov_b32 v212, 0
s_cmp_lg_u32 s20, 0
s_cbranch_scc1 L_p1_nz
s_mov_b64 exec, 1
buffer_store_dword v212, v212, s[16:19], s42 offen sc1
buffer_store_dword v212, v212, s[16:19], s43 offen sc1
s_mov_b64 exec, -1
L_p1_nz:
s_cmp_ge_u32 s22, 26
s_cbranch_scc1 L_p1_roleB
s_lshl_b32 s40, s20, 15
v_lshl_add_u32 v7, v1, 4, s40
v_add_u32 v8, 4096, v7
v_add_u32 v9, 8192, v7
v_add_u32 v10, 12288, v7
s_mov_b32 s12, s66
s_mov_b32 s13, s67
s_mov_b32 s14, 2097152
s_mov_b32 s15, 0x00020000
s_mov_b32 s31, 1330267456
s_mov_b32 s40, s22
s_cmp_ge_u32 s22, 4
s_cselect_b32 s31, 1667127636, s31
s_cselect_b32 s41, 4, 0
s_sub_u32 s42, s22, s41
s_min_u32 s40, s40, s42
s_cmp_ge_u32 s22, 8
s_cselect_b32 s31, 2003987816, s31
s_cselect_b32 s41, 8, 0
s_sub_u32 s42, s22, s41
s_min_u32 s40, s40, s42
s_cmp_ge_u32 s22, 12
s_cselect_b32 s31, 1330267456, s31
s_cselect_b32 s41, 12, 0
s_sub_u32 s42, s22, s41
s_min_u32 s40, s40, s42
s_cmp_ge_u32 s22, 16
s_cselect_b32 s31, 1667127636, s31
s_cselect_b32 s41, 16, 0
s_sub_u32 s42, s22, s41
s_min_u32 s40, s40, s42
s_cmp_ge_u32 s22, 20
s_cselect_b32 s31, 2003987816, s31
s_cselect_b32 s41, 20, 0
s_sub_u32 s42, s22, s41
s_min_u32 s40, s40, s42
s_cmp_ge_u32 s22, 24
s_cselect_b32 s31, 15420, s31
s_cselect_b32 s41, 24, 0
s_sub_u32 s42, s22, s41
s_min_u32 s40, s40, s42
s_mul_i32 s40, s40, 8
s_lshr_b32 s31, s31, s40
s_and_b32 s31, s31, 255
s_lshr_b32 s23, s31, 6
s_add_u32 s23, s23, 2
s_and_b32 s31, s31, 63
s_lshl_b32 s31, s31, 1
s_mov_b32 s40, 50327552
s_bitcmp1_b32 s40, s22
s_cbranch_scc1 L_p1_roleV
L_p1_roleK:
s_lshl_b32 s38, s21, 17
s_add_u32 s38, s38, 0
s_mov_b32 s30, 1040356334
s_mov_b32 s8, s70
s_mov_b32 s9, s71
s_mov_b32 s10, 4194304
s_mov_b32 s11, 0x00020000
s_lshl_b32 s36, s31, 6
s_mov_b32 s37, 524288
s_and_b32 s40, s21, 3
s_lshl_b32 s40, s40, 2
s_add_u32 s40, s40, s20
s_mul_i32 s40, s40, 16
v_min_u32 v212, 31, v1
v_lshrrev_b32 v213, 1, v212
v_add_u32 v213, s40, v213
s_lshr_b32 s40, s37, 6
v_mul_lo_u32 v213, v213, s40
v_and_b32 v212, 1, v212
v_lshl_add_u32 v216, v212, 7, v213
s_mul_i32 s44, s37, 4
s_add_u32 s44, s44, s36
s_mov_b32 s43, s36
s_lshr_b32 s40, s2, 3
s_lshl_b32 s40, s40, 2
s_add_u32 s40, s40, s20
s_and_b32 s41, s2, 1
s_lshl_b32 s41, s41, 7
s_add_u32 s40, s40, s41
s_lshl_b32 s56, s40, 13
s_mul_i32 s57, s40, 10240
v_min_u32 v212, 31, v1
v_lshrrev_b32 v213, 2, v212
v_and_b32 v212, 3, v212
v_lshlrev_b32 v212, 7, v212
v_lshl_add_u32 v217, v213, 10, v212
v_min_u32 v212, 39, v1
v_mul_u32_u24 v213, 52, v212
v_lshrrev_b32 v213, 8, v213
v_mul_u32_u24 v214, 5, v213
v_sub_u32 v212, v212, v214
v_lshlrev_b32 v212, 7, v212
v_mul_u32_u24 v213, 1280, v213
v_add_u32 v218, v212, v213
s_mov_b32 s48, s66
s_mov_b32 s49, s67
s_mov_b32 s50, 2097152
s_mov_b32 s51, 0x00020000
s_mov_b32 s60, s76
s_mov_b32 s61, s77
s_mov_b32 s62, 2621440
s_mov_b32 s63, 0x00020000
buffer_load_dword v6, v217, s[48:51], s56 offen offset:0
buffer_load_dword v6, v216, s[8:11], s43 offen
s_and_b32 s40, s2, 6
s_cmp_lg_u32 s40, 6
s_cbranch_scc1 L_pf_K_0
buffer_load_dword v6, v218, s[60:63], s57 offen offset:0
L_pf_K_0:
s_lshr_b32 s40, s37, 6
v_lshrrev_b32 v220, 4, v1
s_lshl_b32 s41, s20, 4
v_add_u32 v221, s41, v220
v_mul_lo_u32 v221, v221, s40
v_lshlrev_b32 v220, 1, v220
v_and_b32 v222, 15, v1
v_xor_b32 v220, v220, v222
s_lshl_b32 s40, s40, 2
s_sub_u32 s40, s40, 1024
v_lshl_add_u32 v208, v220, 4, v221
v_add_u32 v209, s40, v208
v_xor_b32 v220, 8, v220
v_lshl_add_u32 v210, v220, 4, v221
s_lshl_b32 s41, s40, 1
v_add_u32 v210, s41, v210
v_add_u32 v211, s40, v210
s_lshl_b32 s40, s21, 2
s_add_u32 s40, s40, s20
s_mul_i32 s40, s40, 65536
v_lshrrev_b32 v220, 3, v1
v_mul_u32_u24 v220, 1024, v220
v_add_u32 v220, s40, v220
v_and_b32 v221, 7, v1
v_lshrrev_b32 v222, 4, v1
v_xor_b32 v221, v221, v222
v_xor_b32 v222, 4, v221
v_lshl_add_u32 v221, v221, 4, v220
v_lshl_add_u32 v222, v222, 4, v220
v_add_u32 v200, 0, v221
v_add_u32 v201, 7168, v222
v_add_u32 v202, 14336, v221
v_add_u32 v203, 21504, v222
v_add_u32 v204, 32768, v221
v_add_u32 v205, 39936, v222
v_add_u32 v206, 47104, v221
v_add_u32 v207, 54272, v222
s_mul_i32 s32, s20, 12288
s_add_u32 s32, s32, 114688
s_add_u32 m0, s34, 65536
s_nop 0
BL4 v208,s[8:11],s36 offen lds
BL4 v209,s[8:11],s36 offen offset:1024 lds
BL4 v210,s[8:11],s36 offen offset:2048 lds
BL4 v211,s[8:11],s36 offen offset:3072 lds
s_add_u32 s36, s36, s37
s_add_u32 m0, s32, 0
s_mov_b32 s33, 0
BL4 v200,s[12:15],s33 offen lds
BL4 v201,s[12:15],s33 offen offset:1024 lds
BL4 v202,s[12:15],s33 offen offset:2048 lds
BL4 v203,s[12:15],s33 offen offset:3072 lds
s_add_u32 m0, s32, 4096
s_nop 0
BL4 v204,s[12:15],s33 offen lds
BL4 v205,s[12:15],s33 offen offset:1024 lds
BL4 v206,s[12:15],s33 offen offset:2048 lds
BL4 v207,s[12:15],s33 offen offset:3072 lds
buffer_load_dword v6, v217, s[48:51], s56 offen offset:512
buffer_load_dword v6, v216, s[8:11], s44 offen
s_and_b32 s40, s2, 6
s_cmp_lg_u32 s40, 6
s_cbranch_scc1 L_pf_K_1
buffer_load_dword v6, v218, s[60:63], s57 offen offset:640
L_pf_K_1:
s_add_u32 m0, s34, 81920
s_nop 0
BL4 v208,s[8:11],s36 offen lds
BL4 v209,s[8:11],s36 offen offset:1024 lds
BL4 v210,s[8:11],s36 offen offset:2048 lds
BL4 v211,s[8:11],s36 offen offset:3072 lds
s_add_u32 s36, s36, s37
s_add_u32 m0, s32, 8192
s_mov_b32 s33, 128
BL4 v200,s[12:15],s33 offen lds
BL4 v201,s[12:15],s33 offen offset:1024 lds
BL4 v202,s[12:15],s33 offen offset:2048 lds
BL4 v203,s[12:15],s33 offen offset:3072 lds
v_and_b32 v220, 15, v1
v_lshrrev_b32 v221, 1, v220
v_lshrrev_b32 v222, 4, v1
v_xor_b32 v221, v221, v222
v_lshlrev_b32 v221, 4, v221
v_lshl_add_u32 v12, v220, 7, v221
v_add_u32 v12, s32, v12
v_xor_b32 v13, 64, v12
v_lshrrev_b32 v220, 4, v1
v_bfe_u32 v221, v1, 2, 2
v_lshl_add_u32 v222, v220, 3, v221
v_lshlrev_b32 v222, 8, v222
v_and_b32 v220, 1, v220
v_lshl_add_u32 v221, v220, 2, v221
v_lshl_add_u32 v222, v221, 5, v222
v_and_b32 v220, 3, v1
v_lshl_add_u32 v222, v220, 3, v222
v_add_u32 v192, 65536, v222
v_xor_b32 v193, 32, v192
v_xor_b32 v194, 64, v192
v_xor_b32 v195, 96, v192
v_xor_b32 v196, 128, v192
v_xor_b32 v197, 160, v192
v_xor_b32 v198, 192, v192
v_xor_b32 v199, 224, v192
v_lshrrev_b32 v212, 3, v1
s_lshl_b32 s40, s20, 7
v_add_u32 v212, s40, v212
v_lshlrev_b32 v212, 13, v212
v_bfe_u32 v213, v1, 4, 1
v_lshlrev_b32 v213, 1, v213
v_and_b32 v214, 7, v1
v_xor_b32 v213, v213, v214
v_lshl_add_u32 v216, v213, 4, v212
v_xor_b32 v213, 4, v213
v_lshl_add_u32 v217, v213, 4, v212
v_add_u32 v218, 129024, v216
v_add_u32 v219, 193536, v217
v_add_u32 v217, 64512, v217
v_lshrrev_b32 v212, 4, v1
v_bfe_u32 v213, v1, 2, 2
v_lshl_add_u32 v214, v212, 3, v213
v_lshlrev_b32 v214, 7, v214
v_and_b32 v212, 1, v212
v_lshrrev_b32 v213, 1, v213
v_lshl_add_u32 v213, v212, 1, v213
v_lshl_add_u32 v214, v213, 5, v214
v_and_b32 v212, 3, v1
v_lshl_add_u32 v5, v212, 3, v214
v_mov_b32 v3, v5
v_xor_b32 v4, 32, v5
s_mov_b32 s27, 0
s_mov_b32 s29, 1073741824
s_lshl_b32 s26, s20, 14
s_lshl_b32 s24, s31, 6
s_add_u32 s25, s24, 256
s_add_u32 s24, s24, 384
s_mov_b32 s92, s68
s_mov_b32 s93, s69
s_mov_b32 s94, 5242880
s_mov_b32 s95, 0x00020000
s_mul_i32 s61, s21, 26
s_add_u32 s61, s61, s22
s_lshl_b32 s61, s61, 2
s_add_u32 s61, s61, s20
s_mul_i32 s61, s61, 6400
v_min_u32 v11, 49, v1
v_lshlrev_b32 v11, 7, v11
s_lshr_b32 s40, s31, 2
s_lshl_b32 s40, s40, 20
s_and_b32 s41, s31, 3
s_lshl_b32 s41, s41, 10
s_add_u32 s40, s40, s41
s_add_u32 s60, s40, s38
s_add_u32 s42, s31, 1
s_lshr_b32 s40, s42, 2
s_lshl_b32 s40, s40, 20
s_and_b32 s41, s42, 3
s_lshl_b32 s41, s41, 10
s_add_u32 s40, s40, s41
s_add_u32 s48, s40, s38
s_add_u32 s49, s48, 4096
s_add_u32 s50, s48, 8192
s_add_u32 s51, s48, 12288
s_add_u32 s42, s31, 2
s_lshr_b32 s40, s42, 2
s_lshl_b32 s40, s40, 20
s_and_b32 s41, s42, 3
s_lshl_b32 s41, s41, 10
s_add_u32 s40, s40, s41
s_add_u32 s52, s40, s38
s_add_u32 s53, s52, 4096
s_add_u32 s54, s52, 8192
s_add_u32 s55, s52, 12288
s_add_u32 s42, s31, 3
s_lshr_b32 s40, s42, 2
s_lshl_b32 s40, s40, 20
s_and_b32 s41, s42, 3
s_lshl_b32 s41, s41, 10
s_add_u32 s40, s40, s41
s_add_u32 s56, s40, s38
s_add_u32 s57, s56, 4096
s_add_u32 s58, s56, 8192
s_add_u32 s59, s56, 12288
s_waitcnt vmcnt(10)
s_barrier
DR a[0:3],v12 offset:0
DR a[16:19],v13 offset:0
DR a[4:7],v12 offset:2048
DR a[20:23],v13 offset:2048
DR a[8:11],v12 offset:4096
DR a[24:27],v13 offset:4096
DR a[12:15],v12 offset:6144
DR a[28:31],v13 offset:6144
s_waitcnt lgkmcnt(4)
s_add_u32 m0, s32, 0
s_nop 0
BL4 v204,s[12:15],s33 offen lds
BL4 v205,s[12:15],s33 offen offset:1024 lds
BL4 v206,s[12:15],s33 offen offset:2048 lds
BL4 v207,s[12:15],s33 offen offset:3072 lds
DTR v[144:145],v192 offset:0
DTR v[146:147],v192 offset:1024
DTR v[148:149],v192 offset:8192
DTR v[150:151],v192 offset:9216
DTR v[152:153],v193 offset:0
DTR v[154:155],v193 offset:1024
DTR v[156:157],v193 offset:8192
DTR v[158:159],v193 offset:9216
DTR v[160:161],v194 offset:0
DTR v[162:163],v194 offset:1024
DTR v[164:165],v194 offset:8192
DTR v[166:167],v194 offset:9216
DTR v[168:169],v195 offset:0
DTR v[170:171],v195 offset:1024
DTR v[172:173],v195 offset:8192
DTR v[174:175],v195 offset:9216
DTR v[176:177],v196 offset:0
DTR v[178:179],v196 offset:1024
DTR v[180:181],v196 offset:8192
DTR v[182:183],v196 offset:9216
s_waitcnt lgkmcnt(15)
M16 v[16:19],v[144:147],a[0:3],0
DTR v[184:185],v197 offset:0
s_add_u32 m0, s32, 4096
M16 v[16:19],v[148:151],a[16:19],v[16:19]
s_mov_b32 s33, 256
M16 v[20:23],v[144:147],a[4:7],0
DTR v[186:187],v197 offset:1024
M16 v[20:23],v[148:151],a[20:23],v[20:23]
BL4 v200,s[12:15],s33 offen lds
M16 v[24:27],v[144:147],a[8:11],0
DTR v[188:189],v197 offset:8192
M16 v[24:27],v[148:151],a[24:27],v[24:27]
BL4 v201,s[12:15],s33 offen offset:1024 lds
M16 v[28:31],v[144:147],a[12:15],0
DTR v[190:191],v197 offset:9216
M16 v[28:31],v[148:151],a[28:31],v[28:31]
s_waitcnt lgkmcnt(15)
M16 v[32:35],v[152:155],a[0:3],0
DTR v[144:145],v198 offset:0
M16 v[32:35],v[156:159],a[16:19],v[32:35]
BL4 v202,s[12:15],s33 offen offset:2048 lds
M16 v[36:39],v[152:155],a[4:7],0
DTR v[146:147],v198 offset:1024
M16 v[36:39],v[156:159],a[20:23],v[36:39]
BL4 v203,s[12:15],s33 offen offset:3072 lds
M16 v[40:43],v[152:155],a[8:11],0
DTR v[148:149],v198 offset:8192
s_waitcnt vmcnt(8)
M16 v[40:43],v[156:159],a[24:27],v[40:43]
DR a[32:35],v12 offset:8192
M16 v[44:47],v[152:155],a[12:15],0
DTR v[150:151],v198 offset:9216
M16 v[44:47],v[156:159],a[28:31],v[44:47]
s_waitcnt lgkmcnt(15)
DR a[48:51],v13 offset:8192
M16 v[48:51],v[160:163],a[0:3],0
DTR v[152:153],v199 offset:0
M16 v[48:51],v[164:167],a[16:19],v[48:51]
DR a[36:39],v12 offset:10240
M16 v[52:55],v[160:163],a[4:7],0
DTR v[154:155],v199 offset:1024
M16 v[52:55],v[164:167],a[20:23],v[52:55]
DR a[52:55],v13 offset:10240
s_waitcnt vmcnt(4)
M16 v[56:59],v[160:163],a[8:11],0
DTR v[156:157],v199 offset:8192
M16 v[56:59],v[164:167],a[24:27],v[56:59]
s_waitcnt lgkmcnt(15)
DR a[40:43],v12 offset:0
M16 v[60:63],v[160:163],a[12:15],0
DTR v[158:159],v199 offset:9216
M16 v[60:63],v[164:167],a[28:31],v[60:63]
s_barrier
DR a[56:59],v13 offset:0
M16 v[64:67],v[168:171],a[0:3],0
DTR v[160:161],v192 offset:16384
M16 v[64:67],v[172:175],a[16:19],v[64:67]
DR a[44:47],v12 offset:2048
M16 v[68:71],v[168:171],a[4:7],0
DTR v[162:163],v192 offset:17408
M16 v[68:71],v[172:175],a[20:23],v[68:71]
DR a[60:63],v13 offset:2048
s_waitcnt lgkmcnt(8)
M16 v[72:75],v[168:171],a[8:11],0
DTR v[164:165],v192 offset:24576
s_add_u32 m0, s32, 8192
M16 v[72:75],v[172:175],a[24:27],v[72:75]
M16 v[76:79],v[168:171],a[12:15],0
DTR v[166:167],v192 offset:25600
M16 v[76:79],v[172:175],a[28:31],v[76:79]
M16 v[80:83],v[176:179],a[0:3],0
DTR v[168:169],v193 offset:16384
M16 v[80:83],v[180:183],a[16:19],v[80:83]
BL4 v204,s[12:15],s33 offen lds
M16 v[84:87],v[176:179],a[4:7],0
DTR v[170:171],v193 offset:17408
M16 v[84:87],v[180:183],a[20:23],v[84:87]
BL4 v205,s[12:15],s33 offen offset:1024 lds
M16 v[88:91],v[176:179],a[8:11],0
DTR v[172:173],v193 offset:24576
M16 v[88:91],v[180:183],a[24:27],v[88:91]
BL4 v206,s[12:15],s33 offen offset:2048 lds
M16 v[92:95],v[176:179],a[12:15],0
DTR v[174:175],v193 offset:25600
M16 v[92:95],v[180:183],a[28:31],v[92:95]
M16 v[96:99],v[184:187],a[0:3],0
DTR v[176:177],v194 offset:16384
M16 v[96:99],v[188:191],a[16:19],v[96:99]
BL4 v207,s[12:15],s33 offen offset:3072 lds
M16 v[100:103],v[184:187],a[4:7],0
DTR v[178:179],v194 offset:17408
s_add_u32 m0, s34, 98304
M16 v[100:103],v[188:191],a[20:23],v[100:103]
BL4 v208,s[8:11],s36 offen lds
M16 v[104:107],v[184:187],a[8:11],0
DTR v[180:181],v194 offset:24576
M16 v[104:107],v[188:191],a[24:27],v[104:107]
BL4 v209,s[8:11],s36 offen offset:1024 lds
M16 v[108:111],v[184:187],a[12:15],0
DTR v[182:183],v194 offset:25600
M16 v[108:111],v[188:191],a[28:31],v[108:111]
M16 v[112:115],v[144:147],a[0:3],0
DTR v[184:185],v195 offset:16384
M16 v[112:115],v[148:151],a[16:19],v[112:115]
BL4 v210,s[8:11],s36 offen offset:2048 lds
M16 v[116:119],v[144:147],a[4:7],0
DTR v[186:187],v195 offset:17408
M16 v[116:119],v[148:151],a[20:23],v[116:119]
BL4 v211,s[8:11],s36 offen offset:3072 lds
M16 v[120:123],v[144:147],a[8:11],0
DTR v[188:189],v195 offset:24576
s_add_u32 s36, s36, s37
M16 v[120:123],v[148:151],a[24:27],v[120:123]
s_add_u32 m0, s26, 0
M16 v[124:127],v[144:147],a[12:15],0
DTR v[190:191],v195 offset:25600
M16 v[124:127],v[148:151],a[28:31],v[124:127]
s_waitcnt lgkmcnt(15)
M16 v[128:131],v[152:155],a[0:3],0
DTR v[144:145],v196 offset:16384
M16 v[128:131],v[156:159],a[16:19],v[128:131]
BL4 v216,s[8:11],s25 offen lds
M16 v[132:135],v[152:155],a[4:7],0
DTR v[146:147],v196 offset:17408
M16 v[132:135],v[156:159],a[20:23],v[132:135]
BL4 v217,s[8:11],s25 offen offset:1024 lds
M16 v[136:139],v[152:155],a[8:11],0
DTR v[148:149],v196 offset:24576
M16 v[136:139],v[156:159],a[24:27],v[136:139]
M16 v[140:143],v[152:155],a[12:15],0
DTR v[150:151],v196 offset:25600
M16 v[140:143],v[156:159],a[28:31],v[140:143]
s_waitcnt lgkmcnt(15)
M16 v[16:19],v[160:163],a[32:35],v[16:19]
DTR v[152:153],v197 offset:16384
s_add_u32 m0, s32, 0
M16 v[16:19],v[164:167],a[48:51],v[16:19]
s_mov_b32 s33, 384
M16 v[20:23],v[160:163],a[36:39],v[20:23]
DTR v[154:155],v197 offset:17408
M16 v[20:23],v[164:167],a[52:55],v[20:23]
BL4 v200,s[12:15],s33 offen lds
M16 v[24:27],v[160:163],a[40:43],v[24:27]
DTR v[156:157],v197 offset:24576
M16 v[24:27],v[164:167],a[56:59],v[24:27]
BL4 v201,s[12:15],s33 offen offset:1024 lds
M16 v[28:31],v[160:163],a[44:47],v[28:31]
DTR v[158:159],v197 offset:25600
M16 v[28:31],v[164:167],a[60:63],v[28:31]
s_waitcnt lgkmcnt(15)
M16 v[32:35],v[168:171],a[32:35],v[32:35]
DTR v[160:161],v198 offset:16384
M16 v[32:35],v[172:175],a[48:51],v[32:35]
BL4 v202,s[12:15],s33 offen offset:2048 lds
M16 v[36:39],v[168:171],a[36:39],v[36:39]
DTR v[162:163],v198 offset:17408
M16 v[36:39],v[172:175],a[52:55],v[36:39]
BL4 v203,s[12:15],s33 offen offset:3072 lds
M16 v[40:43],v[168:171],a[40:43],v[40:43]
DTR v[164:165],v198 offset:24576
s_waitcnt vmcnt(14)
M16 v[40:43],v[172:175],a[56:59],v[40:43]
DR a[64:67],v12 offset:4096
M16 v[44:47],v[168:171],a[44:47],v[44:47]
DTR v[166:167],v198 offset:25600
M16 v[44:47],v[172:175],a[60:63],v[44:47]
s_waitcnt lgkmcnt(15)
DR a[80:83],v13 offset:4096
M16 v[48:51],v[176:179],a[32:35],v[48:51]
DTR v[168:169],v199 offset:16384
M16 v[48:51],v[180:183],a[48:51],v[48:51]
DR a[68:71],v12 offset:6144
M16 v[52:55],v[176:179],a[36:39],v[52:55]
DTR v[170:171],v199 offset:17408
M16 v[52:55],v[180:183],a[52:55],v[52:55]
DR a[84:87],v13 offset:6144
s_waitcnt vmcnt(10)
M16 v[56:59],v[176:179],a[40:43],v[56:59]
DTR v[172:173],v199 offset:24576
M16 v[56:59],v[180:183],a[56:59],v[56:59]
s_waitcnt lgkmcnt(15)
DR a[72:75],v12 offset:8192
M16 v[60:63],v[176:179],a[44:47],v[60:63]
DTR v[174:175],v199 offset:25600
s_waitcnt vmcnt(6)
M16 v[60:63],v[180:183],a[60:63],v[60:63]
s_barrier
DR a[88:91],v13 offset:8192
M16 v[64:67],v[184:187],a[32:35],v[64:67]
DTR v[176:177],v192 offset:32768
M16 v[64:67],v[188:191],a[48:51],v[64:67]
DR a[76:79],v12 offset:10240
M16 v[68:71],v[184:187],a[36:39],v[68:71]
DTR v[178:179],v192 offset:33792
M16 v[68:71],v[188:191],a[52:55],v[68:71]
DR a[92:95],v13 offset:10240
s_waitcnt lgkmcnt(8)
M16 v[72:75],v[184:187],a[40:43],v[72:75]
DTR v[180:181],v192 offset:40960
s_add_u32 m0, s32, 4096
M16 v[72:75],v[188:191],a[56:59],v[72:75]
M16 v[76:79],v[184:187],a[44:47],v[76:79]
DTR v[182:183],v192 offset:41984
M16 v[76:79],v[188:191],a[60:63],v[76:79]
M16 v[80:83],v[144:147],a[32:35],v[80:83]
DTR v[184:185],v193 offset:32768
M16 v[80:83],v[148:151],a[48:51],v[80:83]
BL4 v204,s[12:15],s33 offen lds
M16 v[84:87],v[144:147],a[36:39],v[84:87]
DTR v[186:187],v193 offset:33792
M16 v[84:87],v[148:151],a[52:55],v[84:87]
BL4 v205,s[12:15],s33 offen offset:1024 lds
M16 v[88:91],v[144:147],a[40:43],v[88:91]
DTR v[188:189],v193 offset:40960
M16 v[88:91],v[148:151],a[56:59],v[88:91]
BL4 v206,s[12:15],s33 offen offset:2048 lds
M16 v[92:95],v[144:147],a[44:47],v[92:95]
DTR v[190:191],v193 offset:41984
M16 v[92:95],v[148:151],a[60:63],v[92:95]
M16 v[96:99],v[152:155],a[32:35],v[96:99]
DTR v[144:145],v194 offset:32768
M16 v[96:99],v[156:159],a[48:51],v[96:99]
BL4 v207,s[12:15],s33 offen offset:3072 lds
M16 v[100:103],v[152:155],a[36:39],v[100:103]
DTR v[146:147],v194 offset:33792
s_add_u32 m0, s34, 65536
M16 v[100:103],v[156:159],a[52:55],v[100:103]
BL4 v208,s[8:11],s36 offen lds
M16 v[104:107],v[152:155],a[40:43],v[104:107]
DTR v[148:149],v194 offset:40960
M16 v[104:107],v[156:159],a[56:59],v[104:107]
BL4 v209,s[8:11],s36 offen offset:1024 lds
M16 v[108:111],v[152:155],a[44:47],v[108:111]
DTR v[150:151],v194 offset:41984
M16 v[108:111],v[156:159],a[60:63],v[108:111]
M16 v[112:115],v[160:163],a[32:35],v[112:115]
DTR v[152:153],v195 offset:32768
M16 v[112:115],v[164:167],a[48:51],v[112:115]
BL4 v210,s[8:11],s36 offen offset:2048 lds
M16 v[116:119],v[160:163],a[36:39],v[116:119]
DTR v[154:155],v195 offset:33792
M16 v[116:119],v[164:167],a[52:55],v[116:119]
BL4 v211,s[8:11],s36 offen offset:3072 lds
M16 v[120:123],v[160:163],a[40:43],v[120:123]
DTR v[156:157],v195 offset:40960
s_add_u32 s36, s36, s37
M16 v[120:123],v[164:167],a[56:59],v[120:123]
s_add_u32 m0, s26, 0
M16 v[124:127],v[160:163],a[44:47],v[124:127]
DTR v[158:159],v195 offset:41984
M16 v[124:127],v[164:167],a[60:63],v[124:127]
s_waitcnt lgkmcnt(15)
M16 v[128:131],v[168:171],a[32:35],v[128:131]
DTR v[160:161],v196 offset:32768
M16 v[128:131],v[172:175],a[48:51],v[128:131]
BL4 v218,s[8:11],s25 offen offset:2048 lds
M16 v[132:135],v[168:171],a[36:39],v[132:135]
DTR v[162:163],v196 offset:33792
M16 v[132:135],v[172:175],a[52:55],v[132:135]
BL4 v219,s[8:11],s25 offen offset:3072 lds
M16 v[136:139],v[168:171],a[40:43],v[136:139]
DTR v[164:165],v196 offset:40960
s_add_u32 s25, s25, 262144
M16 v[136:139],v[172:175],a[56:59],v[136:139]
M16 v[140:143],v[168:171],a[44:47],v[140:143]
DTR v[166:167],v196 offset:41984
M16 v[140:143],v[172:175],a[60:63],v[140:143]
s_waitcnt lgkmcnt(15)
M16 v[16:19],v[176:179],a[64:67],v[16:19]
DTR v[168:169],v197 offset:32768
s_add_u32 m0, s32, 8192
M16 v[16:19],v[180:183],a[80:83],v[16:19]
s_mov_b32 s33, 512
M16 v[20:23],v[176:179],a[68:71],v[20:23]
DTR v[170:171],v197 offset:33792
M16 v[20:23],v[180:183],a[84:87],v[20:23]
BL4 v200,s[12:15],s33 offen lds
M16 v[24:27],v[176:179],a[72:75],v[24:27]
DTR v[172:173],v197 offset:40960
M16 v[24:27],v[180:183],a[88:91],v[24:27]
BL4 v201,s[12:15],s33 offen offset:1024 lds
M16 v[28:31],v[176:179],a[76:79],v[28:31]
DTR v[174:175],v197 offset:41984
M16 v[28:31],v[180:183],a[92:95],v[28:31]
s_waitcnt lgkmcnt(15)
M16 v[32:35],v[184:187],a[64:67],v[32:35]
DTR v[176:177],v198 offset:32768
M16 v[32:35],v[188:191],a[80:83],v[32:35]
BL4 v202,s[12:15],s33 offen offset:2048 lds
M16 v[36:39],v[184:187],a[68:71],v[36:39]
DTR v[178:179],v198 offset:33792
M16 v[36:39],v[188:191],a[84:87],v[36:39]
BL4 v203,s[12:15],s33 offen offset:3072 lds
M16 v[40:43],v[184:187],a[72:75],v[40:43]
DTR v[180:181],v198 offset:40960
s_waitcnt vmcnt(14)
M16 v[40:43],v[188:191],a[88:91],v[40:43]
DR a[96:99],v12 offset:0
M16 v[44:47],v[184:187],a[76:79],v[44:47]
DTR v[182:183],v198 offset:41984
M16 v[44:47],v[188:191],a[92:95],v[44:47]
s_waitcnt lgkmcnt(15)
DR a[112:115],v13 offset:0
M16 v[48:51],v[144:147],a[64:67],v[48:51]
DTR v[184:185],v199 offset:32768
M16 v[48:51],v[148:151],a[80:83],v[48:51]
DR a[100:103],v12 offset:2048
M16 v[52:55],v[144:147],a[68:71],v[52:55]
DTR v[186:187],v199 offset:33792
M16 v[52:55],v[148:151],a[84:87],v[52:55]
DR a[116:119],v13 offset:2048
s_waitcnt vmcnt(10)
M16 v[56:59],v[144:147],a[72:75],v[56:59]
DTR v[188:189],v199 offset:40960
M16 v[56:59],v[148:151],a[88:91],v[56:59]
s_waitcnt lgkmcnt(15)
DR a[104:107],v12 offset:4096
M16 v[60:63],v[144:147],a[76:79],v[60:63]
DTR v[190:191],v199 offset:41984
s_waitcnt vmcnt(6)
M16 v[60:63],v[148:151],a[92:95],v[60:63]
s_barrier
DR a[120:123],v13 offset:4096
M16 v[64:67],v[152:155],a[64:67],v[64:67]
DTR v[144:145],v192 offset:0
M16 v[64:67],v[156:159],a[80:83],v[64:67]
DR a[108:111],v12 offset:6144
M16 v[68:71],v[152:155],a[68:71],v[68:71]
DTR v[146:147],v192 offset:1024
M16 v[68:71],v[156:159],a[84:87],v[68:71]
DR a[124:127],v13 offset:6144
s_waitcnt lgkmcnt(8)
M16 v[72:75],v[152:155],a[72:75],v[72:75]
DTR v[148:149],v192 offset:8192
s_add_u32 m0, s32, 0
M16 v[72:75],v[156:159],a[88:91],v[72:75]
M16 v[76:79],v[152:155],a[76:79],v[76:79]
DTR v[150:151],v192 offset:9216
M16 v[76:79],v[156:159],a[92:95],v[76:79]
M16 v[80:83],v[160:163],a[64:67],v[80:83]
DTR v[152:153],v193 offset:0
M16 v[80:83],v[164:167],a[80:83],v[80:83]
BL4 v204,s[12:15],s33 offen lds
M16 v[84:87],v[160:163],a[68:71],v[84:87]
DTR v[154:155],v193 offset:1024
M16 v[84:87],v[164:167],a[84:87],v[84:87]
BL4 v205,s[12:15],s33 offen offset:1024 lds
M16 v[88:91],v[160:163],a[72:75],v[88:91]
DTR v[156:157],v193 offset:8192
M16 v[88:91],v[164:167],a[88:91],v[88:91]
BL4 v206,s[12:15],s33 offen offset:2048 lds
M16 v[92:95],v[160:163],a[76:79],v[92:95]
DTR v[158:159],v193 offset:9216
M16 v[92:95],v[164:167],a[92:95],v[92:95]
M16 v[96:99],v[168:171],a[64:67],v[96:99]
DTR v[160:161],v194 offset:0
M16 v[96:99],v[172:175],a[80:83],v[96:99]
BL4 v207,s[12:15],s33 offen offset:3072 lds
M16 v[100:103],v[168:171],a[68:71],v[100:103]
DTR v[162:163],v194 offset:1024
s_add_u32 m0, s34, 81920
M16 v[100:103],v[172:175],a[84:87],v[100:103]
BL4 v208,s[8:11],s36 offen lds
M16 v[104:107],v[168:171],a[72:75],v[104:107]
DTR v[164:165],v194 offset:8192
M16 v[104:107],v[172:175],a[88:91],v[104:107]
BL4 v209,s[8:11],s36 offen offset:1024 lds
M16 v[108:111],v[168:171],a[76:79],v[108:111]
DTR v[166:167],v194 offset:9216
M16 v[108:111],v[172:175],a[92:95],v[108:111]
M16 v[112:115],v[176:179],a[64:67],v[112:115]
DTR v[168:169],v195 offset:0
M16 v[112:115],v[180:183],a[80:83],v[112:115]
BL4 v210,s[8:11],s36 offen offset:2048 lds
M16 v[116:119],v[176:179],a[68:71],v[116:119]
DTR v[170:171],v195 offset:1024
M16 v[116:119],v[180:183],a[84:87],v[116:119]
BL4 v211,s[8:11],s36 offen offset:3072 lds
M16 v[120:123],v[176:179],a[72:75],v[120:123]
DTR v[172:173],v195 offset:8192
s_add_u32 s36, s36, s37
M16 v[120:123],v[180:183],a[88:91],v[120:123]
s_add_u32 m0, s26, 4096
M16 v[124:127],v[176:179],a[76:79],v[124:127]
DTR v[174:175],v195 offset:9216
M16 v[124:127],v[180:183],a[92:95],v[124:127]
s_waitcnt lgkmcnt(15)
M16 v[128:131],v[184:187],a[64:67],v[128:131]
DTR v[176:177],v196 offset:0
M16 v[128:131],v[188:191],a[80:83],v[128:131]
BL4 v216,s[8:11],s25 offen lds
M16 v[132:135],v[184:187],a[68:71],v[132:135]
DTR v[178:179],v196 offset:1024
M16 v[132:135],v[188:191],a[84:87],v[132:135]
BL4 v217,s[8:11],s25 offen offset:1024 lds
M16 v[136:139],v[184:187],a[72:75],v[136:139]
DTR v[180:181],v196 offset:8192
M16 v[136:139],v[188:191],a[88:91],v[136:139]
M16 v[140:143],v[184:187],a[76:79],v[140:143]
DTR v[182:183],v196 offset:9216
M16 v[140:143],v[188:191],a[92:95],v[140:143]
s_waitcnt lgkmcnt(15)
M16 v[16:19],v[144:147],a[96:99],v[16:19]
DTR v[184:185],v197 offset:0
s_add_u32 m0, s32, 4096
M16 v[16:19],v[148:151],a[112:115],v[16:19]
s_mov_b32 s33, 640
M16 v[20:23],v[144:147],a[100:103],v[20:23]
DTR v[186:187],v197 offset:1024
M16 v[20:23],v[148:151],a[116:119],v[20:23]
BL4 v200,s[12:15],s33 offen lds
M16 v[24:27],v[144:147],a[104:107],v[24:27]
DTR v[188:189],v197 offset:8192
M16 v[24:27],v[148:151],a[120:123],v[24:27]
BL4 v201,s[12:15],s33 offen offset:1024 lds
M16 v[28:31],v[144:147],a[108:111],v[28:31]
DTR v[190:191],v197 offset:9216
M16 v[28:31],v[148:151],a[124:127],v[28:31]
s_waitcnt lgkmcnt(15)
M16 v[32:35],v[152:155],a[96:99],v[32:35]
DTR v[144:145],v198 offset:0
M16 v[32:35],v[156:159],a[112:115],v[32:35]
BL4 v202,s[12:15],s33 offen offset:2048 lds
M16 v[36:39],v[152:155],a[100:103],v[36:39]
DTR v[146:147],v198 offset:1024
M16 v[36:39],v[156:159],a[116:119],v[36:39]
BL4 v203,s[12:15],s33 offen offset:3072 lds
M16 v[40:43],v[152:155],a[104:107],v[40:43]
DTR v[148:149],v198 offset:8192
s_waitcnt vmcnt(14)
M16 v[40:43],v[156:159],a[120:123],v[40:43]
DR a[128:131],v12 offset:8192
M16 v[44:47],v[152:155],a[108:111],v[44:47]
DTR v[150:151],v198 offset:9216
M16 v[44:47],v[156:159],a[124:127],v[44:47]
s_waitcnt lgkmcnt(15)
DR a[144:147],v13 offset:8192
M16 v[48:51],v[160:163],a[96:99],v[48:51]
DTR v[152:153],v199 offset:0
M16 v[48:51],v[164:167],a[112:115],v[48:51]
DR a[132:135],v12 offset:10240
M16 v[52:55],v[160:163],a[100:103],v[52:55]
DTR v[154:155],v199 offset:1024
M16 v[52:55],v[164:167],a[116:119],v[52:55]
DR a[148:151],v13 offset:10240
s_waitcnt vmcnt(10)
M16 v[56:59],v[160:163],a[104:107],v[56:59]
DTR v[156:157],v199 offset:8192
M16 v[56:59],v[164:167],a[120:123],v[56:59]
s_waitcnt lgkmcnt(15)
DR a[136:139],v12 offset:0
M16 v[60:63],v[160:163],a[108:111],v[60:63]
DTR v[158:159],v199 offset:9216
s_waitcnt vmcnt(6)
M16 v[60:63],v[164:167],a[124:127],v[60:63]
s_barrier
DR a[152:155],v13 offset:0
M16 v[64:67],v[168:171],a[96:99],v[64:67]
DTR v[160:161],v192 offset:16384
M16 v[64:67],v[172:175],a[112:115],v[64:67]
DR a[140:143],v12 offset:2048
M16 v[68:71],v[168:171],a[100:103],v[68:71]
DTR v[162:163],v192 offset:17408
M16 v[68:71],v[172:175],a[116:119],v[68:71]
DR a[156:159],v13 offset:2048
s_waitcnt lgkmcnt(8)
M16 v[72:75],v[168:171],a[104:107],v[72:75]
DTR v[164:165],v192 offset:24576
s_add_u32 m0, s32, 8192
M16 v[72:75],v[172:175],a[120:123],v[72:75]
M16 v[76:79],v[168:171],a[108:111],v[76:79]
DTR v[166:167],v192 offset:25600
M16 v[76:79],v[172:175],a[124:127],v[76:79]
M16 v[80:83],v[176:179],a[96:99],v[80:83]
DTR v[168:169],v193 offset:16384
M16 v[80:83],v[180:183],a[112:115],v[80:83]
BL4 v204,s[12:15],s33 offen lds
M16 v[84:87],v[176:179],a[100:103],v[84:87]
DTR v[170:171],v193 offset:17408
M16 v[84:87],v[180:183],a[116:119],v[84:87]
BL4 v205,s[12:15],s33 offen offset:1024 lds
M16 v[88:91],v[176:179],a[104:107],v[88:91]
DTR v[172:173],v193 offset:24576
M16 v[88:91],v[180:183],a[120:123],v[88:91]
BL4 v206,s[12:15],s33 offen offset:2048 lds
M16 v[92:95],v[176:179],a[108:111],v[92:95]
DTR v[174:175],v193 offset:25600
M16 v[92:95],v[180:183],a[124:127],v[92:95]
M16 v[96:99],v[184:187],a[96:99],v[96:99]
DTR v[176:177],v194 offset:16384
M16 v[96:99],v[188:191],a[112:115],v[96:99]
BL4 v207,s[12:15],s33 offen offset:3072 lds
M16 v[100:103],v[184:187],a[100:103],v[100:103]
DTR v[178:179],v194 offset:17408
s_add_u32 m0, s34, 98304
M16 v[100:103],v[188:191],a[116:119],v[100:103]
BL4 v208,s[8:11],s36 offen lds
M16 v[104:107],v[184:187],a[104:107],v[104:107]
DTR v[180:181],v194 offset:24576
M16 v[104:107],v[188:191],a[120:123],v[104:107]
BL4 v209,s[8:11],s36 offen offset:1024 lds
M16 v[108:111],v[184:187],a[108:111],v[108:111]
DTR v[182:183],v194 offset:25600
M16 v[108:111],v[188:191],a[124:127],v[108:111]
M16 v[112:115],v[144:147],a[96:99],v[112:115]
DTR v[184:185],v195 offset:16384
M16 v[112:115],v[148:151],a[112:115],v[112:115]
BL4 v210,s[8:11],s36 offen offset:2048 lds
M16 v[116:119],v[144:147],a[100:103],v[116:119]
DTR v[186:187],v195 offset:17408
M16 v[116:119],v[148:151],a[116:119],v[116:119]
BL4 v211,s[8:11],s36 offen offset:3072 lds
M16 v[120:123],v[144:147],a[104:107],v[120:123]
DTR v[188:189],v195 offset:24576
s_add_u32 s36, s36, s37
M16 v[120:123],v[148:151],a[120:123],v[120:123]
s_add_u32 m0, s26, 4096
M16 v[124:127],v[144:147],a[108:111],v[124:127]
DTR v[190:191],v195 offset:25600
M16 v[124:127],v[148:151],a[124:127],v[124:127]
s_waitcnt lgkmcnt(15)
M16 v[128:131],v[152:155],a[96:99],v[128:131]
DTR v[144:145],v196 offset:16384
M16 v[128:131],v[156:159],a[112:115],v[128:131]
BL4 v218,s[8:11],s25 offen offset:2048 lds
M16 v[132:135],v[152:155],a[100:103],v[132:135]
DTR v[146:147],v196 offset:17408
M16 v[132:135],v[156:159],a[116:119],v[132:135]
BL4 v219,s[8:11],s25 offen offset:3072 lds
M16 v[136:139],v[152:155],a[104:107],v[136:139]
DTR v[148:149],v196 offset:24576
s_add_u32 s25, s25, 262144
M16 v[136:139],v[156:159],a[120:123],v[136:139]
M16 v[140:143],v[152:155],a[108:111],v[140:143]
DTR v[150:151],v196 offset:25600
M16 v[140:143],v[156:159],a[124:127],v[140:143]
s_waitcnt lgkmcnt(15)
M16 v[16:19],v[160:163],a[128:131],v[16:19]
DTR v[152:153],v197 offset:16384
s_add_u32 m0, s32, 0
M16 v[16:19],v[164:167],a[144:147],v[16:19]
s_mov_b32 s33, 768
M16 v[20:23],v[160:163],a[132:135],v[20:23]
DTR v[154:155],v197 offset:17408
M16 v[20:23],v[164:167],a[148:151],v[20:23]
BL4 v200,s[12:15],s33 offen lds
M16 v[24:27],v[160:163],a[136:139],v[24:27]
DTR v[156:157],v197 offset:24576
M16 v[24:27],v[164:167],a[152:155],v[24:27]
BL4 v201,s[12:15],s33 offen offset:1024 lds
M16 v[28:31],v[160:163],a[140:143],v[28:31]
DTR v[158:159],v197 offset:25600
M16 v[28:31],v[164:167],a[156:159],v[28:31]
s_waitcnt lgkmcnt(15)
M16 v[32:35],v[168:171],a[128:131],v[32:35]
DTR v[160:161],v198 offset:16384
M16 v[32:35],v[172:175],a[144:147],v[32:35]
BL4 v202,s[12:15],s33 offen offset:2048 lds
M16 v[36:39],v[168:171],a[132:135],v[36:39]
DTR v[162:163],v198 offset:17408
M16 v[36:39],v[172:175],a[148:151],v[36:39]
BL4 v203,s[12:15],s33 offen offset:3072 lds
M16 v[40:43],v[168:171],a[136:139],v[40:43]
DTR v[164:165],v198 offset:24576
s_waitcnt vmcnt(14)
M16 v[40:43],v[172:175],a[152:155],v[40:43]
DR a[160:163],v12 offset:4096
M16 v[44:47],v[168:171],a[140:143],v[44:47]
DTR v[166:167],v198 offset:25600
M16 v[44:47],v[172:175],a[156:159],v[44:47]
s_waitcnt lgkmcnt(15)
DR a[176:179],v13 offset:4096
M16 v[48:51],v[176:179],a[128:131],v[48:51]
DTR v[168:169],v199 offset:16384
M16 v[48:51],v[180:183],a[144:147],v[48:51]
DR a[164:167],v12 offset:6144
M16 v[52:55],v[176:179],a[132:135],v[52:55]
DTR v[170:171],v199 offset:17408
M16 v[52:55],v[180:183],a[148:151],v[52:55]
DR a[180:183],v13 offset:6144
s_waitcnt vmcnt(10)
M16 v[56:59],v[176:179],a[136:139],v[56:59]
DTR v[172:173],v199 offset:24576
M16 v[56:59],v[180:183],a[152:155],v[56:59]
s_waitcnt lgkmcnt(15)
DR a[168:171],v12 offset:8192
M16 v[60:63],v[176:179],a[140:143],v[60:63]
DTR v[174:175],v199 offset:25600
s_waitcnt vmcnt(6)
M16 v[60:63],v[180:183],a[156:159],v[60:63]
s_barrier
DR a[184:187],v13 offset:8192
M16 v[64:67],v[184:187],a[128:131],v[64:67]
DTR v[176:177],v192 offset:32768
M16 v[64:67],v[188:191],a[144:147],v[64:67]
DR a[172:175],v12 offset:10240
M16 v[68:71],v[184:187],a[132:135],v[68:71]
DTR v[178:179],v192 offset:33792
M16 v[68:71],v[188:191],a[148:151],v[68:71]
DR a[188:191],v13 offset:10240
s_waitcnt lgkmcnt(8)
M16 v[72:75],v[184:187],a[136:139],v[72:75]
DTR v[180:181],v192 offset:40960
s_add_u32 m0, s32, 4096
M16 v[72:75],v[188:191],a[152:155],v[72:75]
M16 v[76:79],v[184:187],a[140:143],v[76:79]
DTR v[182:183],v192 offset:41984
M16 v[76:79],v[188:191],a[156:159],v[76:79]
M16 v[80:83],v[144:147],a[128:131],v[80:83]
DTR v[184:185],v193 offset:32768
M16 v[80:83],v[148:151],a[144:147],v[80:83]
BL4 v204,s[12:15],s33 offen lds
M16 v[84:87],v[144:147],a[132:135],v[84:87]
DTR v[186:187],v193 offset:33792
M16 v[84:87],v[148:151],a[148:151],v[84:87]
BL4 v205,s[12:15],s33 offen offset:1024 lds
M16 v[88:91],v[144:147],a[136:139],v[88:91]
DTR v[188:189],v193 offset:40960
M16 v[88:91],v[148:151],a[152:155],v[88:91]
BL4 v206,s[12:15],s33 offen offset:2048 lds
M16 v[92:95],v[144:147],a[140:143],v[92:95]
DTR v[190:191],v193 offset:41984
M16 v[92:95],v[148:151],a[156:159],v[92:95]
M16 v[96:99],v[152:155],a[128:131],v[96:99]
DTR v[144:145],v194 offset:32768
M16 v[96:99],v[156:159],a[144:147],v[96:99]
BL4 v207,s[12:15],s33 offen offset:3072 lds
M16 v[100:103],v[152:155],a[132:135],v[100:103]
DTR v[146:147],v194 offset:33792
s_add_u32 m0, s34, 65536
M16 v[100:103],v[156:159],a[148:151],v[100:103]
BL4 v208,s[8:11],s36 offen lds
M16 v[104:107],v[152:155],a[136:139],v[104:107]
DTR v[148:149],v194 offset:40960
M16 v[104:107],v[156:159],a[152:155],v[104:107]
BL4 v209,s[8:11],s36 offen offset:1024 lds
M16 v[108:111],v[152:155],a[140:143],v[108:111]
DTR v[150:151],v194 offset:41984
M16 v[108:111],v[156:159],a[156:159],v[108:111]
M16 v[112:115],v[160:163],a[128:131],v[112:115]
DTR v[152:153],v195 offset:32768
M16 v[112:115],v[164:167],a[144:147],v[112:115]
BL4 v210,s[8:11],s36 offen offset:2048 lds
M16 v[116:119],v[160:163],a[132:135],v[116:119]
DTR v[154:155],v195 offset:33792
M16 v[116:119],v[164:167],a[148:151],v[116:119]
BL4 v211,s[8:11],s36 offen offset:3072 lds
M16 v[120:123],v[160:163],a[136:139],v[120:123]
DTR v[156:157],v195 offset:40960
s_add_u32 s36, s36, s37
M16 v[120:123],v[164:167],a[152:155],v[120:123]
s_add_u32 m0, s26, 8192
M16 v[124:127],v[160:163],a[140:143],v[124:127]
DTR v[158:159],v195 offset:41984
M16 v[124:127],v[164:167],a[156:159],v[124:127]
s_waitcnt lgkmcnt(15)
M16 v[128:131],v[168:171],a[128:131],v[128:131]
DTR v[160:161],v196 offset:32768
M16 v[128:131],v[172:175],a[144:147],v[128:131]
BL4 v216,s[8:11],s25 offen lds
M16 v[132:135],v[168:171],a[132:135],v[132:135]
DTR v[162:163],v196 offset:33792
M16 v[132:135],v[172:175],a[148:151],v[132:135]
BL4 v217,s[8:11],s25 offen offset:1024 lds
M16 v[136:139],v[168:171],a[136:139],v[136:139]
DTR v[164:165],v196 offset:40960
M16 v[136:139],v[172:175],a[152:155],v[136:139]
M16 v[140:143],v[168:171],a[140:143],v[140:143]
DTR v[166:167],v196 offset:41984
M16 v[140:143],v[172:175],a[156:159],v[140:143]
s_waitcnt lgkmcnt(15)
M16 v[16:19],v[176:179],a[160:163],v[16:19]
DTR v[168:169],v197 offset:32768
s_add_u32 m0, s32, 8192
M16 v[16:19],v[180:183],a[176:179],v[16:19]
s_mov_b32 s33, 896
M16 v[20:23],v[176:179],a[164:167],v[20:23]
DTR v[170:171],v197 offset:33792
M16 v[20:23],v[180:183],a[180:183],v[20:23]
BL4 v200,s[12:15],s33 offen lds
M16 v[24:27],v[176:179],a[168:171],v[24:27]
DTR v[172:173],v197 offset:40960
M16 v[24:27],v[180:183],a[184:187],v[24:27]
BL4 v201,s[12:15],s33 offen offset:1024 lds
M16 v[28:31],v[176:179],a[172:175],v[28:31]
DTR v[174:175],v197 offset:41984
M16 v[28:31],v[180:183],a[188:191],v[28:31]
s_waitcnt lgkmcnt(15)
M16 v[32:35],v[184:187],a[160:163],v[32:35]
DTR v[176:177],v198 offset:32768
M16 v[32:35],v[188:191],a[176:179],v[32:35]
BL4 v202,s[12:15],s33 offen offset:2048 lds
M16 v[36:39],v[184:187],a[164:167],v[36:39]
DTR v[178:179],v198 offset:33792
M16 v[36:39],v[188:191],a[180:183],v[36:39]
BL4 v203,s[12:15],s33 offen offset:3072 lds
M16 v[40:43],v[184:187],a[168:171],v[40:43]
DTR v[180:181],v198 offset:40960
s_waitcnt vmcnt(14)
M16 v[40:43],v[188:191],a[184:187],v[40:43]
DR a[192:195],v12 offset:0
M16 v[44:47],v[184:187],a[172:175],v[44:47]
DTR v[182:183],v198 offset:41984
M16 v[44:47],v[188:191],a[188:191],v[44:47]
s_waitcnt lgkmcnt(15)
DR a[208:211],v13 offset:0
M16 v[48:51],v[144:147],a[160:163],v[48:51]
DTR v[184:185],v199 offset:32768
M16 v[48:51],v[148:151],a[176:179],v[48:51]
DR a[196:199],v12 offset:2048
M16 v[52:55],v[144:147],a[164:167],v[52:55]
DTR v[186:187],v199 offset:33792
M16 v[52:55],v[148:151],a[180:183],v[52:55]
DR a[212:215],v13 offset:2048
s_waitcnt vmcnt(10)
M16 v[56:59],v[144:147],a[168:171],v[56:59]
DTR v[188:189],v199 offset:40960
M16 v[56:59],v[148:151],a[184:187],v[56:59]
s_waitcnt lgkmcnt(15)
DR a[200:203],v12 offset:4096
M16 v[60:63],v[144:147],a[172:175],v[60:63]
DTR v[190:191],v199 offset:41984
s_waitcnt vmcnt(6)
M16 v[60:63],v[148:151],a[188:191],v[60:63]
s_barrier
DR a[216:219],v13 offset:4096
M16 v[64:67],v[152:155],a[160:163],v[64:67]
DTR v[144:145],v192 offset:0
M16 v[64:67],v[156:159],a[176:179],v[64:67]
DR a[204:207],v12 offset:6144
M16 v[68:71],v[152:155],a[164:167],v[68:71]
DTR v[146:147],v192 offset:1024
M16 v[68:71],v[156:159],a[180:183],v[68:71]
DR a[220:223],v13 offset:6144
s_waitcnt lgkmcnt(8)
M16 v[72:75],v[152:155],a[168:171],v[72:75]
DTR v[148:149],v192 offset:8192
s_add_u32 m0, s32, 0
M16 v[72:75],v[156:159],a[184:187],v[72:75]
M16 v[76:79],v[152:155],a[172:175],v[76:79]
DTR v[150:151],v192 offset:9216
M16 v[76:79],v[156:159],a[188:191],v[76:79]
M16 v[80:83],v[160:163],a[160:163],v[80:83]
DTR v[152:153],v193 offset:0
M16 v[80:83],v[164:167],a[176:179],v[80:83]
BL4 v204,s[12:15],s33 offen lds
M16 v[84:87],v[160:163],a[164:167],v[84:87]
DTR v[154:155],v193 offset:1024
M16 v[84:87],v[164:167],a[180:183],v[84:87]
BL4 v205,s[12:15],s33 offen offset:1024 lds
M16 v[88:91],v[160:163],a[168:171],v[88:91]
DTR v[156:157],v193 offset:8192
M16 v[88:91],v[164:167],a[184:187],v[88:91]
BL4 v206,s[12:15],s33 offen offset:2048 lds
M16 v[92:95],v[160:163],a[172:175],v[92:95]
DTR v[158:159],v193 offset:9216
M16 v[92:95],v[164:167],a[188:191],v[92:95]
M16 v[96:99],v[168:171],a[160:163],v[96:99]
DTR v[160:161],v194 offset:0
M16 v[96:99],v[172:175],a[176:179],v[96:99]
BL4 v207,s[12:15],s33 offen offset:3072 lds
M16 v[100:103],v[168:171],a[164:167],v[100:103]
DTR v[162:163],v194 offset:1024
s_add_u32 m0, s34, 81920
M16 v[100:103],v[172:175],a[180:183],v[100:103]
BL4 v208,s[8:11],s36 offen lds
M16 v[104:107],v[168:171],a[168:171],v[104:107]
DTR v[164:165],v194 offset:8192
M16 v[104:107],v[172:175],a[184:187],v[104:107]
BL4 v209,s[8:11],s36 offen offset:1024 lds
M16 v[108:111],v[168:171],a[172:175],v[108:111]
DTR v[166:167],v194 offset:9216
M16 v[108:111],v[172:175],a[188:191],v[108:111]
M16 v[112:115],v[176:179],a[160:163],v[112:115]
DTR v[168:169],v195 offset:0
M16 v[112:115],v[180:183],a[176:179],v[112:115]
BL4 v210,s[8:11],s36 offen offset:2048 lds
M16 v[116:119],v[176:179],a[164:167],v[116:119]
DTR v[170:171],v195 offset:1024
M16 v[116:119],v[180:183],a[180:183],v[116:119]
BL4 v211,s[8:11],s36 offen offset:3072 lds
M16 v[120:123],v[176:179],a[168:171],v[120:123]
DTR v[172:173],v195 offset:8192
s_add_u32 s36, s36, s37
M16 v[120:123],v[180:183],a[184:187],v[120:123]
s_add_u32 m0, s26, 8192
M16 v[124:127],v[176:179],a[172:175],v[124:127]
DTR v[174:175],v195 offset:9216
M16 v[124:127],v[180:183],a[188:191],v[124:127]
s_waitcnt lgkmcnt(15)
M16 v[128:131],v[184:187],a[160:163],v[128:131]
DTR v[176:177],v196 offset:0
M16 v[128:131],v[188:191],a[176:179],v[128:131]
BL4 v218,s[8:11],s25 offen offset:2048 lds
M16 v[132:135],v[184:187],a[164:167],v[132:135]
DTR v[178:179],v196 offset:1024
M16 v[132:135],v[188:191],a[180:183],v[132:135]
BL4 v219,s[8:11],s25 offen offset:3072 lds
M16 v[136:139],v[184:187],a[168:171],v[136:139]
DTR v[180:181],v196 offset:8192
s_add_u32 s25, s25, 262144
M16 v[136:139],v[188:191],a[184:187],v[136:139]
M16 v[140:143],v[184:187],a[172:175],v[140:143]
DTR v[182:183],v196 offset:9216
M16 v[140:143],v[188:191],a[188:191],v[140:143]
s_waitcnt lgkmcnt(15)
M16 v[16:19],v[144:147],a[192:195],v[16:19]
DTR v[184:185],v197 offset:0
s_waitcnt vmcnt(10)
M16 v[16:19],v[148:151],a[208:211],v[16:19]
DR a[224:227],v12 offset:8192
M16 v[20:23],v[144:147],a[196:199],v[20:23]
DTR v[186:187],v197 offset:1024
M16 v[20:23],v[148:151],a[212:215],v[20:23]
DR a[240:243],v13 offset:8192
M16 v[24:27],v[144:147],a[200:203],v[24:27]
DTR v[188:189],v197 offset:8192
M16 v[24:27],v[148:151],a[216:219],v[24:27]
DR a[228:231],v12 offset:10240
M16 v[28:31],v[144:147],a[204:207],v[28:31]
DTR v[190:191],v197 offset:9216
M16 v[28:31],v[148:151],a[220:223],v[28:31]
s_waitcnt lgkmcnt(15)
DR a[244:247],v13 offset:10240
M16 v[32:35],v[152:155],a[192:195],v[32:35]
DTR v[144:145],v198 offset:0
M16 v[32:35],v[156:159],a[208:211],v[32:35]
M16 v[36:39],v[152:155],a[196:199],v[36:39]
DTR v[146:147],v198 offset:1024
M16 v[36:39],v[156:159],a[212:215],v[36:39]
M16 v[40:43],v[152:155],a[200:203],v[40:43]
DTR v[148:149],v198 offset:8192
M16 v[40:43],v[156:159],a[216:219],v[40:43]
M16 v[44:47],v[152:155],a[204:207],v[44:47]
DTR v[150:151],v198 offset:9216
M16 v[44:47],v[156:159],a[220:223],v[44:47]
M16 v[48:51],v[160:163],a[192:195],v[48:51]
DTR v[152:153],v199 offset:0
M16 v[48:51],v[164:167],a[208:211],v[48:51]
M16 v[52:55],v[160:163],a[196:199],v[52:55]
DTR v[154:155],v199 offset:1024
s_waitcnt vmcnt(6)
M16 v[52:55],v[164:167],a[212:215],v[52:55]
DR a[232:235],v12 offset:0
M16 v[56:59],v[160:163],a[200:203],v[56:59]
DTR v[156:157],v199 offset:8192
M16 v[56:59],v[164:167],a[216:219],v[56:59]
s_waitcnt lgkmcnt(15)
DR a[248:251],v13 offset:0
M16 v[60:63],v[160:163],a[204:207],v[60:63]
DTR v[158:159],v199 offset:9216
s_waitcnt vmcnt(2)
M16 v[60:63],v[164:167],a[220:223],v[60:63]
s_barrier
DR a[236:239],v12 offset:2048
M16 v[64:67],v[168:171],a[192:195],v[64:67]
DTR v[160:161],v192 offset:16384
M16 v[64:67],v[172:175],a[208:211],v[64:67]
DR a[252:255],v13 offset:2048
s_waitcnt lgkmcnt(13)
M16 v[68:71],v[168:171],a[196:199],v[68:71]
DTR v[162:163],v192 offset:17408
s_add_u32 m0, s26, 12288
M16 v[68:71],v[172:175],a[212:215],v[68:71]
BL4 v216,s[8:11],s25 offen lds
M16 v[72:75],v[168:171],a[200:203],v[72:75]
DTR v[164:165],v192 offset:24576
M16 v[72:75],v[172:175],a[216:219],v[72:75]
BL4 v217,s[8:11],s25 offen offset:1024 lds
M16 v[76:79],v[168:171],a[204:207],v[76:79]
DTR v[166:167],v192 offset:25600
M16 v[76:79],v[172:175],a[220:223],v[76:79]
M16 v[80:83],v[176:179],a[192:195],v[80:83]
DTR v[168:169],v193 offset:16384
M16 v[80:83],v[180:183],a[208:211],v[80:83]
M16 v[84:87],v[176:179],a[196:199],v[84:87]
DTR v[170:171],v193 offset:17408
M16 v[84:87],v[180:183],a[212:215],v[84:87]
M16 v[88:91],v[176:179],a[200:203],v[88:91]
DTR v[172:173],v193 offset:24576
M16 v[88:91],v[180:183],a[216:219],v[88:91]
M16 v[92:95],v[176:179],a[204:207],v[92:95]
DTR v[174:175],v193 offset:25600
M16 v[92:95],v[180:183],a[220:223],v[92:95]
M16 v[96:99],v[184:187],a[192:195],v[96:99]
DTR v[176:177],v194 offset:16384
M16 v[96:99],v[188:191],a[208:211],v[96:99]
M16 v[100:103],v[184:187],a[196:199],v[100:103]
DTR v[178:179],v194 offset:17408
M16 v[100:103],v[188:191],a[212:215],v[100:103]
M16 v[104:107],v[184:187],a[200:203],v[104:107]
DTR v[180:181],v194 offset:24576
M16 v[104:107],v[188:191],a[216:219],v[104:107]
M16 v[108:111],v[184:187],a[204:207],v[108:111]
DTR v[182:183],v194 offset:25600
M16 v[108:111],v[188:191],a[220:223],v[108:111]
s_waitcnt lgkmcnt(15)
M16 v[112:115],v[144:147],a[192:195],v[112:115]
DTR v[184:185],v195 offset:16384
M16 v[112:115],v[148:151],a[208:211],v[112:115]
M16 v[116:119],v[144:147],a[196:199],v[116:119]
DTR v[186:187],v195 offset:17408
M16 v[116:119],v[148:151],a[212:215],v[116:119]
M16 v[120:123],v[144:147],a[200:203],v[120:123]
DTR v[188:189],v195 offset:24576
M16 v[120:123],v[148:151],a[216:219],v[120:123]
M16 v[124:127],v[144:147],a[204:207],v[124:127]
DTR v[190:191],v195 offset:25600
M16 v[124:127],v[148:151],a[220:223],v[124:127]
s_waitcnt lgkmcnt(15)
M16 v[128:131],v[152:155],a[192:195],v[128:131]
DTR v[144:145],v196 offset:16384
M16 v[128:131],v[156:159],a[208:211],v[128:131]
M16 v[132:135],v[152:155],a[196:199],v[132:135]
DTR v[146:147],v196 offset:17408
M16 v[132:135],v[156:159],a[212:215],v[132:135]
M16 v[136:139],v[152:155],a[200:203],v[136:139]
DTR v[148:149],v196 offset:24576
M16 v[136:139],v[156:159],a[216:219],v[136:139]
M16 v[140:143],v[152:155],a[204:207],v[140:143]
DTR v[150:151],v196 offset:25600
M16 v[140:143],v[156:159],a[220:223],v[140:143]
s_waitcnt lgkmcnt(15)
M16 v[16:19],v[160:163],a[224:227],v[16:19]
DTR v[152:153],v197 offset:16384
M16 v[16:19],v[164:167],a[240:243],v[16:19]
M16 v[20:23],v[160:163],a[228:231],v[20:23]
DTR v[154:155],v197 offset:17408
M16 v[20:23],v[164:167],a[244:247],v[20:23]
M16 v[24:27],v[160:163],a[232:235],v[24:27]
DTR v[156:157],v197 offset:24576
M16 v[24:27],v[164:167],a[248:251],v[24:27]
M16 v[28:31],v[160:163],a[236:239],v[28:31]
DTR v[158:159],v197 offset:25600
M16 v[28:31],v[164:167],a[252:255],v[28:31]
s_waitcnt lgkmcnt(15)
M16 v[32:35],v[168:171],a[224:227],v[32:35]
DTR v[160:161],v198 offset:16384
M16 v[32:35],v[172:175],a[240:243],v[32:35]
v_mul_f32 v16, s30, v16
v_mul_f32 v17, s30, v17
M16 v[36:39],v[168:171],a[228:231],v[36:39]
DTR v[162:163],v198 offset:17408
v_mul_f32 v18, s30, v18
M16 v[36:39],v[172:175],a[244:247],v[36:39]
v_mul_f32 v19, s30, v19
CVT v224,v16,v17
M16 v[40:43],v[168:171],a[232:235],v[40:43]
DTR v[164:165],v198 offset:24576
CVT v225,v18,v19
M16 v[40:43],v[172:175],a[248:251],v[40:43]
v_mul_f32 v20, s30, v20
v_mul_f32 v21, s30, v21
M16 v[44:47],v[168:171],a[236:239],v[44:47]
DTR v[166:167],v198 offset:25600
v_mul_f32 v22, s30, v22
M16 v[44:47],v[172:175],a[252:255],v[44:47]
s_waitcnt lgkmcnt(15)
v_mul_f32 v23, s30, v23
CVT v228,v20,v21
M16 v[48:51],v[176:179],a[224:227],v[48:51]
DTR v[168:169],v199 offset:16384
CVT v229,v22,v23
M16 v[48:51],v[180:183],a[240:243],v[48:51]
v_mul_f32 v24, s30, v24
v_mul_f32 v25, s30, v25
M16 v[52:55],v[176:179],a[228:231],v[52:55]
DTR v[170:171],v199 offset:17408
v_mul_f32 v26, s30, v26
M16 v[52:55],v[180:183],a[244:247],v[52:55]
v_mul_f32 v27, s30, v27
CVT v232,v24,v25
M16 v[56:59],v[176:179],a[232:235],v[56:59]
DTR v[172:173],v199 offset:24576
CVT v233,v26,v27
M16 v[56:59],v[180:183],a[248:251],v[56:59]
s_waitcnt lgkmcnt(15)
v_mul_f32 v28, s30, v28
v_mul_f32 v29, s30, v29
M16 v[60:63],v[176:179],a[236:239],v[60:63]
DTR v[174:175],v199 offset:25600
v_mul_f32 v30, s30, v30
M16 v[60:63],v[180:183],a[252:255],v[60:63]
v_mul_f32 v31, s30, v31
CVT v236,v28,v29
M16 v[64:67],v[184:187],a[224:227],v[64:67]
s_add_u32 m0, s26, 12288
CVT v237,v30,v31
v_mul_f32 v32, s30, v32
M16 v[64:67],v[188:191],a[240:243],v[64:67]
BL4 v218,s[8:11],s25 offen offset:2048 lds
M16 v[68:71],v[184:187],a[228:231],v[68:71]
BL4 v219,s[8:11],s25 offen offset:3072 lds
M16 v[68:71],v[188:191],a[244:247],v[68:71]
s_add_u32 s25, s25, 262144
v_mul_f32 v33, s30, v33
v_mul_f32 v34, s30, v34
M16 v[72:75],v[184:187],a[232:235],v[72:75]
v_mul_f32 v35, s30, v35
CVT v226,v32,v33
M16 v[72:75],v[188:191],a[248:251],v[72:75]
CVT v227,v34,v35
v_mul_f32 v36, s30, v36
M16 v[76:79],v[184:187],a[236:239],v[76:79]
BS4 v[224:227],v7,s[16:19],s60 offen sc1
M16 v[76:79],v[188:191],a[252:255],v[76:79]
s_waitcnt lgkmcnt(12)
v_mul_f32 v37, s30, v37
v_mul_f32 v38, s30, v38
M16 v[80:83],v[144:147],a[224:227],v[80:83]
v_mul_f32 v39, s30, v39
CVT v230,v36,v37
M16 v[80:83],v[148:151],a[240:243],v[80:83]
CVT v231,v38,v39
v_mul_f32 v40, s30, v40
M16 v[84:87],v[144:147],a[228:231],v[84:87]
BS4 v[228:231],v8,s[16:19],s60 offen sc1
M16 v[84:87],v[148:151],a[244:247],v[84:87]
v_mul_f32 v41, s30, v41
v_mul_f32 v42, s30, v42
M16 v[88:91],v[144:147],a[232:235],v[88:91]
v_mul_f32 v43, s30, v43
CVT v234,v40,v41
M16 v[88:91],v[148:151],a[248:251],v[88:91]
CVT v235,v42,v43
v_mul_f32 v44, s30, v44
M16 v[92:95],v[144:147],a[236:239],v[92:95]
BS4 v[232:235],v9,s[16:19],s60 offen sc1
M16 v[92:95],v[148:151],a[252:255],v[92:95]
s_waitcnt lgkmcnt(8)
v_mul_f32 v45, s30, v45
v_mul_f32 v46, s30, v46
M16 v[96:99],v[152:155],a[224:227],v[96:99]
v_mul_f32 v47, s30, v47
CVT v238,v44,v45
M16 v[96:99],v[156:159],a[240:243],v[96:99]
CVT v239,v46,v47
v_mul_f32 v48, s30, v48
M16 v[100:103],v[152:155],a[228:231],v[100:103]
BS4 v[236:239],v10,s[16:19],s60 offen sc1
M16 v[100:103],v[156:159],a[244:247],v[100:103]
v_mul_f32 v49, s30, v49
v_mul_f32 v50, s30, v50
M16 v[104:107],v[152:155],a[232:235],v[104:107]
v_mul_f32 v51, s30, v51
CVT v240,v48,v49
M16 v[104:107],v[156:159],a[248:251],v[104:107]
CVT v241,v50,v51
v_mul_f32 v52, s30, v52
M16 v[108:111],v[152:155],a[236:239],v[108:111]
v_mul_f32 v53, s30, v53
v_mul_f32 v54, s30, v54
M16 v[108:111],v[156:159],a[252:255],v[108:111]
s_waitcnt lgkmcnt(4)
v_mul_f32 v55, s30, v55
CVT v244,v52,v53
M16 v[112:115],v[160:163],a[224:227],v[112:115]
CVT v245,v54,v55
v_mul_f32 v56, s30, v56
M16 v[112:115],v[164:167],a[240:243],v[112:115]
v_mul_f32 v57, s30, v57
v_mul_f32 v58, s30, v58
M16 v[116:119],v[160:163],a[228:231],v[116:119]
v_mul_f32 v59, s30, v59
CVT v248,v56,v57
M16 v[116:119],v[164:167],a[244:247],v[116:119]
CVT v249,v58,v59
v_mul_f32 v60, s30, v60
M16 v[120:123],v[160:163],a[232:235],v[120:123]
v_mul_f32 v61, s30, v61
v_mul_f32 v62, s30, v62
M16 v[120:123],v[164:167],a[248:251],v[120:123]
v_mul_f32 v63, s30, v63
CVT v252,v60,v61
M16 v[124:127],v[160:163],a[236:239],v[124:127]
CVT v253,v62,v63
v_mul_f32 v64, s30, v64
M16 v[124:127],v[164:167],a[252:255],v[124:127]
s_waitcnt lgkmcnt(0)
v_mul_f32 v65, s30, v65
v_mul_f32 v66, s30, v66
M16 v[128:131],v[168:171],a[224:227],v[128:131]
v_mul_f32 v67, s30, v67
CVT v242,v64,v65
M16 v[128:131],v[172:175],a[240:243],v[128:131]
CVT v243,v66,v67
v_mul_f32 v68, s30, v68
M16 v[132:135],v[168:171],a[228:231],v[132:135]
v_mul_f32 v69, s30, v69
v_mul_f32 v70, s30, v70
M16 v[132:135],v[172:175],a[244:247],v[132:135]
v_mul_f32 v71, s30, v71
CVT v246,v68,v69
M16 v[136:139],v[168:171],a[232:235],v[136:139]
CVT v247,v70,v71
v_mul_f32 v72, s30, v72
M16 v[136:139],v[172:175],a[248:251],v[136:139]
v_mul_f32 v73, s30, v73
v_mul_f32 v74, s30, v74
M16 v[140:143],v[168:171],a[236:239],v[140:143]
v_mul_f32 v75, s30, v75
CVT v250,v72,v73
M16 v[140:143],v[172:175],a[252:255],v[140:143]
CVT v251,v74,v75
s_nop 7
v_mul_f32 v76, s30, v76
v_mul_f32 v77, s30, v77
v_mul_f32 v78, s30, v78
v_mul_f32 v79, s30, v79
CVT v254,v76,v77
CVT v255,v78,v79
v_mul_f32 v80, s30, v80
v_mul_f32 v81, s30, v81
v_mul_f32 v82, s30, v82
v_mul_f32 v83, s30, v83
CVT v16,v80,v81
CVT v17,v82,v83
v_mul_f32 v84, s30, v84
v_mul_f32 v85, s30, v85
v_mul_f32 v86, s30, v86
v_mul_f32 v87, s30, v87
CVT v20,v84,v85
CVT v21,v86,v87
v_mul_f32 v88, s30, v88
v_mul_f32 v89, s30, v89
v_mul_f32 v90, s30, v90
v_mul_f32 v91, s30, v91
CVT v24,v88,v89
CVT v25,v90,v91
v_mul_f32 v92, s30, v92
v_mul_f32 v93, s30, v93
v_mul_f32 v94, s30, v94
v_mul_f32 v95, s30, v95
CVT v28,v92,v93
CVT v29,v94,v95
v_mul_f32 v96, s30, v96
v_mul_f32 v97, s30, v97
v_mul_f32 v98, s30, v98
v_mul_f32 v99, s30, v99
CVT v18,v96,v97
CVT v19,v98,v99
v_mul_f32 v100, s30, v100
v_mul_f32 v101, s30, v101
v_mul_f32 v102, s30, v102
v_mul_f32 v103, s30, v103
CVT v22,v100,v101
CVT v23,v102,v103
v_mul_f32 v104, s30, v104
v_mul_f32 v105, s30, v105
v_mul_f32 v106, s30, v106
v_mul_f32 v107, s30, v107
CVT v26,v104,v105
CVT v27,v106,v107
v_mul_f32 v108, s30, v108
v_mul_f32 v109, s30, v109
v_mul_f32 v110, s30, v110
v_mul_f32 v111, s30, v111
CVT v30,v108,v109
CVT v31,v110,v111
v_mul_f32 v112, s30, v112
v_mul_f32 v113, s30, v113
v_mul_f32 v114, s30, v114
v_mul_f32 v115, s30, v115
CVT v32,v112,v113
CVT v33,v114,v115
v_mul_f32 v116, s30, v116
v_mul_f32 v117, s30, v117
v_mul_f32 v118, s30, v118
v_mul_f32 v119, s30, v119
CVT v36,v116,v117
CVT v37,v118,v119
v_mul_f32 v120, s30, v120
v_mul_f32 v121, s30, v121
v_mul_f32 v122, s30, v122
v_mul_f32 v123, s30, v123
CVT v40,v120,v121
CVT v41,v122,v123
v_mul_f32 v124, s30, v124
v_mul_f32 v125, s30, v125
v_mul_f32 v126, s30, v126
v_mul_f32 v127, s30, v127
CVT v44,v124,v125
CVT v45,v126,v127
v_mul_f32 v128, s30, v128
v_mul_f32 v129, s30, v129
v_mul_f32 v130, s30, v130
v_mul_f32 v131, s30, v131
CVT v34,v128,v129
CVT v35,v130,v131
v_mul_f32 v132, s30, v132
v_mul_f32 v133, s30, v133
v_mul_f32 v134, s30, v134
v_mul_f32 v135, s30, v135
CVT v38,v132,v133
CVT v39,v134,v135
v_mul_f32 v136, s30, v136
v_mul_f32 v137, s30, v137
v_mul_f32 v138, s30, v138
v_mul_f32 v139, s30, v139
CVT v42,v136,v137
CVT v43,v138,v139
v_mul_f32 v140, s30, v140
v_mul_f32 v141, s30, v141
v_mul_f32 v142, s30, v142
v_mul_f32 v143, s30, v143
CVT v46,v140,v141
CVT v47,v142,v143
v_mov_b32 v48, v240
v_mov_b32 v49, v241
v_mov_b32 v50, v242
v_mov_b32 v51, v243
v_mov_b32 v52, v244
v_mov_b32 v53, v245
v_mov_b32 v54, v246
v_mov_b32 v55, v247
v_mov_b32 v56, v248
v_mov_b32 v57, v249
v_mov_b32 v58, v250
v_mov_b32 v59, v251
v_mov_b32 v60, v252
v_mov_b32 v61, v253
v_mov_b32 v62, v254
v_mov_b32 v63, v255
v_mov_b32 v64, v16
v_mov_b32 v65, v17
v_mov_b32 v66, v18
v_mov_b32 v67, v19
v_mov_b32 v68, v20
v_mov_b32 v69, v21
v_mov_b32 v70, v22
v_mov_b32 v71, v23
v_mov_b32 v72, v24
v_mov_b32 v73, v25
v_mov_b32 v74, v26
v_mov_b32 v75, v27
v_mov_b32 v76, v28
v_mov_b32 v77, v29
v_mov_b32 v78, v30
v_mov_b32 v79, v31
v_mov_b32 v80, v32
v_mov_b32 v81, v33
v_mov_b32 v82, v34
v_mov_b32 v83, v35
v_mov_b32 v84, v36
v_mov_b32 v85, v37
v_mov_b32 v86, v38
v_mov_b32 v87, v39
v_mov_b32 v88, v40
v_mov_b32 v89, v41
v_mov_b32 v90, v42
v_mov_b32 v91, v43
v_mov_b32 v92, v44
v_mov_b32 v93, v45
v_mov_b32 v94, v46
v_mov_b32 v95, v47
s_add_u32 s31, s31, 4
s_waitcnt vmcnt(4)
s_barrier
DTR v[144:145],v3 offset:0
DTR v[146:147],v3 offset:512
DTR v[148:149],v3 offset:4096
DTR v[150:151],v3 offset:4608
DTR v[152:153],v3 offset:8192
DTR v[154:155],v3 offset:8704
DTR v[156:157],v3 offset:12288
DTR v[158:159],v3 offset:12800
DTR v[160:161],v4 offset:0
DTR v[162:163],v4 offset:512
DTR v[164:165],v4 offset:4096
DTR v[166:167],v4 offset:4608
DTR v[168:169],v4 offset:8192
DTR v[170:171],v4 offset:8704
DTR v[172:173],v4 offset:12288
DTR v[174:175],v4 offset:12800
s_waitcnt lgkmcnt(0)
s_lshl_b32 s97, s21, 2
s_mov_b32 s12, s64
s_mov_b32 s13, s65
s_mov_b32 s14, 2621440
s_mov_b32 s15, 0x00020000
s_lshr_b32 s40, s2, 3
s_lshl_b32 s41, s40, 2
s_add_u32 s41, s41, s20
s_mul_i32 s62, s41, 40960
s_and_b32 s42, s2, 7
s_lshl_b32 s42, s42, 10
s_add_u32 s62, s62, s42
s_and_b32 s41, s41, 15
s_lshr_b32 s40, s2, 5
s_sub_u32 s40, 7, s40
s_lshl_b32 s40, s40, 4
s_add_u32 s40, s40, s41
s_mul_i32 s63, s40, 20480
s_add_u32 s6, s63, 10240
v_min_u32 v112, 39, v1
v_lshrrev_b32 v113, 3, v112
v_lshlrev_b32 v113, 13, v113
v_and_b32 v112, 7, v112
v_lshl_add_u32 v112, v112, 7, v113
v_lshrrev_b32 v113, 3, v1
v_mul_u32_u24 v113, 1280, v113
v_and_b32 v114, 7, v1
v_lshl_add_u32 v113, v114, 7, v113
v_and_b32 v115, 31, v1
v_lshrrev_b32 v114, 1, v115
v_mul_u32_u24 v114, 1280, v114
v_and_b32 v115, 1, v115
v_lshl_add_u32 v114, v115, 7, v114
s_and_b32 s39, s23, 1
L_p1_K:
M16 v[16:19],v[144:147],a[0:3],0
DTR v[176:177],v3 offset:16384
v_mul_f32 v36, s30, v36
M16 v[16:19],v[148:151],a[16:19],v[16:19]
DTR v[178:179],v3 offset:16896
v_mul_f32 v37, s30, v37
M16 v[16:19],v[152:155],a[32:35],v[16:19]
v_mul_f32 v38, s30, v38
v_mul_f32 v39, s30, v39
M16 v[16:19],v[156:159],a[48:51],v[16:19]
DTR v[180:181],v3 offset:20480
CVT v102,v36,v37
M16 v[20:23],v[144:147],a[4:7],0
DTR v[182:183],v3 offset:20992
CVT v103,v38,v39
M16 v[20:23],v[148:151],a[20:23],v[20:23]
BS4 v[100:103],v8,s[16:19],s29 offen sc1
M16 v[20:23],v[152:155],a[36:39],v[20:23]
DTR v[184:185],v3 offset:24576
v_mul_f32 v40, s30, v40
M16 v[20:23],v[156:159],a[52:55],v[20:23]
DTR v[186:187],v3 offset:25088
v_mul_f32 v41, s30, v41
M16 v[24:27],v[144:147],a[8:11],0
v_mul_f32 v42, s30, v42
v_mul_f32 v43, s30, v43
M16 v[24:27],v[148:151],a[24:27],v[24:27]
DTR v[188:189],v3 offset:28672
CVT v106,v40,v41
M16 v[24:27],v[152:155],a[40:43],v[24:27]
DTR v[190:191],v3 offset:29184
CVT v107,v42,v43
M16 v[24:27],v[156:159],a[56:59],v[24:27]
BS4 v[104:107],v9,s[16:19],s29 offen sc1
M16 v[28:31],v[144:147],a[12:15],0
DTR v[192:193],v4 offset:16384
v_mul_f32 v44, s30, v44
M16 v[28:31],v[148:151],a[28:31],v[28:31]
DTR v[194:195],v4 offset:16896
v_mul_f32 v45, s30, v45
M16 v[28:31],v[152:155],a[44:47],v[28:31]
v_mul_f32 v46, s30, v46
v_mul_f32 v47, s30, v47
M16 v[28:31],v[156:159],a[60:63],v[28:31]
DTR v[196:197],v4 offset:20480
CVT v110,v44,v45
M16 v[32:35],v[160:163],a[0:3],0
DTR v[198:199],v4 offset:20992
CVT v111,v46,v47
M16 v[32:35],v[164:167],a[16:19],v[32:35]
BS4 v[108:111],v10,s[16:19],s29 offen sc1
M16 v[32:35],v[168:171],a[32:35],v[32:35]
DTR v[200:201],v4 offset:24576
M16 v[32:35],v[172:175],a[48:51],v[32:35]
DTR v[202:203],v4 offset:25088
M16 v[36:39],v[160:163],a[4:7],0
s_cmp_gt_u32 s23, 1
s_cselect_b32 s25, s24, s46
s_add_u32 s24, s24, 128
M16 v[36:39],v[164:167],a[20:23],v[36:39]
DTR v[204:205],v4 offset:28672
s_xor_b32 s26, s26, 65536
M16 v[36:39],v[168:171],a[36:39],v[36:39]
DTR v[206:207],v4 offset:29184
s_mov_b32 m0, s26
M16 v[36:39],v[172:175],a[52:55],v[36:39]
BL4 v216,s[8:11],s25 offen lds
M16 v[40:43],v[160:163],a[8:11],0
M16 v[40:43],v[164:167],a[24:27],v[40:43]
BL4 v217,s[8:11],s25 offen offset:1024 lds
M16 v[40:43],v[168:171],a[40:43],v[40:43]
M16 v[40:43],v[172:175],a[56:59],v[40:43]
BL4 v218,s[8:11],s25 offen offset:2048 lds
M16 v[44:47],v[160:163],a[12:15],0
M16 v[44:47],v[164:167],a[28:31],v[44:47]
BL4 v219,s[8:11],s25 offen offset:3072 lds
M16 v[44:47],v[168:171],a[44:47],v[44:47]
s_add_u32 m0, m0, 4096
s_add_u32 s25, s25, 262144
M16 v[44:47],v[172:175],a[60:63],v[44:47]
s_waitcnt lgkmcnt(0)
M16 v[16:19],v[176:179],a[64:67],v[16:19]
DTR v[144:145],v3 offset:32768
s_lshr_b32 s40, s31, 2
M16 v[16:19],v[180:183],a[80:83],v[16:19]
DTR v[146:147],v3 offset:33280
s_lshl_b32 s40, s40, 20
M16 v[16:19],v[184:187],a[96:99],v[16:19]
s_and_b32 s41, s31, 3
s_lshl_b32 s41, s41, 10
s_add_u32 s40, s40, s41
M16 v[16:19],v[188:191],a[112:115],v[16:19]
DTR v[148:149],v3 offset:36864
s_add_u32 s28, s40, s38
M16 v[20:23],v[176:179],a[68:71],v[20:23]
DTR v[150:151],v3 offset:37376
M16 v[20:23],v[180:183],a[84:87],v[20:23]
BL4 v216,s[8:11],s25 offen lds
M16 v[20:23],v[184:187],a[100:103],v[20:23]
DTR v[152:153],v3 offset:40960
M16 v[20:23],v[188:191],a[116:119],v[20:23]
DTR v[154:155],v3 offset:41472
M16 v[24:27],v[176:179],a[72:75],v[24:27]
BL4 v217,s[8:11],s25 offen offset:1024 lds
M16 v[24:27],v[180:183],a[88:91],v[24:27]
DTR v[156:157],v3 offset:45056
M16 v[24:27],v[184:187],a[104:107],v[24:27]
DTR v[158:159],v3 offset:45568
M16 v[24:27],v[188:191],a[120:123],v[24:27]
BL4 v218,s[8:11],s25 offen offset:2048 lds
M16 v[28:31],v[176:179],a[76:79],v[28:31]
DTR v[160:161],v4 offset:32768
M16 v[28:31],v[180:183],a[92:95],v[28:31]
DTR v[162:163],v4 offset:33280
M16 v[28:31],v[184:187],a[108:111],v[28:31]
BL4 v219,s[8:11],s25 offen offset:3072 lds
M16 v[28:31],v[188:191],a[124:127],v[28:31]
DTR v[164:165],v4 offset:36864
s_add_u32 m0, m0, 4096
M16 v[32:35],v[192:195],a[64:67],v[32:35]
DTR v[166:167],v4 offset:37376
s_add_u32 s25, s25, 262144
M16 v[32:35],v[196:199],a[80:83],v[32:35]
BL4 v216,s[8:11],s25 offen lds
M16 v[32:35],v[200:203],a[96:99],v[32:35]
DTR v[168:169],v4 offset:40960
M16 v[32:35],v[204:207],a[112:115],v[32:35]
DTR v[170:171],v4 offset:41472
M16 v[36:39],v[192:195],a[68:71],v[36:39]
BL4 v217,s[8:11],s25 offen offset:1024 lds
M16 v[36:39],v[196:199],a[84:87],v[36:39]
DTR v[172:173],v4 offset:45056
M16 v[36:39],v[200:203],a[100:103],v[36:39]
DTR v[174:175],v4 offset:45568
M16 v[36:39],v[204:207],a[116:119],v[36:39]
BL4 v218,s[8:11],s25 offen offset:2048 lds
M16 v[40:43],v[192:195],a[72:75],v[40:43]
M16 v[40:43],v[196:199],a[88:91],v[40:43]
BL4 v219,s[8:11],s25 offen offset:3072 lds
M16 v[40:43],v[200:203],a[104:107],v[40:43]
s_add_u32 m0, m0, 4096
s_add_u32 s25, s25, 262144
M16 v[40:43],v[204:207],a[120:123],v[40:43]
BL4 v216,s[8:11],s25 offen lds
M16 v[44:47],v[192:195],a[76:79],v[44:47]
M16 v[44:47],v[196:199],a[92:95],v[44:47]
BL4 v217,s[8:11],s25 offen offset:1024 lds
M16 v[44:47],v[200:203],a[108:111],v[44:47]
M16 v[44:47],v[204:207],a[124:127],v[44:47]
s_waitcnt lgkmcnt(0)
M16 v[16:19],v[144:147],a[128:131],v[16:19]
DTR v[176:177],v3 offset:49152
M16 v[16:19],v[148:151],a[144:147],v[16:19]
DTR v[178:179],v3 offset:49664
M16 v[16:19],v[152:155],a[160:163],v[16:19]
BL4 v218,s[8:11],s25 offen offset:2048 lds
M16 v[16:19],v[156:159],a[176:179],v[16:19]
DTR v[180:181],v3 offset:53248
M16 v[20:23],v[144:147],a[132:135],v[20:23]
DTR v[182:183],v3 offset:53760
M16 v[20:23],v[148:151],a[148:151],v[20:23]
BL4 v219,s[8:11],s25 offen offset:3072 lds
M16 v[20:23],v[152:155],a[164:167],v[20:23]
DTR v[184:185],v3 offset:57344
M16 v[20:23],v[156:159],a[180:183],v[20:23]
DTR v[186:187],v3 offset:57856
M16 v[24:27],v[144:147],a[136:139],v[24:27]
BS4 v[48:51],v7,s[16:19],s48 offen sc1
M16 v[24:27],v[148:151],a[152:155],v[24:27]
DTR v[188:189],v3 offset:61440
M16 v[24:27],v[152:155],a[168:171],v[24:27]
DTR v[190:191],v3 offset:61952
M16 v[24:27],v[156:159],a[184:187],v[24:27]
M16 v[28:31],v[144:147],a[140:143],v[28:31]
DTR v[192:193],v4 offset:49152
M16 v[28:31],v[148:151],a[156:159],v[28:31]
DTR v[194:195],v4 offset:49664
M16 v[28:31],v[152:155],a[172:175],v[28:31]
M16 v[28:31],v[156:159],a[188:191],v[28:31]
DTR v[196:197],v4 offset:53248
M16 v[32:35],v[160:163],a[128:131],v[32:35]
DTR v[198:199],v4 offset:53760
M16 v[32:35],v[164:167],a[144:147],v[32:35]
M16 v[32:35],v[168:171],a[160:163],v[32:35]
DTR v[200:201],v4 offset:57344
M16 v[32:35],v[172:175],a[176:179],v[32:35]
DTR v[202:203],v4 offset:57856
M16 v[36:39],v[160:163],a[132:135],v[36:39]
BS4 v[52:55],v7,s[16:19],s49 offen sc1
M16 v[36:39],v[164:167],a[148:151],v[36:39]
DTR v[204:205],v4 offset:61440
M16 v[36:39],v[168:171],a[164:167],v[36:39]
DTR v[206:207],v4 offset:61952
M16 v[36:39],v[172:175],a[180:183],v[36:39]
M16 v[40:43],v[160:163],a[136:139],v[40:43]
v_xor_b32 v3, 64, v3
v_xor_b32 v4, 64, v4
M16 v[40:43],v[164:167],a[152:155],v[40:43]
M16 v[40:43],v[168:171],a[168:171],v[40:43]
M16 v[40:43],v[172:175],a[184:187],v[40:43]
M16 v[44:47],v[160:163],a[140:143],v[44:47]
M16 v[44:47],v[164:167],a[156:159],v[44:47]
M16 v[44:47],v[168:171],a[172:175],v[44:47]
M16 v[44:47],v[172:175],a[188:191],v[44:47]
s_waitcnt lgkmcnt(0)
M16 v[16:19],v[176:179],a[192:195],v[16:19]
DTR v[144:145],v3 offset:0
M16 v[16:19],v[180:183],a[208:211],v[16:19]
DTR v[146:147],v3 offset:512
M16 v[16:19],v[184:187],a[224:227],v[16:19]
M16 v[16:19],v[188:191],a[240:243],v[16:19]
DTR v[148:149],v3 offset:4096
M16 v[20:23],v[176:179],a[196:199],v[20:23]
DTR v[150:151],v3 offset:4608
M16 v[20:23],v[180:183],a[212:215],v[20:23]
M16 v[20:23],v[184:187],a[228:231],v[20:23]
DTR v[152:153],v3 offset:8192
M16 v[20:23],v[188:191],a[244:247],v[20:23]
DTR v[154:155],v3 offset:8704
M16 v[24:27],v[176:179],a[200:203],v[24:27]
M16 v[24:27],v[180:183],a[216:219],v[24:27]
DTR v[156:157],v3 offset:12288
M16 v[24:27],v[184:187],a[232:235],v[24:27]
DTR v[158:159],v3 offset:12800
M16 v[24:27],v[188:191],a[248:251],v[24:27]
v_mul_f32 v16, s30, v16
v_mul_f32 v17, s30, v17
M16 v[28:31],v[176:179],a[204:207],v[28:31]
DTR v[160:161],v4 offset:0
v_mul_f32 v18, s30, v18
M16 v[28:31],v[180:183],a[220:223],v[28:31]
DTR v[162:163],v4 offset:512
v_mul_f32 v19, s30, v19
M16 v[28:31],v[184:187],a[236:239],v[28:31]
CVT v96,v16,v17
CVT v97,v18,v19
M16 v[28:31],v[188:191],a[252:255],v[28:31]
DTR v[164:165],v4 offset:4096
v_mul_f32 v20, s30, v20
M16 v[32:35],v[192:195],a[192:195],v[32:35]
DTR v[166:167],v4 offset:4608
v_mul_f32 v21, s30, v21
M16 v[32:35],v[196:199],a[208:211],v[32:35]
v_mul_f32 v22, s30, v22
v_mul_f32 v23, s30, v23
M16 v[32:35],v[200:203],a[224:227],v[32:35]
DTR v[168:169],v4 offset:8192
CVT v100,v20,v21
M16 v[32:35],v[204:207],a[240:243],v[32:35]
DTR v[170:171],v4 offset:8704
CVT v101,v22,v23
M16 v[36:39],v[192:195],a[196:199],v[36:39]
v_mul_f32 v24, s30, v24
v_mul_f32 v25, s30, v25
M16 v[36:39],v[196:199],a[212:215],v[36:39]
DTR v[172:173],v4 offset:12288
v_mul_f32 v26, s30, v26
M16 v[36:39],v[200:203],a[228:231],v[36:39]
DTR v[174:175],v4 offset:12800
v_mul_f32 v27, s30, v27
M16 v[36:39],v[204:207],a[244:247],v[36:39]
CVT v104,v24,v25
CVT v105,v26,v27
M16 v[40:43],v[192:195],a[200:203],v[40:43]
v_mul_f32 v28, s30, v28
v_mul_f32 v29, s30, v29
M16 v[40:43],v[196:199],a[216:219],v[40:43]
v_mul_f32 v30, s30, v30
v_mul_f32 v31, s30, v31
M16 v[40:43],v[200:203],a[232:235],v[40:43]
CVT v108,v28,v29
CVT v109,v30,v31
M16 v[40:43],v[204:207],a[248:251],v[40:43]
v_mul_f32 v32, s30, v32
v_mul_f32 v33, s30, v33
M16 v[44:47],v[192:195],a[204:207],v[44:47]
s_mov_b32 s29, s28
v_mul_f32 v34, s30, v34
v_mul_f32 v35, s30, v35
M16 v[44:47],v[196:199],a[220:223],v[44:47]
s_add_u32 s31, s31, 1
CVT v98,v32,v33
CVT v99,v34,v35
M16 v[44:47],v[200:203],a[236:239],v[44:47]
BS4 v[96:99],v7,s[16:19],s28 offen sc1
M16 v[44:47],v[204:207],a[252:255],v[44:47]
s_waitcnt lgkmcnt(0)
M16 v[16:19],v[144:147],a[0:3],0
DTR v[176:177],v3 offset:16384
v_mul_f32 v36, s30, v36
M16 v[16:19],v[148:151],a[16:19],v[16:19]
DTR v[178:179],v3 offset:16896
v_mul_f32 v37, s30, v37
M16 v[16:19],v[152:155],a[32:35],v[16:19]
v_mul_f32 v38, s30, v38
v_mul_f32 v39, s30, v39
M16 v[16:19],v[156:159],a[48:51],v[16:19]
DTR v[180:181],v3 offset:20480
CVT v102,v36,v37
M16 v[20:23],v[144:147],a[4:7],0
DTR v[182:183],v3 offset:20992
CVT v103,v38,v39
M16 v[20:23],v[148:151],a[20:23],v[20:23]
BS4 v[100:103],v8,s[16:19],s29 offen sc1
M16 v[20:23],v[152:155],a[36:39],v[20:23]
DTR v[184:185],v3 offset:24576
v_mul_f32 v40, s30, v40
M16 v[20:23],v[156:159],a[52:55],v[20:23]
DTR v[186:187],v3 offset:25088
v_mul_f32 v41, s30, v41
M16 v[24:27],v[144:147],a[8:11],0
v_mul_f32 v42, s30, v42
v_mul_f32 v43, s30, v43
M16 v[24:27],v[148:151],a[24:27],v[24:27]
DTR v[188:189],v3 offset:28672
CVT v106,v40,v41
M16 v[24:27],v[152:155],a[40:43],v[24:27]
DTR v[190:191],v3 offset:29184
CVT v107,v42,v43
M16 v[24:27],v[156:159],a[56:59],v[24:27]
BS4 v[104:107],v9,s[16:19],s29 offen sc1
M16 v[28:31],v[144:147],a[12:15],0
DTR v[192:193],v4 offset:16384
v_mul_f32 v44, s30, v44
M16 v[28:31],v[148:151],a[28:31],v[28:31]
DTR v[194:195],v4 offset:16896
v_mul_f32 v45, s30, v45
M16 v[28:31],v[152:155],a[44:47],v[28:31]
v_mul_f32 v46, s30, v46
v_mul_f32 v47, s30, v47
M16 v[28:31],v[156:159],a[60:63],v[28:31]
DTR v[196:197],v4 offset:20480
CVT v110,v44,v45
M16 v[32:35],v[160:163],a[0:3],0
DTR v[198:199],v4 offset:20992
CVT v111,v46,v47
M16 v[32:35],v[164:167],a[16:19],v[32:35]
BS4 v[108:111],v10,s[16:19],s29 offen sc1
M16 v[32:35],v[168:171],a[32:35],v[32:35]
DTR v[200:201],v4 offset:24576
M16 v[32:35],v[172:175],a[48:51],v[32:35]
DTR v[202:203],v4 offset:25088
M16 v[36:39],v[160:163],a[4:7],0
M16 v[36:39],v[164:167],a[20:23],v[36:39]
DTR v[204:205],v4 offset:28672
M16 v[36:39],v[168:171],a[36:39],v[36:39]
DTR v[206:207],v4 offset:29184
M16 v[36:39],v[172:175],a[52:55],v[36:39]
M16 v[40:43],v[160:163],a[8:11],0
M16 v[40:43],v[164:167],a[24:27],v[40:43]
M16 v[40:43],v[168:171],a[40:43],v[40:43]
BS4 v[56:59],v7,s[16:19],s50 offen sc1
M16 v[40:43],v[172:175],a[56:59],v[40:43]
M16 v[44:47],v[160:163],a[12:15],0
M16 v[44:47],v[164:167],a[28:31],v[44:47]
M16 v[44:47],v[168:171],a[44:47],v[44:47]
M16 v[44:47],v[172:175],a[60:63],v[44:47]
s_waitcnt lgkmcnt(0)
M16 v[16:19],v[176:179],a[64:67],v[16:19]
DTR v[144:145],v3 offset:32768
s_lshr_b32 s40, s31, 2
M16 v[16:19],v[180:183],a[80:83],v[16:19]
DTR v[146:147],v3 offset:33280
s_lshl_b32 s40, s40, 20
M16 v[16:19],v[184:187],a[96:99],v[16:19]
s_and_b32 s41, s31, 3
s_lshl_b32 s41, s41, 10
s_add_u32 s40, s40, s41
M16 v[16:19],v[188:191],a[112:115],v[16:19]
DTR v[148:149],v3 offset:36864
s_add_u32 s28, s40, s38
M16 v[20:23],v[176:179],a[68:71],v[20:23]
DTR v[150:151],v3 offset:37376
M16 v[20:23],v[180:183],a[84:87],v[20:23]
BS4 v[60:63],v7,s[16:19],s51 offen sc1
M16 v[20:23],v[184:187],a[100:103],v[20:23]
DTR v[152:153],v3 offset:40960
M16 v[20:23],v[188:191],a[116:119],v[20:23]
DTR v[154:155],v3 offset:41472
M16 v[24:27],v[176:179],a[72:75],v[24:27]
M16 v[24:27],v[180:183],a[88:91],v[24:27]
DTR v[156:157],v3 offset:45056
M16 v[24:27],v[184:187],a[104:107],v[24:27]
DTR v[158:159],v3 offset:45568
M16 v[24:27],v[188:191],a[120:123],v[24:27]
M16 v[28:31],v[176:179],a[76:79],v[28:31]
DTR v[160:161],v4 offset:32768
M16 v[28:31],v[180:183],a[92:95],v[28:31]
DTR v[162:163],v4 offset:33280
M16 v[28:31],v[184:187],a[108:111],v[28:31]
M16 v[28:31],v[188:191],a[124:127],v[28:31]
DTR v[164:165],v4 offset:36864
M16 v[32:35],v[192:195],a[64:67],v[32:35]
DTR v[166:167],v4 offset:37376
M16 v[32:35],v[196:199],a[80:83],v[32:35]
BS4 v[64:67],v7,s[16:19],s52 offen sc1
M16 v[32:35],v[200:203],a[96:99],v[32:35]
DTR v[168:169],v4 offset:40960
M16 v[32:35],v[204:207],a[112:115],v[32:35]
DTR v[170:171],v4 offset:41472
M16 v[36:39],v[192:195],a[68:71],v[36:39]
M16 v[36:39],v[196:199],a[84:87],v[36:39]
DTR v[172:173],v4 offset:45056
M16 v[36:39],v[200:203],a[100:103],v[36:39]
DTR v[174:175],v4 offset:45568
M16 v[36:39],v[204:207],a[116:119],v[36:39]
M16 v[40:43],v[192:195],a[72:75],v[40:43]
M16 v[40:43],v[196:199],a[88:91],v[40:43]
M16 v[40:43],v[200:203],a[104:107],v[40:43]
M16 v[40:43],v[204:207],a[120:123],v[40:43]
BS4 v[68:71],v7,s[16:19],s53 offen sc1
M16 v[44:47],v[192:195],a[76:79],v[44:47]
M16 v[44:47],v[196:199],a[92:95],v[44:47]
M16 v[44:47],v[200:203],a[108:111],v[44:47]
v_mov_b32 v48, v72
v_mov_b32 v49, v73
M16 v[44:47],v[204:207],a[124:127],v[44:47]
s_waitcnt lgkmcnt(0)
v_mov_b32 v50, v74
v_mov_b32 v51, v75
M16 v[16:19],v[144:147],a[128:131],v[16:19]
DTR v[176:177],v3 offset:49152
v_mov_b32 v52, v76
M16 v[16:19],v[148:151],a[144:147],v[16:19]
DTR v[178:179],v3 offset:49664
v_mov_b32 v53, v77
M16 v[16:19],v[152:155],a[160:163],v[16:19]
s_cmp_eq_u32 s23, 2
s_cselect_b32 s43, s61, s46
v_mov_b32 v54, v78
M16 v[16:19],v[156:159],a[176:179],v[16:19]
DTR v[180:181],v3 offset:53248
v_mov_b32 v55, v79
M16 v[20:23],v[144:147],a[132:135],v[20:23]
DTR v[182:183],v3 offset:53760
v_mov_b32 v56, v80
M16 v[20:23],v[148:151],a[148:151],v[20:23]
v_mov_b32 v57, v81
v_mov_b32 v58, v82
M16 v[20:23],v[152:155],a[164:167],v[20:23]
DTR v[184:185],v3 offset:57344
v_mov_b32 v59, v83
M16 v[20:23],v[156:159],a[180:183],v[20:23]
DTR v[186:187],v3 offset:57856
v_mov_b32 v60, v84
M16 v[24:27],v[144:147],a[136:139],v[24:27]
v_mov_b32 v61, v85
v_mov_b32 v62, v86
M16 v[24:27],v[148:151],a[152:155],v[24:27]
DTR v[188:189],v3 offset:61440
v_mov_b32 v63, v87
M16 v[24:27],v[152:155],a[168:171],v[24:27]
DTR v[190:191],v3 offset:61952
v_mov_b32 v64, v88
M16 v[24:27],v[156:159],a[184:187],v[24:27]
v_mov_b32 v65, v89
v_mov_b32 v66, v90
M16 v[28:31],v[144:147],a[140:143],v[28:31]
DTR v[192:193],v4 offset:49152
v_mov_b32 v67, v91
M16 v[28:31],v[148:151],a[156:159],v[28:31]
DTR v[194:195],v4 offset:49664
v_mov_b32 v68, v92
M16 v[28:31],v[152:155],a[172:175],v[28:31]
v_mov_b32 v69, v93
v_mov_b32 v70, v94
M16 v[28:31],v[156:159],a[188:191],v[28:31]
DTR v[196:197],v4 offset:53248
v_mov_b32 v71, v95
M16 v[32:35],v[160:163],a[128:131],v[32:35]
DTR v[198:199],v4 offset:53760
s_mov_b32 s48, s54
M16 v[32:35],v[164:167],a[144:147],v[32:35]
s_mov_b32 s49, s55
s_mov_b32 s50, s56
s_mov_b32 s51, s57
M16 v[32:35],v[168:171],a[160:163],v[32:35]
DTR v[200:201],v4 offset:57344
s_mov_b32 s52, s58
M16 v[32:35],v[172:175],a[176:179],v[32:35]
DTR v[202:203],v4 offset:57856
s_mov_b32 s53, s59
M16 v[36:39],v[160:163],a[132:135],v[36:39]
s_mov_b32 s54, s46
s_mov_b32 s55, s46
s_mov_b32 s56, s46
M16 v[36:39],v[164:167],a[148:151],v[36:39]
DTR v[204:205],v4 offset:61440
s_mov_b32 s57, s46
M16 v[36:39],v[168:171],a[164:167],v[36:39]
DTR v[206:207],v4 offset:61952
s_mov_b32 s58, s46
M16 v[36:39],v[172:175],a[180:183],v[36:39]
s_mov_b32 s59, s46
M16 v[40:43],v[160:163],a[136:139],v[40:43]
s_xor_b32 s27, s27, 65536
M16 v[40:43],v[164:167],a[152:155],v[40:43]
v_add_u32 v3, s27, v5
M16 v[40:43],v[168:171],a[168:171],v[40:43]
v_xor_b32 v4, 32, v3
M16 v[40:43],v[172:175],a[184:187],v[40:43]
M16 v[44:47],v[160:163],a[140:143],v[44:47]
M16 v[44:47],v[164:167],a[156:159],v[44:47]
s_waitcnt lgkmcnt(0)
M16 v[44:47],v[168:171],a[172:175],v[44:47]
s_waitcnt vmcnt(10)
M16 v[44:47],v[172:175],a[188:191],v[44:47]
s_barrier
M16 v[16:19],v[176:179],a[192:195],v[16:19]
DTR v[144:145],v3 offset:0
M16 v[16:19],v[180:183],a[208:211],v[16:19]
DTR v[146:147],v3 offset:512
M16 v[16:19],v[184:187],a[224:227],v[16:19]
buffer_load_dword v116, v11, s[92:95], s43 offen
M16 v[16:19],v[188:191],a[240:243],v[16:19]
DTR v[148:149],v3 offset:4096
M16 v[20:23],v[176:179],a[196:199],v[20:23]
DTR v[150:151],v3 offset:4608
M16 v[20:23],v[180:183],a[212:215],v[20:23]
M16 v[20:23],v[184:187],a[228:231],v[20:23]
DTR v[152:153],v3 offset:8192
M16 v[20:23],v[188:191],a[244:247],v[20:23]
DTR v[154:155],v3 offset:8704
M16 v[24:27],v[176:179],a[200:203],v[24:27]
M16 v[24:27],v[180:183],a[216:219],v[24:27]
DTR v[156:157],v3 offset:12288
M16 v[24:27],v[184:187],a[232:235],v[24:27]
DTR v[158:159],v3 offset:12800
M16 v[24:27],v[188:191],a[248:251],v[24:27]
v_mul_f32 v16, s30, v16
v_mul_f32 v17, s30, v17
M16 v[28:31],v[176:179],a[204:207],v[28:31]
DTR v[160:161],v4 offset:0
v_mul_f32 v18, s30, v18
M16 v[28:31],v[180:183],a[220:223],v[28:31]
DTR v[162:163],v4 offset:512
v_mul_f32 v19, s30, v19
M16 v[28:31],v[184:187],a[236:239],v[28:31]
CVT v96,v16,v17
CVT v97,v18,v19
M16 v[28:31],v[188:191],a[252:255],v[28:31]
DTR v[164:165],v4 offset:4096
v_mul_f32 v20, s30, v20
M16 v[32:35],v[192:195],a[192:195],v[32:35]
DTR v[166:167],v4 offset:4608
v_mul_f32 v21, s30, v21
M16 v[32:35],v[196:199],a[208:211],v[32:35]
v_mul_f32 v22, s30, v22
v_mul_f32 v23, s30, v23
M16 v[32:35],v[200:203],a[224:227],v[32:35]
DTR v[168:169],v4 offset:8192
CVT v100,v20,v21
M16 v[32:35],v[204:207],a[240:243],v[32:35]
DTR v[170:171],v4 offset:8704
CVT v101,v22,v23
M16 v[36:39],v[192:195],a[196:199],v[36:39]
v_mul_f32 v24, s30, v24
v_mul_f32 v25, s30, v25
M16 v[36:39],v[196:199],a[212:215],v[36:39]
DTR v[172:173],v4 offset:12288
v_mul_f32 v26, s30, v26
M16 v[36:39],v[200:203],a[228:231],v[36:39]
DTR v[174:175],v4 offset:12800
v_mul_f32 v27, s30, v27
M16 v[36:39],v[204:207],a[244:247],v[36:39]
CVT v104,v24,v25
CVT v105,v26,v27
M16 v[40:43],v[192:195],a[200:203],v[40:43]
v_mul_f32 v28, s30, v28
v_mul_f32 v29, s30, v29
M16 v[40:43],v[196:199],a[216:219],v[40:43]
v_mul_f32 v30, s30, v30
v_mul_f32 v31, s30, v31
M16 v[40:43],v[200:203],a[232:235],v[40:43]
CVT v108,v28,v29
CVT v109,v30,v31
M16 v[40:43],v[204:207],a[248:251],v[40:43]
v_mul_f32 v32, s30, v32
v_mul_f32 v33, s30, v33
M16 v[44:47],v[192:195],a[204:207],v[44:47]
s_mov_b32 s29, s28
v_mul_f32 v34, s30, v34
v_mul_f32 v35, s30, v35
M16 v[44:47],v[196:199],a[220:223],v[44:47]
s_add_u32 s31, s31, 1
CVT v98,v32,v33
CVT v99,v34,v35
M16 v[44:47],v[200:203],a[236:239],v[44:47]
s_sub_u32 s23, s23, 1
M16 v[44:47],v[204:207],a[252:255],v[44:47]
s_waitcnt lgkmcnt(0)
BS4 v[96:99],v7,s[16:19],s28 offen sc1
s_cmp_lg_u32 s23, s39
s_cbranch_scc1 L_p1_K
s_cmp_lg_u32 s23, 0
s_cbranch_scc1 L_p1_K_last
s_nop 7
v_mul_f32 v36, s30, v36
v_mul_f32 v37, s30, v37
v_mul_f32 v38, s30, v38
v_mul_f32 v39, s30, v39
CVT v102,v36,v37
CVT v103,v38,v39
BS4 v[100:103],v8,s[16:19],s29 offen sc1
v_mul_f32 v40, s30, v40
v_mul_f32 v41, s30, v41
v_mul_f32 v42, s30, v42
v_mul_f32 v43, s30, v43
CVT v106,v40,v41
CVT v107,v42,v43
BS4 v[104:107],v9,s[16:19],s29 offen sc1
v_mul_f32 v44, s30, v44
v_mul_f32 v45, s30, v45
v_mul_f32 v46, s30, v46
v_mul_f32 v47, s30, v47
CVT v110,v44,v45
CVT v111,v46,v47
BS4 v[108:111],v10,s[16:19],s29 offen sc1
s_branch L_p2_entry
L_p1_K_last:
M16 v[16:19],v[144:147],a[0:3],0
DTR v[176:177],v3 offset:16384
v_mul_f32 v36, s30, v36
M16 v[16:19],v[148:151],a[16:19],v[16:19]
DTR v[178:179],v3 offset:16896
v_mul_f32 v37, s30, v37
M16 v[16:19],v[152:155],a[32:35],v[16:19]
v_mul_f32 v38, s30, v38
v_mul_f32 v39, s30, v39
M16 v[16:19],v[156:159],a[48:51],v[16:19]
DTR v[180:181],v3 offset:20480
CVT v102,v36,v37
M16 v[20:23],v[144:147],a[4:7],0
DTR v[182:183],v3 offset:20992
CVT v103,v38,v39
M16 v[20:23],v[148:151],a[20:23],v[20:23]
BS4 v[100:103],v8,s[16:19],s29 offen sc1
M16 v[20:23],v[152:155],a[36:39],v[20:23]
DTR v[184:185],v3 offset:24576
v_mul_f32 v40, s30, v40
M16 v[20:23],v[156:159],a[52:55],v[20:23]
DTR v[186:187],v3 offset:25088
v_mul_f32 v41, s30, v41
M16 v[24:27],v[144:147],a[8:11],0
v_mul_f32 v42, s30, v42
v_mul_f32 v43, s30, v43
M16 v[24:27],v[148:151],a[24:27],v[24:27]
DTR v[188:189],v3 offset:28672
CVT v106,v40,v41
M16 v[24:27],v[152:155],a[40:43],v[24:27]
DTR v[190:191],v3 offset:29184
CVT v107,v42,v43
M16 v[24:27],v[156:159],a[56:59],v[24:27]
BS4 v[104:107],v9,s[16:19],s29 offen sc1
M16 v[28:31],v[144:147],a[12:15],0
DTR v[192:193],v4 offset:16384
v_mul_f32 v44, s30, v44
M16 v[28:31],v[148:151],a[28:31],v[28:31]
DTR v[194:195],v4 offset:16896
v_mul_f32 v45, s30, v45
M16 v[28:31],v[152:155],a[44:47],v[28:31]
v_mul_f32 v46, s30, v46
v_mul_f32 v47, s30, v47
M16 v[28:31],v[156:159],a[60:63],v[28:31]
DTR v[196:197],v4 offset:20480
CVT v110,v44,v45
M16 v[32:35],v[160:163],a[0:3],0
DTR v[198:199],v4 offset:20992
CVT v111,v46,v47
M16 v[32:35],v[164:167],a[16:19],v[32:35]
BS4 v[108:111],v10,s[16:19],s29 offen sc1
M16 v[32:35],v[168:171],a[32:35],v[32:35]
DTR v[200:201],v4 offset:24576
s_and_b32 s43, s2, 7
M16 v[32:35],v[172:175],a[48:51],v[32:35]
DTR v[202:203],v4 offset:25088
s_lshl_b32 s43, s43, 2
M16 v[36:39],v[160:163],a[4:7],0
s_bfe_u32 s44, s2, 0x20003
s_add_u32 s21, s43, s44
s_lshr_b32 s22, s2, 5
M16 v[36:39],v[164:167],a[20:23],v[36:39]
DTR v[204:205],v4 offset:28672
s_mov_b32 s4, s68
M16 v[36:39],v[168:171],a[36:39],v[36:39]
DTR v[206:207],v4 offset:29184
s_mov_b32 s5, s69
M16 v[36:39],v[172:175],a[52:55],v[36:39]
s_mov_b32 s6, 5242880
s_mov_b32 s7, 0x00020000
s_mov_b32 s92, s64
M16 v[40:43],v[160:163],a[8:11],0
s_mov_b32 s93, s65
s_mov_b32 s94, 2621440
s_mov_b32 s95, 0x00020000
M16 v[40:43],v[164:167],a[24:27],v[40:43]
s_lshl_b32 s70, s21, 8
s_mov_b32 s71, 524288
s_lshl_b32 s73, s20, 12
M16 v[40:43],v[168:171],a[40:43],v[40:43]
s_lshl_b32 s66, s20, 13
s_add_u32 s66, s66, 131072
s_add_u32 s72, s73, 49152
M16 v[40:43],v[172:175],a[56:59],v[40:43]
s_lshr_b32 s43, s71, 6
v_lshrrev_b32 v120, 4, v1
s_lshl_b32 s44, s20, 4
M16 v[44:47],v[160:163],a[12:15],0
v_add_u32 v121, s44, v120
v_mul_lo_u32 v121, v121, s43
M16 v[44:47],v[164:167],a[28:31],v[44:47]
v_lshlrev_b32 v120, 1, v120
v_and_b32 v122, 15, v1
M16 v[44:47],v[168:171],a[44:47],v[44:47]
v_xor_b32 v120, v120, v122
s_lshl_b32 s43, s43, 2
M16 v[44:47],v[172:175],a[60:63],v[44:47]
s_waitcnt lgkmcnt(0)
s_sub_u32 s43, s43, 1024
v_lshl_add_u32 v208, v120, 4, v121
M16 v[16:19],v[176:179],a[64:67],v[16:19]
DTR v[144:145],v3 offset:32768
s_lshr_b32 s40, s31, 2
M16 v[16:19],v[180:183],a[80:83],v[16:19]
DTR v[146:147],v3 offset:33280
s_lshl_b32 s40, s40, 20
M16 v[16:19],v[184:187],a[96:99],v[16:19]
s_and_b32 s41, s31, 3
s_lshl_b32 s41, s41, 10
s_add_u32 s40, s40, s41
M16 v[16:19],v[188:191],a[112:115],v[16:19]
DTR v[148:149],v3 offset:36864
s_add_u32 s28, s40, s38
M16 v[20:23],v[176:179],a[68:71],v[20:23]
DTR v[150:151],v3 offset:37376
v_add_u32 v209, s43, v208
M16 v[20:23],v[180:183],a[84:87],v[20:23]
v_xor_b32 v120, 8, v120
v_lshl_add_u32 v210, v120, 4, v121
M16 v[20:23],v[184:187],a[100:103],v[20:23]
DTR v[152:153],v3 offset:40960
s_lshl_b32 s44, s43, 1
M16 v[20:23],v[188:191],a[116:119],v[20:23]
DTR v[154:155],v3 offset:41472
v_add_u32 v210, s44, v210
M16 v[24:27],v[176:179],a[72:75],v[24:27]
v_add_u32 v211, s43, v210
s_lshl_b32 s43, s22, 3
M16 v[24:27],v[180:183],a[88:91],v[24:27]
DTR v[156:157],v3 offset:45056
s_add_u32 s43, s43, s20
M16 v[24:27],v[184:187],a[104:107],v[24:27]
DTR v[158:159],v3 offset:45568
s_mul_i32 s43, s43, 20480
M16 v[24:27],v[188:191],a[120:123],v[24:27]
s_lshl_b32 s44, s22, 2
s_sub_u32 s44, 30, s44
s_mul_i32 s44, s44, 81920
M16 v[28:31],v[176:179],a[76:79],v[28:31]
DTR v[160:161],v4 offset:32768
v_lshrrev_b32 v120, 3, v1
M16 v[28:31],v[180:183],a[92:95],v[28:31]
DTR v[162:163],v4 offset:33280
v_mul_u32_u24 v120, 1280, v120
M16 v[28:31],v[184:187],a[108:111],v[28:31]
v_add_u32 v120, s43, v120
v_and_b32 v121, 7, v1
M16 v[28:31],v[188:191],a[124:127],v[28:31]
DTR v[164:165],v4 offset:36864
v_lshrrev_b32 v122, 4, v1
M16 v[32:35],v[192:195],a[64:67],v[32:35]
DTR v[166:167],v4 offset:37376
v_xor_b32 v121, v121, v122
M16 v[32:35],v[196:199],a[80:83],v[32:35]
v_xor_b32 v122, 4, v121
v_lshl_add_u32 v121, v121, 4, v120
M16 v[32:35],v[200:203],a[96:99],v[32:35]
DTR v[168:169],v4 offset:40960
v_lshl_add_u32 v122, v122, 4, v120
M16 v[32:35],v[204:207],a[112:115],v[32:35]
DTR v[170:171],v4 offset:41472
v_add_u32 v220, 0, v121
M16 v[36:39],v[192:195],a[68:71],v[36:39]
v_add_u32 v221, 9216, v122
v_add_u32 v222, 79872, v121
M16 v[36:39],v[196:199],a[84:87],v[36:39]
DTR v[172:173],v4 offset:45056
v_add_u32 v223, 89088, v122
M16 v[36:39],v[200:203],a[100:103],v[36:39]
DTR v[174:175],v4 offset:45568
v_add_u32 v121, s44, v121
M16 v[36:39],v[204:207],a[116:119],v[36:39]
v_add_u32 v122, s44, v122
v_add_u32 v224, 0, v121
M16 v[40:43],v[192:195],a[72:75],v[40:43]
v_add_u32 v225, 9216, v122
v_add_u32 v226, 79872, v121
M16 v[40:43],v[196:199],a[88:91],v[40:43]
v_add_u32 v227, 89088, v122
v_and_b32 v120, 15, v1
M16 v[40:43],v[200:203],a[104:107],v[40:43]
v_lshrrev_b32 v121, 1, v120
v_lshrrev_b32 v122, 4, v1
M16 v[40:43],v[204:207],a[120:123],v[40:43]
v_xor_b32 v121, v121, v122
v_lshlrev_b32 v121, 4, v121
M16 v[44:47],v[192:195],a[76:79],v[44:47]
v_lshl_add_u32 v212, v120, 7, v121
v_add_u32 v212, s66, v212
M16 v[44:47],v[196:199],a[92:95],v[44:47]
v_xor_b32 v213, 64, v212
v_lshrrev_b32 v120, 4, v1
M16 v[44:47],v[200:203],a[108:111],v[44:47]
v_bfe_u32 v121, v1, 2, 2
v_lshl_add_u32 v122, v120, 3, v121
M16 v[44:47],v[204:207],a[124:127],v[44:47]
s_waitcnt lgkmcnt(0)
v_lshlrev_b32 v122, 8, v122
v_and_b32 v120, 1, v120
M16 v[16:19],v[144:147],a[128:131],v[16:19]
DTR v[176:177],v3 offset:49152
v_lshl_add_u32 v121, v120, 2, v121
M16 v[16:19],v[148:151],a[144:147],v[16:19]
DTR v[178:179],v3 offset:49664
v_lshl_add_u32 v122, v121, 5, v122
M16 v[16:19],v[152:155],a[160:163],v[16:19]
v_and_b32 v120, 3, v1
v_lshl_add_u32 v122, v120, 3, v122
M16 v[16:19],v[156:159],a[176:179],v[16:19]
DTR v[180:181],v3 offset:53248
v_add_u32 v228, 81920, v122
M16 v[20:23],v[144:147],a[132:135],v[20:23]
DTR v[182:183],v3 offset:53760
v_xor_b32 v229, 32, v228
M16 v[20:23],v[148:151],a[148:151],v[20:23]
v_xor_b32 v230, 64, v228
v_xor_b32 v231, 96, v228
M16 v[20:23],v[152:155],a[164:167],v[20:23]
DTR v[184:185],v3 offset:57344
v_xor_b32 v232, 128, v228
M16 v[20:23],v[156:159],a[180:183],v[20:23]
DTR v[186:187],v3 offset:57856
v_xor_b32 v233, 160, v228
M16 v[24:27],v[144:147],a[136:139],v[24:27]
v_xor_b32 v234, 192, v228
v_xor_b32 v235, 224, v228
M16 v[24:27],v[148:151],a[152:155],v[24:27]
DTR v[188:189],v3 offset:61440
s_sub_u32 s43, s72, s66
M16 v[24:27],v[152:155],a[168:171],v[24:27]
DTR v[190:191],v3 offset:61952
v_add_u32 v214, s43, v212
M16 v[24:27],v[156:159],a[184:187],v[24:27]
v_add_u32 v215, s43, v213
M16 v[28:31],v[144:147],a[140:143],v[28:31]
DTR v[192:193],v4 offset:49152
M16 v[28:31],v[148:151],a[156:159],v[28:31]
DTR v[194:195],v4 offset:49664
M16 v[28:31],v[152:155],a[172:175],v[28:31]
M16 v[28:31],v[156:159],a[188:191],v[28:31]
DTR v[196:197],v4 offset:53248
M16 v[32:35],v[160:163],a[128:131],v[32:35]
DTR v[198:199],v4 offset:53760
M16 v[32:35],v[164:167],a[144:147],v[32:35]
M16 v[32:35],v[168:171],a[160:163],v[32:35]
DTR v[200:201],v4 offset:57344
M16 v[32:35],v[172:175],a[176:179],v[32:35]
DTR v[202:203],v4 offset:57856
M16 v[36:39],v[160:163],a[132:135],v[36:39]
M16 v[36:39],v[164:167],a[148:151],v[36:39]
DTR v[204:205],v4 offset:61440
M16 v[36:39],v[168:171],a[164:167],v[36:39]
DTR v[206:207],v4 offset:61952
M16 v[36:39],v[172:175],a[180:183],v[36:39]
M16 v[40:43],v[160:163],a[136:139],v[40:43]
v_xor_b32 v3, 64, v3
v_xor_b32 v4, 64, v4
M16 v[40:43],v[164:167],a[152:155],v[40:43]
M16 v[40:43],v[168:171],a[168:171],v[40:43]
M16 v[40:43],v[172:175],a[184:187],v[40:43]
M16 v[44:47],v[160:163],a[140:143],v[44:47]
M16 v[44:47],v[164:167],a[156:159],v[44:47]
M16 v[44:47],v[168:171],a[172:175],v[44:47]
M16 v[44:47],v[172:175],a[188:191],v[44:47]
s_waitcnt lgkmcnt(0)
M16 v[16:19],v[176:179],a[192:195],v[16:19]
DTR v[144:145],v3 offset:0
M16 v[16:19],v[180:183],a[208:211],v[16:19]
DTR v[146:147],v3 offset:512
M16 v[16:19],v[184:187],a[224:227],v[16:19]
M16 v[16:19],v[188:191],a[240:243],v[16:19]
DTR v[148:149],v3 offset:4096
M16 v[20:23],v[176:179],a[196:199],v[20:23]
DTR v[150:151],v3 offset:4608
M16 v[20:23],v[180:183],a[212:215],v[20:23]
M16 v[20:23],v[184:187],a[228:231],v[20:23]
DTR v[152:153],v3 offset:8192
M16 v[20:23],v[188:191],a[244:247],v[20:23]
DTR v[154:155],v3 offset:8704
M16 v[24:27],v[176:179],a[200:203],v[24:27]
M16 v[24:27],v[180:183],a[216:219],v[24:27]
DTR v[156:157],v3 offset:12288
M16 v[24:27],v[184:187],a[232:235],v[24:27]
DTR v[158:159],v3 offset:12800
M16 v[24:27],v[188:191],a[248:251],v[24:27]
v_mul_f32 v16, s30, v16
v_mul_f32 v17, s30, v17
M16 v[28:31],v[176:179],a[204:207],v[28:31]
DTR v[160:161],v4 offset:0
v_mul_f32 v18, s30, v18
M16 v[28:31],v[180:183],a[220:223],v[28:31]
DTR v[162:163],v4 offset:512
v_mul_f32 v19, s30, v19
M16 v[28:31],v[184:187],a[236:239],v[28:31]
CVT v96,v16,v17
CVT v97,v18,v19
M16 v[28:31],v[188:191],a[252:255],v[28:31]
DTR v[164:165],v4 offset:4096
v_mul_f32 v20, s30, v20
M16 v[32:35],v[192:195],a[192:195],v[32:35]
DTR v[166:167],v4 offset:4608
v_mul_f32 v21, s30, v21
M16 v[32:35],v[196:199],a[208:211],v[32:35]
v_mul_f32 v22, s30, v22
v_mul_f32 v23, s30, v23
M16 v[32:35],v[200:203],a[224:227],v[32:35]
DTR v[168:169],v4 offset:8192
CVT v100,v20,v21
M16 v[32:35],v[204:207],a[240:243],v[32:35]
DTR v[170:171],v4 offset:8704
CVT v101,v22,v23
M16 v[36:39],v[192:195],a[196:199],v[36:39]
v_mul_f32 v24, s30, v24
v_mul_f32 v25, s30, v25
M16 v[36:39],v[196:199],a[212:215],v[36:39]
DTR v[172:173],v4 offset:12288
v_mul_f32 v26, s30, v26
M16 v[36:39],v[200:203],a[228:231],v[36:39]
DTR v[174:175],v4 offset:12800
v_mul_f32 v27, s30, v27
M16 v[36:39],v[204:207],a[244:247],v[36:39]
CVT v104,v24,v25
CVT v105,v26,v27
M16 v[40:43],v[192:195],a[200:203],v[40:43]
v_mul_f32 v28, s30, v28
v_mul_f32 v29, s30, v29
M16 v[40:43],v[196:199],a[216:219],v[40:43]
v_mul_f32 v30, s30, v30
v_mul_f32 v31, s30, v31
M16 v[40:43],v[200:203],a[232:235],v[40:43]
CVT v108,v28,v29
CVT v109,v30,v31
M16 v[40:43],v[204:207],a[248:251],v[40:43]
v_mul_f32 v32, s30, v32
v_mul_f32 v33, s30, v33
M16 v[44:47],v[192:195],a[204:207],v[44:47]
s_mov_b32 s29, s28
v_mul_f32 v34, s30, v34
v_mul_f32 v35, s30, v35
M16 v[44:47],v[196:199],a[220:223],v[44:47]
s_add_u32 s31, s31, 1
CVT v98,v32,v33
CVT v99,v34,v35
M16 v[44:47],v[200:203],a[236:239],v[44:47]
BS4 v[96:99],v7,s[16:19],s28 offen sc1
M16 v[44:47],v[204:207],a[252:255],v[44:47]
s_waitcnt lgkmcnt(0)
M16 v[16:19],v[144:147],a[0:3],0
DTR v[176:177],v3 offset:16384
v_mul_f32 v36, s30, v36
M16 v[16:19],v[148:151],a[16:19],v[16:19]
DTR v[178:179],v3 offset:16896
v_mul_f32 v37, s30, v37
M16 v[16:19],v[152:155],a[32:35],v[16:19]
v_mul_f32 v38, s30, v38
v_mul_f32 v39, s30, v39
M16 v[16:19],v[156:159],a[48:51],v[16:19]
DTR v[180:181],v3 offset:20480
CVT v102,v36,v37
M16 v[20:23],v[144:147],a[4:7],0
DTR v[182:183],v3 offset:20992
CVT v103,v38,v39
M16 v[20:23],v[148:151],a[20:23],v[20:23]
BS4 v[100:103],v8,s[16:19],s29 offen sc1
M16 v[20:23],v[152:155],a[36:39],v[20:23]
DTR v[184:185],v3 offset:24576
v_mul_f32 v40, s30, v40
M16 v[20:23],v[156:159],a[52:55],v[20:23]
DTR v[186:187],v3 offset:25088
v_mul_f32 v41, s30, v41
M16 v[24:27],v[144:147],a[8:11],0
v_mul_f32 v42, s30, v42
v_mul_f32 v43, s30, v43
M16 v[24:27],v[148:151],a[24:27],v[24:27]
DTR v[188:189],v3 offset:28672
CVT v106,v40,v41
M16 v[24:27],v[152:155],a[40:43],v[24:27]
DTR v[190:191],v3 offset:29184
CVT v107,v42,v43
M16 v[24:27],v[156:159],a[56:59],v[24:27]
BS4 v[104:107],v9,s[16:19],s29 offen sc1
M16 v[28:31],v[144:147],a[12:15],0
DTR v[192:193],v4 offset:16384
v_mul_f32 v44, s30, v44
M16 v[28:31],v[148:151],a[28:31],v[28:31]
DTR v[194:195],v4 offset:16896
v_mul_f32 v45, s30, v45
M16 v[28:31],v[152:155],a[44:47],v[28:31]
v_mul_f32 v46, s30, v46
v_mul_f32 v47, s30, v47
M16 v[28:31],v[156:159],a[60:63],v[28:31]
DTR v[196:197],v4 offset:20480
CVT v110,v44,v45
M16 v[32:35],v[160:163],a[0:3],0
DTR v[198:199],v4 offset:20992
CVT v111,v46,v47
M16 v[32:35],v[164:167],a[16:19],v[32:35]
BS4 v[108:111],v10,s[16:19],s29 offen sc1
M16 v[32:35],v[168:171],a[32:35],v[32:35]
DTR v[200:201],v4 offset:24576
s_add_u32 m0, s73, 81920
M16 v[32:35],v[172:175],a[48:51],v[32:35]
DTR v[202:203],v4 offset:25088
M16 v[36:39],v[160:163],a[4:7],0
BL4 v208,s[4:7],s70 offen lds
M16 v[36:39],v[164:167],a[20:23],v[36:39]
DTR v[204:205],v4 offset:28672
M16 v[36:39],v[168:171],a[36:39],v[36:39]
DTR v[206:207],v4 offset:29184
M16 v[36:39],v[172:175],a[52:55],v[36:39]
BL4 v209,s[4:7],s70 offen offset:1024 lds
M16 v[40:43],v[160:163],a[8:11],0
M16 v[40:43],v[164:167],a[24:27],v[40:43]
BL4 v210,s[4:7],s70 offen offset:2048 lds
M16 v[40:43],v[168:171],a[40:43],v[40:43]
M16 v[40:43],v[172:175],a[56:59],v[40:43]
BL4 v211,s[4:7],s70 offen offset:3072 lds
M16 v[44:47],v[160:163],a[12:15],0
M16 v[44:47],v[164:167],a[28:31],v[44:47]
s_add_u32 s70, s70, s71
s_add_u32 m0, s66, 0
M16 v[44:47],v[168:171],a[44:47],v[44:47]
s_mov_b32 s67, 0
M16 v[44:47],v[172:175],a[60:63],v[44:47]
s_waitcnt lgkmcnt(0)
M16 v[16:19],v[176:179],a[64:67],v[16:19]
DTR v[144:145],v3 offset:32768
s_lshr_b32 s40, s31, 2
M16 v[16:19],v[180:183],a[80:83],v[16:19]
DTR v[146:147],v3 offset:33280
s_lshl_b32 s40, s40, 20
M16 v[16:19],v[184:187],a[96:99],v[16:19]
s_and_b32 s41, s31, 3
s_lshl_b32 s41, s41, 10
s_add_u32 s40, s40, s41
M16 v[16:19],v[188:191],a[112:115],v[16:19]
DTR v[148:149],v3 offset:36864
s_add_u32 s28, s40, s38
M16 v[20:23],v[176:179],a[68:71],v[20:23]
DTR v[150:151],v3 offset:37376
M16 v[20:23],v[180:183],a[84:87],v[20:23]
BL4 v220,s[92:95],s67 offen lds
M16 v[20:23],v[184:187],a[100:103],v[20:23]
DTR v[152:153],v3 offset:40960
M16 v[20:23],v[188:191],a[116:119],v[20:23]
DTR v[154:155],v3 offset:41472
M16 v[24:27],v[176:179],a[72:75],v[24:27]
BL4 v221,s[92:95],s67 offen offset:1024 lds
M16 v[24:27],v[180:183],a[88:91],v[24:27]
DTR v[156:157],v3 offset:45056
M16 v[24:27],v[184:187],a[104:107],v[24:27]
DTR v[158:159],v3 offset:45568
M16 v[24:27],v[188:191],a[120:123],v[24:27]
BL4 v222,s[92:95],s67 offen offset:2048 lds
M16 v[28:31],v[176:179],a[76:79],v[28:31]
DTR v[160:161],v4 offset:32768
M16 v[28:31],v[180:183],a[92:95],v[28:31]
DTR v[162:163],v4 offset:33280
M16 v[28:31],v[184:187],a[108:111],v[28:31]
BL4 v223,s[92:95],s67 offen offset:3072 lds
M16 v[28:31],v[188:191],a[124:127],v[28:31]
DTR v[164:165],v4 offset:36864
M16 v[32:35],v[192:195],a[64:67],v[32:35]
DTR v[166:167],v4 offset:37376
s_add_u32 m0, s66, 4096
M16 v[32:35],v[196:199],a[80:83],v[32:35]
M16 v[32:35],v[200:203],a[96:99],v[32:35]
DTR v[168:169],v4 offset:40960
M16 v[32:35],v[204:207],a[112:115],v[32:35]
DTR v[170:171],v4 offset:41472
M16 v[36:39],v[192:195],a[68:71],v[36:39]
BL4 v224,s[92:95],s67 offen lds
M16 v[36:39],v[196:199],a[84:87],v[36:39]
DTR v[172:173],v4 offset:45056
M16 v[36:39],v[200:203],a[100:103],v[36:39]
DTR v[174:175],v4 offset:45568
M16 v[36:39],v[204:207],a[116:119],v[36:39]
BL4 v225,s[92:95],s67 offen offset:1024 lds
M16 v[40:43],v[192:195],a[72:75],v[40:43]
M16 v[40:43],v[196:199],a[88:91],v[40:43]
BL4 v226,s[92:95],s67 offen offset:2048 lds
M16 v[40:43],v[200:203],a[104:107],v[40:43]
M16 v[40:43],v[204:207],a[120:123],v[40:43]
BL4 v227,s[92:95],s67 offen offset:3072 lds
M16 v[44:47],v[192:195],a[76:79],v[44:47]
M16 v[44:47],v[196:199],a[92:95],v[44:47]
s_add_u32 m0, s73, 98304
M16 v[44:47],v[200:203],a[108:111],v[44:47]
BL4 v208,s[4:7],s70 offen lds
M16 v[44:47],v[204:207],a[124:127],v[44:47]
s_waitcnt lgkmcnt(0)
M16 v[16:19],v[144:147],a[128:131],v[16:19]
DTR v[176:177],v3 offset:49152
M16 v[16:19],v[148:151],a[144:147],v[16:19]
DTR v[178:179],v3 offset:49664
M16 v[16:19],v[152:155],a[160:163],v[16:19]
BL4 v209,s[4:7],s70 offen offset:1024 lds
M16 v[16:19],v[156:159],a[176:179],v[16:19]
DTR v[180:181],v3 offset:53248
M16 v[20:23],v[144:147],a[132:135],v[20:23]
DTR v[182:183],v3 offset:53760
M16 v[20:23],v[148:151],a[148:151],v[20:23]
BL4 v210,s[4:7],s70 offen offset:2048 lds
M16 v[20:23],v[152:155],a[164:167],v[20:23]
DTR v[184:185],v3 offset:57344
M16 v[20:23],v[156:159],a[180:183],v[20:23]
DTR v[186:187],v3 offset:57856
M16 v[24:27],v[144:147],a[136:139],v[24:27]
BL4 v211,s[4:7],s70 offen offset:3072 lds
M16 v[24:27],v[148:151],a[152:155],v[24:27]
DTR v[188:189],v3 offset:61440
M16 v[24:27],v[152:155],a[168:171],v[24:27]
DTR v[190:191],v3 offset:61952
s_add_u32 s70, s70, s71
M16 v[24:27],v[156:159],a[184:187],v[24:27]
M16 v[28:31],v[144:147],a[140:143],v[28:31]
DTR v[192:193],v4 offset:49152
M16 v[28:31],v[148:151],a[156:159],v[28:31]
DTR v[194:195],v4 offset:49664
M16 v[28:31],v[152:155],a[172:175],v[28:31]
M16 v[28:31],v[156:159],a[188:191],v[28:31]
DTR v[196:197],v4 offset:53248
M16 v[32:35],v[160:163],a[128:131],v[32:35]
DTR v[198:199],v4 offset:53760
M16 v[32:35],v[164:167],a[144:147],v[32:35]
M16 v[32:35],v[168:171],a[160:163],v[32:35]
DTR v[200:201],v4 offset:57344
M16 v[32:35],v[172:175],a[176:179],v[32:35]
DTR v[202:203],v4 offset:57856
M16 v[36:39],v[160:163],a[132:135],v[36:39]
M16 v[36:39],v[164:167],a[148:151],v[36:39]
DTR v[204:205],v4 offset:61440
M16 v[36:39],v[168:171],a[164:167],v[36:39]
DTR v[206:207],v4 offset:61952
M16 v[36:39],v[172:175],a[180:183],v[36:39]
M16 v[40:43],v[160:163],a[136:139],v[40:43]
s_xor_b32 s27, s27, 65536
M16 v[40:43],v[164:167],a[152:155],v[40:43]
v_add_u32 v3, s27, v5
M16 v[40:43],v[168:171],a[168:171],v[40:43]
v_xor_b32 v4, 32, v3
M16 v[40:43],v[172:175],a[184:187],v[40:43]
M16 v[44:47],v[160:163],a[140:143],v[44:47]
M16 v[44:47],v[164:167],a[156:159],v[44:47]
s_waitcnt lgkmcnt(0)
M16 v[44:47],v[168:171],a[172:175],v[44:47]
M16 v[44:47],v[172:175],a[188:191],v[44:47]
s_barrier
M16 v[16:19],v[176:179],a[192:195],v[16:19]
DTR v[144:145],v3 offset:0
M16 v[16:19],v[180:183],a[208:211],v[16:19]
DTR v[146:147],v3 offset:512
M16 v[16:19],v[184:187],a[224:227],v[16:19]
M16 v[16:19],v[188:191],a[240:243],v[16:19]
DTR v[148:149],v3 offset:4096
M16 v[20:23],v[176:179],a[196:199],v[20:23]
DTR v[150:151],v3 offset:4608
M16 v[20:23],v[180:183],a[212:215],v[20:23]
M16 v[20:23],v[184:187],a[228:231],v[20:23]
DTR v[152:153],v3 offset:8192
M16 v[20:23],v[188:191],a[244:247],v[20:23]
DTR v[154:155],v3 offset:8704
M16 v[24:27],v[176:179],a[200:203],v[24:27]
M16 v[24:27],v[180:183],a[216:219],v[24:27]
DTR v[156:157],v3 offset:12288
M16 v[24:27],v[184:187],a[232:235],v[24:27]
DTR v[158:159],v3 offset:12800
M16 v[24:27],v[188:191],a[248:251],v[24:27]
v_mul_f32 v16, s30, v16
v_mul_f32 v17, s30, v17
M16 v[28:31],v[176:179],a[204:207],v[28:31]
DTR v[160:161],v4 offset:0
v_mul_f32 v18, s30, v18
M16 v[28:31],v[180:183],a[220:223],v[28:31]
DTR v[162:163],v4 offset:512
v_mul_f32 v19, s30, v19
M16 v[28:31],v[184:187],a[236:239],v[28:31]
CVT v96,v16,v17
CVT v97,v18,v19
M16 v[28:31],v[188:191],a[252:255],v[28:31]
DTR v[164:165],v4 offset:4096
v_mul_f32 v20, s30, v20
M16 v[32:35],v[192:195],a[192:195],v[32:35]
DTR v[166:167],v4 offset:4608
v_mul_f32 v21, s30, v21
M16 v[32:35],v[196:199],a[208:211],v[32:35]
v_mul_f32 v22, s30, v22
v_mul_f32 v23, s30, v23
M16 v[32:35],v[200:203],a[224:227],v[32:35]
DTR v[168:169],v4 offset:8192
CVT v100,v20,v21
M16 v[32:35],v[204:207],a[240:243],v[32:35]
DTR v[170:171],v4 offset:8704
CVT v101,v22,v23
M16 v[36:39],v[192:195],a[196:199],v[36:39]
v_mul_f32 v24, s30, v24
v_mul_f32 v25, s30, v25
M16 v[36:39],v[196:199],a[212:215],v[36:39]
DTR v[172:173],v4 offset:12288
v_mul_f32 v26, s30, v26
M16 v[36:39],v[200:203],a[228:231],v[36:39]
DTR v[174:175],v4 offset:12800
v_mul_f32 v27, s30, v27
M16 v[36:39],v[204:207],a[244:247],v[36:39]
CVT v104,v24,v25
CVT v105,v26,v27
M16 v[40:43],v[192:195],a[200:203],v[40:43]
v_mul_f32 v28, s30, v28
v_mul_f32 v29, s30, v29
M16 v[40:43],v[196:199],a[216:219],v[40:43]
v_mul_f32 v30, s30, v30
v_mul_f32 v31, s30, v31
M16 v[40:43],v[200:203],a[232:235],v[40:43]
CVT v108,v28,v29
CVT v109,v30,v31
M16 v[40:43],v[204:207],a[248:251],v[40:43]
v_mul_f32 v32, s30, v32
v_mul_f32 v33, s30, v33
M16 v[44:47],v[192:195],a[204:207],v[44:47]
s_mov_b32 s29, s28
v_mul_f32 v34, s30, v34
v_mul_f32 v35, s30, v35
M16 v[44:47],v[196:199],a[220:223],v[44:47]
s_add_u32 s31, s31, 1
CVT v98,v32,v33
CVT v99,v34,v35
M16 v[44:47],v[200:203],a[236:239],v[44:47]
s_sub_u32 s23, s23, 1
M16 v[44:47],v[204:207],a[252:255],v[44:47]
s_waitcnt lgkmcnt(0)
BS4 v[96:99],v7,s[16:19],s28 offen sc1
s_nop 7
v_mul_f32 v36, s30, v36
v_mul_f32 v37, s30, v37
v_mul_f32 v38, s30, v38
v_mul_f32 v39, s30, v39
CVT v102,v36,v37
CVT v103,v38,v39
BS4 v[100:103],v8,s[16:19],s29 offen sc1
v_mul_f32 v40, s30, v40
v_mul_f32 v41, s30, v41
v_mul_f32 v42, s30, v42
v_mul_f32 v43, s30, v43
CVT v106,v40,v41
CVT v107,v42,v43
BS4 v[104:107],v9,s[16:19],s29 offen sc1
v_mul_f32 v44, s30, v44
v_mul_f32 v45, s30, v45
v_mul_f32 v46, s30, v46
v_mul_f32 v47, s30, v47
CVT v110,v44,v45
CVT v111,v46,v47
BS4 v[108:111],v10,s[16:19],s29 offen sc1
s_branch L_p2_entry_early
L_p1_roleV:
s_lshl_b32 s38, s21, 17
s_add_u32 s38, s38, 16384
s_mov_b32 s8, s72
s_mov_b32 s9, s73
s_mov_b32 s10, 4194304
s_mov_b32 s11, 0x00020000
s_lshl_b32 s36, s31, 6
s_mov_b32 s37, 524288
s_and_b32 s40, s21, 3
s_lshl_b32 s40, s40, 2
s_add_u32 s40, s40, s20
s_mul_i32 s40, s40, 16
v_min_u32 v212, 31, v1
v_lshrrev_b32 v213, 1, v212
v_add_u32 v213, s40, v213
s_lshr_b32 s40, s37, 6
v_mul_lo_u32 v213, v213, s40
v_and_b32 v212, 1, v212
v_lshl_add_u32 v216, v212, 7, v213
s_mul_i32 s44, s37, 4
s_add_u32 s44, s44, s36
s_mov_b32 s43, s36
s_lshr_b32 s40, s2, 3
s_lshl_b32 s40, s40, 2
s_add_u32 s40, s40, s20
s_and_b32 s41, s2, 1
s_lshl_b32 s41, s41, 7
s_add_u32 s40, s40, s41
s_lshl_b32 s56, s40, 13
s_mul_i32 s57, s40, 10240
v_min_u32 v212, 31, v1
v_lshrrev_b32 v213, 2, v212
v_and_b32 v212, 3, v212
v_lshlrev_b32 v212, 7, v212
v_lshl_add_u32 v217, v213, 10, v212
v_min_u32 v212, 39, v1
v_mul_u32_u24 v213, 52, v212
v_lshrrev_b32 v213, 8, v213
v_mul_u32_u24 v214, 5, v213
v_sub_u32 v212, v212, v214
v_lshlrev_b32 v212, 7, v212
v_mul_u32_u24 v213, 1280, v213
v_add_u32 v218, v212, v213
s_mov_b32 s48, s66
s_mov_b32 s49, s67
s_mov_b32 s50, 2097152
s_mov_b32 s51, 0x00020000
s_mov_b32 s60, s76
s_mov_b32 s61, s77
s_mov_b32 s62, 2621440
s_mov_b32 s63, 0x00020000
buffer_load_dword v6, v217, s[48:51], s56 offen offset:0
buffer_load_dword v6, v216, s[8:11], s43 offen
s_and_b32 s40, s2, 6
s_cmp_lg_u32 s40, 6
s_cbranch_scc1 L_pf_V_0
buffer_load_dword v6, v218, s[60:63], s57 offen offset:0
L_pf_V_0:
s_lshr_b32 s40, s37, 6
v_lshrrev_b32 v220, 4, v1
s_lshl_b32 s41, s20, 4
v_add_u32 v221, s41, v220
v_mul_lo_u32 v221, v221, s40
v_lshlrev_b32 v220, 1, v220
v_and_b32 v222, 15, v1
v_xor_b32 v220, v220, v222
s_lshl_b32 s40, s40, 2
s_sub_u32 s40, s40, 1024
v_lshl_add_u32 v208, v220, 4, v221
v_add_u32 v209, s40, v208
v_xor_b32 v220, 8, v220
v_lshl_add_u32 v210, v220, 4, v221
s_lshl_b32 s41, s40, 1
v_add_u32 v210, s41, v210
v_add_u32 v211, s40, v210
s_lshl_b32 s40, s21, 2
s_add_u32 s40, s40, s20
s_mul_i32 s40, s40, 65536
v_lshrrev_b32 v220, 3, v1
v_mul_u32_u24 v220, 1024, v220
v_add_u32 v220, s40, v220
v_and_b32 v221, 7, v1
v_lshrrev_b32 v222, 4, v1
v_xor_b32 v221, v221, v222
v_xor_b32 v222, 4, v221
v_lshl_add_u32 v221, v221, 4, v220
v_lshl_add_u32 v222, v222, 4, v220
v_add_u32 v200, 0, v221
v_add_u32 v201, 7168, v222
v_add_u32 v202, 14336, v221
v_add_u32 v203, 21504, v222
v_add_u32 v204, 32768, v221
v_add_u32 v205, 39936, v222
v_add_u32 v206, 47104, v221
v_add_u32 v207, 54272, v222
s_mul_i32 s32, s20, 12288
s_add_u32 s32, s32, 114688
s_add_u32 m0, s34, 65536
s_nop 0
BL4 v208,s[8:11],s36 offen lds
BL4 v209,s[8:11],s36 offen offset:1024 lds
BL4 v210,s[8:11],s36 offen offset:2048 lds
BL4 v211,s[8:11],s36 offen offset:3072 lds
s_add_u32 s36, s36, s37
s_add_u32 m0, s32, 0
s_mov_b32 s33, 0
BL4 v200,s[12:15],s33 offen lds
BL4 v201,s[12:15],s33 offen offset:1024 lds
BL4 v202,s[12:15],s33 offen offset:2048 lds
BL4 v203,s[12:15],s33 offen offset:3072 lds
s_add_u32 m0, s32, 4096
s_nop 0
BL4 v204,s[12:15],s33 offen lds
BL4 v205,s[12:15],s33 offen offset:1024 lds
BL4 v206,s[12:15],s33 offen offset:2048 lds
BL4 v207,s[12:15],s33 offen offset:3072 lds
buffer_load_dword v6, v217, s[48:51], s56 offen offset:512
buffer_load_dword v6, v216, s[8:11], s44 offen
s_and_b32 s40, s2, 6
s_cmp_lg_u32 s40, 6
s_cbranch_scc1 L_pf_V_1
buffer_load_dword v6, v218, s[60:63], s57 offen offset:640
L_pf_V_1:
s_add_u32 m0, s34, 81920
s_nop 0
BL4 v208,s[8:11],s36 offen lds
BL4 v209,s[8:11],s36 offen offset:1024 lds
BL4 v210,s[8:11],s36 offen offset:2048 lds
BL4 v211,s[8:11],s36 offen offset:3072 lds
s_add_u32 s36, s36, s37
s_add_u32 m0, s32, 8192
s_mov_b32 s33, 128
BL4 v200,s[12:15],s33 offen lds
BL4 v201,s[12:15],s33 offen offset:1024 lds
BL4 v202,s[12:15],s33 offen offset:2048 lds
BL4 v203,s[12:15],s33 offen offset:3072 lds
v_and_b32 v220, 15, v1
v_lshrrev_b32 v221, 1, v220
v_lshrrev_b32 v222, 4, v1
v_xor_b32 v221, v221, v222
v_lshlrev_b32 v221, 4, v221
v_lshl_add_u32 v12, v220, 7, v221
v_add_u32 v12, s32, v12
v_xor_b32 v13, 64, v12
v_lshrrev_b32 v220, 4, v1
v_bfe_u32 v221, v1, 2, 2
v_lshl_add_u32 v222, v220, 3, v221
v_lshlrev_b32 v222, 8, v222
v_and_b32 v220, 1, v220
v_lshl_add_u32 v221, v220, 2, v221
v_lshl_add_u32 v222, v221, 5, v222
v_and_b32 v220, 3, v1
v_lshl_add_u32 v222, v220, 3, v222
v_add_u32 v192, 65536, v222
v_xor_b32 v193, 32, v192
v_xor_b32 v194, 64, v192
v_xor_b32 v195, 96, v192
v_xor_b32 v196, 128, v192
v_xor_b32 v197, 160, v192
v_xor_b32 v198, 192, v192
v_xor_b32 v199, 224, v192
v_lshrrev_b32 v212, 3, v1
s_lshl_b32 s40, s20, 7
v_add_u32 v212, s40, v212
v_lshlrev_b32 v212, 13, v212
v_bfe_u32 v213, v1, 4, 1
v_lshlrev_b32 v213, 1, v213
v_and_b32 v214, 7, v1
v_xor_b32 v213, v213, v214
v_lshl_add_u32 v216, v213, 4, v212
v_xor_b32 v213, 4, v213
v_lshl_add_u32 v217, v213, 4, v212
v_add_u32 v218, 129024, v216
v_add_u32 v219, 193536, v217
v_add_u32 v217, 64512, v217
v_lshrrev_b32 v212, 4, v1
v_bfe_u32 v213, v1, 2, 2
v_lshl_add_u32 v214, v212, 3, v213
v_lshlrev_b32 v214, 7, v214
v_and_b32 v212, 1, v212
v_lshrrev_b32 v213, 1, v213
v_lshl_add_u32 v213, v212, 1, v213
v_lshl_add_u32 v214, v213, 5, v214
v_and_b32 v212, 3, v1
v_lshl_add_u32 v5, v212, 3, v214
v_mov_b32 v3, v5
v_xor_b32 v4, 32, v5
s_mov_b32 s27, 0
s_mov_b32 s29, 1073741824
s_lshl_b32 s26, s20, 14
s_lshl_b32 s24, s31, 6
s_add_u32 s25, s24, 256
s_add_u32 s24, s24, 384
s_mov_b32 s92, s68
s_mov_b32 s93, s69
s_mov_b32 s94, 5242880
s_mov_b32 s95, 0x00020000
s_mul_i32 s61, s21, 26
s_add_u32 s61, s61, s22
s_lshl_b32 s61, s61, 2
s_add_u32 s61, s61, s20
s_mul_i32 s61, s61, 6400
v_min_u32 v11, 49, v1
v_lshlrev_b32 v11, 7, v11
s_lshr_b32 s40, s31, 2
s_lshl_b32 s40, s40, 20
s_and_b32 s41, s31, 3
s_lshl_b32 s41, s41, 12
s_add_u32 s40, s40, s41
s_add_u32 s60, s40, s38
s_add_u32 s42, s31, 1
s_lshr_b32 s40, s42, 2
s_lshl_b32 s40, s40, 20
s_and_b32 s41, s42, 3
s_lshl_b32 s41, s41, 12
s_add_u32 s40, s40, s41
s_add_u32 s48, s40, s38
s_add_u32 s49, s48, 1024
s_add_u32 s50, s48, 2048
s_add_u32 s51, s48, 3072
s_add_u32 s42, s31, 2
s_lshr_b32 s40, s42, 2
s_lshl_b32 s40, s40, 20
s_and_b32 s41, s42, 3
s_lshl_b32 s41, s41, 12
s_add_u32 s40, s40, s41
s_add_u32 s52, s40, s38
s_add_u32 s53, s52, 1024
s_add_u32 s54, s52, 2048
s_add_u32 s55, s52, 3072
s_add_u32 s42, s31, 3
s_lshr_b32 s40, s42, 2
s_lshl_b32 s40, s40, 20
s_and_b32 s41, s42, 3
s_lshl_b32 s41, s41, 12
s_add_u32 s40, s40, s41
s_add_u32 s56, s40, s38
s_add_u32 s57, s56, 1024
s_add_u32 s58, s56, 2048
s_add_u32 s59, s56, 3072
s_waitcnt vmcnt(10)
s_barrier
DR a[0:3],v12 offset:0
DR a[16:19],v13 offset:0
DR a[4:7],v12 offset:2048
DR a[20:23],v13 offset:2048
DR a[8:11],v12 offset:4096
DR a[24:27],v13 offset:4096
DR a[12:15],v12 offset:6144
DR a[28:31],v13 offset:6144
s_waitcnt lgkmcnt(4)
s_add_u32 m0, s32, 0
s_nop 0
BL4 v204,s[12:15],s33 offen lds
BL4 v205,s[12:15],s33 offen offset:1024 lds
BL4 v206,s[12:15],s33 offen offset:2048 lds
BL4 v207,s[12:15],s33 offen offset:3072 lds
DTR v[144:145],v192 offset:0
DTR v[146:147],v192 offset:1024
DTR v[148:149],v192 offset:8192
DTR v[150:151],v192 offset:9216
DTR v[152:153],v193 offset:0
DTR v[154:155],v193 offset:1024
DTR v[156:157],v193 offset:8192
DTR v[158:159],v193 offset:9216
DTR v[160:161],v194 offset:0
DTR v[162:163],v194 offset:1024
DTR v[164:165],v194 offset:8192
DTR v[166:167],v194 offset:9216
DTR v[168:169],v195 offset:0
DTR v[170:171],v195 offset:1024
DTR v[172:173],v195 offset:8192
DTR v[174:175],v195 offset:9216
DTR v[176:177],v196 offset:0
DTR v[178:179],v196 offset:1024
DTR v[180:181],v196 offset:8192
DTR v[182:183],v196 offset:9216
s_waitcnt lgkmcnt(15)
M16 v[16:19],a[0:3],v[144:147],0
DTR v[184:185],v197 offset:0
s_add_u32 m0, s32, 4096
M16 v[16:19],a[16:19],v[148:151],v[16:19]
s_mov_b32 s33, 256
M16 v[20:23],a[4:7],v[144:147],0
DTR v[186:187],v197 offset:1024
M16 v[20:23],a[20:23],v[148:151],v[20:23]
BL4 v200,s[12:15],s33 offen lds
M16 v[24:27],a[8:11],v[144:147],0
DTR v[188:189],v197 offset:8192
M16 v[24:27],a[24:27],v[148:151],v[24:27]
BL4 v201,s[12:15],s33 offen offset:1024 lds
M16 v[28:31],a[12:15],v[144:147],0
DTR v[190:191],v197 offset:9216
M16 v[28:31],a[28:31],v[148:151],v[28:31]
s_waitcnt lgkmcnt(15)
M16 v[32:35],a[0:3],v[152:155],0
DTR v[144:145],v198 offset:0
M16 v[32:35],a[16:19],v[156:159],v[32:35]
BL4 v202,s[12:15],s33 offen offset:2048 lds
M16 v[36:39],a[4:7],v[152:155],0
DTR v[146:147],v198 offset:1024
M16 v[36:39],a[20:23],v[156:159],v[36:39]
BL4 v203,s[12:15],s33 offen offset:3072 lds
M16 v[40:43],a[8:11],v[152:155],0
DTR v[148:149],v198 offset:8192
s_waitcnt vmcnt(8)
M16 v[40:43],a[24:27],v[156:159],v[40:43]
DR a[32:35],v12 offset:8192
M16 v[44:47],a[12:15],v[152:155],0
DTR v[150:151],v198 offset:9216
M16 v[44:47],a[28:31],v[156:159],v[44:47]
s_waitcnt lgkmcnt(15)
DR a[48:51],v13 offset:8192
M16 v[48:51],a[0:3],v[160:163],0
DTR v[152:153],v199 offset:0
M16 v[48:51],a[16:19],v[164:167],v[48:51]
DR a[36:39],v12 offset:10240
M16 v[52:55],a[4:7],v[160:163],0
DTR v[154:155],v199 offset:1024
M16 v[52:55],a[20:23],v[164:167],v[52:55]
DR a[52:55],v13 offset:10240
s_waitcnt vmcnt(4)
M16 v[56:59],a[8:11],v[160:163],0
DTR v[156:157],v199 offset:8192
M16 v[56:59],a[24:27],v[164:167],v[56:59]
s_waitcnt lgkmcnt(15)
DR a[40:43],v12 offset:0
M16 v[60:63],a[12:15],v[160:163],0
DTR v[158:159],v199 offset:9216
M16 v[60:63],a[28:31],v[164:167],v[60:63]
s_barrier
DR a[56:59],v13 offset:0
M16 v[64:67],a[0:3],v[168:171],0
DTR v[160:161],v192 offset:16384
M16 v[64:67],a[16:19],v[172:175],v[64:67]
DR a[44:47],v12 offset:2048
M16 v[68:71],a[4:7],v[168:171],0
DTR v[162:163],v192 offset:17408
M16 v[68:71],a[20:23],v[172:175],v[68:71]
DR a[60:63],v13 offset:2048
s_waitcnt lgkmcnt(8)
M16 v[72:75],a[8:11],v[168:171],0
DTR v[164:165],v192 offset:24576
s_add_u32 m0, s32, 8192
M16 v[72:75],a[24:27],v[172:175],v[72:75]
M16 v[76:79],a[12:15],v[168:171],0
DTR v[166:167],v192 offset:25600
M16 v[76:79],a[28:31],v[172:175],v[76:79]
M16 v[80:83],a[0:3],v[176:179],0
DTR v[168:169],v193 offset:16384
M16 v[80:83],a[16:19],v[180:183],v[80:83]
BL4 v204,s[12:15],s33 offen lds
M16 v[84:87],a[4:7],v[176:179],0
DTR v[170:171],v193 offset:17408
M16 v[84:87],a[20:23],v[180:183],v[84:87]
BL4 v205,s[12:15],s33 offen offset:1024 lds
M16 v[88:91],a[8:11],v[176:179],0
DTR v[172:173],v193 offset:24576
M16 v[88:91],a[24:27],v[180:183],v[88:91]
BL4 v206,s[12:15],s33 offen offset:2048 lds
M16 v[92:95],a[12:15],v[176:179],0
DTR v[174:175],v193 offset:25600
M16 v[92:95],a[28:31],v[180:183],v[92:95]
M16 v[96:99],a[0:3],v[184:187],0
DTR v[176:177],v194 offset:16384
M16 v[96:99],a[16:19],v[188:191],v[96:99]
BL4 v207,s[12:15],s33 offen offset:3072 lds
M16 v[100:103],a[4:7],v[184:187],0
DTR v[178:179],v194 offset:17408
s_add_u32 m0, s34, 98304
M16 v[100:103],a[20:23],v[188:191],v[100:103]
BL4 v208,s[8:11],s36 offen lds
M16 v[104:107],a[8:11],v[184:187],0
DTR v[180:181],v194 offset:24576
M16 v[104:107],a[24:27],v[188:191],v[104:107]
BL4 v209,s[8:11],s36 offen offset:1024 lds
M16 v[108:111],a[12:15],v[184:187],0
DTR v[182:183],v194 offset:25600
M16 v[108:111],a[28:31],v[188:191],v[108:111]
M16 v[112:115],a[0:3],v[144:147],0
DTR v[184:185],v195 offset:16384
M16 v[112:115],a[16:19],v[148:151],v[112:115]
BL4 v210,s[8:11],s36 offen offset:2048 lds
M16 v[116:119],a[4:7],v[144:147],0
DTR v[186:187],v195 offset:17408
M16 v[116:119],a[20:23],v[148:151],v[116:119]
BL4 v211,s[8:11],s36 offen offset:3072 lds
M16 v[120:123],a[8:11],v[144:147],0
DTR v[188:189],v195 offset:24576
s_add_u32 s36, s36, s37
M16 v[120:123],a[24:27],v[148:151],v[120:123]
s_add_u32 m0, s26, 0
M16 v[124:127],a[12:15],v[144:147],0
DTR v[190:191],v195 offset:25600
M16 v[124:127],a[28:31],v[148:151],v[124:127]
s_waitcnt lgkmcnt(15)
M16 v[128:131],a[0:3],v[152:155],0
DTR v[144:145],v196 offset:16384
M16 v[128:131],a[16:19],v[156:159],v[128:131]
BL4 v216,s[8:11],s25 offen lds
M16 v[132:135],a[4:7],v[152:155],0
DTR v[146:147],v196 offset:17408
M16 v[132:135],a[20:23],v[156:159],v[132:135]
BL4 v217,s[8:11],s25 offen offset:1024 lds
M16 v[136:139],a[8:11],v[152:155],0
DTR v[148:149],v196 offset:24576
M16 v[136:139],a[24:27],v[156:159],v[136:139]
M16 v[140:143],a[12:15],v[152:155],0
DTR v[150:151],v196 offset:25600
M16 v[140:143],a[28:31],v[156:159],v[140:143]
s_waitcnt lgkmcnt(15)
M16 v[16:19],a[32:35],v[160:163],v[16:19]
DTR v[152:153],v197 offset:16384
s_add_u32 m0, s32, 0
M16 v[16:19],a[48:51],v[164:167],v[16:19]
s_mov_b32 s33, 384
M16 v[20:23],a[36:39],v[160:163],v[20:23]
DTR v[154:155],v197 offset:17408
M16 v[20:23],a[52:55],v[164:167],v[20:23]
BL4 v200,s[12:15],s33 offen lds
M16 v[24:27],a[40:43],v[160:163],v[24:27]
DTR v[156:157],v197 offset:24576
M16 v[24:27],a[56:59],v[164:167],v[24:27]
BL4 v201,s[12:15],s33 offen offset:1024 lds
M16 v[28:31],a[44:47],v[160:163],v[28:31]
DTR v[158:159],v197 offset:25600
M16 v[28:31],a[60:63],v[164:167],v[28:31]
s_waitcnt lgkmcnt(15)
M16 v[32:35],a[32:35],v[168:171],v[32:35]
DTR v[160:161],v198 offset:16384
M16 v[32:35],a[48:51],v[172:175],v[32:35]
BL4 v202,s[12:15],s33 offen offset:2048 lds
M16 v[36:39],a[36:39],v[168:171],v[36:39]
DTR v[162:163],v198 offset:17408
M16 v[36:39],a[52:55],v[172:175],v[36:39]
BL4 v203,s[12:15],s33 offen offset:3072 lds
M16 v[40:43],a[40:43],v[168:171],v[40:43]
DTR v[164:165],v198 offset:24576
s_waitcnt vmcnt(14)
M16 v[40:43],a[56:59],v[172:175],v[40:43]
DR a[64:67],v12 offset:4096
M16 v[44:47],a[44:47],v[168:171],v[44:47]
DTR v[166:167],v198 offset:25600
M16 v[44:47],a[60:63],v[172:175],v[44:47]
s_waitcnt lgkmcnt(15)
DR a[80:83],v13 offset:4096
M16 v[48:51],a[32:35],v[176:179],v[48:51]
DTR v[168:169],v199 offset:16384
M16 v[48:51],a[48:51],v[180:183],v[48:51]
DR a[68:71],v12 offset:6144
M16 v[52:55],a[36:39],v[176:179],v[52:55]
DTR v[170:171],v199 offset:17408
M16 v[52:55],a[52:55],v[180:183],v[52:55]
DR a[84:87],v13 offset:6144
s_waitcnt vmcnt(10)
M16 v[56:59],a[40:43],v[176:179],v[56:59]
DTR v[172:173],v199 offset:24576
M16 v[56:59],a[56:59],v[180:183],v[56:59]
s_waitcnt lgkmcnt(15)
DR a[72:75],v12 offset:8192
M16 v[60:63],a[44:47],v[176:179],v[60:63]
DTR v[174:175],v199 offset:25600
s_waitcnt vmcnt(6)
M16 v[60:63],a[60:63],v[180:183],v[60:63]
s_barrier
DR a[88:91],v13 offset:8192
M16 v[64:67],a[32:35],v[184:187],v[64:67]
DTR v[176:177],v192 offset:32768
M16 v[64:67],a[48:51],v[188:191],v[64:67]
DR a[76:79],v12 offset:10240
M16 v[68:71],a[36:39],v[184:187],v[68:71]
DTR v[178:179],v192 offset:33792
M16 v[68:71],a[52:55],v[188:191],v[68:71]
DR a[92:95],v13 offset:10240
s_waitcnt lgkmcnt(8)
M16 v[72:75],a[40:43],v[184:187],v[72:75]
DTR v[180:181],v192 offset:40960
s_add_u32 m0, s32, 4096
M16 v[72:75],a[56:59],v[188:191],v[72:75]
M16 v[76:79],a[44:47],v[184:187],v[76:79]
DTR v[182:183],v192 offset:41984
M16 v[76:79],a[60:63],v[188:191],v[76:79]
M16 v[80:83],a[32:35],v[144:147],v[80:83]
DTR v[184:185],v193 offset:32768
M16 v[80:83],a[48:51],v[148:151],v[80:83]
BL4 v204,s[12:15],s33 offen lds
M16 v[84:87],a[36:39],v[144:147],v[84:87]
DTR v[186:187],v193 offset:33792
M16 v[84:87],a[52:55],v[148:151],v[84:87]
BL4 v205,s[12:15],s33 offen offset:1024 lds
M16 v[88:91],a[40:43],v[144:147],v[88:91]
DTR v[188:189],v193 offset:40960
M16 v[88:91],a[56:59],v[148:151],v[88:91]
BL4 v206,s[12:15],s33 offen offset:2048 lds
M16 v[92:95],a[44:47],v[144:147],v[92:95]
DTR v[190:191],v193 offset:41984
M16 v[92:95],a[60:63],v[148:151],v[92:95]
M16 v[96:99],a[32:35],v[152:155],v[96:99]
DTR v[144:145],v194 offset:32768
M16 v[96:99],a[48:51],v[156:159],v[96:99]
BL4 v207,s[12:15],s33 offen offset:3072 lds
M16 v[100:103],a[36:39],v[152:155],v[100:103]
DTR v[146:147],v194 offset:33792
s_add_u32 m0, s34, 65536
M16 v[100:103],a[52:55],v[156:159],v[100:103]
BL4 v208,s[8:11],s36 offen lds
M16 v[104:107],a[40:43],v[152:155],v[104:107]
DTR v[148:149],v194 offset:40960
M16 v[104:107],a[56:59],v[156:159],v[104:107]
BL4 v209,s[8:11],s36 offen offset:1024 lds
M16 v[108:111],a[44:47],v[152:155],v[108:111]
DTR v[150:151],v194 offset:41984
M16 v[108:111],a[60:63],v[156:159],v[108:111]
M16 v[112:115],a[32:35],v[160:163],v[112:115]
DTR v[152:153],v195 offset:32768
M16 v[112:115],a[48:51],v[164:167],v[112:115]
BL4 v210,s[8:11],s36 offen offset:2048 lds
M16 v[116:119],a[36:39],v[160:163],v[116:119]
DTR v[154:155],v195 offset:33792
M16 v[116:119],a[52:55],v[164:167],v[116:119]
BL4 v211,s[8:11],s36 offen offset:3072 lds
M16 v[120:123],a[40:43],v[160:163],v[120:123]
DTR v[156:157],v195 offset:40960
s_add_u32 s36, s36, s37
M16 v[120:123],a[56:59],v[164:167],v[120:123]
s_add_u32 m0, s26, 0
M16 v[124:127],a[44:47],v[160:163],v[124:127]
DTR v[158:159],v195 offset:41984
M16 v[124:127],a[60:63],v[164:167],v[124:127]
s_waitcnt lgkmcnt(15)
M16 v[128:131],a[32:35],v[168:171],v[128:131]
DTR v[160:161],v196 offset:32768
M16 v[128:131],a[48:51],v[172:175],v[128:131]
BL4 v218,s[8:11],s25 offen offset:2048 lds
M16 v[132:135],a[36:39],v[168:171],v[132:135]
DTR v[162:163],v196 offset:33792
M16 v[132:135],a[52:55],v[172:175],v[132:135]
BL4 v219,s[8:11],s25 offen offset:3072 lds
M16 v[136:139],a[40:43],v[168:171],v[136:139]
DTR v[164:165],v196 offset:40960
s_add_u32 s25, s25, 262144
M16 v[136:139],a[56:59],v[172:175],v[136:139]
M16 v[140:143],a[44:47],v[168:171],v[140:143]
DTR v[166:167],v196 offset:41984
M16 v[140:143],a[60:63],v[172:175],v[140:143]
s_waitcnt lgkmcnt(15)
M16 v[16:19],a[64:67],v[176:179],v[16:19]
DTR v[168:169],v197 offset:32768
s_add_u32 m0, s32, 8192
M16 v[16:19],a[80:83],v[180:183],v[16:19]
s_mov_b32 s33, 512
M16 v[20:23],a[68:71],v[176:179],v[20:23]
DTR v[170:171],v197 offset:33792
M16 v[20:23],a[84:87],v[180:183],v[20:23]
BL4 v200,s[12:15],s33 offen lds
M16 v[24:27],a[72:75],v[176:179],v[24:27]
DTR v[172:173],v197 offset:40960
M16 v[24:27],a[88:91],v[180:183],v[24:27]
BL4 v201,s[12:15],s33 offen offset:1024 lds
M16 v[28:31],a[76:79],v[176:179],v[28:31]
DTR v[174:175],v197 offset:41984
M16 v[28:31],a[92:95],v[180:183],v[28:31]
s_waitcnt lgkmcnt(15)
M16 v[32:35],a[64:67],v[184:187],v[32:35]
DTR v[176:177],v198 offset:32768
M16 v[32:35],a[80:83],v[188:191],v[32:35]
BL4 v202,s[12:15],s33 offen offset:2048 lds
M16 v[36:39],a[68:71],v[184:187],v[36:39]
DTR v[178:179],v198 offset:33792
M16 v[36:39],a[84:87],v[188:191],v[36:39]
BL4 v203,s[12:15],s33 offen offset:3072 lds
M16 v[40:43],a[72:75],v[184:187],v[40:43]
DTR v[180:181],v198 offset:40960
s_waitcnt vmcnt(14)
M16 v[40:43],a[88:91],v[188:191],v[40:43]
DR a[96:99],v12 offset:0
M16 v[44:47],a[76:79],v[184:187],v[44:47]
DTR v[182:183],v198 offset:41984
M16 v[44:47],a[92:95],v[188:191],v[44:47]
s_waitcnt lgkmcnt(15)
DR a[112:115],v13 offset:0
M16 v[48:51],a[64:67],v[144:147],v[48:51]
DTR v[184:185],v199 offset:32768
M16 v[48:51],a[80:83],v[148:151],v[48:51]
DR a[100:103],v12 offset:2048
M16 v[52:55],a[68:71],v[144:147],v[52:55]
DTR v[186:187],v199 offset:33792
M16 v[52:55],a[84:87],v[148:151],v[52:55]
DR a[116:119],v13 offset:2048
s_waitcnt vmcnt(10)
M16 v[56:59],a[72:75],v[144:147],v[56:59]
DTR v[188:189],v199 offset:40960
M16 v[56:59],a[88:91],v[148:151],v[56:59]
s_waitcnt lgkmcnt(15)
DR a[104:107],v12 offset:4096
M16 v[60:63],a[76:79],v[144:147],v[60:63]
DTR v[190:191],v199 offset:41984
s_waitcnt vmcnt(6)
M16 v[60:63],a[92:95],v[148:151],v[60:63]
s_barrier
DR a[120:123],v13 offset:4096
M16 v[64:67],a[64:67],v[152:155],v[64:67]
DTR v[144:145],v192 offset:0
M16 v[64:67],a[80:83],v[156:159],v[64:67]
DR a[108:111],v12 offset:6144
M16 v[68:71],a[68:71],v[152:155],v[68:71]
DTR v[146:147],v192 offset:1024
M16 v[68:71],a[84:87],v[156:159],v[68:71]
DR a[124:127],v13 offset:6144
s_waitcnt lgkmcnt(8)
M16 v[72:75],a[72:75],v[152:155],v[72:75]
DTR v[148:149],v192 offset:8192
s_add_u32 m0, s32, 0
M16 v[72:75],a[88:91],v[156:159],v[72:75]
M16 v[76:79],a[76:79],v[152:155],v[76:79]
DTR v[150:151],v192 offset:9216
M16 v[76:79],a[92:95],v[156:159],v[76:79]
M16 v[80:83],a[64:67],v[160:163],v[80:83]
DTR v[152:153],v193 offset:0
M16 v[80:83],a[80:83],v[164:167],v[80:83]
BL4 v204,s[12:15],s33 offen lds
M16 v[84:87],a[68:71],v[160:163],v[84:87]
DTR v[154:155],v193 offset:1024
M16 v[84:87],a[84:87],v[164:167],v[84:87]
BL4 v205,s[12:15],s33 offen offset:1024 lds
M16 v[88:91],a[72:75],v[160:163],v[88:91]
DTR v[156:157],v193 offset:8192
M16 v[88:91],a[88:91],v[164:167],v[88:91]
BL4 v206,s[12:15],s33 offen offset:2048 lds
M16 v[92:95],a[76:79],v[160:163],v[92:95]
DTR v[158:159],v193 offset:9216
M16 v[92:95],a[92:95],v[164:167],v[92:95]
M16 v[96:99],a[64:67],v[168:171],v[96:99]
DTR v[160:161],v194 offset:0
M16 v[96:99],a[80:83],v[172:175],v[96:99]
BL4 v207,s[12:15],s33 offen offset:3072 lds
M16 v[100:103],a[68:71],v[168:171],v[100:103]
DTR v[162:163],v194 offset:1024
s_add_u32 m0, s34, 81920
M16 v[100:103],a[84:87],v[172:175],v[100:103]
BL4 v208,s[8:11],s36 offen lds
M16 v[104:107],a[72:75],v[168:171],v[104:107]
DTR v[164:165],v194 offset:8192
M16 v[104:107],a[88:91],v[172:175],v[104:107]
BL4 v209,s[8:11],s36 offen offset:1024 lds
M16 v[108:111],a[76:79],v[168:171],v[108:111]
DTR v[166:167],v194 offset:9216
M16 v[108:111],a[92:95],v[172:175],v[108:111]
M16 v[112:115],a[64:67],v[176:179],v[112:115]
DTR v[168:169],v195 offset:0
M16 v[112:115],a[80:83],v[180:183],v[112:115]
BL4 v210,s[8:11],s36 offen offset:2048 lds
M16 v[116:119],a[68:71],v[176:179],v[116:119]
DTR v[170:171],v195 offset:1024
M16 v[116:119],a[84:87],v[180:183],v[116:119]
BL4 v211,s[8:11],s36 offen offset:3072 lds
M16 v[120:123],a[72:75],v[176:179],v[120:123]
DTR v[172:173],v195 offset:8192
s_add_u32 s36, s36, s37
M16 v[120:123],a[88:91],v[180:183],v[120:123]
s_add_u32 m0, s26, 4096
M16 v[124:127],a[76:79],v[176:179],v[124:127]
DTR v[174:175],v195 offset:9216
M16 v[124:127],a[92:95],v[180:183],v[124:127]
s_waitcnt lgkmcnt(15)
M16 v[128:131],a[64:67],v[184:187],v[128:131]
DTR v[176:177],v196 offset:0
M16 v[128:131],a[80:83],v[188:191],v[128:131]
BL4 v216,s[8:11],s25 offen lds
M16 v[132:135],a[68:71],v[184:187],v[132:135]
DTR v[178:179],v196 offset:1024
M16 v[132:135],a[84:87],v[188:191],v[132:135]
BL4 v217,s[8:11],s25 offen offset:1024 lds
M16 v[136:139],a[72:75],v[184:187],v[136:139]
DTR v[180:181],v196 offset:8192
M16 v[136:139],a[88:91],v[188:191],v[136:139]
M16 v[140:143],a[76:79],v[184:187],v[140:143]
DTR v[182:183],v196 offset:9216
M16 v[140:143],a[92:95],v[188:191],v[140:143]
s_waitcnt lgkmcnt(15)
M16 v[16:19],a[96:99],v[144:147],v[16:19]
DTR v[184:185],v197 offset:0
s_add_u32 m0, s32, 4096
M16 v[16:19],a[112:115],v[148:151],v[16:19]
s_mov_b32 s33, 640
M16 v[20:23],a[100:103],v[144:147],v[20:23]
DTR v[186:187],v197 offset:1024
M16 v[20:23],a[116:119],v[148:151],v[20:23]
BL4 v200,s[12:15],s33 offen lds
M16 v[24:27],a[104:107],v[144:147],v[24:27]
DTR v[188:189],v197 offset:8192
M16 v[24:27],a[120:123],v[148:151],v[24:27]
BL4 v201,s[12:15],s33 offen offset:1024 lds
M16 v[28:31],a[108:111],v[144:147],v[28:31]
DTR v[190:191],v197 offset:9216
M16 v[28:31],a[124:127],v[148:151],v[28:31]
s_waitcnt lgkmcnt(15)
M16 v[32:35],a[96:99],v[152:155],v[32:35]
DTR v[144:145],v198 offset:0
M16 v[32:35],a[112:115],v[156:159],v[32:35]
BL4 v202,s[12:15],s33 offen offset:2048 lds
M16 v[36:39],a[100:103],v[152:155],v[36:39]
DTR v[146:147],v198 offset:1024
M16 v[36:39],a[116:119],v[156:159],v[36:39]
BL4 v203,s[12:15],s33 offen offset:3072 lds
M16 v[40:43],a[104:107],v[152:155],v[40:43]
DTR v[148:149],v198 offset:8192
s_waitcnt vmcnt(14)
M16 v[40:43],a[120:123],v[156:159],v[40:43]
DR a[128:131],v12 offset:8192
M16 v[44:47],a[108:111],v[152:155],v[44:47]
DTR v[150:151],v198 offset:9216
M16 v[44:47],a[124:127],v[156:159],v[44:47]
s_waitcnt lgkmcnt(15)
DR a[144:147],v13 offset:8192
M16 v[48:51],a[96:99],v[160:163],v[48:51]
DTR v[152:153],v199 offset:0
M16 v[48:51],a[112:115],v[164:167],v[48:51]
DR a[132:135],v12 offset:10240
M16 v[52:55],a[100:103],v[160:163],v[52:55]
DTR v[154:155],v199 offset:1024
M16 v[52:55],a[116:119],v[164:167],v[52:55]
DR a[148:151],v13 offset:10240
s_waitcnt vmcnt(10)
M16 v[56:59],a[104:107],v[160:163],v[56:59]
DTR v[156:157],v199 offset:8192
M16 v[56:59],a[120:123],v[164:167],v[56:59]
s_waitcnt lgkmcnt(15)
DR a[136:139],v12 offset:0
M16 v[60:63],a[108:111],v[160:163],v[60:63]
DTR v[158:159],v199 offset:9216
s_waitcnt vmcnt(6)
M16 v[60:63],a[124:127],v[164:167],v[60:63]
s_barrier
DR a[152:155],v13 offset:0
M16 v[64:67],a[96:99],v[168:171],v[64:67]
DTR v[160:161],v192 offset:16384
M16 v[64:67],a[112:115],v[172:175],v[64:67]
DR a[140:143],v12 offset:2048
M16 v[68:71],a[100:103],v[168:171],v[68:71]
DTR v[162:163],v192 offset:17408
M16 v[68:71],a[116:119],v[172:175],v[68:71]
DR a[156:159],v13 offset:2048
s_waitcnt lgkmcnt(8)
M16 v[72:75],a[104:107],v[168:171],v[72:75]
DTR v[164:165],v192 offset:24576
s_add_u32 m0, s32, 8192
M16 v[72:75],a[120:123],v[172:175],v[72:75]
M16 v[76:79],a[108:111],v[168:171],v[76:79]
DTR v[166:167],v192 offset:25600
M16 v[76:79],a[124:127],v[172:175],v[76:79]
M16 v[80:83],a[96:99],v[176:179],v[80:83]
DTR v[168:169],v193 offset:16384
M16 v[80:83],a[112:115],v[180:183],v[80:83]
BL4 v204,s[12:15],s33 offen lds
M16 v[84:87],a[100:103],v[176:179],v[84:87]
DTR v[170:171],v193 offset:17408
M16 v[84:87],a[116:119],v[180:183],v[84:87]
BL4 v205,s[12:15],s33 offen offset:1024 lds
M16 v[88:91],a[104:107],v[176:179],v[88:91]
DTR v[172:173],v193 offset:24576
M16 v[88:91],a[120:123],v[180:183],v[88:91]
BL4 v206,s[12:15],s33 offen offset:2048 lds
M16 v[92:95],a[108:111],v[176:179],v[92:95]
DTR v[174:175],v193 offset:25600
M16 v[92:95],a[124:127],v[180:183],v[92:95]
M16 v[96:99],a[96:99],v[184:187],v[96:99]
DTR v[176:177],v194 offset:16384
M16 v[96:99],a[112:115],v[188:191],v[96:99]
BL4 v207,s[12:15],s33 offen offset:3072 lds
M16 v[100:103],a[100:103],v[184:187],v[100:103]
DTR v[178:179],v194 offset:17408
s_add_u32 m0, s34, 98304
M16 v[100:103],a[116:119],v[188:191],v[100:103]
BL4 v208,s[8:11],s36 offen lds
M16 v[104:107],a[104:107],v[184:187],v[104:107]
DTR v[180:181],v194 offset:24576
M16 v[104:107],a[120:123],v[188:191],v[104:107]
BL4 v209,s[8:11],s36 offen offset:1024 lds
M16 v[108:111],a[108:111],v[184:187],v[108:111]
DTR v[182:183],v194 offset:25600
M16 v[108:111],a[124:127],v[188:191],v[108:111]
M16 v[112:115],a[96:99],v[144:147],v[112:115]
DTR v[184:185],v195 offset:16384
M16 v[112:115],a[112:115],v[148:151],v[112:115]
BL4 v210,s[8:11],s36 offen offset:2048 lds
M16 v[116:119],a[100:103],v[144:147],v[116:119]
DTR v[186:187],v195 offset:17408
M16 v[116:119],a[116:119],v[148:151],v[116:119]
BL4 v211,s[8:11],s36 offen offset:3072 lds
M16 v[120:123],a[104:107],v[144:147],v[120:123]
DTR v[188:189],v195 offset:24576
s_add_u32 s36, s36, s37
M16 v[120:123],a[120:123],v[148:151],v[120:123]
s_add_u32 m0, s26, 4096
M16 v[124:127],a[108:111],v[144:147],v[124:127]
DTR v[190:191],v195 offset:25600
M16 v[124:127],a[124:127],v[148:151],v[124:127]
s_waitcnt lgkmcnt(15)
M16 v[128:131],a[96:99],v[152:155],v[128:131]
DTR v[144:145],v196 offset:16384
M16 v[128:131],a[112:115],v[156:159],v[128:131]
BL4 v218,s[8:11],s25 offen offset:2048 lds
M16 v[132:135],a[100:103],v[152:155],v[132:135]
DTR v[146:147],v196 offset:17408
M16 v[132:135],a[116:119],v[156:159],v[132:135]
BL4 v219,s[8:11],s25 offen offset:3072 lds
M16 v[136:139],a[104:107],v[152:155],v[136:139]
DTR v[148:149],v196 offset:24576
s_add_u32 s25, s25, 262144
M16 v[136:139],a[120:123],v[156:159],v[136:139]
M16 v[140:143],a[108:111],v[152:155],v[140:143]
DTR v[150:151],v196 offset:25600
M16 v[140:143],a[124:127],v[156:159],v[140:143]
s_waitcnt lgkmcnt(15)
M16 v[16:19],a[128:131],v[160:163],v[16:19]
DTR v[152:153],v197 offset:16384
s_add_u32 m0, s32, 0
M16 v[16:19],a[144:147],v[164:167],v[16:19]
s_mov_b32 s33, 768
M16 v[20:23],a[132:135],v[160:163],v[20:23]
DTR v[154:155],v197 offset:17408
M16 v[20:23],a[148:151],v[164:167],v[20:23]
BL4 v200,s[12:15],s33 offen lds
M16 v[24:27],a[136:139],v[160:163],v[24:27]
DTR v[156:157],v197 offset:24576
M16 v[24:27],a[152:155],v[164:167],v[24:27]
BL4 v201,s[12:15],s33 offen offset:1024 lds
M16 v[28:31],a[140:143],v[160:163],v[28:31]
DTR v[158:159],v197 offset:25600
M16 v[28:31],a[156:159],v[164:167],v[28:31]
s_waitcnt lgkmcnt(15)
M16 v[32:35],a[128:131],v[168:171],v[32:35]
DTR v[160:161],v198 offset:16384
M16 v[32:35],a[144:147],v[172:175],v[32:35]
BL4 v202,s[12:15],s33 offen offset:2048 lds
M16 v[36:39],a[132:135],v[168:171],v[36:39]
DTR v[162:163],v198 offset:17408
M16 v[36:39],a[148:151],v[172:175],v[36:39]
BL4 v203,s[12:15],s33 offen offset:3072 lds
M16 v[40:43],a[136:139],v[168:171],v[40:43]
DTR v[164:165],v198 offset:24576
s_waitcnt vmcnt(14)
M16 v[40:43],a[152:155],v[172:175],v[40:43]
DR a[160:163],v12 offset:4096
M16 v[44:47],a[140:143],v[168:171],v[44:47]
DTR v[166:167],v198 offset:25600
M16 v[44:47],a[156:159],v[172:175],v[44:47]
s_waitcnt lgkmcnt(15)
DR a[176:179],v13 offset:4096
M16 v[48:51],a[128:131],v[176:179],v[48:51]
DTR v[168:169],v199 offset:16384
M16 v[48:51],a[144:147],v[180:183],v[48:51]
DR a[164:167],v12 offset:6144
M16 v[52:55],a[132:135],v[176:179],v[52:55]
DTR v[170:171],v199 offset:17408
M16 v[52:55],a[148:151],v[180:183],v[52:55]
DR a[180:183],v13 offset:6144
s_waitcnt vmcnt(10)
M16 v[56:59],a[136:139],v[176:179],v[56:59]
DTR v[172:173],v199 offset:24576
M16 v[56:59],a[152:155],v[180:183],v[56:59]
s_waitcnt lgkmcnt(15)
DR a[168:171],v12 offset:8192
M16 v[60:63],a[140:143],v[176:179],v[60:63]
DTR v[174:175],v199 offset:25600
s_waitcnt vmcnt(6)
M16 v[60:63],a[156:159],v[180:183],v[60:63]
s_barrier
DR a[184:187],v13 offset:8192
M16 v[64:67],a[128:131],v[184:187],v[64:67]
DTR v[176:177],v192 offset:32768
M16 v[64:67],a[144:147],v[188:191],v[64:67]
DR a[172:175],v12 offset:10240
M16 v[68:71],a[132:135],v[184:187],v[68:71]
DTR v[178:179],v192 offset:33792
M16 v[68:71],a[148:151],v[188:191],v[68:71]
DR a[188:191],v13 offset:10240
s_waitcnt lgkmcnt(8)
M16 v[72:75],a[136:139],v[184:187],v[72:75]
DTR v[180:181],v192 offset:40960
s_add_u32 m0, s32, 4096
M16 v[72:75],a[152:155],v[188:191],v[72:75]
M16 v[76:79],a[140:143],v[184:187],v[76:79]
DTR v[182:183],v192 offset:41984
M16 v[76:79],a[156:159],v[188:191],v[76:79]
M16 v[80:83],a[128:131],v[144:147],v[80:83]
DTR v[184:185],v193 offset:32768
M16 v[80:83],a[144:147],v[148:151],v[80:83]
BL4 v204,s[12:15],s33 offen lds
M16 v[84:87],a[132:135],v[144:147],v[84:87]
DTR v[186:187],v193 offset:33792
M16 v[84:87],a[148:151],v[148:151],v[84:87]
BL4 v205,s[12:15],s33 offen offset:1024 lds
M16 v[88:91],a[136:139],v[144:147],v[88:91]
DTR v[188:189],v193 offset:40960
M16 v[88:91],a[152:155],v[148:151],v[88:91]
BL4 v206,s[12:15],s33 offen offset:2048 lds
M16 v[92:95],a[140:143],v[144:147],v[92:95]
DTR v[190:191],v193 offset:41984
M16 v[92:95],a[156:159],v[148:151],v[92:95]
M16 v[96:99],a[128:131],v[152:155],v[96:99]
DTR v[144:145],v194 offset:32768
M16 v[96:99],a[144:147],v[156:159],v[96:99]
BL4 v207,s[12:15],s33 offen offset:3072 lds
M16 v[100:103],a[132:135],v[152:155],v[100:103]
DTR v[146:147],v194 offset:33792
s_add_u32 m0, s34, 65536
M16 v[100:103],a[148:151],v[156:159],v[100:103]
BL4 v208,s[8:11],s36 offen lds
M16 v[104:107],a[136:139],v[152:155],v[104:107]
DTR v[148:149],v194 offset:40960
M16 v[104:107],a[152:155],v[156:159],v[104:107]
BL4 v209,s[8:11],s36 offen offset:1024 lds
M16 v[108:111],a[140:143],v[152:155],v[108:111]
DTR v[150:151],v194 offset:41984
M16 v[108:111],a[156:159],v[156:159],v[108:111]
M16 v[112:115],a[128:131],v[160:163],v[112:115]
DTR v[152:153],v195 offset:32768
M16 v[112:115],a[144:147],v[164:167],v[112:115]
BL4 v210,s[8:11],s36 offen offset:2048 lds
M16 v[116:119],a[132:135],v[160:163],v[116:119]
DTR v[154:155],v195 offset:33792
M16 v[116:119],a[148:151],v[164:167],v[116:119]
BL4 v211,s[8:11],s36 offen offset:3072 lds
M16 v[120:123],a[136:139],v[160:163],v[120:123]
DTR v[156:157],v195 offset:40960
s_add_u32 s36, s36, s37
M16 v[120:123],a[152:155],v[164:167],v[120:123]
s_add_u32 m0, s26, 8192
M16 v[124:127],a[140:143],v[160:163],v[124:127]
DTR v[158:159],v195 offset:41984
M16 v[124:127],a[156:159],v[164:167],v[124:127]
s_waitcnt lgkmcnt(15)
M16 v[128:131],a[128:131],v[168:171],v[128:131]
DTR v[160:161],v196 offset:32768
M16 v[128:131],a[144:147],v[172:175],v[128:131]
BL4 v216,s[8:11],s25 offen lds
M16 v[132:135],a[132:135],v[168:171],v[132:135]
DTR v[162:163],v196 offset:33792
M16 v[132:135],a[148:151],v[172:175],v[132:135]
BL4 v217,s[8:11],s25 offen offset:1024 lds
M16 v[136:139],a[136:139],v[168:171],v[136:139]
DTR v[164:165],v196 offset:40960
M16 v[136:139],a[152:155],v[172:175],v[136:139]
M16 v[140:143],a[140:143],v[168:171],v[140:143]
DTR v[166:167],v196 offset:41984
M16 v[140:143],a[156:159],v[172:175],v[140:143]
s_waitcnt lgkmcnt(15)
M16 v[16:19],a[160:163],v[176:179],v[16:19]
DTR v[168:169],v197 offset:32768
s_add_u32 m0, s32, 8192
M16 v[16:19],a[176:179],v[180:183],v[16:19]
s_mov_b32 s33, 896
M16 v[20:23],a[164:167],v[176:179],v[20:23]
DTR v[170:171],v197 offset:33792
M16 v[20:23],a[180:183],v[180:183],v[20:23]
BL4 v200,s[12:15],s33 offen lds
M16 v[24:27],a[168:171],v[176:179],v[24:27]
DTR v[172:173],v197 offset:40960
M16 v[24:27],a[184:187],v[180:183],v[24:27]
BL4 v201,s[12:15],s33 offen offset:1024 lds
M16 v[28:31],a[172:175],v[176:179],v[28:31]
DTR v[174:175],v197 offset:41984
M16 v[28:31],a[188:191],v[180:183],v[28:31]
s_waitcnt lgkmcnt(15)
M16 v[32:35],a[160:163],v[184:187],v[32:35]
DTR v[176:177],v198 offset:32768
M16 v[32:35],a[176:179],v[188:191],v[32:35]
BL4 v202,s[12:15],s33 offen offset:2048 lds
M16 v[36:39],a[164:167],v[184:187],v[36:39]
DTR v[178:179],v198 offset:33792
M16 v[36:39],a[180:183],v[188:191],v[36:39]
BL4 v203,s[12:15],s33 offen offset:3072 lds
M16 v[40:43],a[168:171],v[184:187],v[40:43]
DTR v[180:181],v198 offset:40960
s_waitcnt vmcnt(14)
M16 v[40:43],a[184:187],v[188:191],v[40:43]
DR a[192:195],v12 offset:0
M16 v[44:47],a[172:175],v[184:187],v[44:47]
DTR v[182:183],v198 offset:41984
M16 v[44:47],a[188:191],v[188:191],v[44:47]
s_waitcnt lgkmcnt(15)
DR a[208:211],v13 offset:0
M16 v[48:51],a[160:163],v[144:147],v[48:51]
DTR v[184:185],v199 offset:32768
M16 v[48:51],a[176:179],v[148:151],v[48:51]
DR a[196:199],v12 offset:2048
M16 v[52:55],a[164:167],v[144:147],v[52:55]
DTR v[186:187],v199 offset:33792
M16 v[52:55],a[180:183],v[148:151],v[52:55]
DR a[212:215],v13 offset:2048
s_waitcnt vmcnt(10)
M16 v[56:59],a[168:171],v[144:147],v[56:59]
DTR v[188:189],v199 offset:40960
M16 v[56:59],a[184:187],v[148:151],v[56:59]
s_waitcnt lgkmcnt(15)
DR a[200:203],v12 offset:4096
M16 v[60:63],a[172:175],v[144:147],v[60:63]
DTR v[190:191],v199 offset:41984
s_waitcnt vmcnt(6)
M16 v[60:63],a[188:191],v[148:151],v[60:63]
s_barrier
DR a[216:219],v13 offset:4096
M16 v[64:67],a[160:163],v[152:155],v[64:67]
DTR v[144:145],v192 offset:0
M16 v[64:67],a[176:179],v[156:159],v[64:67]
DR a[204:207],v12 offset:6144
M16 v[68:71],a[164:167],v[152:155],v[68:71]
DTR v[146:147],v192 offset:1024
M16 v[68:71],a[180:183],v[156:159],v[68:71]
DR a[220:223],v13 offset:6144
s_waitcnt lgkmcnt(8)
M16 v[72:75],a[168:171],v[152:155],v[72:75]
DTR v[148:149],v192 offset:8192
s_add_u32 m0, s32, 0
M16 v[72:75],a[184:187],v[156:159],v[72:75]
M16 v[76:79],a[172:175],v[152:155],v[76:79]
DTR v[150:151],v192 offset:9216
M16 v[76:79],a[188:191],v[156:159],v[76:79]
M16 v[80:83],a[160:163],v[160:163],v[80:83]
DTR v[152:153],v193 offset:0
M16 v[80:83],a[176:179],v[164:167],v[80:83]
BL4 v204,s[12:15],s33 offen lds
M16 v[84:87],a[164:167],v[160:163],v[84:87]
DTR v[154:155],v193 offset:1024
M16 v[84:87],a[180:183],v[164:167],v[84:87]
BL4 v205,s[12:15],s33 offen offset:1024 lds
M16 v[88:91],a[168:171],v[160:163],v[88:91]
DTR v[156:157],v193 offset:8192
M16 v[88:91],a[184:187],v[164:167],v[88:91]
BL4 v206,s[12:15],s33 offen offset:2048 lds
M16 v[92:95],a[172:175],v[160:163],v[92:95]
DTR v[158:159],v193 offset:9216
M16 v[92:95],a[188:191],v[164:167],v[92:95]
M16 v[96:99],a[160:163],v[168:171],v[96:99]
DTR v[160:161],v194 offset:0
M16 v[96:99],a[176:179],v[172:175],v[96:99]
BL4 v207,s[12:15],s33 offen offset:3072 lds
M16 v[100:103],a[164:167],v[168:171],v[100:103]
DTR v[162:163],v194 offset:1024
s_add_u32 m0, s34, 81920
M16 v[100:103],a[180:183],v[172:175],v[100:103]
BL4 v208,s[8:11],s36 offen lds
M16 v[104:107],a[168:171],v[168:171],v[104:107]
DTR v[164:165],v194 offset:8192
M16 v[104:107],a[184:187],v[172:175],v[104:107]
BL4 v209,s[8:11],s36 offen offset:1024 lds
M16 v[108:111],a[172:175],v[168:171],v[108:111]
DTR v[166:167],v194 offset:9216
M16 v[108:111],a[188:191],v[172:175],v[108:111]
M16 v[112:115],a[160:163],v[176:179],v[112:115]
DTR v[168:169],v195 offset:0
M16 v[112:115],a[176:179],v[180:183],v[112:115]
BL4 v210,s[8:11],s36 offen offset:2048 lds
M16 v[116:119],a[164:167],v[176:179],v[116:119]
DTR v[170:171],v195 offset:1024
M16 v[116:119],a[180:183],v[180:183],v[116:119]
BL4 v211,s[8:11],s36 offen offset:3072 lds
M16 v[120:123],a[168:171],v[176:179],v[120:123]
DTR v[172:173],v195 offset:8192
s_add_u32 s36, s36, s37
M16 v[120:123],a[184:187],v[180:183],v[120:123]
s_add_u32 m0, s26, 8192
M16 v[124:127],a[172:175],v[176:179],v[124:127]
DTR v[174:175],v195 offset:9216
M16 v[124:127],a[188:191],v[180:183],v[124:127]
s_waitcnt lgkmcnt(15)
M16 v[128:131],a[160:163],v[184:187],v[128:131]
DTR v[176:177],v196 offset:0
M16 v[128:131],a[176:179],v[188:191],v[128:131]
BL4 v218,s[8:11],s25 offen offset:2048 lds
M16 v[132:135],a[164:167],v[184:187],v[132:135]
DTR v[178:179],v196 offset:1024
M16 v[132:135],a[180:183],v[188:191],v[132:135]
BL4 v219,s[8:11],s25 offen offset:3072 lds
M16 v[136:139],a[168:171],v[184:187],v[136:139]
DTR v[180:181],v196 offset:8192
s_add_u32 s25, s25, 262144
M16 v[136:139],a[184:187],v[188:191],v[136:139]
M16 v[140:143],a[172:175],v[184:187],v[140:143]
DTR v[182:183],v196 offset:9216
M16 v[140:143],a[188:191],v[188:191],v[140:143]
s_waitcnt lgkmcnt(15)
M16 v[16:19],a[192:195],v[144:147],v[16:19]
DTR v[184:185],v197 offset:0
s_waitcnt vmcnt(10)
M16 v[16:19],a[208:211],v[148:151],v[16:19]
DR a[224:227],v12 offset:8192
M16 v[20:23],a[196:199],v[144:147],v[20:23]
DTR v[186:187],v197 offset:1024
M16 v[20:23],a[212:215],v[148:151],v[20:23]
DR a[240:243],v13 offset:8192
M16 v[24:27],a[200:203],v[144:147],v[24:27]
DTR v[188:189],v197 offset:8192
M16 v[24:27],a[216:219],v[148:151],v[24:27]
DR a[228:231],v12 offset:10240
M16 v[28:31],a[204:207],v[144:147],v[28:31]
DTR v[190:191],v197 offset:9216
M16 v[28:31],a[220:223],v[148:151],v[28:31]
s_waitcnt lgkmcnt(15)
DR a[244:247],v13 offset:10240
M16 v[32:35],a[192:195],v[152:155],v[32:35]
DTR v[144:145],v198 offset:0
M16 v[32:35],a[208:211],v[156:159],v[32:35]
M16 v[36:39],a[196:199],v[152:155],v[36:39]
DTR v[146:147],v198 offset:1024
M16 v[36:39],a[212:215],v[156:159],v[36:39]
M16 v[40:43],a[200:203],v[152:155],v[40:43]
DTR v[148:149],v198 offset:8192
M16 v[40:43],a[216:219],v[156:159],v[40:43]
M16 v[44:47],a[204:207],v[152:155],v[44:47]
DTR v[150:151],v198 offset:9216
M16 v[44:47],a[220:223],v[156:159],v[44:47]
M16 v[48:51],a[192:195],v[160:163],v[48:51]
DTR v[152:153],v199 offset:0
M16 v[48:51],a[208:211],v[164:167],v[48:51]
M16 v[52:55],a[196:199],v[160:163],v[52:55]
DTR v[154:155],v199 offset:1024
s_waitcnt vmcnt(6)
M16 v[52:55],a[212:215],v[164:167],v[52:55]
DR a[232:235],v12 offset:0
M16 v[56:59],a[200:203],v[160:163],v[56:59]
DTR v[156:157],v199 offset:8192
M16 v[56:59],a[216:219],v[164:167],v[56:59]
s_waitcnt lgkmcnt(15)
DR a[248:251],v13 offset:0
M16 v[60:63],a[204:207],v[160:163],v[60:63]
DTR v[158:159],v199 offset:9216
s_waitcnt vmcnt(2)
M16 v[60:63],a[220:223],v[164:167],v[60:63]
s_barrier
DR a[236:239],v12 offset:2048
M16 v[64:67],a[192:195],v[168:171],v[64:67]
DTR v[160:161],v192 offset:16384
M16 v[64:67],a[208:211],v[172:175],v[64:67]
DR a[252:255],v13 offset:2048
s_waitcnt lgkmcnt(13)
M16 v[68:71],a[196:199],v[168:171],v[68:71]
DTR v[162:163],v192 offset:17408
s_add_u32 m0, s26, 12288
M16 v[68:71],a[212:215],v[172:175],v[68:71]
BL4 v216,s[8:11],s25 offen lds
M16 v[72:75],a[200:203],v[168:171],v[72:75]
DTR v[164:165],v192 offset:24576
M16 v[72:75],a[216:219],v[172:175],v[72:75]
BL4 v217,s[8:11],s25 offen offset:1024 lds
M16 v[76:79],a[204:207],v[168:171],v[76:79]
DTR v[166:167],v192 offset:25600
M16 v[76:79],a[220:223],v[172:175],v[76:79]
M16 v[80:83],a[192:195],v[176:179],v[80:83]
DTR v[168:169],v193 offset:16384
M16 v[80:83],a[208:211],v[180:183],v[80:83]
M16 v[84:87],a[196:199],v[176:179],v[84:87]
DTR v[170:171],v193 offset:17408
M16 v[84:87],a[212:215],v[180:183],v[84:87]
M16 v[88:91],a[200:203],v[176:179],v[88:91]
DTR v[172:173],v193 offset:24576
M16 v[88:91],a[216:219],v[180:183],v[88:91]
M16 v[92:95],a[204:207],v[176:179],v[92:95]
DTR v[174:175],v193 offset:25600
M16 v[92:95],a[220:223],v[180:183],v[92:95]
M16 v[96:99],a[192:195],v[184:187],v[96:99]
DTR v[176:177],v194 offset:16384
M16 v[96:99],a[208:211],v[188:191],v[96:99]
M16 v[100:103],a[196:199],v[184:187],v[100:103]
DTR v[178:179],v194 offset:17408
M16 v[100:103],a[212:215],v[188:191],v[100:103]
M16 v[104:107],a[200:203],v[184:187],v[104:107]
DTR v[180:181],v194 offset:24576
M16 v[104:107],a[216:219],v[188:191],v[104:107]
M16 v[108:111],a[204:207],v[184:187],v[108:111]
DTR v[182:183],v194 offset:25600
M16 v[108:111],a[220:223],v[188:191],v[108:111]
s_waitcnt lgkmcnt(15)
M16 v[112:115],a[192:195],v[144:147],v[112:115]
DTR v[184:185],v195 offset:16384
M16 v[112:115],a[208:211],v[148:151],v[112:115]
M16 v[116:119],a[196:199],v[144:147],v[116:119]
DTR v[186:187],v195 offset:17408
M16 v[116:119],a[212:215],v[148:151],v[116:119]
M16 v[120:123],a[200:203],v[144:147],v[120:123]
DTR v[188:189],v195 offset:24576
M16 v[120:123],a[216:219],v[148:151],v[120:123]
M16 v[124:127],a[204:207],v[144:147],v[124:127]
DTR v[190:191],v195 offset:25600
M16 v[124:127],a[220:223],v[148:151],v[124:127]
s_waitcnt lgkmcnt(15)
M16 v[128:131],a[192:195],v[152:155],v[128:131]
DTR v[144:145],v196 offset:16384
M16 v[128:131],a[208:211],v[156:159],v[128:131]
M16 v[132:135],a[196:199],v[152:155],v[132:135]
DTR v[146:147],v196 offset:17408
M16 v[132:135],a[212:215],v[156:159],v[132:135]
M16 v[136:139],a[200:203],v[152:155],v[136:139]
DTR v[148:149],v196 offset:24576
M16 v[136:139],a[216:219],v[156:159],v[136:139]
M16 v[140:143],a[204:207],v[152:155],v[140:143]
DTR v[150:151],v196 offset:25600
M16 v[140:143],a[220:223],v[156:159],v[140:143]
s_waitcnt lgkmcnt(15)
M16 v[16:19],a[224:227],v[160:163],v[16:19]
DTR v[152:153],v197 offset:16384
M16 v[16:19],a[240:243],v[164:167],v[16:19]
M16 v[20:23],a[228:231],v[160:163],v[20:23]
DTR v[154:155],v197 offset:17408
M16 v[20:23],a[244:247],v[164:167],v[20:23]
M16 v[24:27],a[232:235],v[160:163],v[24:27]
DTR v[156:157],v197 offset:24576
M16 v[24:27],a[248:251],v[164:167],v[24:27]
M16 v[28:31],a[236:239],v[160:163],v[28:31]
DTR v[158:159],v197 offset:25600
M16 v[28:31],a[252:255],v[164:167],v[28:31]
s_waitcnt lgkmcnt(15)
M16 v[32:35],a[224:227],v[168:171],v[32:35]
DTR v[160:161],v198 offset:16384
M16 v[32:35],a[240:243],v[172:175],v[32:35]
CVT v224,v16,v17
CVT v225,v18,v19
M16 v[36:39],a[228:231],v[168:171],v[36:39]
DTR v[162:163],v198 offset:17408
M16 v[36:39],a[244:247],v[172:175],v[36:39]
CVT v226,v20,v21
CVT v227,v22,v23
M16 v[40:43],a[232:235],v[168:171],v[40:43]
DTR v[164:165],v198 offset:24576
M16 v[40:43],a[248:251],v[172:175],v[40:43]
BS4 v[224:227],v7,s[16:19],s60 offen sc1
M16 v[44:47],a[236:239],v[168:171],v[44:47]
DTR v[166:167],v198 offset:25600
CVT v228,v24,v25
M16 v[44:47],a[252:255],v[172:175],v[44:47]
s_waitcnt lgkmcnt(15)
CVT v229,v26,v27
CVT v230,v28,v29
M16 v[48:51],a[224:227],v[176:179],v[48:51]
DTR v[168:169],v199 offset:16384
CVT v231,v30,v31
M16 v[48:51],a[240:243],v[180:183],v[48:51]
BS4 v[228:231],v7,s[16:19],s60 offen offset:1024 sc1
M16 v[52:55],a[228:231],v[176:179],v[52:55]
DTR v[170:171],v199 offset:17408
CVT v232,v32,v33
M16 v[52:55],a[244:247],v[180:183],v[52:55]
CVT v233,v34,v35
CVT v234,v36,v37
M16 v[56:59],a[232:235],v[176:179],v[56:59]
DTR v[172:173],v199 offset:24576
CVT v235,v38,v39
M16 v[56:59],a[248:251],v[180:183],v[56:59]
s_waitcnt lgkmcnt(15)
CVT v236,v40,v41
CVT v237,v42,v43
M16 v[60:63],a[236:239],v[176:179],v[60:63]
DTR v[174:175],v199 offset:25600
M16 v[60:63],a[252:255],v[180:183],v[60:63]
BS4 v[232:235],v7,s[16:19],s60 offen offset:2048 sc1
M16 v[64:67],a[224:227],v[184:187],v[64:67]
s_add_u32 m0, s26, 12288
CVT v238,v44,v45
CVT v239,v46,v47
M16 v[64:67],a[240:243],v[188:191],v[64:67]
BL4 v218,s[8:11],s25 offen offset:2048 lds
M16 v[68:71],a[228:231],v[184:187],v[68:71]
BL4 v219,s[8:11],s25 offen offset:3072 lds
M16 v[68:71],a[244:247],v[188:191],v[68:71]
s_add_u32 s25, s25, 262144
CVT v240,v48,v49
CVT v241,v50,v51
M16 v[72:75],a[232:235],v[184:187],v[72:75]
BS4 v[236:239],v7,s[16:19],s60 offen offset:3072 sc1
M16 v[72:75],a[248:251],v[188:191],v[72:75]
CVT v242,v52,v53
CVT v243,v54,v55
M16 v[76:79],a[236:239],v[184:187],v[76:79]
CVT v244,v56,v57
CVT v245,v58,v59
M16 v[76:79],a[252:255],v[188:191],v[76:79]
s_waitcnt lgkmcnt(12)
CVT v246,v60,v61
CVT v247,v62,v63
M16 v[80:83],a[224:227],v[144:147],v[80:83]
M16 v[80:83],a[240:243],v[148:151],v[80:83]
CVT v248,v64,v65
CVT v249,v66,v67
M16 v[84:87],a[228:231],v[144:147],v[84:87]
M16 v[84:87],a[244:247],v[148:151],v[84:87]
CVT v250,v68,v69
CVT v251,v70,v71
M16 v[88:91],a[232:235],v[144:147],v[88:91]
M16 v[88:91],a[248:251],v[148:151],v[88:91]
CVT v252,v72,v73
CVT v253,v74,v75
M16 v[92:95],a[236:239],v[144:147],v[92:95]
M16 v[92:95],a[252:255],v[148:151],v[92:95]
s_waitcnt lgkmcnt(8)
CVT v254,v76,v77
CVT v255,v78,v79
M16 v[96:99],a[224:227],v[152:155],v[96:99]
M16 v[96:99],a[240:243],v[156:159],v[96:99]
CVT v16,v80,v81
CVT v17,v82,v83
M16 v[100:103],a[228:231],v[152:155],v[100:103]
M16 v[100:103],a[244:247],v[156:159],v[100:103]
CVT v18,v84,v85
CVT v19,v86,v87
M16 v[104:107],a[232:235],v[152:155],v[104:107]
M16 v[104:107],a[248:251],v[156:159],v[104:107]
CVT v20,v88,v89
CVT v21,v90,v91
M16 v[108:111],a[236:239],v[152:155],v[108:111]
M16 v[108:111],a[252:255],v[156:159],v[108:111]
s_waitcnt lgkmcnt(4)
CVT v22,v92,v93
CVT v23,v94,v95
M16 v[112:115],a[224:227],v[160:163],v[112:115]
M16 v[112:115],a[240:243],v[164:167],v[112:115]
CVT v24,v96,v97
CVT v25,v98,v99
M16 v[116:119],a[228:231],v[160:163],v[116:119]
M16 v[116:119],a[244:247],v[164:167],v[116:119]
CVT v26,v100,v101
CVT v27,v102,v103
M16 v[120:123],a[232:235],v[160:163],v[120:123]
M16 v[120:123],a[248:251],v[164:167],v[120:123]
CVT v28,v104,v105
CVT v29,v106,v107
M16 v[124:127],a[236:239],v[160:163],v[124:127]
M16 v[124:127],a[252:255],v[164:167],v[124:127]
s_waitcnt lgkmcnt(0)
CVT v30,v108,v109
CVT v31,v110,v111
M16 v[128:131],a[224:227],v[168:171],v[128:131]
M16 v[128:131],a[240:243],v[172:175],v[128:131]
CVT v32,v112,v113
CVT v33,v114,v115
M16 v[132:135],a[228:231],v[168:171],v[132:135]
M16 v[132:135],a[244:247],v[172:175],v[132:135]
CVT v34,v116,v117
CVT v35,v118,v119
M16 v[136:139],a[232:235],v[168:171],v[136:139]
M16 v[136:139],a[248:251],v[172:175],v[136:139]
CVT v36,v120,v121
CVT v37,v122,v123
M16 v[140:143],a[236:239],v[168:171],v[140:143]
M16 v[140:143],a[252:255],v[172:175],v[140:143]
s_nop 7
CVT v38,v124,v125
CVT v39,v126,v127
CVT v40,v128,v129
CVT v41,v130,v131
CVT v42,v132,v133
CVT v43,v134,v135
CVT v44,v136,v137
CVT v45,v138,v139
CVT v46,v140,v141
CVT v47,v142,v143
v_mov_b32 v48, v240
v_mov_b32 v49, v241
v_mov_b32 v50, v242
v_mov_b32 v51, v243
v_mov_b32 v52, v244
v_mov_b32 v53, v245
v_mov_b32 v54, v246
v_mov_b32 v55, v247
v_mov_b32 v56, v248
v_mov_b32 v57, v249
v_mov_b32 v58, v250
v_mov_b32 v59, v251
v_mov_b32 v60, v252
v_mov_b32 v61, v253
v_mov_b32 v62, v254
v_mov_b32 v63, v255
v_mov_b32 v64, v16
v_mov_b32 v65, v17
v_mov_b32 v66, v18
v_mov_b32 v67, v19
v_mov_b32 v68, v20
v_mov_b32 v69, v21
v_mov_b32 v70, v22
v_mov_b32 v71, v23
v_mov_b32 v72, v24
v_mov_b32 v73, v25
v_mov_b32 v74, v26
v_mov_b32 v75, v27
v_mov_b32 v76, v28
v_mov_b32 v77, v29
v_mov_b32 v78, v30
v_mov_b32 v79, v31
v_mov_b32 v80, v32
v_mov_b32 v81, v33
v_mov_b32 v82, v34
v_mov_b32 v83, v35
v_mov_b32 v84, v36
v_mov_b32 v85, v37
v_mov_b32 v86, v38
v_mov_b32 v87, v39
v_mov_b32 v88, v40
v_mov_b32 v89, v41
v_mov_b32 v90, v42
v_mov_b32 v91, v43
v_mov_b32 v92, v44
v_mov_b32 v93, v45
v_mov_b32 v94, v46
v_mov_b32 v95, v47
s_add_u32 s31, s31, 4
s_waitcnt vmcnt(1)
s_barrier
DTR v[144:145],v3 offset:0
DTR v[146:147],v3 offset:512
DTR v[148:149],v3 offset:4096
DTR v[150:151],v3 offset:4608
DTR v[152:153],v3 offset:8192
DTR v[154:155],v3 offset:8704
DTR v[156:157],v3 offset:12288
DTR v[158:159],v3 offset:12800
DTR v[160:161],v4 offset:0
DTR v[162:163],v4 offset:512
DTR v[164:165],v4 offset:4096
DTR v[166:167],v4 offset:4608
DTR v[168:169],v4 offset:8192
DTR v[170:171],v4 offset:8704
DTR v[172:173],v4 offset:12288
DTR v[174:175],v4 offset:12800
s_waitcnt lgkmcnt(0)
s_lshl_b32 s97, s21, 2
s_mov_b32 s12, s64
s_mov_b32 s13, s65
s_mov_b32 s14, 2621440
s_mov_b32 s15, 0x00020000
s_lshr_b32 s40, s2, 3
s_lshl_b32 s41, s40, 2
s_add_u32 s41, s41, s20
s_mul_i32 s62, s41, 40960
s_and_b32 s42, s2, 7
s_lshl_b32 s42, s42, 10
s_add_u32 s62, s62, s42
s_and_b32 s41, s41, 15
s_lshr_b32 s40, s2, 5
s_sub_u32 s40, 7, s40
s_lshl_b32 s40, s40, 4
s_add_u32 s40, s40, s41
s_mul_i32 s63, s40, 20480
s_add_u32 s6, s63, 10240
v_min_u32 v112, 39, v1
v_lshrrev_b32 v113, 3, v112
v_lshlrev_b32 v113, 13, v113
v_and_b32 v112, 7, v112
v_lshl_add_u32 v112, v112, 7, v113
v_lshrrev_b32 v113, 3, v1
v_mul_u32_u24 v113, 1280, v113
v_and_b32 v114, 7, v1
v_lshl_add_u32 v113, v114, 7, v113
v_and_b32 v115, 31, v1
v_lshrrev_b32 v114, 1, v115
v_mul_u32_u24 v114, 1280, v114
v_and_b32 v115, 1, v115
v_lshl_add_u32 v114, v115, 7, v114
s_and_b32 s39, s23, 1
L_p1_V:
M16 v[16:19],a[0:3],v[144:147],0
DTR v[176:177],v3 offset:16384
CVT v106,v36,v37
M16 v[16:19],a[16:19],v[148:151],v[16:19]
DTR v[178:179],v3 offset:16896
CVT v107,v38,v39
M16 v[16:19],a[32:35],v[152:155],v[16:19]
BS4 v[104:107],v7,s[16:19],s29 offen offset:2048 sc1
M16 v[16:19],a[48:51],v[156:159],v[16:19]
DTR v[180:181],v3 offset:20480
CVT v108,v40,v41
M16 v[20:23],a[4:7],v[144:147],0
DTR v[182:183],v3 offset:20992
CVT v109,v42,v43
M16 v[20:23],a[20:23],v[148:151],v[20:23]
s_cmp_gt_u32 s23, 1
s_cselect_b32 s25, s24, s46
s_add_u32 s24, s24, 128
M16 v[20:23],a[36:39],v[152:155],v[20:23]
DTR v[184:185],v3 offset:24576
s_xor_b32 s26, s26, 65536
M16 v[20:23],a[52:55],v[156:159],v[20:23]
DTR v[186:187],v3 offset:25088
CVT v110,v44,v45
M16 v[24:27],a[8:11],v[144:147],0
CVT v111,v46,v47
s_mov_b32 m0, s26
M16 v[24:27],a[24:27],v[148:151],v[24:27]
DTR v[188:189],v3 offset:28672
M16 v[24:27],a[40:43],v[152:155],v[24:27]
DTR v[190:191],v3 offset:29184
M16 v[24:27],a[56:59],v[156:159],v[24:27]
BS4 v[108:111],v7,s[16:19],s29 offen offset:3072 sc1
M16 v[28:31],a[12:15],v[144:147],0
DTR v[192:193],v4 offset:16384
M16 v[28:31],a[28:31],v[148:151],v[28:31]
DTR v[194:195],v4 offset:16896
M16 v[28:31],a[44:47],v[152:155],v[28:31]
BL4 v216,s[8:11],s25 offen lds
M16 v[28:31],a[60:63],v[156:159],v[28:31]
DTR v[196:197],v4 offset:20480
M16 v[32:35],a[0:3],v[160:163],0
DTR v[198:199],v4 offset:20992
M16 v[32:35],a[16:19],v[164:167],v[32:35]
BL4 v217,s[8:11],s25 offen offset:1024 lds
M16 v[32:35],a[32:35],v[168:171],v[32:35]
DTR v[200:201],v4 offset:24576
M16 v[32:35],a[48:51],v[172:175],v[32:35]
DTR v[202:203],v4 offset:25088
M16 v[36:39],a[4:7],v[160:163],0
BL4 v218,s[8:11],s25 offen offset:2048 lds
M16 v[36:39],a[20:23],v[164:167],v[36:39]
DTR v[204:205],v4 offset:28672
M16 v[36:39],a[36:39],v[168:171],v[36:39]
DTR v[206:207],v4 offset:29184
M16 v[36:39],a[52:55],v[172:175],v[36:39]
BL4 v219,s[8:11],s25 offen offset:3072 lds
M16 v[40:43],a[8:11],v[160:163],0
s_add_u32 m0, m0, 4096
s_add_u32 s25, s25, 262144
M16 v[40:43],a[24:27],v[164:167],v[40:43]
BL4 v216,s[8:11],s25 offen lds
M16 v[40:43],a[40:43],v[168:171],v[40:43]
M16 v[40:43],a[56:59],v[172:175],v[40:43]
BL4 v217,s[8:11],s25 offen offset:1024 lds
M16 v[44:47],a[12:15],v[160:163],0
M16 v[44:47],a[28:31],v[164:167],v[44:47]
BL4 v218,s[8:11],s25 offen offset:2048 lds
M16 v[44:47],a[44:47],v[168:171],v[44:47]
M16 v[44:47],a[60:63],v[172:175],v[44:47]
s_waitcnt lgkmcnt(0)
M16 v[16:19],a[64:67],v[176:179],v[16:19]
DTR v[144:145],v3 offset:32768
s_lshr_b32 s40, s31, 2
M16 v[16:19],a[80:83],v[180:183],v[16:19]
DTR v[146:147],v3 offset:33280
s_lshl_b32 s40, s40, 20
M16 v[16:19],a[96:99],v[184:187],v[16:19]
s_and_b32 s41, s31, 3
s_lshl_b32 s41, s41, 12
s_add_u32 s40, s40, s41
M16 v[16:19],a[112:115],v[188:191],v[16:19]
DTR v[148:149],v3 offset:36864
s_add_u32 s28, s40, s38
M16 v[20:23],a[68:71],v[176:179],v[20:23]
DTR v[150:151],v3 offset:37376
M16 v[20:23],a[84:87],v[180:183],v[20:23]
BL4 v219,s[8:11],s25 offen offset:3072 lds
M16 v[20:23],a[100:103],v[184:187],v[20:23]
DTR v[152:153],v3 offset:40960
s_add_u32 m0, m0, 4096
M16 v[20:23],a[116:119],v[188:191],v[20:23]
DTR v[154:155],v3 offset:41472
s_add_u32 s25, s25, 262144
M16 v[24:27],a[72:75],v[176:179],v[24:27]
BL4 v216,s[8:11],s25 offen lds
M16 v[24:27],a[88:91],v[180:183],v[24:27]
DTR v[156:157],v3 offset:45056
M16 v[24:27],a[104:107],v[184:187],v[24:27]
DTR v[158:159],v3 offset:45568
M16 v[24:27],a[120:123],v[188:191],v[24:27]
BL4 v217,s[8:11],s25 offen offset:1024 lds
M16 v[28:31],a[76:79],v[176:179],v[28:31]
DTR v[160:161],v4 offset:32768
M16 v[28:31],a[92:95],v[180:183],v[28:31]
DTR v[162:163],v4 offset:33280
M16 v[28:31],a[108:111],v[184:187],v[28:31]
BL4 v218,s[8:11],s25 offen offset:2048 lds
M16 v[28:31],a[124:127],v[188:191],v[28:31]
DTR v[164:165],v4 offset:36864
M16 v[32:35],a[64:67],v[192:195],v[32:35]
DTR v[166:167],v4 offset:37376
M16 v[32:35],a[80:83],v[196:199],v[32:35]
BL4 v219,s[8:11],s25 offen offset:3072 lds
M16 v[32:35],a[96:99],v[200:203],v[32:35]
DTR v[168:169],v4 offset:40960
s_add_u32 m0, m0, 4096
M16 v[32:35],a[112:115],v[204:207],v[32:35]
DTR v[170:171],v4 offset:41472
s_add_u32 s25, s25, 262144
M16 v[36:39],a[68:71],v[192:195],v[36:39]
BL4 v216,s[8:11],s25 offen lds
M16 v[36:39],a[84:87],v[196:199],v[36:39]
DTR v[172:173],v4 offset:45056
M16 v[36:39],a[100:103],v[200:203],v[36:39]
DTR v[174:175],v4 offset:45568
M16 v[36:39],a[116:119],v[204:207],v[36:39]
BL4 v217,s[8:11],s25 offen offset:1024 lds
M16 v[40:43],a[72:75],v[192:195],v[40:43]
M16 v[40:43],a[88:91],v[196:199],v[40:43]
BL4 v218,s[8:11],s25 offen offset:2048 lds
M16 v[40:43],a[104:107],v[200:203],v[40:43]
M16 v[40:43],a[120:123],v[204:207],v[40:43]
BL4 v219,s[8:11],s25 offen offset:3072 lds
M16 v[44:47],a[76:79],v[192:195],v[44:47]
M16 v[44:47],a[92:95],v[196:199],v[44:47]
M16 v[44:47],a[108:111],v[200:203],v[44:47]
M16 v[44:47],a[124:127],v[204:207],v[44:47]
s_waitcnt lgkmcnt(0)
M16 v[16:19],a[128:131],v[144:147],v[16:19]
DTR v[176:177],v3 offset:49152
M16 v[16:19],a[144:147],v[148:151],v[16:19]
DTR v[178:179],v3 offset:49664
M16 v[16:19],a[160:163],v[152:155],v[16:19]
BS4 v[48:51],v7,s[16:19],s48 offen sc1
M16 v[16:19],a[176:179],v[156:159],v[16:19]
DTR v[180:181],v3 offset:53248
M16 v[20:23],a[132:135],v[144:147],v[20:23]
DTR v[182:183],v3 offset:53760
M16 v[20:23],a[148:151],v[148:151],v[20:23]
M16 v[20:23],a[164:167],v[152:155],v[20:23]
DTR v[184:185],v3 offset:57344
M16 v[20:23],a[180:183],v[156:159],v[20:23]
DTR v[186:187],v3 offset:57856
M16 v[24:27],a[136:139],v[144:147],v[24:27]
M16 v[24:27],a[152:155],v[148:151],v[24:27]
DTR v[188:189],v3 offset:61440
M16 v[24:27],a[168:171],v[152:155],v[24:27]
DTR v[190:191],v3 offset:61952
M16 v[24:27],a[184:187],v[156:159],v[24:27]
M16 v[28:31],a[140:143],v[144:147],v[28:31]
DTR v[192:193],v4 offset:49152
M16 v[28:31],a[156:159],v[148:151],v[28:31]
DTR v[194:195],v4 offset:49664
M16 v[28:31],a[172:175],v[152:155],v[28:31]
BS4 v[52:55],v7,s[16:19],s49 offen sc1
M16 v[28:31],a[188:191],v[156:159],v[28:31]
DTR v[196:197],v4 offset:53248
M16 v[32:35],a[128:131],v[160:163],v[32:35]
DTR v[198:199],v4 offset:53760
M16 v[32:35],a[144:147],v[164:167],v[32:35]
M16 v[32:35],a[160:163],v[168:171],v[32:35]
DTR v[200:201],v4 offset:57344
M16 v[32:35],a[176:179],v[172:175],v[32:35]
DTR v[202:203],v4 offset:57856
M16 v[36:39],a[132:135],v[160:163],v[36:39]
M16 v[36:39],a[148:151],v[164:167],v[36:39]
DTR v[204:205],v4 offset:61440
M16 v[36:39],a[164:167],v[168:171],v[36:39]
DTR v[206:207],v4 offset:61952
M16 v[36:39],a[180:183],v[172:175],v[36:39]
M16 v[40:43],a[136:139],v[160:163],v[40:43]
v_xor_b32 v3, 64, v3
v_xor_b32 v4, 64, v4
M16 v[40:43],a[152:155],v[164:167],v[40:43]
M16 v[40:43],a[168:171],v[168:171],v[40:43]
M16 v[40:43],a[184:187],v[172:175],v[40:43]
M16 v[44:47],a[140:143],v[160:163],v[44:47]
M16 v[44:47],a[156:159],v[164:167],v[44:47]
M16 v[44:47],a[172:175],v[168:171],v[44:47]
M16 v[44:47],a[188:191],v[172:175],v[44:47]
s_waitcnt lgkmcnt(0)
M16 v[16:19],a[192:195],v[176:179],v[16:19]
DTR v[144:145],v3 offset:0
M16 v[16:19],a[208:211],v[180:183],v[16:19]
DTR v[146:147],v3 offset:512
M16 v[16:19],a[224:227],v[184:187],v[16:19]
M16 v[16:19],a[240:243],v[188:191],v[16:19]
DTR v[148:149],v3 offset:4096
M16 v[20:23],a[196:199],v[176:179],v[20:23]
DTR v[150:151],v3 offset:4608
M16 v[20:23],a[212:215],v[180:183],v[20:23]
M16 v[20:23],a[228:231],v[184:187],v[20:23]
DTR v[152:153],v3 offset:8192
M16 v[20:23],a[244:247],v[188:191],v[20:23]
DTR v[154:155],v3 offset:8704
M16 v[24:27],a[200:203],v[176:179],v[24:27]
M16 v[24:27],a[216:219],v[180:183],v[24:27]
DTR v[156:157],v3 offset:12288
M16 v[24:27],a[232:235],v[184:187],v[24:27]
DTR v[158:159],v3 offset:12800
M16 v[24:27],a[248:251],v[188:191],v[24:27]
CVT v96,v16,v17
CVT v97,v18,v19
M16 v[28:31],a[204:207],v[176:179],v[28:31]
DTR v[160:161],v4 offset:0
M16 v[28:31],a[220:223],v[180:183],v[28:31]
DTR v[162:163],v4 offset:512
M16 v[28:31],a[236:239],v[184:187],v[28:31]
M16 v[28:31],a[252:255],v[188:191],v[28:31]
DTR v[164:165],v4 offset:4096
CVT v98,v20,v21
M16 v[32:35],a[192:195],v[192:195],v[32:35]
DTR v[166:167],v4 offset:4608
CVT v99,v22,v23
M16 v[32:35],a[208:211],v[196:199],v[32:35]
BS4 v[96:99],v7,s[16:19],s28 offen sc1
M16 v[32:35],a[224:227],v[200:203],v[32:35]
DTR v[168:169],v4 offset:8192
M16 v[32:35],a[240:243],v[204:207],v[32:35]
DTR v[170:171],v4 offset:8704
CVT v100,v24,v25
M16 v[36:39],a[196:199],v[192:195],v[36:39]
CVT v101,v26,v27
M16 v[36:39],a[212:215],v[196:199],v[36:39]
DTR v[172:173],v4 offset:12288
M16 v[36:39],a[228:231],v[200:203],v[36:39]
DTR v[174:175],v4 offset:12800
M16 v[36:39],a[244:247],v[204:207],v[36:39]
CVT v102,v28,v29
CVT v103,v30,v31
M16 v[40:43],a[200:203],v[192:195],v[40:43]
BS4 v[100:103],v7,s[16:19],s28 offen offset:1024 sc1
M16 v[40:43],a[216:219],v[196:199],v[40:43]
M16 v[40:43],a[232:235],v[200:203],v[40:43]
M16 v[40:43],a[248:251],v[204:207],v[40:43]
CVT v104,v32,v33
CVT v105,v34,v35
M16 v[44:47],a[204:207],v[192:195],v[44:47]
s_mov_b32 s29, s28
M16 v[44:47],a[220:223],v[196:199],v[44:47]
s_add_u32 s31, s31, 1
M16 v[44:47],a[236:239],v[200:203],v[44:47]
M16 v[44:47],a[252:255],v[204:207],v[44:47]
s_waitcnt lgkmcnt(0)
M16 v[16:19],a[0:3],v[144:147],0
DTR v[176:177],v3 offset:16384
CVT v106,v36,v37
M16 v[16:19],a[16:19],v[148:151],v[16:19]
DTR v[178:179],v3 offset:16896
CVT v107,v38,v39
M16 v[16:19],a[32:35],v[152:155],v[16:19]
BS4 v[104:107],v7,s[16:19],s29 offen offset:2048 sc1
M16 v[16:19],a[48:51],v[156:159],v[16:19]
DTR v[180:181],v3 offset:20480
CVT v108,v40,v41
M16 v[20:23],a[4:7],v[144:147],0
DTR v[182:183],v3 offset:20992
CVT v109,v42,v43
M16 v[20:23],a[20:23],v[148:151],v[20:23]
M16 v[20:23],a[36:39],v[152:155],v[20:23]
DTR v[184:185],v3 offset:24576
M16 v[20:23],a[52:55],v[156:159],v[20:23]
DTR v[186:187],v3 offset:25088
CVT v110,v44,v45
M16 v[24:27],a[8:11],v[144:147],0
CVT v111,v46,v47
M16 v[24:27],a[24:27],v[148:151],v[24:27]
DTR v[188:189],v3 offset:28672
M16 v[24:27],a[40:43],v[152:155],v[24:27]
DTR v[190:191],v3 offset:29184
M16 v[24:27],a[56:59],v[156:159],v[24:27]
BS4 v[108:111],v7,s[16:19],s29 offen offset:3072 sc1
M16 v[28:31],a[12:15],v[144:147],0
DTR v[192:193],v4 offset:16384
M16 v[28:31],a[28:31],v[148:151],v[28:31]
DTR v[194:195],v4 offset:16896
M16 v[28:31],a[44:47],v[152:155],v[28:31]
M16 v[28:31],a[60:63],v[156:159],v[28:31]
DTR v[196:197],v4 offset:20480
M16 v[32:35],a[0:3],v[160:163],0
DTR v[198:199],v4 offset:20992
M16 v[32:35],a[16:19],v[164:167],v[32:35]
M16 v[32:35],a[32:35],v[168:171],v[32:35]
DTR v[200:201],v4 offset:24576
M16 v[32:35],a[48:51],v[172:175],v[32:35]
DTR v[202:203],v4 offset:25088
M16 v[36:39],a[4:7],v[160:163],0
M16 v[36:39],a[20:23],v[164:167],v[36:39]
DTR v[204:205],v4 offset:28672
M16 v[36:39],a[36:39],v[168:171],v[36:39]
DTR v[206:207],v4 offset:29184
M16 v[36:39],a[52:55],v[172:175],v[36:39]
M16 v[40:43],a[8:11],v[160:163],0
M16 v[40:43],a[24:27],v[164:167],v[40:43]
M16 v[40:43],a[40:43],v[168:171],v[40:43]
BS4 v[56:59],v7,s[16:19],s50 offen sc1
M16 v[40:43],a[56:59],v[172:175],v[40:43]
M16 v[44:47],a[12:15],v[160:163],0
M16 v[44:47],a[28:31],v[164:167],v[44:47]
M16 v[44:47],a[44:47],v[168:171],v[44:47]
M16 v[44:47],a[60:63],v[172:175],v[44:47]
s_waitcnt lgkmcnt(0)
M16 v[16:19],a[64:67],v[176:179],v[16:19]
DTR v[144:145],v3 offset:32768
s_lshr_b32 s40, s31, 2
M16 v[16:19],a[80:83],v[180:183],v[16:19]
DTR v[146:147],v3 offset:33280
s_lshl_b32 s40, s40, 20
M16 v[16:19],a[96:99],v[184:187],v[16:19]
s_and_b32 s41, s31, 3
s_lshl_b32 s41, s41, 12
s_add_u32 s40, s40, s41
M16 v[16:19],a[112:115],v[188:191],v[16:19]
DTR v[148:149],v3 offset:36864
s_add_u32 s28, s40, s38
M16 v[20:23],a[68:71],v[176:179],v[20:23]
DTR v[150:151],v3 offset:37376
M16 v[20:23],a[84:87],v[180:183],v[20:23]
BS4 v[60:63],v7,s[16:19],s51 offen sc1
M16 v[20:23],a[100:103],v[184:187],v[20:23]
DTR v[152:153],v3 offset:40960
M16 v[20:23],a[116:119],v[188:191],v[20:23]
DTR v[154:155],v3 offset:41472
M16 v[24:27],a[72:75],v[176:179],v[24:27]
M16 v[24:27],a[88:91],v[180:183],v[24:27]
DTR v[156:157],v3 offset:45056
M16 v[24:27],a[104:107],v[184:187],v[24:27]
DTR v[158:159],v3 offset:45568
M16 v[24:27],a[120:123],v[188:191],v[24:27]
M16 v[28:31],a[76:79],v[176:179],v[28:31]
DTR v[160:161],v4 offset:32768
M16 v[28:31],a[92:95],v[180:183],v[28:31]
DTR v[162:163],v4 offset:33280
M16 v[28:31],a[108:111],v[184:187],v[28:31]
M16 v[28:31],a[124:127],v[188:191],v[28:31]
DTR v[164:165],v4 offset:36864
M16 v[32:35],a[64:67],v[192:195],v[32:35]
DTR v[166:167],v4 offset:37376
M16 v[32:35],a[80:83],v[196:199],v[32:35]
BS4 v[64:67],v7,s[16:19],s52 offen sc1
M16 v[32:35],a[96:99],v[200:203],v[32:35]
DTR v[168:169],v4 offset:40960
M16 v[32:35],a[112:115],v[204:207],v[32:35]
DTR v[170:171],v4 offset:41472
M16 v[36:39],a[68:71],v[192:195],v[36:39]
M16 v[36:39],a[84:87],v[196:199],v[36:39]
DTR v[172:173],v4 offset:45056
M16 v[36:39],a[100:103],v[200:203],v[36:39]
DTR v[174:175],v4 offset:45568
M16 v[36:39],a[116:119],v[204:207],v[36:39]
M16 v[40:43],a[72:75],v[192:195],v[40:43]
M16 v[40:43],a[88:91],v[196:199],v[40:43]
M16 v[40:43],a[104:107],v[200:203],v[40:43]
M16 v[40:43],a[120:123],v[204:207],v[40:43]
BS4 v[68:71],v7,s[16:19],s53 offen sc1
M16 v[44:47],a[76:79],v[192:195],v[44:47]
M16 v[44:47],a[92:95],v[196:199],v[44:47]
M16 v[44:47],a[108:111],v[200:203],v[44:47]
v_mov_b32 v48, v72
v_mov_b32 v49, v73
M16 v[44:47],a[124:127],v[204:207],v[44:47]
s_waitcnt lgkmcnt(0)
v_mov_b32 v50, v74
v_mov_b32 v51, v75
M16 v[16:19],a[128:131],v[144:147],v[16:19]
DTR v[176:177],v3 offset:49152
v_mov_b32 v52, v76
M16 v[16:19],a[144:147],v[148:151],v[16:19]
DTR v[178:179],v3 offset:49664
v_mov_b32 v53, v77
M16 v[16:19],a[160:163],v[152:155],v[16:19]
s_cmp_eq_u32 s23, 2
s_cselect_b32 s43, s61, s46
v_mov_b32 v54, v78
M16 v[16:19],a[176:179],v[156:159],v[16:19]
DTR v[180:181],v3 offset:53248
v_mov_b32 v55, v79
M16 v[20:23],a[132:135],v[144:147],v[20:23]
DTR v[182:183],v3 offset:53760
v_mov_b32 v56, v80
M16 v[20:23],a[148:151],v[148:151],v[20:23]
v_mov_b32 v57, v81
v_mov_b32 v58, v82
M16 v[20:23],a[164:167],v[152:155],v[20:23]
DTR v[184:185],v3 offset:57344
v_mov_b32 v59, v83
M16 v[20:23],a[180:183],v[156:159],v[20:23]
DTR v[186:187],v3 offset:57856
v_mov_b32 v60, v84
M16 v[24:27],a[136:139],v[144:147],v[24:27]
v_mov_b32 v61, v85
v_mov_b32 v62, v86
M16 v[24:27],a[152:155],v[148:151],v[24:27]
DTR v[188:189],v3 offset:61440
v_mov_b32 v63, v87
M16 v[24:27],a[168:171],v[152:155],v[24:27]
DTR v[190:191],v3 offset:61952
v_mov_b32 v64, v88
M16 v[24:27],a[184:187],v[156:159],v[24:27]
v_mov_b32 v65, v89
v_mov_b32 v66, v90
M16 v[28:31],a[140:143],v[144:147],v[28:31]
DTR v[192:193],v4 offset:49152
v_mov_b32 v67, v91
M16 v[28:31],a[156:159],v[148:151],v[28:31]
DTR v[194:195],v4 offset:49664
v_mov_b32 v68, v92
M16 v[28:31],a[172:175],v[152:155],v[28:31]
v_mov_b32 v69, v93
v_mov_b32 v70, v94
M16 v[28:31],a[188:191],v[156:159],v[28:31]
DTR v[196:197],v4 offset:53248
v_mov_b32 v71, v95
M16 v[32:35],a[128:131],v[160:163],v[32:35]
DTR v[198:199],v4 offset:53760
s_mov_b32 s48, s54
M16 v[32:35],a[144:147],v[164:167],v[32:35]
s_mov_b32 s49, s55
s_mov_b32 s50, s56
s_mov_b32 s51, s57
M16 v[32:35],a[160:163],v[168:171],v[32:35]
DTR v[200:201],v4 offset:57344
s_mov_b32 s52, s58
M16 v[32:35],a[176:179],v[172:175],v[32:35]
DTR v[202:203],v4 offset:57856
s_mov_b32 s53, s59
M16 v[36:39],a[132:135],v[160:163],v[36:39]
s_mov_b32 s54, s46
s_mov_b32 s55, s46
s_mov_b32 s56, s46
M16 v[36:39],a[148:151],v[164:167],v[36:39]
DTR v[204:205],v4 offset:61440
s_mov_b32 s57, s46
M16 v[36:39],a[164:167],v[168:171],v[36:39]
DTR v[206:207],v4 offset:61952
s_mov_b32 s58, s46
M16 v[36:39],a[180:183],v[172:175],v[36:39]
s_mov_b32 s59, s46
M16 v[40:43],a[136:139],v[160:163],v[40:43]
s_xor_b32 s27, s27, 65536
M16 v[40:43],a[152:155],v[164:167],v[40:43]
v_add_u32 v3, s27, v5
M16 v[40:43],a[168:171],v[168:171],v[40:43]
v_xor_b32 v4, 32, v3
M16 v[40:43],a[184:187],v[172:175],v[40:43]
M16 v[44:47],a[140:143],v[160:163],v[44:47]
M16 v[44:47],a[156:159],v[164:167],v[44:47]
s_waitcnt lgkmcnt(0)
M16 v[44:47],a[172:175],v[168:171],v[44:47]
s_waitcnt vmcnt(10)
M16 v[44:47],a[188:191],v[172:175],v[44:47]
s_barrier
M16 v[16:19],a[192:195],v[176:179],v[16:19]
DTR v[144:145],v3 offset:0
M16 v[16:19],a[208:211],v[180:183],v[16:19]
DTR v[146:147],v3 offset:512
M16 v[16:19],a[224:227],v[184:187],v[16:19]
buffer_load_dword v116, v11, s[92:95], s43 offen
M16 v[16:19],a[240:243],v[188:191],v[16:19]
DTR v[148:149],v3 offset:4096
M16 v[20:23],a[196:199],v[176:179],v[20:23]
DTR v[150:151],v3 offset:4608
M16 v[20:23],a[212:215],v[180:183],v[20:23]
M16 v[20:23],a[228:231],v[184:187],v[20:23]
DTR v[152:153],v3 offset:8192
M16 v[20:23],a[244:247],v[188:191],v[20:23]
DTR v[154:155],v3 offset:8704
M16 v[24:27],a[200:203],v[176:179],v[24:27]
M16 v[24:27],a[216:219],v[180:183],v[24:27]
DTR v[156:157],v3 offset:12288
M16 v[24:27],a[232:235],v[184:187],v[24:27]
DTR v[158:159],v3 offset:12800
M16 v[24:27],a[248:251],v[188:191],v[24:27]
CVT v96,v16,v17
CVT v97,v18,v19
M16 v[28:31],a[204:207],v[176:179],v[28:31]
DTR v[160:161],v4 offset:0
M16 v[28:31],a[220:223],v[180:183],v[28:31]
DTR v[162:163],v4 offset:512
M16 v[28:31],a[236:239],v[184:187],v[28:31]
M16 v[28:31],a[252:255],v[188:191],v[28:31]
DTR v[164:165],v4 offset:4096
CVT v98,v20,v21
M16 v[32:35],a[192:195],v[192:195],v[32:35]
DTR v[166:167],v4 offset:4608
CVT v99,v22,v23
M16 v[32:35],a[208:211],v[196:199],v[32:35]
BS4 v[96:99],v7,s[16:19],s28 offen sc1
M16 v[32:35],a[224:227],v[200:203],v[32:35]
DTR v[168:169],v4 offset:8192
M16 v[32:35],a[240:243],v[204:207],v[32:35]
DTR v[170:171],v4 offset:8704
CVT v100,v24,v25
M16 v[36:39],a[196:199],v[192:195],v[36:39]
CVT v101,v26,v27
M16 v[36:39],a[212:215],v[196:199],v[36:39]
DTR v[172:173],v4 offset:12288
M16 v[36:39],a[228:231],v[200:203],v[36:39]
DTR v[174:175],v4 offset:12800
M16 v[36:39],a[244:247],v[204:207],v[36:39]
CVT v102,v28,v29
CVT v103,v30,v31
M16 v[40:43],a[200:203],v[192:195],v[40:43]
BS4 v[100:103],v7,s[16:19],s28 offen offset:1024 sc1
M16 v[40:43],a[216:219],v[196:199],v[40:43]
M16 v[40:43],a[232:235],v[200:203],v[40:43]
M16 v[40:43],a[248:251],v[204:207],v[40:43]
CVT v104,v32,v33
CVT v105,v34,v35
M16 v[44:47],a[204:207],v[192:195],v[44:47]
s_mov_b32 s29, s28
M16 v[44:47],a[220:223],v[196:199],v[44:47]
s_add_u32 s31, s31, 1
M16 v[44:47],a[236:239],v[200:203],v[44:47]
s_sub_u32 s23, s23, 1
M16 v[44:47],a[252:255],v[204:207],v[44:47]
s_waitcnt lgkmcnt(0)
s_cmp_lg_u32 s23, s39
s_cbranch_scc1 L_p1_V
s_cmp_lg_u32 s23, 0
s_cbranch_scc1 L_p1_V_last
s_nop 7
CVT v106,v36,v37
CVT v107,v38,v39
BS4 v[104:107],v7,s[16:19],s29 offen offset:2048 sc1
CVT v108,v40,v41
CVT v109,v42,v43
CVT v110,v44,v45
CVT v111,v46,v47
BS4 v[108:111],v7,s[16:19],s29 offen offset:3072 sc1
s_branch L_p2_entry
L_p1_V_last:
M16 v[16:19],a[0:3],v[144:147],0
DTR v[176:177],v3 offset:16384
CVT v106,v36,v37
M16 v[16:19],a[16:19],v[148:151],v[16:19]
DTR v[178:179],v3 offset:16896
CVT v107,v38,v39
M16 v[16:19],a[32:35],v[152:155],v[16:19]
BS4 v[104:107],v7,s[16:19],s29 offen offset:2048 sc1
M16 v[16:19],a[48:51],v[156:159],v[16:19]
DTR v[180:181],v3 offset:20480
CVT v108,v40,v41
M16 v[20:23],a[4:7],v[144:147],0
DTR v[182:183],v3 offset:20992
CVT v109,v42,v43
M16 v[20:23],a[20:23],v[148:151],v[20:23]
s_and_b32 s43, s2, 7
s_lshl_b32 s43, s43, 2
s_bfe_u32 s44, s2, 0x20003
M16 v[20:23],a[36:39],v[152:155],v[20:23]
DTR v[184:185],v3 offset:24576
s_add_u32 s21, s43, s44
M16 v[20:23],a[52:55],v[156:159],v[20:23]
DTR v[186:187],v3 offset:25088
CVT v110,v44,v45
M16 v[24:27],a[8:11],v[144:147],0
CVT v111,v46,v47
s_lshr_b32 s22, s2, 5
M16 v[24:27],a[24:27],v[148:151],v[24:27]
DTR v[188:189],v3 offset:28672
s_mov_b32 s4, s68
M16 v[24:27],a[40:43],v[152:155],v[24:27]
DTR v[190:191],v3 offset:29184
s_mov_b32 s5, s69
M16 v[24:27],a[56:59],v[156:159],v[24:27]
BS4 v[108:111],v7,s[16:19],s29 offen offset:3072 sc1
M16 v[28:31],a[12:15],v[144:147],0
DTR v[192:193],v4 offset:16384
s_mov_b32 s6, 5242880
M16 v[28:31],a[28:31],v[148:151],v[28:31]
DTR v[194:195],v4 offset:16896
s_mov_b32 s7, 0x00020000
M16 v[28:31],a[44:47],v[152:155],v[28:31]
s_mov_b32 s92, s64
s_mov_b32 s93, s65
s_mov_b32 s94, 2621440
M16 v[28:31],a[60:63],v[156:159],v[28:31]
DTR v[196:197],v4 offset:20480
s_mov_b32 s95, 0x00020000
M16 v[32:35],a[0:3],v[160:163],0
DTR v[198:199],v4 offset:20992
s_lshl_b32 s70, s21, 8
M16 v[32:35],a[16:19],v[164:167],v[32:35]
s_mov_b32 s71, 524288
s_lshl_b32 s73, s20, 12
s_lshl_b32 s66, s20, 13
M16 v[32:35],a[32:35],v[168:171],v[32:35]
DTR v[200:201],v4 offset:24576
s_add_u32 s66, s66, 131072
M16 v[32:35],a[48:51],v[172:175],v[32:35]
DTR v[202:203],v4 offset:25088
s_add_u32 s72, s73, 49152
M16 v[36:39],a[4:7],v[160:163],0
s_lshr_b32 s43, s71, 6
v_lshrrev_b32 v120, 4, v1
s_lshl_b32 s44, s20, 4
M16 v[36:39],a[20:23],v[164:167],v[36:39]
DTR v[204:205],v4 offset:28672
v_add_u32 v121, s44, v120
M16 v[36:39],a[36:39],v[168:171],v[36:39]
DTR v[206:207],v4 offset:29184
v_mul_lo_u32 v121, v121, s43
M16 v[36:39],a[52:55],v[172:175],v[36:39]
v_lshlrev_b32 v120, 1, v120
v_and_b32 v122, 15, v1
M16 v[40:43],a[8:11],v[160:163],0
v_xor_b32 v120, v120, v122
s_lshl_b32 s43, s43, 2
M16 v[40:43],a[24:27],v[164:167],v[40:43]
s_sub_u32 s43, s43, 1024
v_lshl_add_u32 v208, v120, 4, v121
v_add_u32 v209, s43, v208
M16 v[40:43],a[40:43],v[168:171],v[40:43]
v_xor_b32 v120, 8, v120
v_lshl_add_u32 v210, v120, 4, v121
M16 v[40:43],a[56:59],v[172:175],v[40:43]
s_lshl_b32 s44, s43, 1
v_add_u32 v210, s44, v210
v_add_u32 v211, s43, v210
M16 v[44:47],a[12:15],v[160:163],0
s_lshl_b32 s43, s22, 3
s_add_u32 s43, s43, s20
s_mul_i32 s43, s43, 20480
M16 v[44:47],a[28:31],v[164:167],v[44:47]
s_lshl_b32 s44, s22, 2
s_sub_u32 s44, 30, s44
s_mul_i32 s44, s44, 81920
M16 v[44:47],a[44:47],v[168:171],v[44:47]
v_lshrrev_b32 v120, 3, v1
v_mul_u32_u24 v120, 1280, v120
M16 v[44:47],a[60:63],v[172:175],v[44:47]
s_waitcnt lgkmcnt(0)
v_add_u32 v120, s43, v120
v_and_b32 v121, 7, v1
M16 v[16:19],a[64:67],v[176:179],v[16:19]
DTR v[144:145],v3 offset:32768
s_lshr_b32 s40, s31, 2
M16 v[16:19],a[80:83],v[180:183],v[16:19]
DTR v[146:147],v3 offset:33280
s_lshl_b32 s40, s40, 20
M16 v[16:19],a[96:99],v[184:187],v[16:19]
s_and_b32 s41, s31, 3
s_lshl_b32 s41, s41, 12
s_add_u32 s40, s40, s41
M16 v[16:19],a[112:115],v[188:191],v[16:19]
DTR v[148:149],v3 offset:36864
s_add_u32 s28, s40, s38
M16 v[20:23],a[68:71],v[176:179],v[20:23]
DTR v[150:151],v3 offset:37376
v_lshrrev_b32 v122, 4, v1
M16 v[20:23],a[84:87],v[180:183],v[20:23]
v_xor_b32 v121, v121, v122
v_xor_b32 v122, 4, v121
M16 v[20:23],a[100:103],v[184:187],v[20:23]
DTR v[152:153],v3 offset:40960
v_lshl_add_u32 v121, v121, 4, v120
M16 v[20:23],a[116:119],v[188:191],v[20:23]
DTR v[154:155],v3 offset:41472
v_lshl_add_u32 v122, v122, 4, v120
M16 v[24:27],a[72:75],v[176:179],v[24:27]
v_add_u32 v220, 0, v121
v_add_u32 v221, 9216, v122
M16 v[24:27],a[88:91],v[180:183],v[24:27]
DTR v[156:157],v3 offset:45056
v_add_u32 v222, 79872, v121
M16 v[24:27],a[104:107],v[184:187],v[24:27]
DTR v[158:159],v3 offset:45568
v_add_u32 v223, 89088, v122
M16 v[24:27],a[120:123],v[188:191],v[24:27]
v_add_u32 v121, s44, v121
v_add_u32 v122, s44, v122
M16 v[28:31],a[76:79],v[176:179],v[28:31]
DTR v[160:161],v4 offset:32768
v_add_u32 v224, 0, v121
M16 v[28:31],a[92:95],v[180:183],v[28:31]
DTR v[162:163],v4 offset:33280
v_add_u32 v225, 9216, v122
M16 v[28:31],a[108:111],v[184:187],v[28:31]
v_add_u32 v226, 79872, v121
v_add_u32 v227, 89088, v122
M16 v[28:31],a[124:127],v[188:191],v[28:31]
DTR v[164:165],v4 offset:36864
v_and_b32 v120, 15, v1
M16 v[32:35],a[64:67],v[192:195],v[32:35]
DTR v[166:167],v4 offset:37376
v_lshrrev_b32 v121, 1, v120
M16 v[32:35],a[80:83],v[196:199],v[32:35]
v_lshrrev_b32 v122, 4, v1
v_xor_b32 v121, v121, v122
M16 v[32:35],a[96:99],v[200:203],v[32:35]
DTR v[168:169],v4 offset:40960
v_lshlrev_b32 v121, 4, v121
M16 v[32:35],a[112:115],v[204:207],v[32:35]
DTR v[170:171],v4 offset:41472
v_lshl_add_u32 v212, v120, 7, v121
M16 v[36:39],a[68:71],v[192:195],v[36:39]
v_add_u32 v212, s66, v212
v_xor_b32 v213, 64, v212
M16 v[36:39],a[84:87],v[196:199],v[36:39]
DTR v[172:173],v4 offset:45056
v_lshrrev_b32 v120, 4, v1
M16 v[36:39],a[100:103],v[200:203],v[36:39]
DTR v[174:175],v4 offset:45568
v_bfe_u32 v121, v1, 2, 2
M16 v[36:39],a[116:119],v[204:207],v[36:39]
v_lshl_add_u32 v122, v120, 3, v121
v_lshlrev_b32 v122, 8, v122
M16 v[40:43],a[72:75],v[192:195],v[40:43]
v_and_b32 v120, 1, v120
v_lshl_add_u32 v121, v120, 2, v121
M16 v[40:43],a[88:91],v[196:199],v[40:43]
v_lshl_add_u32 v122, v121, 5, v122
v_and_b32 v120, 3, v1
M16 v[40:43],a[104:107],v[200:203],v[40:43]
v_lshl_add_u32 v122, v120, 3, v122
v_add_u32 v228, 81920, v122
M16 v[40:43],a[120:123],v[204:207],v[40:43]
v_xor_b32 v229, 32, v228
v_xor_b32 v230, 64, v228
M16 v[44:47],a[76:79],v[192:195],v[44:47]
v_xor_b32 v231, 96, v228
v_xor_b32 v232, 128, v228
M16 v[44:47],a[92:95],v[196:199],v[44:47]
v_xor_b32 v233, 160, v228
v_xor_b32 v234, 192, v228
M16 v[44:47],a[108:111],v[200:203],v[44:47]
v_xor_b32 v235, 224, v228
s_sub_u32 s43, s72, s66
M16 v[44:47],a[124:127],v[204:207],v[44:47]
s_waitcnt lgkmcnt(0)
v_add_u32 v214, s43, v212
v_add_u32 v215, s43, v213
M16 v[16:19],a[128:131],v[144:147],v[16:19]
DTR v[176:177],v3 offset:49152
M16 v[16:19],a[144:147],v[148:151],v[16:19]
DTR v[178:179],v3 offset:49664
M16 v[16:19],a[160:163],v[152:155],v[16:19]
M16 v[16:19],a[176:179],v[156:159],v[16:19]
DTR v[180:181],v3 offset:53248
M16 v[20:23],a[132:135],v[144:147],v[20:23]
DTR v[182:183],v3 offset:53760
M16 v[20:23],a[148:151],v[148:151],v[20:23]
M16 v[20:23],a[164:167],v[152:155],v[20:23]
DTR v[184:185],v3 offset:57344
M16 v[20:23],a[180:183],v[156:159],v[20:23]
DTR v[186:187],v3 offset:57856
M16 v[24:27],a[136:139],v[144:147],v[24:27]
M16 v[24:27],a[152:155],v[148:151],v[24:27]
DTR v[188:189],v3 offset:61440
M16 v[24:27],a[168:171],v[152:155],v[24:27]
DTR v[190:191],v3 offset:61952
M16 v[24:27],a[184:187],v[156:159],v[24:27]
M16 v[28:31],a[140:143],v[144:147],v[28:31]
DTR v[192:193],v4 offset:49152
M16 v[28:31],a[156:159],v[148:151],v[28:31]
DTR v[194:195],v4 offset:49664
M16 v[28:31],a[172:175],v[152:155],v[28:31]
M16 v[28:31],a[188:191],v[156:159],v[28:31]
DTR v[196:197],v4 offset:53248
M16 v[32:35],a[128:131],v[160:163],v[32:35]
DTR v[198:199],v4 offset:53760
M16 v[32:35],a[144:147],v[164:167],v[32:35]
M16 v[32:35],a[160:163],v[168:171],v[32:35]
DTR v[200:201],v4 offset:57344
M16 v[32:35],a[176:179],v[172:175],v[32:35]
DTR v[202:203],v4 offset:57856
M16 v[36:39],a[132:135],v[160:163],v[36:39]
M16 v[36:39],a[148:151],v[164:167],v[36:39]
DTR v[204:205],v4 offset:61440
M16 v[36:39],a[164:167],v[168:171],v[36:39]
DTR v[206:207],v4 offset:61952
M16 v[36:39],a[180:183],v[172:175],v[36:39]
M16 v[40:43],a[136:139],v[160:163],v[40:43]
v_xor_b32 v3, 64, v3
v_xor_b32 v4, 64, v4
M16 v[40:43],a[152:155],v[164:167],v[40:43]
M16 v[40:43],a[168:171],v[168:171],v[40:43]
M16 v[40:43],a[184:187],v[172:175],v[40:43]
M16 v[44:47],a[140:143],v[160:163],v[44:47]
M16 v[44:47],a[156:159],v[164:167],v[44:47]
M16 v[44:47],a[172:175],v[168:171],v[44:47]
M16 v[44:47],a[188:191],v[172:175],v[44:47]
s_waitcnt lgkmcnt(0)
M16 v[16:19],a[192:195],v[176:179],v[16:19]
DTR v[144:145],v3 offset:0
M16 v[16:19],a[208:211],v[180:183],v[16:19]
DTR v[146:147],v3 offset:512
M16 v[16:19],a[224:227],v[184:187],v[16:19]
M16 v[16:19],a[240:243],v[188:191],v[16:19]
DTR v[148:149],v3 offset:4096
M16 v[20:23],a[196:199],v[176:179],v[20:23]
DTR v[150:151],v3 offset:4608
M16 v[20:23],a[212:215],v[180:183],v[20:23]
M16 v[20:23],a[228:231],v[184:187],v[20:23]
DTR v[152:153],v3 offset:8192
M16 v[20:23],a[244:247],v[188:191],v[20:23]
DTR v[154:155],v3 offset:8704
M16 v[24:27],a[200:203],v[176:179],v[24:27]
M16 v[24:27],a[216:219],v[180:183],v[24:27]
DTR v[156:157],v3 offset:12288
M16 v[24:27],a[232:235],v[184:187],v[24:27]
DTR v[158:159],v3 offset:12800
M16 v[24:27],a[248:251],v[188:191],v[24:27]
CVT v96,v16,v17
CVT v97,v18,v19
M16 v[28:31],a[204:207],v[176:179],v[28:31]
DTR v[160:161],v4 offset:0
M16 v[28:31],a[220:223],v[180:183],v[28:31]
DTR v[162:163],v4 offset:512
M16 v[28:31],a[236:239],v[184:187],v[28:31]
M16 v[28:31],a[252:255],v[188:191],v[28:31]
DTR v[164:165],v4 offset:4096
CVT v98,v20,v21
M16 v[32:35],a[192:195],v[192:195],v[32:35]
DTR v[166:167],v4 offset:4608
CVT v99,v22,v23
M16 v[32:35],a[208:211],v[196:199],v[32:35]
BS4 v[96:99],v7,s[16:19],s28 offen sc1
M16 v[32:35],a[224:227],v[200:203],v[32:35]
DTR v[168:169],v4 offset:8192
M16 v[32:35],a[240:243],v[204:207],v[32:35]
DTR v[170:171],v4 offset:8704
CVT v100,v24,v25
M16 v[36:39],a[196:199],v[192:195],v[36:39]
CVT v101,v26,v27
M16 v[36:39],a[212:215],v[196:199],v[36:39]
DTR v[172:173],v4 offset:12288
M16 v[36:39],a[228:231],v[200:203],v[36:39]
DTR v[174:175],v4 offset:12800
M16 v[36:39],a[244:247],v[204:207],v[36:39]
CVT v102,v28,v29
CVT v103,v30,v31
M16 v[40:43],a[200:203],v[192:195],v[40:43]
BS4 v[100:103],v7,s[16:19],s28 offen offset:1024 sc1
M16 v[40:43],a[216:219],v[196:199],v[40:43]
M16 v[40:43],a[232:235],v[200:203],v[40:43]
M16 v[40:43],a[248:251],v[204:207],v[40:43]
CVT v104,v32,v33
CVT v105,v34,v35
M16 v[44:47],a[204:207],v[192:195],v[44:47]
s_mov_b32 s29, s28
M16 v[44:47],a[220:223],v[196:199],v[44:47]
s_add_u32 s31, s31, 1
M16 v[44:47],a[236:239],v[200:203],v[44:47]
M16 v[44:47],a[252:255],v[204:207],v[44:47]
s_waitcnt lgkmcnt(0)
M16 v[16:19],a[0:3],v[144:147],0
DTR v[176:177],v3 offset:16384
CVT v106,v36,v37
M16 v[16:19],a[16:19],v[148:151],v[16:19]
DTR v[178:179],v3 offset:16896
CVT v107,v38,v39
M16 v[16:19],a[32:35],v[152:155],v[16:19]
BS4 v[104:107],v7,s[16:19],s29 offen offset:2048 sc1
M16 v[16:19],a[48:51],v[156:159],v[16:19]
DTR v[180:181],v3 offset:20480
CVT v108,v40,v41
M16 v[20:23],a[4:7],v[144:147],0
DTR v[182:183],v3 offset:20992
CVT v109,v42,v43
M16 v[20:23],a[20:23],v[148:151],v[20:23]
s_add_u32 m0, s73, 81920
M16 v[20:23],a[36:39],v[152:155],v[20:23]
DTR v[184:185],v3 offset:24576
M16 v[20:23],a[52:55],v[156:159],v[20:23]
DTR v[186:187],v3 offset:25088
CVT v110,v44,v45
M16 v[24:27],a[8:11],v[144:147],0
CVT v111,v46,v47
M16 v[24:27],a[24:27],v[148:151],v[24:27]
DTR v[188:189],v3 offset:28672
M16 v[24:27],a[40:43],v[152:155],v[24:27]
DTR v[190:191],v3 offset:29184
M16 v[24:27],a[56:59],v[156:159],v[24:27]
BS4 v[108:111],v7,s[16:19],s29 offen offset:3072 sc1
M16 v[28:31],a[12:15],v[144:147],0
DTR v[192:193],v4 offset:16384
M16 v[28:31],a[28:31],v[148:151],v[28:31]
DTR v[194:195],v4 offset:16896
M16 v[28:31],a[44:47],v[152:155],v[28:31]
BL4 v208,s[4:7],s70 offen lds
M16 v[28:31],a[60:63],v[156:159],v[28:31]
DTR v[196:197],v4 offset:20480
M16 v[32:35],a[0:3],v[160:163],0
DTR v[198:199],v4 offset:20992
M16 v[32:35],a[16:19],v[164:167],v[32:35]
BL4 v209,s[4:7],s70 offen offset:1024 lds
M16 v[32:35],a[32:35],v[168:171],v[32:35]
DTR v[200:201],v4 offset:24576
M16 v[32:35],a[48:51],v[172:175],v[32:35]
DTR v[202:203],v4 offset:25088
M16 v[36:39],a[4:7],v[160:163],0
BL4 v210,s[4:7],s70 offen offset:2048 lds
M16 v[36:39],a[20:23],v[164:167],v[36:39]
DTR v[204:205],v4 offset:28672
M16 v[36:39],a[36:39],v[168:171],v[36:39]
DTR v[206:207],v4 offset:29184
M16 v[36:39],a[52:55],v[172:175],v[36:39]
BL4 v211,s[4:7],s70 offen offset:3072 lds
M16 v[40:43],a[8:11],v[160:163],0
M16 v[40:43],a[24:27],v[164:167],v[40:43]
s_add_u32 s70, s70, s71
s_add_u32 m0, s66, 0
M16 v[40:43],a[40:43],v[168:171],v[40:43]
s_mov_b32 s67, 0
M16 v[40:43],a[56:59],v[172:175],v[40:43]
BL4 v220,s[92:95],s67 offen lds
M16 v[44:47],a[12:15],v[160:163],0
M16 v[44:47],a[28:31],v[164:167],v[44:47]
BL4 v221,s[92:95],s67 offen offset:1024 lds
M16 v[44:47],a[44:47],v[168:171],v[44:47]
M16 v[44:47],a[60:63],v[172:175],v[44:47]
s_waitcnt lgkmcnt(0)
M16 v[16:19],a[64:67],v[176:179],v[16:19]
DTR v[144:145],v3 offset:32768
s_lshr_b32 s40, s31, 2
M16 v[16:19],a[80:83],v[180:183],v[16:19]
DTR v[146:147],v3 offset:33280
s_lshl_b32 s40, s40, 20
M16 v[16:19],a[96:99],v[184:187],v[16:19]
s_and_b32 s41, s31, 3
s_lshl_b32 s41, s41, 12
s_add_u32 s40, s40, s41
M16 v[16:19],a[112:115],v[188:191],v[16:19]
DTR v[148:149],v3 offset:36864
s_add_u32 s28, s40, s38
M16 v[20:23],a[68:71],v[176:179],v[20:23]
DTR v[150:151],v3 offset:37376
M16 v[20:23],a[84:87],v[180:183],v[20:23]
BL4 v222,s[92:95],s67 offen offset:2048 lds
M16 v[20:23],a[100:103],v[184:187],v[20:23]
DTR v[152:153],v3 offset:40960
M16 v[20:23],a[116:119],v[188:191],v[20:23]
DTR v[154:155],v3 offset:41472
M16 v[24:27],a[72:75],v[176:179],v[24:27]
BL4 v223,s[92:95],s67 offen offset:3072 lds
M16 v[24:27],a[88:91],v[180:183],v[24:27]
DTR v[156:157],v3 offset:45056
M16 v[24:27],a[104:107],v[184:187],v[24:27]
DTR v[158:159],v3 offset:45568
s_add_u32 m0, s66, 4096
M16 v[24:27],a[120:123],v[188:191],v[24:27]
M16 v[28:31],a[76:79],v[176:179],v[28:31]
DTR v[160:161],v4 offset:32768
M16 v[28:31],a[92:95],v[180:183],v[28:31]
DTR v[162:163],v4 offset:33280
M16 v[28:31],a[108:111],v[184:187],v[28:31]
BL4 v224,s[92:95],s67 offen lds
M16 v[28:31],a[124:127],v[188:191],v[28:31]
DTR v[164:165],v4 offset:36864
M16 v[32:35],a[64:67],v[192:195],v[32:35]
DTR v[166:167],v4 offset:37376
M16 v[32:35],a[80:83],v[196:199],v[32:35]
BL4 v225,s[92:95],s67 offen offset:1024 lds
M16 v[32:35],a[96:99],v[200:203],v[32:35]
DTR v[168:169],v4 offset:40960
M16 v[32:35],a[112:115],v[204:207],v[32:35]
DTR v[170:171],v4 offset:41472
M16 v[36:39],a[68:71],v[192:195],v[36:39]
BL4 v226,s[92:95],s67 offen offset:2048 lds
M16 v[36:39],a[84:87],v[196:199],v[36:39]
DTR v[172:173],v4 offset:45056
M16 v[36:39],a[100:103],v[200:203],v[36:39]
DTR v[174:175],v4 offset:45568
M16 v[36:39],a[116:119],v[204:207],v[36:39]
BL4 v227,s[92:95],s67 offen offset:3072 lds
M16 v[40:43],a[72:75],v[192:195],v[40:43]
M16 v[40:43],a[88:91],v[196:199],v[40:43]
s_add_u32 m0, s73, 98304
M16 v[40:43],a[104:107],v[200:203],v[40:43]
BL4 v208,s[4:7],s70 offen lds
M16 v[40:43],a[120:123],v[204:207],v[40:43]
M16 v[44:47],a[76:79],v[192:195],v[44:47]
BL4 v209,s[4:7],s70 offen offset:1024 lds
M16 v[44:47],a[92:95],v[196:199],v[44:47]
M16 v[44:47],a[108:111],v[200:203],v[44:47]
BL4 v210,s[4:7],s70 offen offset:2048 lds
M16 v[44:47],a[124:127],v[204:207],v[44:47]
s_waitcnt lgkmcnt(0)
M16 v[16:19],a[128:131],v[144:147],v[16:19]
DTR v[176:177],v3 offset:49152
M16 v[16:19],a[144:147],v[148:151],v[16:19]
DTR v[178:179],v3 offset:49664
M16 v[16:19],a[160:163],v[152:155],v[16:19]
BL4 v211,s[4:7],s70 offen offset:3072 lds
M16 v[16:19],a[176:179],v[156:159],v[16:19]
DTR v[180:181],v3 offset:53248
M16 v[20:23],a[132:135],v[144:147],v[20:23]
DTR v[182:183],v3 offset:53760
s_add_u32 s70, s70, s71
M16 v[20:23],a[148:151],v[148:151],v[20:23]
M16 v[20:23],a[164:167],v[152:155],v[20:23]
DTR v[184:185],v3 offset:57344
M16 v[20:23],a[180:183],v[156:159],v[20:23]
DTR v[186:187],v3 offset:57856
M16 v[24:27],a[136:139],v[144:147],v[24:27]
M16 v[24:27],a[152:155],v[148:151],v[24:27]
DTR v[188:189],v3 offset:61440
M16 v[24:27],a[168:171],v[152:155],v[24:27]
DTR v[190:191],v3 offset:61952
M16 v[24:27],a[184:187],v[156:159],v[24:27]
M16 v[28:31],a[140:143],v[144:147],v[28:31]
DTR v[192:193],v4 offset:49152
M16 v[28:31],a[156:159],v[148:151],v[28:31]
DTR v[194:195],v4 offset:49664
M16 v[28:31],a[172:175],v[152:155],v[28:31]
M16 v[28:31],a[188:191],v[156:159],v[28:31]
DTR v[196:197],v4 offset:53248
M16 v[32:35],a[128:131],v[160:163],v[32:35]
DTR v[198:199],v4 offset:53760
M16 v[32:35],a[144:147],v[164:167],v[32:35]
M16 v[32:35],a[160:163],v[168:171],v[32:35]
DTR v[200:201],v4 offset:57344
M16 v[32:35],a[176:179],v[172:175],v[32:35]
DTR v[202:203],v4 offset:57856
M16 v[36:39],a[132:135],v[160:163],v[36:39]
M16 v[36:39],a[148:151],v[164:167],v[36:39]
DTR v[204:205],v4 offset:61440
M16 v[36:39],a[164:167],v[168:171],v[36:39]
DTR v[206:207],v4 offset:61952
M16 v[36:39],a[180:183],v[172:175],v[36:39]
M16 v[40:43],a[136:139],v[160:163],v[40:43]
s_xor_b32 s27, s27, 65536
M16 v[40:43],a[152:155],v[164:167],v[40:43]
v_add_u32 v3, s27, v5
M16 v[40:43],a[168:171],v[168:171],v[40:43]
v_xor_b32 v4, 32, v3
M16 v[40:43],a[184:187],v[172:175],v[40:43]
M16 v[44:47],a[140:143],v[160:163],v[44:47]
M16 v[44:47],a[156:159],v[164:167],v[44:47]
s_waitcnt lgkmcnt(0)
M16 v[44:47],a[172:175],v[168:171],v[44:47]
M16 v[44:47],a[188:191],v[172:175],v[44:47]
s_barrier
M16 v[16:19],a[192:195],v[176:179],v[16:19]
DTR v[144:145],v3 offset:0
M16 v[16:19],a[208:211],v[180:183],v[16:19]
DTR v[146:147],v3 offset:512
M16 v[16:19],a[224:227],v[184:187],v[16:19]
M16 v[16:19],a[240:243],v[188:191],v[16:19]
DTR v[148:149],v3 offset:4096
M16 v[20:23],a[196:199],v[176:179],v[20:23]
DTR v[150:151],v3 offset:4608
M16 v[20:23],a[212:215],v[180:183],v[20:23]
M16 v[20:23],a[228:231],v[184:187],v[20:23]
DTR v[152:153],v3 offset:8192
M16 v[20:23],a[244:247],v[188:191],v[20:23]
DTR v[154:155],v3 offset:8704
M16 v[24:27],a[200:203],v[176:179],v[24:27]
M16 v[24:27],a[216:219],v[180:183],v[24:27]
DTR v[156:157],v3 offset:12288
M16 v[24:27],a[232:235],v[184:187],v[24:27]
DTR v[158:159],v3 offset:12800
M16 v[24:27],a[248:251],v[188:191],v[24:27]
CVT v96,v16,v17
CVT v97,v18,v19
M16 v[28:31],a[204:207],v[176:179],v[28:31]
DTR v[160:161],v4 offset:0
M16 v[28:31],a[220:223],v[180:183],v[28:31]
DTR v[162:163],v4 offset:512
M16 v[28:31],a[236:239],v[184:187],v[28:31]
M16 v[28:31],a[252:255],v[188:191],v[28:31]
DTR v[164:165],v4 offset:4096
CVT v98,v20,v21
M16 v[32:35],a[192:195],v[192:195],v[32:35]
DTR v[166:167],v4 offset:4608
CVT v99,v22,v23
M16 v[32:35],a[208:211],v[196:199],v[32:35]
BS4 v[96:99],v7,s[16:19],s28 offen sc1
M16 v[32:35],a[224:227],v[200:203],v[32:35]
DTR v[168:169],v4 offset:8192
M16 v[32:35],a[240:243],v[204:207],v[32:35]
DTR v[170:171],v4 offset:8704
CVT v100,v24,v25
M16 v[36:39],a[196:199],v[192:195],v[36:39]
CVT v101,v26,v27
M16 v[36:39],a[212:215],v[196:199],v[36:39]
DTR v[172:173],v4 offset:12288
M16 v[36:39],a[228:231],v[200:203],v[36:39]
DTR v[174:175],v4 offset:12800
M16 v[36:39],a[244:247],v[204:207],v[36:39]
CVT v102,v28,v29
CVT v103,v30,v31
M16 v[40:43],a[200:203],v[192:195],v[40:43]
BS4 v[100:103],v7,s[16:19],s28 offen offset:1024 sc1
M16 v[40:43],a[216:219],v[196:199],v[40:43]
M16 v[40:43],a[232:235],v[200:203],v[40:43]
M16 v[40:43],a[248:251],v[204:207],v[40:43]
CVT v104,v32,v33
CVT v105,v34,v35
M16 v[44:47],a[204:207],v[192:195],v[44:47]
s_mov_b32 s29, s28
M16 v[44:47],a[220:223],v[196:199],v[44:47]
s_add_u32 s31, s31, 1
M16 v[44:47],a[236:239],v[200:203],v[44:47]
s_sub_u32 s23, s23, 1
M16 v[44:47],a[252:255],v[204:207],v[44:47]
s_waitcnt lgkmcnt(0)
s_nop 7
CVT v106,v36,v37
CVT v107,v38,v39
BS4 v[104:107],v7,s[16:19],s29 offen offset:2048 sc1
CVT v108,v40,v41
CVT v109,v42,v43
CVT v110,v44,v45
CVT v111,v46,v47
BS4 v[108:111],v7,s[16:19],s29 offen offset:3072 sc1
s_branch L_p2_entry_early
L_p1_roleB:
s_sub_u32 s31, s22, 26
s_lshl_b32 s31, s31, 2
s_lshl_b32 s36, s31, 6
s_mov_b32 s37, 81920
s_mul_i32 s38, s21, 327680
s_add_u32 s38, s38, 67108864
s_mov_b32 s30, 1051011932
s_mul_i32 s40, s20, 81920
v_lshl_add_u32 v7, v1, 4, s40
v_add_u32 v8, 20480, v7
v_add_u32 v9, 40960, v7
v_add_u32 v10, 61440, v7
s_mov_b32 s8, s78
s_mov_b32 s9, s79
s_mov_b32 s10, 819200
s_mov_b32 s11, 0x00020000
s_mov_b32 s12, s76
s_mov_b32 s13, s77
s_mov_b32 s14, 2621440
s_mov_b32 s15, 0x00020000
s_cmp_eq_u32 s22, 31
s_cbranch_scc1 L_p1_B_kv
s_and_b32 s40, s21, 3
s_lshl_b32 s40, s40, 2
s_add_u32 s40, s40, s20
s_mul_i32 s40, s40, 20
v_min_u32 v212, 39, v1
v_lshrrev_b32 v213, 1, v212
v_add_u32 v213, s40, v213
s_lshr_b32 s40, s37, 6
v_mul_lo_u32 v213, v213, s40
v_and_b32 v212, 1, v212
v_lshl_add_u32 v216, v212, 7, v213
s_mul_i32 s44, s37, 5
s_add_u32 s44, s44, s36
s_mov_b32 s43, s36
s_lshr_b32 s40, s2, 3
s_lshl_b32 s40, s40, 2
s_add_u32 s40, s40, s20
s_and_b32 s41, s2, 1
s_lshl_b32 s41, s41, 7
s_add_u32 s40, s40, s41
s_lshl_b32 s56, s40, 13
s_mul_i32 s57, s40, 10240
v_min_u32 v212, 31, v1
v_lshrrev_b32 v213, 2, v212
v_and_b32 v212, 3, v212
v_lshlrev_b32 v212, 7, v212
v_lshl_add_u32 v217, v213, 10, v212
v_min_u32 v212, 39, v1
v_mul_u32_u24 v213, 52, v212
v_lshrrev_b32 v213, 8, v213
v_mul_u32_u24 v214, 5, v213
v_sub_u32 v212, v212, v214
v_lshlrev_b32 v212, 7, v212
v_mul_u32_u24 v213, 1280, v213
v_add_u32 v218, v212, v213
s_mov_b32 s48, s66
s_mov_b32 s49, s67
s_mov_b32 s50, 2097152
s_mov_b32 s51, 0x00020000
s_mov_b32 s60, s76
s_mov_b32 s61, s77
s_mov_b32 s62, 2621440
s_mov_b32 s63, 0x00020000
buffer_load_dword v6, v217, s[48:51], s56 offen offset:0
buffer_load_dword v6, v216, s[8:11], s43 offen
s_and_b32 s40, s2, 6
s_cmp_lg_u32 s40, 6
s_cbranch_scc1 L_pf_Q_0
buffer_load_dword v6, v218, s[60:63], s57 offen offset:0
L_pf_Q_0:
s_lshr_b32 s40, s37, 6
v_lshrrev_b32 v220, 4, v1
s_lshl_b32 s41, s20, 4
v_add_u32 v221, s41, v220
v_mul_lo_u32 v221, v221, s40
v_lshlrev_b32 v220, 1, v220
v_and_b32 v222, 15, v1
v_xor_b32 v220, v220, v222
s_lshl_b32 s40, s40, 2
s_sub_u32 s40, s40, 1024
v_lshl_add_u32 v208, v220, 4, v221
v_add_u32 v209, s40, v208
v_xor_b32 v220, 8, v220
v_lshl_add_u32 v210, v220, 4, v221
s_lshl_b32 s41, s40, 1
v_add_u32 v210, s41, v210
v_add_u32 v211, s40, v210
s_lshl_b32 s40, s21, 2
s_add_u32 s40, s40, s20
s_mul_i32 s40, s40, 81920
v_lshrrev_b32 v220, 3, v1
v_mul_u32_u24 v220, 1280, v220
v_add_u32 v220, s40, v220
v_and_b32 v221, 7, v1
v_lshrrev_b32 v222, 4, v1
v_xor_b32 v221, v221, v222
v_xor_b32 v222, 4, v221
v_lshl_add_u32 v221, v221, 4, v220
v_lshl_add_u32 v222, v222, 4, v220
v_add_u32 v200, 0, v221
v_add_u32 v201, 9216, v222
v_add_u32 v202, 18432, v221
v_add_u32 v203, 27648, v222
v_add_u32 v204, 40960, v221
v_add_u32 v205, 50176, v222
v_add_u32 v206, 59392, v221
v_add_u32 v207, 68608, v222
s_mul_i32 s32, s20, 12288
s_add_u32 s32, s32, 114688
s_add_u32 m0, s34, 65536
s_nop 0
BL4 v208,s[8:11],s36 offen lds
BL4 v209,s[8:11],s36 offen offset:1024 lds
BL4 v210,s[8:11],s36 offen offset:2048 lds
BL4 v211,s[8:11],s36 offen offset:3072 lds
s_add_u32 s36, s36, s37
s_add_u32 m0, s32, 0
s_mov_b32 s33, 0
BL4 v200,s[12:15],s33 offen lds
BL4 v201,s[12:15],s33 offen offset:1024 lds
BL4 v202,s[12:15],s33 offen offset:2048 lds
BL4 v203,s[12:15],s33 offen offset:3072 lds
s_add_u32 m0, s32, 4096
s_nop 0
BL4 v204,s[12:15],s33 offen lds
BL4 v205,s[12:15],s33 offen offset:1024 lds
BL4 v206,s[12:15],s33 offen offset:2048 lds
BL4 v207,s[12:15],s33 offen offset:3072 lds
buffer_load_dword v6, v217, s[48:51], s56 offen offset:512
buffer_load_dword v6, v216, s[8:11], s44 offen
s_and_b32 s40, s2, 6
s_cmp_lg_u32 s40, 6
s_cbranch_scc1 L_pf_Q_1
buffer_load_dword v6, v218, s[60:63], s57 offen offset:640
L_pf_Q_1:
s_add_u32 m0, s34, 81920
s_nop 0
BL4 v208,s[8:11],s36 offen lds
BL4 v209,s[8:11],s36 offen offset:1024 lds
BL4 v210,s[8:11],s36 offen offset:2048 lds
BL4 v211,s[8:11],s36 offen offset:3072 lds
s_add_u32 s36, s36, s37
s_add_u32 m0, s32, 8192
s_mov_b32 s33, 128
BL4 v200,s[12:15],s33 offen lds
BL4 v201,s[12:15],s33 offen offset:1024 lds
BL4 v202,s[12:15],s33 offen offset:2048 lds
BL4 v203,s[12:15],s33 offen offset:3072 lds
v_and_b32 v220, 15, v1
v_lshrrev_b32 v221, 1, v220
v_lshrrev_b32 v222, 4, v1
v_xor_b32 v221, v221, v222
v_lshlrev_b32 v221, 4, v221
v_lshl_add_u32 v12, v220, 7, v221
v_add_u32 v12, s32, v12
v_xor_b32 v13, 64, v12
v_lshrrev_b32 v220, 4, v1
v_bfe_u32 v221, v1, 2, 2
v_lshl_add_u32 v222, v220, 3, v221
v_lshlrev_b32 v222, 8, v222
v_and_b32 v220, 1, v220
v_lshl_add_u32 v221, v220, 2, v221
v_lshl_add_u32 v222, v221, 5, v222
v_and_b32 v220, 3, v1
v_lshl_add_u32 v222, v220, 3, v222
v_add_u32 v192, 65536, v222
v_xor_b32 v193, 32, v192
v_xor_b32 v194, 64, v192
v_xor_b32 v195, 96, v192
v_xor_b32 v196, 128, v192
v_xor_b32 v197, 160, v192
v_xor_b32 v198, 192, v192
v_xor_b32 v199, 224, v192
s_mul_i32 s40, s21, 6
s_add_u32 s40, s40, s22
s_sub_u32 s40, s40, 26
s_lshl_b32 s40, s40, 2
s_add_u32 s40, s40, s20
s_and_b32 s41, s40, 1
s_lshr_b32 s40, s40, 1
s_mul_i32 s40, s40, 6
s_cmp_eq_u32 s41, 0
s_cselect_b32 s48, s70, s72
s_cselect_b32 s49, s71, s73
s_mov_b32 s50, 4194304
s_mov_b32 s51, 0x00020000
v_min_u32 v212, 59, v1
v_mul_u32_u24 v213, 43, v212
v_lshrrev_b32 v213, 8, v213
v_mul_u32_u24 v214, 6, v213
v_sub_u32 v212, v212, v214
v_add_u32 v212, s40, v212
v_lshlrev_b32 v212, 13, v212
v_mul_u32_u24 v213, 6, v213
s_cmp_eq_u32 s41, 0
s_mov_b32 s42, 3594830274
s_cselect_b32 s42, 3594830274, s42
s_mov_b32 s43, 199923206
s_cselect_b32 s43, 199923206, s43
v_lshrrev_b64 v[214:215], v213, s[42:43]
v_and_b32 v214, 63, v214
v_lshl_add_u32 v214, v214, 7, v212
buffer_load_dword v6, v214, s[48:51], 0 offen
s_cmp_eq_u32 s41, 0
s_mov_b32 s42, 1209003636
s_cselect_b32 s42, 1209003636, s42
s_mov_b32 s43, 140270883
s_cselect_b32 s43, 140270883, s43
v_lshrrev_b64 v[214:215], v213, s[42:43]
v_and_b32 v214, 63, v214
v_lshl_add_u32 v214, v214, 7, v212
buffer_load_dword v6, v214, s[48:51], 0 offen
s_cmp_eq_u32 s41, 0
s_mov_b32 s42, 4208397030
s_cselect_b32 s42, 4208397030, s42
s_mov_b32 s43, 80618575
s_cselect_b32 s43, 80618575, s43
v_lshrrev_b64 v[214:215], v213, s[42:43]
v_and_b32 v214, 63, v214
v_lshl_add_u32 v214, v214, 7, v212
buffer_load_dword v6, v214, s[48:51], 0 offen
s_cmp_eq_u32 s41, 0
s_mov_b32 s42, 1822304088
s_cselect_b32 s42, 1822304088, s42
s_mov_b32 s43, 251391852
s_cselect_b32 s43, 251391852, s43
v_lshrrev_b64 v[214:215], v213, s[42:43]
v_and_b32 v214, 63, v214
v_lshl_add_u32 v214, v214, 7, v212
buffer_load_dword v6, v214, s[48:51], 0 offen
v_and_b32 v212, 15, v1
v_mul_u32_u24 v212, 272, v212
v_lshrrev_b32 v213, 4, v1
v_lshl_add_u32 v212, v213, 3, v212
s_mul_i32 s40, s20, 8704
v_add_u32 v3, s40, v212
v_mul_u32_u24 v212, 272, v213
v_and_b32 v214, 15, v1
v_lshl_add_u32 v212, v214, 4, v212
v_add_u32 v4, s40, v212
v_mul_u32_u24 v212, 1280, v213
v_lshl_add_u32 v2, v214, 4, v212
s_lshl_b32 s40, s21, 2
s_add_u32 s40, s40, s20
s_mul_i32 s28, s40, 81920
s_lshl_b32 s40, s31, 6
s_add_u32 s28, s28, s40
s_add_u32 s28, s28, 67108864
s_waitcnt vmcnt(10)
s_barrier
DR a[0:3],v12 offset:0
DR a[16:19],v13 offset:0
DR a[4:7],v12 offset:2048
DR a[20:23],v13 offset:2048
DR a[8:11],v12 offset:4096
DR a[24:27],v13 offset:4096
DR a[12:15],v12 offset:6144
DR a[28:31],v13 offset:6144
s_waitcnt lgkmcnt(4)
s_add_u32 m0, s32, 0
s_nop 0
BL4 v204,s[12:15],s33 offen lds
BL4 v205,s[12:15],s33 offen offset:1024 lds
BL4 v206,s[12:15],s33 offen offset:2048 lds
BL4 v207,s[12:15],s33 offen offset:3072 lds
DTR v[144:145],v192 offset:0
DTR v[146:147],v192 offset:1024
DTR v[148:149],v192 offset:8192
DTR v[150:151],v192 offset:9216
DTR v[152:153],v193 offset:0
DTR v[154:155],v193 offset:1024
DTR v[156:157],v193 offset:8192
DTR v[158:159],v193 offset:9216
DTR v[160:161],v194 offset:0
DTR v[162:163],v194 offset:1024
DTR v[164:165],v194 offset:8192
DTR v[166:167],v194 offset:9216
DTR v[168:169],v195 offset:0
DTR v[170:171],v195 offset:1024
DTR v[172:173],v195 offset:8192
DTR v[174:175],v195 offset:9216
DTR v[176:177],v196 offset:0
DTR v[178:179],v196 offset:1024
DTR v[180:181],v196 offset:8192
DTR v[182:183],v196 offset:9216
s_waitcnt lgkmcnt(15)
M16 v[16:19],v[144:147],a[0:3],0
DTR v[184:185],v197 offset:0
s_add_u32 m0, s32, 4096
M16 v[16:19],v[148:151],a[16:19],v[16:19]
s_mov_b32 s33, 256
M16 v[20:23],v[144:147],a[4:7],0
DTR v[186:187],v197 offset:1024
M16 v[20:23],v[148:151],a[20:23],v[20:23]
BL4 v200,s[12:15],s33 offen lds
M16 v[24:27],v[144:147],a[8:11],0
DTR v[188:189],v197 offset:8192
M16 v[24:27],v[148:151],a[24:27],v[24:27]
BL4 v201,s[12:15],s33 offen offset:1024 lds
M16 v[28:31],v[144:147],a[12:15],0
DTR v[190:191],v197 offset:9216
M16 v[28:31],v[148:151],a[28:31],v[28:31]
s_waitcnt lgkmcnt(15)
M16 v[32:35],v[152:155],a[0:3],0
DTR v[144:145],v198 offset:0
M16 v[32:35],v[156:159],a[16:19],v[32:35]
BL4 v202,s[12:15],s33 offen offset:2048 lds
M16 v[36:39],v[152:155],a[4:7],0
DTR v[146:147],v198 offset:1024
M16 v[36:39],v[156:159],a[20:23],v[36:39]
BL4 v203,s[12:15],s33 offen offset:3072 lds
M16 v[40:43],v[152:155],a[8:11],0
DTR v[148:149],v198 offset:8192
s_waitcnt vmcnt(8)
M16 v[40:43],v[156:159],a[24:27],v[40:43]
DR a[32:35],v12 offset:8192
M16 v[44:47],v[152:155],a[12:15],0
DTR v[150:151],v198 offset:9216
M16 v[44:47],v[156:159],a[28:31],v[44:47]
s_waitcnt lgkmcnt(15)
DR a[48:51],v13 offset:8192
M16 v[48:51],v[160:163],a[0:3],0
DTR v[152:153],v199 offset:0
M16 v[48:51],v[164:167],a[16:19],v[48:51]
DR a[36:39],v12 offset:10240
M16 v[52:55],v[160:163],a[4:7],0
DTR v[154:155],v199 offset:1024
M16 v[52:55],v[164:167],a[20:23],v[52:55]
DR a[52:55],v13 offset:10240
s_waitcnt vmcnt(4)
M16 v[56:59],v[160:163],a[8:11],0
DTR v[156:157],v199 offset:8192
M16 v[56:59],v[164:167],a[24:27],v[56:59]
s_waitcnt lgkmcnt(15)
DR a[40:43],v12 offset:0
M16 v[60:63],v[160:163],a[12:15],0
DTR v[158:159],v199 offset:9216
M16 v[60:63],v[164:167],a[28:31],v[60:63]
s_barrier
DR a[56:59],v13 offset:0
M16 v[64:67],v[168:171],a[0:3],0
DTR v[160:161],v192 offset:16384
M16 v[64:67],v[172:175],a[16:19],v[64:67]
DR a[44:47],v12 offset:2048
M16 v[68:71],v[168:171],a[4:7],0
DTR v[162:163],v192 offset:17408
M16 v[68:71],v[172:175],a[20:23],v[68:71]
DR a[60:63],v13 offset:2048
s_waitcnt lgkmcnt(8)
M16 v[72:75],v[168:171],a[8:11],0
DTR v[164:165],v192 offset:24576
s_add_u32 m0, s32, 8192
M16 v[72:75],v[172:175],a[24:27],v[72:75]
M16 v[76:79],v[168:171],a[12:15],0
DTR v[166:167],v192 offset:25600
M16 v[76:79],v[172:175],a[28:31],v[76:79]
M16 v[80:83],v[176:179],a[0:3],0
DTR v[168:169],v193 offset:16384
M16 v[80:83],v[180:183],a[16:19],v[80:83]
BL4 v204,s[12:15],s33 offen lds
M16 v[84:87],v[176:179],a[4:7],0
DTR v[170:171],v193 offset:17408
M16 v[84:87],v[180:183],a[20:23],v[84:87]
BL4 v205,s[12:15],s33 offen offset:1024 lds
M16 v[88:91],v[176:179],a[8:11],0
DTR v[172:173],v193 offset:24576
M16 v[88:91],v[180:183],a[24:27],v[88:91]
BL4 v206,s[12:15],s33 offen offset:2048 lds
M16 v[92:95],v[176:179],a[12:15],0
DTR v[174:175],v193 offset:25600
M16 v[92:95],v[180:183],a[28:31],v[92:95]
M16 v[96:99],v[184:187],a[0:3],0
DTR v[176:177],v194 offset:16384
M16 v[96:99],v[188:191],a[16:19],v[96:99]
BL4 v207,s[12:15],s33 offen offset:3072 lds
M16 v[100:103],v[184:187],a[4:7],0
DTR v[178:179],v194 offset:17408
s_add_u32 m0, s34, 98304
M16 v[100:103],v[188:191],a[20:23],v[100:103]
BL4 v208,s[8:11],s36 offen lds
M16 v[104:107],v[184:187],a[8:11],0
DTR v[180:181],v194 offset:24576
M16 v[104:107],v[188:191],a[24:27],v[104:107]
BL4 v209,s[8:11],s36 offen offset:1024 lds
M16 v[108:111],v[184:187],a[12:15],0
DTR v[182:183],v194 offset:25600
M16 v[108:111],v[188:191],a[28:31],v[108:111]
M16 v[112:115],v[144:147],a[0:3],0
DTR v[184:185],v195 offset:16384
M16 v[112:115],v[148:151],a[16:19],v[112:115]
BL4 v210,s[8:11],s36 offen offset:2048 lds
M16 v[116:119],v[144:147],a[4:7],0
DTR v[186:187],v195 offset:17408
M16 v[116:119],v[148:151],a[20:23],v[116:119]
BL4 v211,s[8:11],s36 offen offset:3072 lds
M16 v[120:123],v[144:147],a[8:11],0
DTR v[188:189],v195 offset:24576
s_add_u32 s36, s36, s37
M16 v[120:123],v[148:151],a[24:27],v[120:123]
M16 v[124:127],v[144:147],a[12:15],0
DTR v[190:191],v195 offset:25600
M16 v[124:127],v[148:151],a[28:31],v[124:127]
s_waitcnt lgkmcnt(15)
M16 v[128:131],v[152:155],a[0:3],0
DTR v[144:145],v196 offset:16384
M16 v[128:131],v[156:159],a[16:19],v[128:131]
M16 v[132:135],v[152:155],a[4:7],0
DTR v[146:147],v196 offset:17408
M16 v[132:135],v[156:159],a[20:23],v[132:135]
M16 v[136:139],v[152:155],a[8:11],0
DTR v[148:149],v196 offset:24576
M16 v[136:139],v[156:159],a[24:27],v[136:139]
M16 v[140:143],v[152:155],a[12:15],0
DTR v[150:151],v196 offset:25600
M16 v[140:143],v[156:159],a[28:31],v[140:143]
s_waitcnt lgkmcnt(15)
M16 v[16:19],v[160:163],a[32:35],v[16:19]
DTR v[152:153],v197 offset:16384
s_add_u32 m0, s32, 0
M16 v[16:19],v[164:167],a[48:51],v[16:19]
s_mov_b32 s33, 384
M16 v[20:23],v[160:163],a[36:39],v[20:23]
DTR v[154:155],v197 offset:17408
M16 v[20:23],v[164:167],a[52:55],v[20:23]
BL4 v200,s[12:15],s33 offen lds
M16 v[24:27],v[160:163],a[40:43],v[24:27]
DTR v[156:157],v197 offset:24576
M16 v[24:27],v[164:167],a[56:59],v[24:27]
BL4 v201,s[12:15],s33 offen offset:1024 lds
M16 v[28:31],v[160:163],a[44:47],v[28:31]
DTR v[158:159],v197 offset:25600
M16 v[28:31],v[164:167],a[60:63],v[28:31]
s_waitcnt lgkmcnt(15)
M16 v[32:35],v[168:171],a[32:35],v[32:35]
DTR v[160:161],v198 offset:16384
M16 v[32:35],v[172:175],a[48:51],v[32:35]
BL4 v202,s[12:15],s33 offen offset:2048 lds
M16 v[36:39],v[168:171],a[36:39],v[36:39]
DTR v[162:163],v198 offset:17408
M16 v[36:39],v[172:175],a[52:55],v[36:39]
BL4 v203,s[12:15],s33 offen offset:3072 lds
M16 v[40:43],v[168:171],a[40:43],v[40:43]
DTR v[164:165],v198 offset:24576
s_waitcnt vmcnt(12)
M16 v[40:43],v[172:175],a[56:59],v[40:43]
DR a[0:3],v12 offset:4096
M16 v[44:47],v[168:171],a[44:47],v[44:47]
DTR v[166:167],v198 offset:25600
M16 v[44:47],v[172:175],a[60:63],v[44:47]
s_waitcnt lgkmcnt(15)
DR a[16:19],v13 offset:4096
M16 v[48:51],v[176:179],a[32:35],v[48:51]
DTR v[168:169],v199 offset:16384
M16 v[48:51],v[180:183],a[48:51],v[48:51]
DR a[4:7],v12 offset:6144
M16 v[52:55],v[176:179],a[36:39],v[52:55]
DTR v[170:171],v199 offset:17408
M16 v[52:55],v[180:183],a[52:55],v[52:55]
DR a[20:23],v13 offset:6144
s_waitcnt vmcnt(8)
M16 v[56:59],v[176:179],a[40:43],v[56:59]
DTR v[172:173],v199 offset:24576
M16 v[56:59],v[180:183],a[56:59],v[56:59]
s_waitcnt lgkmcnt(15)
DR a[8:11],v12 offset:8192
M16 v[60:63],v[176:179],a[44:47],v[60:63]
DTR v[174:175],v199 offset:25600
s_waitcnt vmcnt(4)
M16 v[60:63],v[180:183],a[60:63],v[60:63]
s_barrier
DR a[24:27],v13 offset:8192
M16 v[64:67],v[184:187],a[32:35],v[64:67]
DTR v[176:177],v192 offset:32768
M16 v[64:67],v[188:191],a[48:51],v[64:67]
DR a[12:15],v12 offset:10240
M16 v[68:71],v[184:187],a[36:39],v[68:71]
DTR v[178:179],v192 offset:33792
M16 v[68:71],v[188:191],a[52:55],v[68:71]
DR a[28:31],v13 offset:10240
s_waitcnt lgkmcnt(8)
M16 v[72:75],v[184:187],a[40:43],v[72:75]
DTR v[180:181],v192 offset:40960
s_add_u32 m0, s32, 4096
M16 v[72:75],v[188:191],a[56:59],v[72:75]
M16 v[76:79],v[184:187],a[44:47],v[76:79]
DTR v[182:183],v192 offset:41984
M16 v[76:79],v[188:191],a[60:63],v[76:79]
M16 v[80:83],v[144:147],a[32:35],v[80:83]
DTR v[184:185],v193 offset:32768
M16 v[80:83],v[148:151],a[48:51],v[80:83]
BL4 v204,s[12:15],s33 offen lds
M16 v[84:87],v[144:147],a[36:39],v[84:87]
DTR v[186:187],v193 offset:33792
M16 v[84:87],v[148:151],a[52:55],v[84:87]
BL4 v205,s[12:15],s33 offen offset:1024 lds
M16 v[88:91],v[144:147],a[40:43],v[88:91]
DTR v[188:189],v193 offset:40960
M16 v[88:91],v[148:151],a[56:59],v[88:91]
BL4 v206,s[12:15],s33 offen offset:2048 lds
M16 v[92:95],v[144:147],a[44:47],v[92:95]
DTR v[190:191],v193 offset:41984
M16 v[92:95],v[148:151],a[60:63],v[92:95]
M16 v[96:99],v[152:155],a[32:35],v[96:99]
DTR v[144:145],v194 offset:32768
M16 v[96:99],v[156:159],a[48:51],v[96:99]
BL4 v207,s[12:15],s33 offen offset:3072 lds
M16 v[100:103],v[152:155],a[36:39],v[100:103]
DTR v[146:147],v194 offset:33792
s_add_u32 m0, s34, 65536
M16 v[100:103],v[156:159],a[52:55],v[100:103]
BL4 v208,s[8:11],s36 offen lds
M16 v[104:107],v[152:155],a[40:43],v[104:107]
DTR v[148:149],v194 offset:40960
M16 v[104:107],v[156:159],a[56:59],v[104:107]
BL4 v209,s[8:11],s36 offen offset:1024 lds
M16 v[108:111],v[152:155],a[44:47],v[108:111]
DTR v[150:151],v194 offset:41984
M16 v[108:111],v[156:159],a[60:63],v[108:111]
M16 v[112:115],v[160:163],a[32:35],v[112:115]
DTR v[152:153],v195 offset:32768
M16 v[112:115],v[164:167],a[48:51],v[112:115]
BL4 v210,s[8:11],s36 offen offset:2048 lds
M16 v[116:119],v[160:163],a[36:39],v[116:119]
DTR v[154:155],v195 offset:33792
M16 v[116:119],v[164:167],a[52:55],v[116:119]
BL4 v211,s[8:11],s36 offen offset:3072 lds
M16 v[120:123],v[160:163],a[40:43],v[120:123]
DTR v[156:157],v195 offset:40960
s_add_u32 s36, s36, s37
M16 v[120:123],v[164:167],a[56:59],v[120:123]
M16 v[124:127],v[160:163],a[44:47],v[124:127]
DTR v[158:159],v195 offset:41984
M16 v[124:127],v[164:167],a[60:63],v[124:127]
s_waitcnt lgkmcnt(15)
M16 v[128:131],v[168:171],a[32:35],v[128:131]
DTR v[160:161],v196 offset:32768
M16 v[128:131],v[172:175],a[48:51],v[128:131]
M16 v[132:135],v[168:171],a[36:39],v[132:135]
DTR v[162:163],v196 offset:33792
M16 v[132:135],v[172:175],a[52:55],v[132:135]
M16 v[136:139],v[168:171],a[40:43],v[136:139]
DTR v[164:165],v196 offset:40960
M16 v[136:139],v[172:175],a[56:59],v[136:139]
M16 v[140:143],v[168:171],a[44:47],v[140:143]
DTR v[166:167],v196 offset:41984
M16 v[140:143],v[172:175],a[60:63],v[140:143]
s_waitcnt lgkmcnt(15)
M16 v[16:19],v[176:179],a[0:3],v[16:19]
DTR v[168:169],v197 offset:32768
s_add_u32 m0, s32, 8192
M16 v[16:19],v[180:183],a[16:19],v[16:19]
s_mov_b32 s33, 512
M16 v[20:23],v[176:179],a[4:7],v[20:23]
DTR v[170:171],v197 offset:33792
M16 v[20:23],v[180:183],a[20:23],v[20:23]
BL4 v200,s[12:15],s33 offen lds
M16 v[24:27],v[176:179],a[8:11],v[24:27]
DTR v[172:173],v197 offset:40960
M16 v[24:27],v[180:183],a[24:27],v[24:27]
BL4 v201,s[12:15],s33 offen offset:1024 lds
M16 v[28:31],v[176:179],a[12:15],v[28:31]
DTR v[174:175],v197 offset:41984
M16 v[28:31],v[180:183],a[28:31],v[28:31]
s_waitcnt lgkmcnt(15)
M16 v[32:35],v[184:187],a[0:3],v[32:35]
DTR v[176:177],v198 offset:32768
M16 v[32:35],v[188:191],a[16:19],v[32:35]
BL4 v202,s[12:15],s33 offen offset:2048 lds
M16 v[36:39],v[184:187],a[4:7],v[36:39]
DTR v[178:179],v198 offset:33792
M16 v[36:39],v[188:191],a[20:23],v[36:39]
BL4 v203,s[12:15],s33 offen offset:3072 lds
M16 v[40:43],v[184:187],a[8:11],v[40:43]
DTR v[180:181],v198 offset:40960
s_waitcnt vmcnt(12)
M16 v[40:43],v[188:191],a[24:27],v[40:43]
DR a[32:35],v12 offset:0
M16 v[44:47],v[184:187],a[12:15],v[44:47]
DTR v[182:183],v198 offset:41984
M16 v[44:47],v[188:191],a[28:31],v[44:47]
s_waitcnt lgkmcnt(15)
DR a[48:51],v13 offset:0
M16 v[48:51],v[144:147],a[0:3],v[48:51]
DTR v[184:185],v199 offset:32768
M16 v[48:51],v[148:151],a[16:19],v[48:51]
DR a[36:39],v12 offset:2048
M16 v[52:55],v[144:147],a[4:7],v[52:55]
DTR v[186:187],v199 offset:33792
M16 v[52:55],v[148:151],a[20:23],v[52:55]
DR a[52:55],v13 offset:2048
s_waitcnt vmcnt(8)
M16 v[56:59],v[144:147],a[8:11],v[56:59]
DTR v[188:189],v199 offset:40960
M16 v[56:59],v[148:151],a[24:27],v[56:59]
s_waitcnt lgkmcnt(15)
DR a[40:43],v12 offset:4096
M16 v[60:63],v[144:147],a[12:15],v[60:63]
DTR v[190:191],v199 offset:41984
s_waitcnt vmcnt(4)
M16 v[60:63],v[148:151],a[28:31],v[60:63]
s_barrier
DR a[56:59],v13 offset:4096
M16 v[64:67],v[152:155],a[0:3],v[64:67]
DTR v[144:145],v192 offset:0
M16 v[64:67],v[156:159],a[16:19],v[64:67]
DR a[44:47],v12 offset:6144
M16 v[68:71],v[152:155],a[4:7],v[68:71]
DTR v[146:147],v192 offset:1024
M16 v[68:71],v[156:159],a[20:23],v[68:71]
DR a[60:63],v13 offset:6144
s_waitcnt lgkmcnt(8)
M16 v[72:75],v[152:155],a[8:11],v[72:75]
DTR v[148:149],v192 offset:8192
s_add_u32 m0, s32, 0
M16 v[72:75],v[156:159],a[24:27],v[72:75]
M16 v[76:79],v[152:155],a[12:15],v[76:79]
DTR v[150:151],v192 offset:9216
M16 v[76:79],v[156:159],a[28:31],v[76:79]
M16 v[80:83],v[160:163],a[0:3],v[80:83]
DTR v[152:153],v193 offset:0
M16 v[80:83],v[164:167],a[16:19],v[80:83]
BL4 v204,s[12:15],s33 offen lds
M16 v[84:87],v[160:163],a[4:7],v[84:87]
DTR v[154:155],v193 offset:1024
M16 v[84:87],v[164:167],a[20:23],v[84:87]
BL4 v205,s[12:15],s33 offen offset:1024 lds
M16 v[88:91],v[160:163],a[8:11],v[88:91]
DTR v[156:157],v193 offset:8192
M16 v[88:91],v[164:167],a[24:27],v[88:91]
BL4 v206,s[12:15],s33 offen offset:2048 lds
M16 v[92:95],v[160:163],a[12:15],v[92:95]
DTR v[158:159],v193 offset:9216
M16 v[92:95],v[164:167],a[28:31],v[92:95]
M16 v[96:99],v[168:171],a[0:3],v[96:99]
DTR v[160:161],v194 offset:0
M16 v[96:99],v[172:175],a[16:19],v[96:99]
BL4 v207,s[12:15],s33 offen offset:3072 lds
M16 v[100:103],v[168:171],a[4:7],v[100:103]
DTR v[162:163],v194 offset:1024
s_add_u32 m0, s34, 81920
M16 v[100:103],v[172:175],a[20:23],v[100:103]
BL4 v208,s[8:11],s36 offen lds
M16 v[104:107],v[168:171],a[8:11],v[104:107]
DTR v[164:165],v194 offset:8192
M16 v[104:107],v[172:175],a[24:27],v[104:107]
BL4 v209,s[8:11],s36 offen offset:1024 lds
M16 v[108:111],v[168:171],a[12:15],v[108:111]
DTR v[166:167],v194 offset:9216
M16 v[108:111],v[172:175],a[28:31],v[108:111]
M16 v[112:115],v[176:179],a[0:3],v[112:115]
DTR v[168:169],v195 offset:0
M16 v[112:115],v[180:183],a[16:19],v[112:115]
BL4 v210,s[8:11],s36 offen offset:2048 lds
M16 v[116:119],v[176:179],a[4:7],v[116:119]
DTR v[170:171],v195 offset:1024
M16 v[116:119],v[180:183],a[20:23],v[116:119]
BL4 v211,s[8:11],s36 offen offset:3072 lds
M16 v[120:123],v[176:179],a[8:11],v[120:123]
DTR v[172:173],v195 offset:8192
s_add_u32 s36, s36, s37
M16 v[120:123],v[180:183],a[24:27],v[120:123]
M16 v[124:127],v[176:179],a[12:15],v[124:127]
DTR v[174:175],v195 offset:9216
M16 v[124:127],v[180:183],a[28:31],v[124:127]
s_waitcnt lgkmcnt(15)
M16 v[128:131],v[184:187],a[0:3],v[128:131]
DTR v[176:177],v196 offset:0
M16 v[128:131],v[188:191],a[16:19],v[128:131]
M16 v[132:135],v[184:187],a[4:7],v[132:135]
DTR v[178:179],v196 offset:1024
M16 v[132:135],v[188:191],a[20:23],v[132:135]
M16 v[136:139],v[184:187],a[8:11],v[136:139]
DTR v[180:181],v196 offset:8192
M16 v[136:139],v[188:191],a[24:27],v[136:139]
M16 v[140:143],v[184:187],a[12:15],v[140:143]
DTR v[182:183],v196 offset:9216
M16 v[140:143],v[188:191],a[28:31],v[140:143]
s_waitcnt lgkmcnt(15)
M16 v[16:19],v[144:147],a[32:35],v[16:19]
DTR v[184:185],v197 offset:0
s_add_u32 m0, s32, 4096
M16 v[16:19],v[148:151],a[48:51],v[16:19]
s_mov_b32 s33, 640
M16 v[20:23],v[144:147],a[36:39],v[20:23]
DTR v[186:187],v197 offset:1024
M16 v[20:23],v[148:151],a[52:55],v[20:23]
BL4 v200,s[12:15],s33 offen lds
M16 v[24:27],v[144:147],a[40:43],v[24:27]
DTR v[188:189],v197 offset:8192
M16 v[24:27],v[148:151],a[56:59],v[24:27]
BL4 v201,s[12:15],s33 offen offset:1024 lds
M16 v[28:31],v[144:147],a[44:47],v[28:31]
DTR v[190:191],v197 offset:9216
M16 v[28:31],v[148:151],a[60:63],v[28:31]
s_waitcnt lgkmcnt(15)
M16 v[32:35],v[152:155],a[32:35],v[32:35]
DTR v[144:145],v198 offset:0
M16 v[32:35],v[156:159],a[48:51],v[32:35]
BL4 v202,s[12:15],s33 offen offset:2048 lds
M16 v[36:39],v[152:155],a[36:39],v[36:39]
DTR v[146:147],v198 offset:1024
M16 v[36:39],v[156:159],a[52:55],v[36:39]
BL4 v203,s[12:15],s33 offen offset:3072 lds
M16 v[40:43],v[152:155],a[40:43],v[40:43]
DTR v[148:149],v198 offset:8192
s_waitcnt vmcnt(12)
M16 v[40:43],v[156:159],a[56:59],v[40:43]
DR a[0:3],v12 offset:8192
M16 v[44:47],v[152:155],a[44:47],v[44:47]
DTR v[150:151],v198 offset:9216
M16 v[44:47],v[156:159],a[60:63],v[44:47]
s_waitcnt lgkmcnt(15)
DR a[16:19],v13 offset:8192
M16 v[48:51],v[160:163],a[32:35],v[48:51]
DTR v[152:153],v199 offset:0
M16 v[48:51],v[164:167],a[48:51],v[48:51]
DR a[4:7],v12 offset:10240
M16 v[52:55],v[160:163],a[36:39],v[52:55]
DTR v[154:155],v199 offset:1024
M16 v[52:55],v[164:167],a[52:55],v[52:55]
DR a[20:23],v13 offset:10240
s_waitcnt vmcnt(8)
M16 v[56:59],v[160:163],a[40:43],v[56:59]
DTR v[156:157],v199 offset:8192
M16 v[56:59],v[164:167],a[56:59],v[56:59]
s_waitcnt lgkmcnt(15)
DR a[8:11],v12 offset:0
M16 v[60:63],v[160:163],a[44:47],v[60:63]
DTR v[158:159],v199 offset:9216
s_waitcnt vmcnt(4)
M16 v[60:63],v[164:167],a[60:63],v[60:63]
s_barrier
DR a[24:27],v13 offset:0
M16 v[64:67],v[168:171],a[32:35],v[64:67]
DTR v[160:161],v192 offset:16384
M16 v[64:67],v[172:175],a[48:51],v[64:67]
DR a[12:15],v12 offset:2048
M16 v[68:71],v[168:171],a[36:39],v[68:71]
DTR v[162:163],v192 offset:17408
M16 v[68:71],v[172:175],a[52:55],v[68:71]
DR a[28:31],v13 offset:2048
s_waitcnt lgkmcnt(8)
M16 v[72:75],v[168:171],a[40:43],v[72:75]
DTR v[164:165],v192 offset:24576
s_add_u32 m0, s32, 8192
M16 v[72:75],v[172:175],a[56:59],v[72:75]
M16 v[76:79],v[168:171],a[44:47],v[76:79]
DTR v[166:167],v192 offset:25600
M16 v[76:79],v[172:175],a[60:63],v[76:79]
M16 v[80:83],v[176:179],a[32:35],v[80:83]
DTR v[168:169],v193 offset:16384
M16 v[80:83],v[180:183],a[48:51],v[80:83]
BL4 v204,s[12:15],s33 offen lds
M16 v[84:87],v[176:179],a[36:39],v[84:87]
DTR v[170:171],v193 offset:17408
M16 v[84:87],v[180:183],a[52:55],v[84:87]
BL4 v205,s[12:15],s33 offen offset:1024 lds
M16 v[88:91],v[176:179],a[40:43],v[88:91]
DTR v[172:173],v193 offset:24576
M16 v[88:91],v[180:183],a[56:59],v[88:91]
BL4 v206,s[12:15],s33 offen offset:2048 lds
M16 v[92:95],v[176:179],a[44:47],v[92:95]
DTR v[174:175],v193 offset:25600
M16 v[92:95],v[180:183],a[60:63],v[92:95]
M16 v[96:99],v[184:187],a[32:35],v[96:99]
DTR v[176:177],v194 offset:16384
M16 v[96:99],v[188:191],a[48:51],v[96:99]
BL4 v207,s[12:15],s33 offen offset:3072 lds
M16 v[100:103],v[184:187],a[36:39],v[100:103]
DTR v[178:179],v194 offset:17408
s_add_u32 m0, s34, 98304
M16 v[100:103],v[188:191],a[52:55],v[100:103]
BL4 v208,s[8:11],s36 offen lds
M16 v[104:107],v[184:187],a[40:43],v[104:107]
DTR v[180:181],v194 offset:24576
M16 v[104:107],v[188:191],a[56:59],v[104:107]
BL4 v209,s[8:11],s36 offen offset:1024 lds
M16 v[108:111],v[184:187],a[44:47],v[108:111]
DTR v[182:183],v194 offset:25600
M16 v[108:111],v[188:191],a[60:63],v[108:111]
M16 v[112:115],v[144:147],a[32:35],v[112:115]
DTR v[184:185],v195 offset:16384
M16 v[112:115],v[148:151],a[48:51],v[112:115]
BL4 v210,s[8:11],s36 offen offset:2048 lds
M16 v[116:119],v[144:147],a[36:39],v[116:119]
DTR v[186:187],v195 offset:17408
M16 v[116:119],v[148:151],a[52:55],v[116:119]
BL4 v211,s[8:11],s36 offen offset:3072 lds
M16 v[120:123],v[144:147],a[40:43],v[120:123]
DTR v[188:189],v195 offset:24576
s_add_u32 s36, s36, s37
M16 v[120:123],v[148:151],a[56:59],v[120:123]
M16 v[124:127],v[144:147],a[44:47],v[124:127]
DTR v[190:191],v195 offset:25600
M16 v[124:127],v[148:151],a[60:63],v[124:127]
s_waitcnt lgkmcnt(15)
M16 v[128:131],v[152:155],a[32:35],v[128:131]
DTR v[144:145],v196 offset:16384
M16 v[128:131],v[156:159],a[48:51],v[128:131]
M16 v[132:135],v[152:155],a[36:39],v[132:135]
DTR v[146:147],v196 offset:17408
M16 v[132:135],v[156:159],a[52:55],v[132:135]
M16 v[136:139],v[152:155],a[40:43],v[136:139]
DTR v[148:149],v196 offset:24576
M16 v[136:139],v[156:159],a[56:59],v[136:139]
M16 v[140:143],v[152:155],a[44:47],v[140:143]
DTR v[150:151],v196 offset:25600
M16 v[140:143],v[156:159],a[60:63],v[140:143]
s_waitcnt lgkmcnt(15)
M16 v[16:19],v[160:163],a[0:3],v[16:19]
DTR v[152:153],v197 offset:16384
s_add_u32 m0, s32, 0
M16 v[16:19],v[164:167],a[16:19],v[16:19]
s_mov_b32 s33, 768
M16 v[20:23],v[160:163],a[4:7],v[20:23]
DTR v[154:155],v197 offset:17408
M16 v[20:23],v[164:167],a[20:23],v[20:23]
BL4 v200,s[12:15],s33 offen lds
M16 v[24:27],v[160:163],a[8:11],v[24:27]
DTR v[156:157],v197 offset:24576
M16 v[24:27],v[164:167],a[24:27],v[24:27]
BL4 v201,s[12:15],s33 offen offset:1024 lds
M16 v[28:31],v[160:163],a[12:15],v[28:31]
DTR v[158:159],v197 offset:25600
M16 v[28:31],v[164:167],a[28:31],v[28:31]
s_waitcnt lgkmcnt(15)
M16 v[32:35],v[168:171],a[0:3],v[32:35]
DTR v[160:161],v198 offset:16384
M16 v[32:35],v[172:175],a[16:19],v[32:35]
BL4 v202,s[12:15],s33 offen offset:2048 lds
M16 v[36:39],v[168:171],a[4:7],v[36:39]
DTR v[162:163],v198 offset:17408
M16 v[36:39],v[172:175],a[20:23],v[36:39]
BL4 v203,s[12:15],s33 offen offset:3072 lds
M16 v[40:43],v[168:171],a[8:11],v[40:43]
DTR v[164:165],v198 offset:24576
s_waitcnt vmcnt(12)
M16 v[40:43],v[172:175],a[24:27],v[40:43]
DR a[32:35],v12 offset:4096
M16 v[44:47],v[168:171],a[12:15],v[44:47]
DTR v[166:167],v198 offset:25600
M16 v[44:47],v[172:175],a[28:31],v[44:47]
s_waitcnt lgkmcnt(15)
DR a[48:51],v13 offset:4096
M16 v[48:51],v[176:179],a[0:3],v[48:51]
DTR v[168:169],v199 offset:16384
M16 v[48:51],v[180:183],a[16:19],v[48:51]
DR a[36:39],v12 offset:6144
M16 v[52:55],v[176:179],a[4:7],v[52:55]
DTR v[170:171],v199 offset:17408
M16 v[52:55],v[180:183],a[20:23],v[52:55]
DR a[52:55],v13 offset:6144
s_waitcnt vmcnt(8)
M16 v[56:59],v[176:179],a[8:11],v[56:59]
DTR v[172:173],v199 offset:24576
M16 v[56:59],v[180:183],a[24:27],v[56:59]
s_waitcnt lgkmcnt(15)
DR a[40:43],v12 offset:8192
M16 v[60:63],v[176:179],a[12:15],v[60:63]
DTR v[174:175],v199 offset:25600
s_waitcnt vmcnt(4)
M16 v[60:63],v[180:183],a[28:31],v[60:63]
s_barrier
DR a[56:59],v13 offset:8192
M16 v[64:67],v[184:187],a[0:3],v[64:67]
DTR v[176:177],v192 offset:32768
M16 v[64:67],v[188:191],a[16:19],v[64:67]
DR a[44:47],v12 offset:10240
M16 v[68:71],v[184:187],a[4:7],v[68:71]
DTR v[178:179],v192 offset:33792
M16 v[68:71],v[188:191],a[20:23],v[68:71]
DR a[60:63],v13 offset:10240
s_waitcnt lgkmcnt(8)
M16 v[72:75],v[184:187],a[8:11],v[72:75]
DTR v[180:181],v192 offset:40960
s_add_u32 m0, s32, 4096
M16 v[72:75],v[188:191],a[24:27],v[72:75]
M16 v[76:79],v[184:187],a[12:15],v[76:79]
DTR v[182:183],v192 offset:41984
M16 v[76:79],v[188:191],a[28:31],v[76:79]
M16 v[80:83],v[144:147],a[0:3],v[80:83]
DTR v[184:185],v193 offset:32768
M16 v[80:83],v[148:151],a[16:19],v[80:83]
BL4 v204,s[12:15],s33 offen lds
M16 v[84:87],v[144:147],a[4:7],v[84:87]
DTR v[186:187],v193 offset:33792
M16 v[84:87],v[148:151],a[20:23],v[84:87]
BL4 v205,s[12:15],s33 offen offset:1024 lds
M16 v[88:91],v[144:147],a[8:11],v[88:91]
DTR v[188:189],v193 offset:40960
M16 v[88:91],v[148:151],a[24:27],v[88:91]
BL4 v206,s[12:15],s33 offen offset:2048 lds
M16 v[92:95],v[144:147],a[12:15],v[92:95]
DTR v[190:191],v193 offset:41984
M16 v[92:95],v[148:151],a[28:31],v[92:95]
M16 v[96:99],v[152:155],a[0:3],v[96:99]
DTR v[144:145],v194 offset:32768
M16 v[96:99],v[156:159],a[16:19],v[96:99]
BL4 v207,s[12:15],s33 offen offset:3072 lds
M16 v[100:103],v[152:155],a[4:7],v[100:103]
DTR v[146:147],v194 offset:33792
s_add_u32 m0, s34, 65536
M16 v[100:103],v[156:159],a[20:23],v[100:103]
BL4 v208,s[8:11],s36 offen lds
M16 v[104:107],v[152:155],a[8:11],v[104:107]
DTR v[148:149],v194 offset:40960
M16 v[104:107],v[156:159],a[24:27],v[104:107]
BL4 v209,s[8:11],s36 offen offset:1024 lds
M16 v[108:111],v[152:155],a[12:15],v[108:111]
DTR v[150:151],v194 offset:41984
M16 v[108:111],v[156:159],a[28:31],v[108:111]
M16 v[112:115],v[160:163],a[0:3],v[112:115]
DTR v[152:153],v195 offset:32768
M16 v[112:115],v[164:167],a[16:19],v[112:115]
BL4 v210,s[8:11],s36 offen offset:2048 lds
M16 v[116:119],v[160:163],a[4:7],v[116:119]
DTR v[154:155],v195 offset:33792
M16 v[116:119],v[164:167],a[20:23],v[116:119]
BL4 v211,s[8:11],s36 offen offset:3072 lds
M16 v[120:123],v[160:163],a[8:11],v[120:123]
DTR v[156:157],v195 offset:40960
s_add_u32 s36, s36, s37
M16 v[120:123],v[164:167],a[24:27],v[120:123]
M16 v[124:127],v[160:163],a[12:15],v[124:127]
DTR v[158:159],v195 offset:41984
M16 v[124:127],v[164:167],a[28:31],v[124:127]
s_waitcnt lgkmcnt(15)
M16 v[128:131],v[168:171],a[0:3],v[128:131]
DTR v[160:161],v196 offset:32768
M16 v[128:131],v[172:175],a[16:19],v[128:131]
M16 v[132:135],v[168:171],a[4:7],v[132:135]
DTR v[162:163],v196 offset:33792
M16 v[132:135],v[172:175],a[20:23],v[132:135]
M16 v[136:139],v[168:171],a[8:11],v[136:139]
DTR v[164:165],v196 offset:40960
M16 v[136:139],v[172:175],a[24:27],v[136:139]
M16 v[140:143],v[168:171],a[12:15],v[140:143]
DTR v[166:167],v196 offset:41984
M16 v[140:143],v[172:175],a[28:31],v[140:143]
s_waitcnt lgkmcnt(15)
M16 v[16:19],v[176:179],a[32:35],v[16:19]
DTR v[168:169],v197 offset:32768
s_add_u32 m0, s32, 8192
M16 v[16:19],v[180:183],a[48:51],v[16:19]
s_mov_b32 s33, 896
M16 v[20:23],v[176:179],a[36:39],v[20:23]
DTR v[170:171],v197 offset:33792
M16 v[20:23],v[180:183],a[52:55],v[20:23]
BL4 v200,s[12:15],s33 offen lds
M16 v[24:27],v[176:179],a[40:43],v[24:27]
DTR v[172:173],v197 offset:40960
M16 v[24:27],v[180:183],a[56:59],v[24:27]
BL4 v201,s[12:15],s33 offen offset:1024 lds
M16 v[28:31],v[176:179],a[44:47],v[28:31]
DTR v[174:175],v197 offset:41984
M16 v[28:31],v[180:183],a[60:63],v[28:31]
s_waitcnt lgkmcnt(15)
M16 v[32:35],v[184:187],a[32:35],v[32:35]
DTR v[176:177],v198 offset:32768
M16 v[32:35],v[188:191],a[48:51],v[32:35]
BL4 v202,s[12:15],s33 offen offset:2048 lds
M16 v[36:39],v[184:187],a[36:39],v[36:39]
DTR v[178:179],v198 offset:33792
M16 v[36:39],v[188:191],a[52:55],v[36:39]
BL4 v203,s[12:15],s33 offen offset:3072 lds
M16 v[40:43],v[184:187],a[40:43],v[40:43]
DTR v[180:181],v198 offset:40960
s_waitcnt vmcnt(12)
M16 v[40:43],v[188:191],a[56:59],v[40:43]
DR a[0:3],v12 offset:0
M16 v[44:47],v[184:187],a[44:47],v[44:47]
DTR v[182:183],v198 offset:41984
M16 v[44:47],v[188:191],a[60:63],v[44:47]
s_waitcnt lgkmcnt(15)
DR a[16:19],v13 offset:0
M16 v[48:51],v[144:147],a[32:35],v[48:51]
DTR v[184:185],v199 offset:32768
M16 v[48:51],v[148:151],a[48:51],v[48:51]
DR a[4:7],v12 offset:2048
M16 v[52:55],v[144:147],a[36:39],v[52:55]
DTR v[186:187],v199 offset:33792
M16 v[52:55],v[148:151],a[52:55],v[52:55]
DR a[20:23],v13 offset:2048
s_waitcnt vmcnt(8)
M16 v[56:59],v[144:147],a[40:43],v[56:59]
DTR v[188:189],v199 offset:40960
M16 v[56:59],v[148:151],a[56:59],v[56:59]
s_waitcnt lgkmcnt(15)
DR a[8:11],v12 offset:4096
M16 v[60:63],v[144:147],a[44:47],v[60:63]
DTR v[190:191],v199 offset:41984
s_waitcnt vmcnt(4)
M16 v[60:63],v[148:151],a[60:63],v[60:63]
s_barrier
DR a[24:27],v13 offset:4096
M16 v[64:67],v[152:155],a[32:35],v[64:67]
DTR v[144:145],v192 offset:0
M16 v[64:67],v[156:159],a[48:51],v[64:67]
DR a[12:15],v12 offset:6144
M16 v[68:71],v[152:155],a[36:39],v[68:71]
DTR v[146:147],v192 offset:1024
M16 v[68:71],v[156:159],a[52:55],v[68:71]
DR a[28:31],v13 offset:6144
s_waitcnt lgkmcnt(8)
M16 v[72:75],v[152:155],a[40:43],v[72:75]
DTR v[148:149],v192 offset:8192
s_add_u32 m0, s32, 0
M16 v[72:75],v[156:159],a[56:59],v[72:75]
M16 v[76:79],v[152:155],a[44:47],v[76:79]
DTR v[150:151],v192 offset:9216
M16 v[76:79],v[156:159],a[60:63],v[76:79]
M16 v[80:83],v[160:163],a[32:35],v[80:83]
DTR v[152:153],v193 offset:0
M16 v[80:83],v[164:167],a[48:51],v[80:83]
BL4 v204,s[12:15],s33 offen lds
M16 v[84:87],v[160:163],a[36:39],v[84:87]
DTR v[154:155],v193 offset:1024
M16 v[84:87],v[164:167],a[52:55],v[84:87]
BL4 v205,s[12:15],s33 offen offset:1024 lds
M16 v[88:91],v[160:163],a[40:43],v[88:91]
DTR v[156:157],v193 offset:8192
M16 v[88:91],v[164:167],a[56:59],v[88:91]
BL4 v206,s[12:15],s33 offen offset:2048 lds
M16 v[92:95],v[160:163],a[44:47],v[92:95]
DTR v[158:159],v193 offset:9216
M16 v[92:95],v[164:167],a[60:63],v[92:95]
M16 v[96:99],v[168:171],a[32:35],v[96:99]
DTR v[160:161],v194 offset:0
M16 v[96:99],v[172:175],a[48:51],v[96:99]
BL4 v207,s[12:15],s33 offen offset:3072 lds
M16 v[100:103],v[168:171],a[36:39],v[100:103]
DTR v[162:163],v194 offset:1024
s_add_u32 m0, s34, 81920
M16 v[100:103],v[172:175],a[52:55],v[100:103]
BL4 v208,s[8:11],s36 offen lds
M16 v[104:107],v[168:171],a[40:43],v[104:107]
DTR v[164:165],v194 offset:8192
M16 v[104:107],v[172:175],a[56:59],v[104:107]
BL4 v209,s[8:11],s36 offen offset:1024 lds
M16 v[108:111],v[168:171],a[44:47],v[108:111]
DTR v[166:167],v194 offset:9216
M16 v[108:111],v[172:175],a[60:63],v[108:111]
M16 v[112:115],v[176:179],a[32:35],v[112:115]
DTR v[168:169],v195 offset:0
M16 v[112:115],v[180:183],a[48:51],v[112:115]
BL4 v210,s[8:11],s36 offen offset:2048 lds
M16 v[116:119],v[176:179],a[36:39],v[116:119]
DTR v[170:171],v195 offset:1024
M16 v[116:119],v[180:183],a[52:55],v[116:119]
BL4 v211,s[8:11],s36 offen offset:3072 lds
M16 v[120:123],v[176:179],a[40:43],v[120:123]
DTR v[172:173],v195 offset:8192
s_add_u32 s36, s36, s37
M16 v[120:123],v[180:183],a[56:59],v[120:123]
M16 v[124:127],v[176:179],a[44:47],v[124:127]
DTR v[174:175],v195 offset:9216
M16 v[124:127],v[180:183],a[60:63],v[124:127]
s_waitcnt lgkmcnt(15)
M16 v[128:131],v[184:187],a[32:35],v[128:131]
DTR v[176:177],v196 offset:0
M16 v[128:131],v[188:191],a[48:51],v[128:131]
M16 v[132:135],v[184:187],a[36:39],v[132:135]
DTR v[178:179],v196 offset:1024
M16 v[132:135],v[188:191],a[52:55],v[132:135]
M16 v[136:139],v[184:187],a[40:43],v[136:139]
DTR v[180:181],v196 offset:8192
M16 v[136:139],v[188:191],a[56:59],v[136:139]
M16 v[140:143],v[184:187],a[44:47],v[140:143]
DTR v[182:183],v196 offset:9216
M16 v[140:143],v[188:191],a[60:63],v[140:143]
s_waitcnt lgkmcnt(15)
M16 v[16:19],v[144:147],a[0:3],v[16:19]
DTR v[184:185],v197 offset:0
s_add_u32 m0, s32, 4096
M16 v[16:19],v[148:151],a[16:19],v[16:19]
s_mov_b32 s33, 1024
M16 v[20:23],v[144:147],a[4:7],v[20:23]
DTR v[186:187],v197 offset:1024
M16 v[20:23],v[148:151],a[20:23],v[20:23]
BL4 v200,s[12:15],s33 offen lds
M16 v[24:27],v[144:147],a[8:11],v[24:27]
DTR v[188:189],v197 offset:8192
M16 v[24:27],v[148:151],a[24:27],v[24:27]
BL4 v201,s[12:15],s33 offen offset:1024 lds
M16 v[28:31],v[144:147],a[12:15],v[28:31]
DTR v[190:191],v197 offset:9216
M16 v[28:31],v[148:151],a[28:31],v[28:31]
s_waitcnt lgkmcnt(15)
M16 v[32:35],v[152:155],a[0:3],v[32:35]
DTR v[144:145],v198 offset:0
M16 v[32:35],v[156:159],a[16:19],v[32:35]
BL4 v202,s[12:15],s33 offen offset:2048 lds
M16 v[36:39],v[152:155],a[4:7],v[36:39]
DTR v[146:147],v198 offset:1024
M16 v[36:39],v[156:159],a[20:23],v[36:39]
BL4 v203,s[12:15],s33 offen offset:3072 lds
M16 v[40:43],v[152:155],a[8:11],v[40:43]
DTR v[148:149],v198 offset:8192
s_waitcnt vmcnt(12)
M16 v[40:43],v[156:159],a[24:27],v[40:43]
DR a[32:35],v12 offset:8192
M16 v[44:47],v[152:155],a[12:15],v[44:47]
DTR v[150:151],v198 offset:9216
M16 v[44:47],v[156:159],a[28:31],v[44:47]
s_waitcnt lgkmcnt(15)
DR a[48:51],v13 offset:8192
M16 v[48:51],v[160:163],a[0:3],v[48:51]
DTR v[152:153],v199 offset:0
M16 v[48:51],v[164:167],a[16:19],v[48:51]
DR a[36:39],v12 offset:10240
M16 v[52:55],v[160:163],a[4:7],v[52:55]
DTR v[154:155],v199 offset:1024
M16 v[52:55],v[164:167],a[20:23],v[52:55]
DR a[52:55],v13 offset:10240
s_waitcnt vmcnt(8)
M16 v[56:59],v[160:163],a[8:11],v[56:59]
DTR v[156:157],v199 offset:8192
M16 v[56:59],v[164:167],a[24:27],v[56:59]
s_waitcnt lgkmcnt(15)
DR a[40:43],v12 offset:0
M16 v[60:63],v[160:163],a[12:15],v[60:63]
DTR v[158:159],v199 offset:9216
s_waitcnt vmcnt(4)
M16 v[60:63],v[164:167],a[28:31],v[60:63]
s_barrier
DR a[56:59],v13 offset:0
M16 v[64:67],v[168:171],a[0:3],v[64:67]
DTR v[160:161],v192 offset:16384
M16 v[64:67],v[172:175],a[16:19],v[64:67]
DR a[44:47],v12 offset:2048
M16 v[68:71],v[168:171],a[4:7],v[68:71]
DTR v[162:163],v192 offset:17408
M16 v[68:71],v[172:175],a[20:23],v[68:71]
DR a[60:63],v13 offset:2048
s_waitcnt lgkmcnt(8)
M16 v[72:75],v[168:171],a[8:11],v[72:75]
DTR v[164:165],v192 offset:24576
s_add_u32 m0, s32, 8192
M16 v[72:75],v[172:175],a[24:27],v[72:75]
M16 v[76:79],v[168:171],a[12:15],v[76:79]
DTR v[166:167],v192 offset:25600
M16 v[76:79],v[172:175],a[28:31],v[76:79]
M16 v[80:83],v[176:179],a[0:3],v[80:83]
DTR v[168:169],v193 offset:16384
M16 v[80:83],v[180:183],a[16:19],v[80:83]
BL4 v204,s[12:15],s33 offen lds
M16 v[84:87],v[176:179],a[4:7],v[84:87]
DTR v[170:171],v193 offset:17408
M16 v[84:87],v[180:183],a[20:23],v[84:87]
BL4 v205,s[12:15],s33 offen offset:1024 lds
M16 v[88:91],v[176:179],a[8:11],v[88:91]
DTR v[172:173],v193 offset:24576
M16 v[88:91],v[180:183],a[24:27],v[88:91]
BL4 v206,s[12:15],s33 offen offset:2048 lds
M16 v[92:95],v[176:179],a[12:15],v[92:95]
DTR v[174:175],v193 offset:25600
M16 v[92:95],v[180:183],a[28:31],v[92:95]
M16 v[96:99],v[184:187],a[0:3],v[96:99]
DTR v[176:177],v194 offset:16384
M16 v[96:99],v[188:191],a[16:19],v[96:99]
BL4 v207,s[12:15],s33 offen offset:3072 lds
M16 v[100:103],v[184:187],a[4:7],v[100:103]
DTR v[178:179],v194 offset:17408
s_add_u32 m0, s34, 98304
M16 v[100:103],v[188:191],a[20:23],v[100:103]
BL4 v208,s[8:11],s36 offen lds
M16 v[104:107],v[184:187],a[8:11],v[104:107]
DTR v[180:181],v194 offset:24576
M16 v[104:107],v[188:191],a[24:27],v[104:107]
BL4 v209,s[8:11],s36 offen offset:1024 lds
M16 v[108:111],v[184:187],a[12:15],v[108:111]
DTR v[182:183],v194 offset:25600
M16 v[108:111],v[188:191],a[28:31],v[108:111]
M16 v[112:115],v[144:147],a[0:3],v[112:115]
DTR v[184:185],v195 offset:16384
M16 v[112:115],v[148:151],a[16:19],v[112:115]
BL4 v210,s[8:11],s36 offen offset:2048 lds
M16 v[116:119],v[144:147],a[4:7],v[116:119]
DTR v[186:187],v195 offset:17408
M16 v[116:119],v[148:151],a[20:23],v[116:119]
BL4 v211,s[8:11],s36 offen offset:3072 lds
M16 v[120:123],v[144:147],a[8:11],v[120:123]
DTR v[188:189],v195 offset:24576
s_add_u32 s36, s36, s37
M16 v[120:123],v[148:151],a[24:27],v[120:123]
M16 v[124:127],v[144:147],a[12:15],v[124:127]
DTR v[190:191],v195 offset:25600
M16 v[124:127],v[148:151],a[28:31],v[124:127]
s_waitcnt lgkmcnt(15)
M16 v[128:131],v[152:155],a[0:3],v[128:131]
DTR v[144:145],v196 offset:16384
M16 v[128:131],v[156:159],a[16:19],v[128:131]
M16 v[132:135],v[152:155],a[4:7],v[132:135]
DTR v[146:147],v196 offset:17408
M16 v[132:135],v[156:159],a[20:23],v[132:135]
M16 v[136:139],v[152:155],a[8:11],v[136:139]
DTR v[148:149],v196 offset:24576
M16 v[136:139],v[156:159],a[24:27],v[136:139]
M16 v[140:143],v[152:155],a[12:15],v[140:143]
DTR v[150:151],v196 offset:25600
M16 v[140:143],v[156:159],a[28:31],v[140:143]
s_waitcnt lgkmcnt(15)
M16 v[16:19],v[160:163],a[32:35],v[16:19]
DTR v[152:153],v197 offset:16384
s_add_u32 m0, s32, 0
M16 v[16:19],v[164:167],a[48:51],v[16:19]
s_mov_b32 s33, 1152
M16 v[20:23],v[160:163],a[36:39],v[20:23]
DTR v[154:155],v197 offset:17408
M16 v[20:23],v[164:167],a[52:55],v[20:23]
BL4 v200,s[12:15],s33 offen lds
M16 v[24:27],v[160:163],a[40:43],v[24:27]
DTR v[156:157],v197 offset:24576
M16 v[24:27],v[164:167],a[56:59],v[24:27]
BL4 v201,s[12:15],s33 offen offset:1024 lds
M16 v[28:31],v[160:163],a[44:47],v[28:31]
DTR v[158:159],v197 offset:25600
M16 v[28:31],v[164:167],a[60:63],v[28:31]
s_waitcnt lgkmcnt(15)
M16 v[32:35],v[168:171],a[32:35],v[32:35]
DTR v[160:161],v198 offset:16384
M16 v[32:35],v[172:175],a[48:51],v[32:35]
BL4 v202,s[12:15],s33 offen offset:2048 lds
M16 v[36:39],v[168:171],a[36:39],v[36:39]
DTR v[162:163],v198 offset:17408
M16 v[36:39],v[172:175],a[52:55],v[36:39]
BL4 v203,s[12:15],s33 offen offset:3072 lds
M16 v[40:43],v[168:171],a[40:43],v[40:43]
DTR v[164:165],v198 offset:24576
s_waitcnt vmcnt(12)
M16 v[40:43],v[172:175],a[56:59],v[40:43]
DR a[0:3],v12 offset:4096
M16 v[44:47],v[168:171],a[44:47],v[44:47]
DTR v[166:167],v198 offset:25600
M16 v[44:47],v[172:175],a[60:63],v[44:47]
s_waitcnt lgkmcnt(15)
DR a[16:19],v13 offset:4096
M16 v[48:51],v[176:179],a[32:35],v[48:51]
DTR v[168:169],v199 offset:16384
M16 v[48:51],v[180:183],a[48:51],v[48:51]
DR a[4:7],v12 offset:6144
M16 v[52:55],v[176:179],a[36:39],v[52:55]
DTR v[170:171],v199 offset:17408
M16 v[52:55],v[180:183],a[52:55],v[52:55]
DR a[20:23],v13 offset:6144
s_waitcnt vmcnt(8)
M16 v[56:59],v[176:179],a[40:43],v[56:59]
DTR v[172:173],v199 offset:24576
M16 v[56:59],v[180:183],a[56:59],v[56:59]
s_waitcnt lgkmcnt(15)
DR a[8:11],v12 offset:8192
M16 v[60:63],v[176:179],a[44:47],v[60:63]
DTR v[174:175],v199 offset:25600
s_waitcnt vmcnt(4)
M16 v[60:63],v[180:183],a[60:63],v[60:63]
s_barrier
DR a[24:27],v13 offset:8192
M16 v[64:67],v[184:187],a[32:35],v[64:67]
DTR v[176:177],v192 offset:32768
M16 v[64:67],v[188:191],a[48:51],v[64:67]
DR a[12:15],v12 offset:10240
M16 v[68:71],v[184:187],a[36:39],v[68:71]
DTR v[178:179],v192 offset:33792
M16 v[68:71],v[188:191],a[52:55],v[68:71]
DR a[28:31],v13 offset:10240
s_waitcnt lgkmcnt(8)
M16 v[72:75],v[184:187],a[40:43],v[72:75]
DTR v[180:181],v192 offset:40960
s_add_u32 m0, s32, 4096
M16 v[72:75],v[188:191],a[56:59],v[72:75]
M16 v[76:79],v[184:187],a[44:47],v[76:79]
DTR v[182:183],v192 offset:41984
M16 v[76:79],v[188:191],a[60:63],v[76:79]
M16 v[80:83],v[144:147],a[32:35],v[80:83]
DTR v[184:185],v193 offset:32768
M16 v[80:83],v[148:151],a[48:51],v[80:83]
BL4 v204,s[12:15],s33 offen lds
M16 v[84:87],v[144:147],a[36:39],v[84:87]
DTR v[186:187],v193 offset:33792
M16 v[84:87],v[148:151],a[52:55],v[84:87]
BL4 v205,s[12:15],s33 offen offset:1024 lds
M16 v[88:91],v[144:147],a[40:43],v[88:91]
DTR v[188:189],v193 offset:40960
M16 v[88:91],v[148:151],a[56:59],v[88:91]
BL4 v206,s[12:15],s33 offen offset:2048 lds
M16 v[92:95],v[144:147],a[44:47],v[92:95]
DTR v[190:191],v193 offset:41984
M16 v[92:95],v[148:151],a[60:63],v[92:95]
M16 v[96:99],v[152:155],a[32:35],v[96:99]
DTR v[144:145],v194 offset:32768
M16 v[96:99],v[156:159],a[48:51],v[96:99]
BL4 v207,s[12:15],s33 offen offset:3072 lds
M16 v[100:103],v[152:155],a[36:39],v[100:103]
DTR v[146:147],v194 offset:33792
s_add_u32 m0, s34, 65536
M16 v[100:103],v[156:159],a[52:55],v[100:103]
BL4 v208,s[8:11],s36 offen lds
M16 v[104:107],v[152:155],a[40:43],v[104:107]
DTR v[148:149],v194 offset:40960
M16 v[104:107],v[156:159],a[56:59],v[104:107]
BL4 v209,s[8:11],s36 offen offset:1024 lds
M16 v[108:111],v[152:155],a[44:47],v[108:111]
DTR v[150:151],v194 offset:41984
M16 v[108:111],v[156:159],a[60:63],v[108:111]
M16 v[112:115],v[160:163],a[32:35],v[112:115]
DTR v[152:153],v195 offset:32768
M16 v[112:115],v[164:167],a[48:51],v[112:115]
BL4 v210,s[8:11],s36 offen offset:2048 lds
M16 v[116:119],v[160:163],a[36:39],v[116:119]
DTR v[154:155],v195 offset:33792
M16 v[116:119],v[164:167],a[52:55],v[116:119]
BL4 v211,s[8:11],s36 offen offset:3072 lds
M16 v[120:123],v[160:163],a[40:43],v[120:123]
DTR v[156:157],v195 offset:40960
s_add_u32 s36, s36, s37
M16 v[120:123],v[164:167],a[56:59],v[120:123]
M16 v[124:127],v[160:163],a[44:47],v[124:127]
DTR v[158:159],v195 offset:41984
M16 v[124:127],v[164:167],a[60:63],v[124:127]
s_waitcnt lgkmcnt(15)
M16 v[128:131],v[168:171],a[32:35],v[128:131]
DTR v[160:161],v196 offset:32768
M16 v[128:131],v[172:175],a[48:51],v[128:131]
M16 v[132:135],v[168:171],a[36:39],v[132:135]
DTR v[162:163],v196 offset:33792
M16 v[132:135],v[172:175],a[52:55],v[132:135]
M16 v[136:139],v[168:171],a[40:43],v[136:139]
DTR v[164:165],v196 offset:40960
M16 v[136:139],v[172:175],a[56:59],v[136:139]
M16 v[140:143],v[168:171],a[44:47],v[140:143]
DTR v[166:167],v196 offset:41984
M16 v[140:143],v[172:175],a[60:63],v[140:143]
s_waitcnt lgkmcnt(15)
M16 v[16:19],v[176:179],a[0:3],v[16:19]
DTR v[168:169],v197 offset:32768
s_waitcnt vmcnt(8)
M16 v[16:19],v[180:183],a[16:19],v[16:19]
DR a[32:35],v12 offset:0
M16 v[20:23],v[176:179],a[4:7],v[20:23]
DTR v[170:171],v197 offset:33792
M16 v[20:23],v[180:183],a[20:23],v[20:23]
DR a[48:51],v13 offset:0
M16 v[24:27],v[176:179],a[8:11],v[24:27]
DTR v[172:173],v197 offset:40960
M16 v[24:27],v[180:183],a[24:27],v[24:27]
DR a[36:39],v12 offset:2048
M16 v[28:31],v[176:179],a[12:15],v[28:31]
DTR v[174:175],v197 offset:41984
M16 v[28:31],v[180:183],a[28:31],v[28:31]
s_waitcnt lgkmcnt(15)
DR a[52:55],v13 offset:2048
M16 v[32:35],v[184:187],a[0:3],v[32:35]
DTR v[176:177],v198 offset:32768
M16 v[32:35],v[188:191],a[16:19],v[32:35]
M16 v[36:39],v[184:187],a[4:7],v[36:39]
DTR v[178:179],v198 offset:33792
M16 v[36:39],v[188:191],a[20:23],v[36:39]
M16 v[40:43],v[184:187],a[8:11],v[40:43]
DTR v[180:181],v198 offset:40960
M16 v[40:43],v[188:191],a[24:27],v[40:43]
M16 v[44:47],v[184:187],a[12:15],v[44:47]
DTR v[182:183],v198 offset:41984
M16 v[44:47],v[188:191],a[28:31],v[44:47]
M16 v[48:51],v[144:147],a[0:3],v[48:51]
DTR v[184:185],v199 offset:32768
M16 v[48:51],v[148:151],a[16:19],v[48:51]
M16 v[52:55],v[144:147],a[4:7],v[52:55]
DTR v[186:187],v199 offset:33792
s_waitcnt vmcnt(4)
M16 v[52:55],v[148:151],a[20:23],v[52:55]
DR a[40:43],v12 offset:4096
M16 v[56:59],v[144:147],a[8:11],v[56:59]
DTR v[188:189],v199 offset:40960
M16 v[56:59],v[148:151],a[24:27],v[56:59]
s_waitcnt lgkmcnt(15)
DR a[56:59],v13 offset:4096
M16 v[60:63],v[144:147],a[12:15],v[60:63]
DTR v[190:191],v199 offset:41984
s_waitcnt vmcnt(0)
M16 v[60:63],v[148:151],a[28:31],v[60:63]
s_barrier
DR a[44:47],v12 offset:6144
M16 v[64:67],v[152:155],a[0:3],v[64:67]
DTR v[144:145],v192 offset:0
M16 v[64:67],v[156:159],a[16:19],v[64:67]
DR a[60:63],v13 offset:6144
s_waitcnt lgkmcnt(13)
M16 v[68:71],v[152:155],a[4:7],v[68:71]
DTR v[146:147],v192 offset:1024
M16 v[68:71],v[156:159],a[20:23],v[68:71]
M16 v[72:75],v[152:155],a[8:11],v[72:75]
DTR v[148:149],v192 offset:8192
M16 v[72:75],v[156:159],a[24:27],v[72:75]
M16 v[76:79],v[152:155],a[12:15],v[76:79]
DTR v[150:151],v192 offset:9216
M16 v[76:79],v[156:159],a[28:31],v[76:79]
M16 v[80:83],v[160:163],a[0:3],v[80:83]
DTR v[152:153],v193 offset:0
M16 v[80:83],v[164:167],a[16:19],v[80:83]
M16 v[84:87],v[160:163],a[4:7],v[84:87]
DTR v[154:155],v193 offset:1024
M16 v[84:87],v[164:167],a[20:23],v[84:87]
M16 v[88:91],v[160:163],a[8:11],v[88:91]
DTR v[156:157],v193 offset:8192
M16 v[88:91],v[164:167],a[24:27],v[88:91]
M16 v[92:95],v[160:163],a[12:15],v[92:95]
DTR v[158:159],v193 offset:9216
M16 v[92:95],v[164:167],a[28:31],v[92:95]
M16 v[96:99],v[168:171],a[0:3],v[96:99]
DTR v[160:161],v194 offset:0
M16 v[96:99],v[172:175],a[16:19],v[96:99]
M16 v[100:103],v[168:171],a[4:7],v[100:103]
DTR v[162:163],v194 offset:1024
M16 v[100:103],v[172:175],a[20:23],v[100:103]
M16 v[104:107],v[168:171],a[8:11],v[104:107]
DTR v[164:165],v194 offset:8192
M16 v[104:107],v[172:175],a[24:27],v[104:107]
M16 v[108:111],v[168:171],a[12:15],v[108:111]
DTR v[166:167],v194 offset:9216
M16 v[108:111],v[172:175],a[28:31],v[108:111]
s_waitcnt lgkmcnt(15)
M16 v[112:115],v[176:179],a[0:3],v[112:115]
DTR v[168:169],v195 offset:0
M16 v[112:115],v[180:183],a[16:19],v[112:115]
M16 v[116:119],v[176:179],a[4:7],v[116:119]
DTR v[170:171],v195 offset:1024
M16 v[116:119],v[180:183],a[20:23],v[116:119]
M16 v[120:123],v[176:179],a[8:11],v[120:123]
DTR v[172:173],v195 offset:8192
M16 v[120:123],v[180:183],a[24:27],v[120:123]
M16 v[124:127],v[176:179],a[12:15],v[124:127]
DTR v[174:175],v195 offset:9216
M16 v[124:127],v[180:183],a[28:31],v[124:127]
s_waitcnt lgkmcnt(15)
M16 v[128:131],v[184:187],a[0:3],v[128:131]
DTR v[176:177],v196 offset:0
M16 v[128:131],v[188:191],a[16:19],v[128:131]
M16 v[132:135],v[184:187],a[4:7],v[132:135]
DTR v[178:179],v196 offset:1024
M16 v[132:135],v[188:191],a[20:23],v[132:135]
M16 v[136:139],v[184:187],a[8:11],v[136:139]
DTR v[180:181],v196 offset:8192
M16 v[136:139],v[188:191],a[24:27],v[136:139]
M16 v[140:143],v[184:187],a[12:15],v[140:143]
DTR v[182:183],v196 offset:9216
M16 v[140:143],v[188:191],a[28:31],v[140:143]
s_waitcnt lgkmcnt(15)
M16 v[16:19],v[144:147],a[32:35],v[16:19]
DTR v[184:185],v197 offset:0
M16 v[16:19],v[148:151],a[48:51],v[16:19]
M16 v[20:23],v[144:147],a[36:39],v[20:23]
DTR v[186:187],v197 offset:1024
M16 v[20:23],v[148:151],a[52:55],v[20:23]
M16 v[24:27],v[144:147],a[40:43],v[24:27]
DTR v[188:189],v197 offset:8192
M16 v[24:27],v[148:151],a[56:59],v[24:27]
M16 v[28:31],v[144:147],a[44:47],v[28:31]
DTR v[190:191],v197 offset:9216
M16 v[28:31],v[148:151],a[60:63],v[28:31]
s_waitcnt lgkmcnt(15)
M16 v[32:35],v[152:155],a[32:35],v[32:35]
DTR v[144:145],v198 offset:0
M16 v[32:35],v[156:159],a[48:51],v[32:35]
v_mul_f32 v16, s30, v16
v_mul_f32 v17, s30, v17
M16 v[36:39],v[152:155],a[36:39],v[36:39]
DTR v[146:147],v198 offset:1024
v_mul_f32 v18, s30, v18
M16 v[36:39],v[156:159],a[52:55],v[36:39]
v_mul_f32 v19, s30, v19
CVT v16,v16,v17
M16 v[40:43],v[152:155],a[40:43],v[40:43]
DTR v[148:149],v198 offset:8192
CVT v17,v18,v19
M16 v[40:43],v[156:159],a[56:59],v[40:43]
v_mul_f32 v20, s30, v20
v_mul_f32 v21, s30, v21
M16 v[44:47],v[152:155],a[44:47],v[44:47]
DTR v[150:151],v198 offset:9216
v_mul_f32 v22, s30, v22
M16 v[44:47],v[156:159],a[60:63],v[44:47]
s_waitcnt lgkmcnt(15)
v_mul_f32 v23, s30, v23
CVT v20,v20,v21
M16 v[48:51],v[160:163],a[32:35],v[48:51]
DTR v[152:153],v199 offset:0
CVT v21,v22,v23
M16 v[48:51],v[164:167],a[48:51],v[48:51]
v_mul_f32 v24, s30, v24
v_mul_f32 v25, s30, v25
M16 v[52:55],v[160:163],a[36:39],v[52:55]
DTR v[154:155],v199 offset:1024
v_mul_f32 v26, s30, v26
M16 v[52:55],v[164:167],a[52:55],v[52:55]
v_mul_f32 v27, s30, v27
CVT v24,v24,v25
M16 v[56:59],v[160:163],a[40:43],v[56:59]
DTR v[156:157],v199 offset:8192
CVT v25,v26,v27
M16 v[56:59],v[164:167],a[56:59],v[56:59]
s_waitcnt lgkmcnt(15)
v_mul_f32 v28, s30, v28
v_mul_f32 v29, s30, v29
M16 v[60:63],v[160:163],a[44:47],v[60:63]
DTR v[158:159],v199 offset:9216
v_mul_f32 v30, s30, v30
M16 v[60:63],v[164:167],a[60:63],v[60:63]
v_mul_f32 v31, s30, v31
CVT v28,v28,v29
M16 v[64:67],v[168:171],a[32:35],v[64:67]
CVT v29,v30,v31
v_mul_f32 v32, s30, v32
M16 v[64:67],v[172:175],a[48:51],v[64:67]
v_mul_f32 v33, s30, v33
v_mul_f32 v34, s30, v34
M16 v[68:71],v[168:171],a[36:39],v[68:71]
v_mul_f32 v35, s30, v35
CVT v32,v32,v33
M16 v[68:71],v[172:175],a[52:55],v[68:71]
CVT v33,v34,v35
v_mul_f32 v36, s30, v36
M16 v[72:75],v[168:171],a[40:43],v[72:75]
v_mul_f32 v37, s30, v37
v_mul_f32 v38, s30, v38
M16 v[72:75],v[172:175],a[56:59],v[72:75]
v_mul_f32 v39, s30, v39
CVT v36,v36,v37
M16 v[76:79],v[168:171],a[44:47],v[76:79]
CVT v37,v38,v39
v_mul_f32 v40, s30, v40
M16 v[76:79],v[172:175],a[60:63],v[76:79]
s_waitcnt lgkmcnt(12)
v_mul_f32 v41, s30, v41
v_mul_f32 v42, s30, v42
M16 v[80:83],v[176:179],a[32:35],v[80:83]
v_mul_f32 v43, s30, v43
CVT v40,v40,v41
M16 v[80:83],v[180:183],a[48:51],v[80:83]
CVT v41,v42,v43
v_mul_f32 v44, s30, v44
M16 v[84:87],v[176:179],a[36:39],v[84:87]
v_mul_f32 v45, s30, v45
v_mul_f32 v46, s30, v46
M16 v[84:87],v[180:183],a[52:55],v[84:87]
v_mul_f32 v47, s30, v47
CVT v44,v44,v45
M16 v[88:91],v[176:179],a[40:43],v[88:91]
CVT v45,v46,v47
v_mul_f32 v48, s30, v48
M16 v[88:91],v[180:183],a[56:59],v[88:91]
v_mul_f32 v49, s30, v49
v_mul_f32 v50, s30, v50
M16 v[92:95],v[176:179],a[44:47],v[92:95]
v_mul_f32 v51, s30, v51
CVT v48,v48,v49
M16 v[92:95],v[180:183],a[60:63],v[92:95]
s_waitcnt lgkmcnt(8)
CVT v49,v50,v51
v_mul_f32 v52, s30, v52
M16 v[96:99],v[184:187],a[32:35],v[96:99]
v_mul_f32 v53, s30, v53
v_mul_f32 v54, s30, v54
M16 v[96:99],v[188:191],a[48:51],v[96:99]
v_mul_f32 v55, s30, v55
CVT v52,v52,v53
M16 v[100:103],v[184:187],a[36:39],v[100:103]
CVT v53,v54,v55
v_mul_f32 v56, s30, v56
M16 v[100:103],v[188:191],a[52:55],v[100:103]
v_mul_f32 v57, s30, v57
v_mul_f32 v58, s30, v58
M16 v[104:107],v[184:187],a[40:43],v[104:107]
v_mul_f32 v59, s30, v59
CVT v56,v56,v57
M16 v[104:107],v[188:191],a[56:59],v[104:107]
CVT v57,v58,v59
v_mul_f32 v60, s30, v60
M16 v[108:111],v[184:187],a[44:47],v[108:111]
v_mul_f32 v61, s30, v61
v_mul_f32 v62, s30, v62
M16 v[108:111],v[188:191],a[60:63],v[108:111]
s_waitcnt lgkmcnt(4)
v_mul_f32 v63, s30, v63
CVT v60,v60,v61
M16 v[112:115],v[144:147],a[32:35],v[112:115]
CVT v61,v62,v63
v_mul_f32 v64, s30, v64
M16 v[112:115],v[148:151],a[48:51],v[112:115]
v_mul_f32 v65, s30, v65
v_mul_f32 v66, s30, v66
M16 v[116:119],v[144:147],a[36:39],v[116:119]
v_mul_f32 v67, s30, v67
CVT v64,v64,v65
M16 v[116:119],v[148:151],a[52:55],v[116:119]
CVT v65,v66,v67
v_mul_f32 v68, s30, v68
M16 v[120:123],v[144:147],a[40:43],v[120:123]
v_mul_f32 v69, s30, v69
v_mul_f32 v70, s30, v70
M16 v[120:123],v[148:151],a[56:59],v[120:123]
v_mul_f32 v71, s30, v71
CVT v68,v68,v69
M16 v[124:127],v[144:147],a[44:47],v[124:127]
CVT v69,v70,v71
v_mul_f32 v72, s30, v72
M16 v[124:127],v[148:151],a[60:63],v[124:127]
s_waitcnt lgkmcnt(0)
v_mul_f32 v73, s30, v73
v_mul_f32 v74, s30, v74
M16 v[128:131],v[152:155],a[32:35],v[128:131]
v_mul_f32 v75, s30, v75
CVT v72,v72,v73
M16 v[128:131],v[156:159],a[48:51],v[128:131]
CVT v73,v74,v75
v_mul_f32 v76, s30, v76
M16 v[132:135],v[152:155],a[36:39],v[132:135]
v_mul_f32 v77, s30, v77
v_mul_f32 v78, s30, v78
M16 v[132:135],v[156:159],a[52:55],v[132:135]
v_mul_f32 v79, s30, v79
CVT v76,v76,v77
M16 v[136:139],v[152:155],a[40:43],v[136:139]
CVT v77,v78,v79
v_mul_f32 v80, s30, v80
M16 v[136:139],v[156:159],a[56:59],v[136:139]
v_mul_f32 v81, s30, v81
v_mul_f32 v82, s30, v82
M16 v[140:143],v[152:155],a[44:47],v[140:143]
v_mul_f32 v83, s30, v83
CVT v80,v80,v81
M16 v[140:143],v[156:159],a[60:63],v[140:143]
CVT v81,v82,v83
v_mul_f32 v84, s30, v84
v_mul_f32 v85, s30, v85
v_mul_f32 v86, s30, v86
v_mul_f32 v87, s30, v87
CVT v84,v84,v85
CVT v85,v86,v87
v_mul_f32 v88, s30, v88
v_mul_f32 v89, s30, v89
v_mul_f32 v90, s30, v90
v_mul_f32 v91, s30, v91
CVT v88,v88,v89
CVT v89,v90,v91
v_mul_f32 v92, s30, v92
v_mul_f32 v93, s30, v93
v_mul_f32 v94, s30, v94
v_mul_f32 v95, s30, v95
CVT v92,v92,v93
CVT v93,v94,v95
v_mul_f32 v96, s30, v96
v_mul_f32 v97, s30, v97
v_mul_f32 v98, s30, v98
v_mul_f32 v99, s30, v99
CVT v96,v96,v97
CVT v97,v98,v99
v_mul_f32 v100, s30, v100
v_mul_f32 v101, s30, v101
v_mul_f32 v102, s30, v102
v_mul_f32 v103, s30, v103
CVT v100,v100,v101
CVT v101,v102,v103
v_mul_f32 v104, s30, v104
v_mul_f32 v105, s30, v105
v_mul_f32 v106, s30, v106
v_mul_f32 v107, s30, v107
CVT v104,v104,v105
CVT v105,v106,v107
v_mul_f32 v108, s30, v108
v_mul_f32 v109, s30, v109
v_mul_f32 v110, s30, v110
v_mul_f32 v111, s30, v111
CVT v108,v108,v109
CVT v109,v110,v111
v_mul_f32 v112, s30, v112
v_mul_f32 v113, s30, v113
v_mul_f32 v114, s30, v114
v_mul_f32 v115, s30, v115
CVT v112,v112,v113
CVT v113,v114,v115
v_mul_f32 v116, s30, v116
v_mul_f32 v117, s30, v117
v_mul_f32 v118, s30, v118
v_mul_f32 v119, s30, v119
CVT v116,v116,v117
CVT v117,v118,v119
v_mul_f32 v120, s30, v120
v_mul_f32 v121, s30, v121
v_mul_f32 v122, s30, v122
v_mul_f32 v123, s30, v123
CVT v120,v120,v121
CVT v121,v122,v123
v_mul_f32 v124, s30, v124
v_mul_f32 v125, s30, v125
v_mul_f32 v126, s30, v126
v_mul_f32 v127, s30, v127
CVT v124,v124,v125
CVT v125,v126,v127
s_nop 7
v_mul_f32 v128, s30, v128
v_mul_f32 v129, s30, v129
v_mul_f32 v130, s30, v130
v_mul_f32 v131, s30, v131
CVT v128,v128,v129
CVT v129,v130,v131
v_mul_f32 v132, s30, v132
v_mul_f32 v133, s30, v133
v_mul_f32 v134, s30, v134
v_mul_f32 v135, s30, v135
CVT v132,v132,v133
CVT v133,v134,v135
v_mul_f32 v136, s30, v136
v_mul_f32 v137, s30, v137
v_mul_f32 v138, s30, v138
v_mul_f32 v139, s30, v139
CVT v136,v136,v137
CVT v137,v138,v139
v_mul_f32 v140, s30, v140
v_mul_f32 v141, s30, v141
v_mul_f32 v142, s30, v142
v_mul_f32 v143, s30, v143
CVT v140,v140,v141
CVT v141,v142,v143
ds_write_b64 v3, v[16:17] offset:0
ds_write_b64 v3, v[32:33] offset:32
ds_write_b64 v3, v[48:49] offset:64
ds_write_b64 v3, v[64:65] offset:96
ds_write_b64 v3, v[80:81] offset:128
ds_write_b64 v3, v[96:97] offset:160
ds_write_b64 v3, v[112:113] offset:192
ds_write_b64 v3, v[128:129] offset:224
ds_write_b64 v3, v[20:21] offset:4352
ds_write_b64 v3, v[36:37] offset:4384
ds_write_b64 v3, v[52:53] offset:4416
ds_write_b64 v3, v[68:69] offset:4448
ds_write_b64 v3, v[84:85] offset:4480
ds_write_b64 v3, v[100:101] offset:4512
ds_write_b64 v3, v[116:117] offset:4544
ds_write_b64 v3, v[132:133] offset:4576
s_waitcnt lgkmcnt(0)
DR v[144:147],v4 offset:0
DR v[148:151],v4 offset:1088
DR v[152:155],v4 offset:2176
DR v[156:159],v4 offset:3264
DR v[160:163],v4 offset:4352
DR v[164:167],v4 offset:5440
DR v[168:171],v4 offset:6528
DR v[172:175],v4 offset:7616
s_waitcnt lgkmcnt(7)
BS4 v[144:147],v2,s[16:19],s28 offen sc1
s_add_u32 s28, s28, 5120
s_waitcnt lgkmcnt(6)
BS4 v[148:151],v2,s[16:19],s28 offen sc1
s_add_u32 s28, s28, 5120
s_waitcnt lgkmcnt(5)
BS4 v[152:155],v2,s[16:19],s28 offen sc1
s_add_u32 s28, s28, 5120
s_waitcnt lgkmcnt(4)
BS4 v[156:159],v2,s[16:19],s28 offen sc1
s_add_u32 s28, s28, 5120
s_waitcnt lgkmcnt(3)
BS4 v[160:163],v2,s[16:19],s28 offen sc1
s_add_u32 s28, s28, 5120
s_waitcnt lgkmcnt(2)
BS4 v[164:167],v2,s[16:19],s28 offen sc1
s_add_u32 s28, s28, 5120
s_waitcnt lgkmcnt(1)
BS4 v[168:171],v2,s[16:19],s28 offen sc1
s_add_u32 s28, s28, 5120
s_waitcnt lgkmcnt(0)
BS4 v[172:175],v2,s[16:19],s28 offen sc1
s_add_u32 s28, s28, 5120
ds_write_b64 v3, v[24:25] offset:0
ds_write_b64 v3, v[40:41] offset:32
ds_write_b64 v3, v[56:57] offset:64
ds_write_b64 v3, v[72:73] offset:96
ds_write_b64 v3, v[88:89] offset:128
ds_write_b64 v3, v[104:105] offset:160
ds_write_b64 v3, v[120:121] offset:192
ds_write_b64 v3, v[136:137] offset:224
ds_write_b64 v3, v[28:29] offset:4352
ds_write_b64 v3, v[44:45] offset:4384
ds_write_b64 v3, v[60:61] offset:4416
ds_write_b64 v3, v[76:77] offset:4448
ds_write_b64 v3, v[92:93] offset:4480
ds_write_b64 v3, v[108:109] offset:4512
ds_write_b64 v3, v[124:125] offset:4544
ds_write_b64 v3, v[140:141] offset:4576
s_waitcnt lgkmcnt(0)
DR v[144:147],v4 offset:0
DR v[148:151],v4 offset:1088
DR v[152:155],v4 offset:2176
DR v[156:159],v4 offset:3264
DR v[160:163],v4 offset:4352
DR v[164:167],v4 offset:5440
DR v[168:171],v4 offset:6528
DR v[172:175],v4 offset:7616
s_waitcnt lgkmcnt(7)
BS4 v[144:147],v2,s[16:19],s28 offen sc1
s_add_u32 s28, s28, 5120
s_waitcnt lgkmcnt(6)
BS4 v[148:151],v2,s[16:19],s28 offen sc1
s_add_u32 s28, s28, 5120
s_waitcnt lgkmcnt(5)
BS4 v[152:155],v2,s[16:19],s28 offen sc1
s_add_u32 s28, s28, 5120
s_waitcnt lgkmcnt(4)
BS4 v[156:159],v2,s[16:19],s28 offen sc1
s_add_u32 s28, s28, 5120
s_waitcnt lgkmcnt(3)
BS4 v[160:163],v2,s[16:19],s28 offen sc1
s_add_u32 s28, s28, 5120
s_waitcnt lgkmcnt(2)
BS4 v[164:167],v2,s[16:19],s28 offen sc1
s_add_u32 s28, s28, 5120
s_waitcnt lgkmcnt(1)
BS4 v[168:171],v2,s[16:19],s28 offen sc1
s_add_u32 s28, s28, 5120
s_waitcnt lgkmcnt(0)
BS4 v[172:175],v2,s[16:19],s28 offen sc1
s_add_u32 s28, s28, 5120
s_branch L_p1_B_end
L_p1_B_kv:
s_and_b32 s40, s21, 3
s_lshl_b32 s40, s40, 2
s_add_u32 s40, s40, s20
s_mul_i32 s40, s40, 20
v_min_u32 v212, 39, v1
v_lshrrev_b32 v213, 1, v212
v_add_u32 v213, s40, v213
s_lshr_b32 s40, s37, 6
v_mul_lo_u32 v213, v213, s40
v_and_b32 v212, 1, v212
v_lshl_add_u32 v216, v212, 7, v213
s_mul_i32 s44, s37, 5
s_add_u32 s44, s44, s36
s_mov_b32 s43, s36
s_lshr_b32 s40, s2, 3
s_lshl_b32 s40, s40, 2
s_add_u32 s40, s40, s20
s_and_b32 s41, s2, 1
s_lshl_b32 s41, s41, 7
s_add_u32 s40, s40, s41
s_lshl_b32 s56, s40, 13
s_mul_i32 s57, s40, 10240
v_min_u32 v212, 31, v1
v_lshrrev_b32 v213, 2, v212
v_and_b32 v212, 3, v212
v_lshlrev_b32 v212, 7, v212
v_lshl_add_u32 v217, v213, 10, v212
v_min_u32 v212, 39, v1
v_mul_u32_u24 v213, 52, v212
v_lshrrev_b32 v213, 8, v213
v_mul_u32_u24 v214, 5, v213
v_sub_u32 v212, v212, v214
v_lshlrev_b32 v212, 7, v212
v_mul_u32_u24 v213, 1280, v213
v_add_u32 v218, v212, v213
s_mov_b32 s48, s66
s_mov_b32 s49, s67
s_mov_b32 s50, 2097152
s_mov_b32 s51, 0x00020000
s_mov_b32 s60, s76
s_mov_b32 s61, s77
s_mov_b32 s62, 2621440
s_mov_b32 s63, 0x00020000
buffer_load_dword v6, v217, s[48:51], s56 offen offset:0
buffer_load_dword v6, v216, s[8:11], s43 offen
s_and_b32 s40, s2, 6
s_cmp_lg_u32 s40, 6
s_cbranch_scc1 L_pf_KVB_0
buffer_load_dword v6, v218, s[60:63], s57 offen offset:0
L_pf_KVB_0:
s_lshr_b32 s40, s37, 6
v_lshrrev_b32 v220, 4, v1
s_lshl_b32 s41, s20, 4
v_add_u32 v221, s41, v220
v_mul_lo_u32 v221, v221, s40
v_lshlrev_b32 v220, 1, v220
v_and_b32 v222, 15, v1
v_xor_b32 v220, v220, v222
s_lshl_b32 s40, s40, 2
s_sub_u32 s40, s40, 1024
v_lshl_add_u32 v208, v220, 4, v221
v_add_u32 v209, s40, v208
v_xor_b32 v220, 8, v220
v_lshl_add_u32 v210, v220, 4, v221
s_lshl_b32 s41, s40, 1
v_add_u32 v210, s41, v210
v_add_u32 v211, s40, v210
s_lshl_b32 s40, s21, 2
s_add_u32 s40, s40, s20
s_mul_i32 s40, s40, 81920
v_lshrrev_b32 v220, 3, v1
v_mul_u32_u24 v220, 1280, v220
v_add_u32 v220, s40, v220
v_and_b32 v221, 7, v1
v_lshrrev_b32 v222, 4, v1
v_xor_b32 v221, v221, v222
v_xor_b32 v222, 4, v221
v_lshl_add_u32 v221, v221, 4, v220
v_lshl_add_u32 v222, v222, 4, v220
v_add_u32 v200, 0, v221
v_add_u32 v201, 9216, v222
v_add_u32 v202, 18432, v221
v_add_u32 v203, 27648, v222
v_add_u32 v204, 40960, v221
v_add_u32 v205, 50176, v222
v_add_u32 v206, 59392, v221
v_add_u32 v207, 68608, v222
s_mul_i32 s32, s20, 12288
s_add_u32 s32, s32, 114688
s_add_u32 m0, s32, 0
s_mov_b32 s33, 0
BL4 v200,s[12:15],s33 offen lds
BL4 v201,s[12:15],s33 offen offset:1024 lds
BL4 v202,s[12:15],s33 offen offset:2048 lds
BL4 v203,s[12:15],s33 offen offset:3072 lds
s_add_u32 m0, s32, 4096
s_nop 0
BL4 v204,s[12:15],s33 offen lds
BL4 v205,s[12:15],s33 offen offset:1024 lds
BL4 v206,s[12:15],s33 offen offset:2048 lds
BL4 v207,s[12:15],s33 offen offset:3072 lds
buffer_load_dword v6, v217, s[48:51], s56 offen offset:512
buffer_load_dword v6, v216, s[8:11], s44 offen
s_and_b32 s40, s2, 6
s_cmp_lg_u32 s40, 6
s_cbranch_scc1 L_pf_KVB_1
buffer_load_dword v6, v218, s[60:63], s57 offen offset:640
L_pf_KVB_1:
s_add_u32 m0, s32, 8192
s_mov_b32 s33, 128
BL4 v200,s[12:15],s33 offen lds
BL4 v201,s[12:15],s33 offen offset:1024 lds
BL4 v202,s[12:15],s33 offen offset:2048 lds
BL4 v203,s[12:15],s33 offen offset:3072 lds
v_and_b32 v220, 15, v1
v_lshrrev_b32 v221, 1, v220
v_lshrrev_b32 v222, 4, v1
v_xor_b32 v221, v221, v222
v_lshlrev_b32 v221, 4, v221
v_lshl_add_u32 v12, v220, 7, v221
v_add_u32 v12, s32, v12
v_xor_b32 v13, 64, v12
v_lshrrev_b32 v220, 4, v1
v_bfe_u32 v221, v1, 2, 2
v_lshl_add_u32 v222, v220, 3, v221
v_lshlrev_b32 v222, 8, v222
v_and_b32 v220, 1, v220
v_lshl_add_u32 v221, v220, 2, v221
v_lshl_add_u32 v222, v221, 5, v222
v_and_b32 v220, 3, v1
v_lshl_add_u32 v222, v220, 3, v222
v_add_u32 v192, 65536, v222
v_xor_b32 v193, 32, v192
v_xor_b32 v194, 64, v192
v_xor_b32 v195, 96, v192
v_lshlrev_b32 v212, 4, v1
s_mov_b32 s48, s80
s_mov_b32 s49, s81
s_mov_b32 s50, 25600
s_mov_b32 s51, 0x00020000
s_add_u32 m0, s35, 0
s_add_u32 s40, s35, 0
BL4 v212,s[48:51],s40 offen lds
s_add_u32 m0, s35, 4096
s_add_u32 s40, s35, 4096
BL4 v212,s[48:51],s40 offen lds
s_add_u32 m0, s35, 8192
s_add_u32 s40, s35, 8192
BL4 v212,s[48:51],s40 offen lds
s_add_u32 m0, s35, 12288
s_add_u32 s40, s35, 12288
BL4 v212,s[48:51],s40 offen lds
s_add_u32 m0, s35, 16384
s_add_u32 s40, s35, 16384
BL4 v212,s[48:51],s40 offen lds
s_add_u32 m0, s35, 20480
s_add_u32 s40, s35, 20480
BL4 v212,s[48:51],s40 offen lds
s_add_u32 m0, s35, 24576
s_add_u32 s40, s35, 24576
s_cmp_eq_u32 s20, 0
s_cbranch_scc0 L_p1_B_sk0
BL4 v212,s[48:51],s40 offen lds
L_p1_B_sk0:
s_mov_b32 s48, s82
s_mov_b32 s49, s83
s_mov_b32 s50, 25600
s_mov_b32 s51, 0x00020000
s_add_u32 m0, s35, 26624
s_add_u32 s40, s35, 0
BL4 v212,s[48:51],s40 offen lds
s_add_u32 m0, s35, 30720
s_add_u32 s40, s35, 4096
BL4 v212,s[48:51],s40 offen lds
s_add_u32 m0, s35, 34816
s_add_u32 s40, s35, 8192
BL4 v212,s[48:51],s40 offen lds
s_add_u32 m0, s35, 38912
s_add_u32 s40, s35, 12288
BL4 v212,s[48:51],s40 offen lds
s_add_u32 m0, s35, 43008
s_add_u32 s40, s35, 16384
BL4 v212,s[48:51],s40 offen lds
s_add_u32 m0, s35, 47104
s_add_u32 s40, s35, 20480
BL4 v212,s[48:51],s40 offen lds
s_add_u32 m0, s35, 51200
s_add_u32 s40, s35, 24576
s_cmp_eq_u32 s20, 0
s_cbranch_scc0 L_p1_B_sk1
BL4 v212,s[48:51],s40 offen lds
L_p1_B_sk1:
s_waitcnt vmcnt(0)
s_mul_i32 s40, s21, 6
s_add_u32 s40, s40, s22
s_sub_u32 s40, s40, 26
s_lshl_b32 s40, s40, 2
s_add_u32 s40, s40, s20
s_and_b32 s41, s40, 1
s_lshr_b32 s40, s40, 1
s_mul_i32 s40, s40, 6
s_cmp_eq_u32 s41, 0
s_cselect_b32 s48, s70, s72
s_cselect_b32 s49, s71, s73
s_mov_b32 s50, 4194304
s_mov_b32 s51, 0x00020000
v_min_u32 v212, 59, v1
v_mul_u32_u24 v213, 43, v212
v_lshrrev_b32 v213, 8, v213
v_mul_u32_u24 v214, 6, v213
v_sub_u32 v212, v212, v214
v_add_u32 v212, s40, v212
v_lshlrev_b32 v212, 13, v212
v_mul_u32_u24 v213, 6, v213
s_cmp_eq_u32 s41, 0
s_mov_b32 s42, 3594830274
s_cselect_b32 s42, 3594830274, s42
s_mov_b32 s43, 199923206
s_cselect_b32 s43, 199923206, s43
v_lshrrev_b64 v[214:215], v213, s[42:43]
v_and_b32 v214, 63, v214
v_lshl_add_u32 v214, v214, 7, v212
buffer_load_dword v6, v214, s[48:51], 0 offen
s_cmp_eq_u32 s41, 0
s_mov_b32 s42, 1209003636
s_cselect_b32 s42, 1209003636, s42
s_mov_b32 s43, 140270883
s_cselect_b32 s43, 140270883, s43
v_lshrrev_b64 v[214:215], v213, s[42:43]
v_and_b32 v214, 63, v214
v_lshl_add_u32 v214, v214, 7, v212
buffer_load_dword v6, v214, s[48:51], 0 offen
s_cmp_eq_u32 s41, 0
s_mov_b32 s42, 4208397030
s_cselect_b32 s42, 4208397030, s42
s_mov_b32 s43, 80618575
s_cselect_b32 s43, 80618575, s43
v_lshrrev_b64 v[214:215], v213, s[42:43]
v_and_b32 v214, 63, v214
v_lshl_add_u32 v214, v214, 7, v212
buffer_load_dword v6, v214, s[48:51], 0 offen
s_cmp_eq_u32 s41, 0
s_mov_b32 s42, 1822304088
s_cselect_b32 s42, 1822304088, s42
s_mov_b32 s43, 251391852
s_cselect_b32 s43, 251391852, s43
v_lshrrev_b64 v[214:215], v213, s[42:43]
v_and_b32 v214, 63, v214
v_lshl_add_u32 v214, v214, 7, v212
buffer_load_dword v6, v214, s[48:51], 0 offen
v_lshrrev_b32 v212, 4, v1
v_bfe_u32 v213, v1, 2, 2
v_lshl_add_u32 v213, v212, 3, v213
v_mul_u32_u24 v213, 40, v213
v_and_b32 v212, 3, v1
v_lshl_add_u32 v192, v212, 3, v213
v_add_u32 v193, 32, v192
v_add_u32 v194, 26624, v192
v_add_u32 v195, 26656, v192
s_waitcnt vmcnt(6)
s_barrier
DR a[0:3],v12 offset:0
DR a[16:19],v13 offset:0
DR a[4:7],v12 offset:2048
DR a[20:23],v13 offset:2048
DR a[8:11],v12 offset:4096
DR a[24:27],v13 offset:4096
DR a[12:15],v12 offset:6144
DR a[28:31],v13 offset:6144
s_waitcnt lgkmcnt(4)
s_add_u32 m0, s32, 0
s_nop 0
BL4 v204,s[12:15],s33 offen lds
BL4 v205,s[12:15],s33 offen offset:1024 lds
BL4 v206,s[12:15],s33 offen offset:2048 lds
BL4 v207,s[12:15],s33 offen offset:3072 lds
DTR v[144:145],v192 offset:0
DTR v[146:147],v192 offset:160
DTR v[148:149],v192 offset:1280
DTR v[150:151],v192 offset:1440
DTR v[152:153],v193 offset:0
DTR v[154:155],v193 offset:160
DTR v[156:157],v193 offset:1280
DTR v[158:159],v193 offset:1440
DTR v[160:161],v194 offset:0
DTR v[162:163],v194 offset:160
DTR v[164:165],v194 offset:1280
DTR v[166:167],v194 offset:1440
s_waitcnt lgkmcnt(8)
M16 v[16:19],v[144:147],a[0:3],0
DTR v[168:169],v195 offset:0
s_add_u32 m0, s32, 4096
M16 v[16:19],v[148:151],a[16:19],v[16:19]
s_mov_b32 s33, 256
M16 v[20:23],v[144:147],a[4:7],0
DTR v[170:171],v195 offset:160
M16 v[20:23],v[148:151],a[20:23],v[20:23]
BL4 v200,s[12:15],s33 offen lds
M16 v[24:27],v[144:147],a[8:11],0
DTR v[172:173],v195 offset:1280
M16 v[24:27],v[148:151],a[24:27],v[24:27]
s_waitcnt lgkmcnt(7)
M16 v[28:31],v[144:147],a[12:15],0
DTR v[174:175],v195 offset:1440
M16 v[28:31],v[148:151],a[28:31],v[28:31]
BL4 v201,s[12:15],s33 offen offset:1024 lds
M16 v[32:35],v[152:155],a[0:3],0
DTR v[144:145],v192 offset:2560
M16 v[32:35],v[156:159],a[16:19],v[32:35]
BL4 v202,s[12:15],s33 offen offset:2048 lds
M16 v[36:39],v[152:155],a[4:7],0
DTR v[146:147],v192 offset:2720
M16 v[36:39],v[156:159],a[20:23],v[36:39]
BL4 v203,s[12:15],s33 offen offset:3072 lds
M16 v[40:43],v[152:155],a[8:11],0
DTR v[148:149],v192 offset:3840
s_waitcnt vmcnt(8)
M16 v[40:43],v[156:159],a[24:27],v[40:43]
DR a[32:35],v12 offset:8192
M16 v[44:47],v[152:155],a[12:15],0
DTR v[150:151],v192 offset:4000
M16 v[44:47],v[156:159],a[28:31],v[44:47]
s_waitcnt lgkmcnt(9)
DR a[48:51],v13 offset:8192
M16 v[48:51],a[0:3],v[160:163],0
DTR v[152:153],v193 offset:2560
M16 v[48:51],a[16:19],v[164:167],v[48:51]
DR a[36:39],v12 offset:10240
M16 v[52:55],a[4:7],v[160:163],0
DTR v[154:155],v193 offset:2720
M16 v[52:55],a[20:23],v[164:167],v[52:55]
DR a[52:55],v13 offset:10240
s_waitcnt vmcnt(4)
M16 v[56:59],a[8:11],v[160:163],0
DTR v[156:157],v193 offset:3840
M16 v[56:59],a[24:27],v[164:167],v[56:59]
DR a[40:43],v12 offset:0
M16 v[60:63],a[12:15],v[160:163],0
DTR v[158:159],v193 offset:4000
M16 v[60:63],a[28:31],v[164:167],v[60:63]
s_waitcnt lgkmcnt(13)
DR a[56:59],v13 offset:0
M16 v[64:67],a[0:3],v[168:171],0
DTR v[160:161],v194 offset:2560
M16 v[64:67],a[16:19],v[172:175],v[64:67]
DR a[44:47],v12 offset:2048
M16 v[68:71],a[4:7],v[168:171],0
DTR v[162:163],v194 offset:2720
M16 v[68:71],a[20:23],v[172:175],v[68:71]
DR a[60:63],v13 offset:2048
s_waitcnt lgkmcnt(8)
M16 v[72:75],a[8:11],v[168:171],0
DTR v[164:165],v194 offset:3840
s_add_u32 m0, s32, 8192
M16 v[72:75],a[24:27],v[172:175],v[72:75]
M16 v[76:79],a[12:15],v[168:171],0
DTR v[166:167],v194 offset:4000
M16 v[76:79],a[28:31],v[172:175],v[76:79]
s_waitcnt lgkmcnt(2)
BL4 v204,s[12:15],s33 offen lds
BL4 v205,s[12:15],s33 offen offset:1024 lds
BL4 v206,s[12:15],s33 offen offset:2048 lds
BL4 v207,s[12:15],s33 offen offset:3072 lds
M16 v[16:19],v[144:147],a[32:35],v[16:19]
DTR v[168:169],v195 offset:2560
s_add_u32 m0, s32, 0
M16 v[16:19],v[148:151],a[48:51],v[16:19]
s_mov_b32 s33, 384
M16 v[20:23],v[144:147],a[36:39],v[20:23]
DTR v[170:171],v195 offset:2720
M16 v[20:23],v[148:151],a[52:55],v[20:23]
BL4 v200,s[12:15],s33 offen lds
M16 v[24:27],v[144:147],a[40:43],v[24:27]
DTR v[172:173],v195 offset:3840
M16 v[24:27],v[148:151],a[56:59],v[24:27]
M16 v[28:31],v[144:147],a[44:47],v[28:31]
DTR v[174:175],v195 offset:4000
M16 v[28:31],v[148:151],a[60:63],v[28:31]
BL4 v201,s[12:15],s33 offen offset:1024 lds
M16 v[32:35],v[152:155],a[32:35],v[32:35]
DTR v[144:145],v192 offset:5120
M16 v[32:35],v[156:159],a[48:51],v[32:35]
BL4 v202,s[12:15],s33 offen offset:2048 lds
M16 v[36:39],v[152:155],a[36:39],v[36:39]
DTR v[146:147],v192 offset:5280
M16 v[36:39],v[156:159],a[52:55],v[36:39]
BL4 v203,s[12:15],s33 offen offset:3072 lds
M16 v[40:43],v[152:155],a[40:43],v[40:43]
DTR v[148:149],v192 offset:6400
s_waitcnt vmcnt(8)
M16 v[40:43],v[156:159],a[56:59],v[40:43]
DR a[0:3],v12 offset:4096
M16 v[44:47],v[152:155],a[44:47],v[44:47]
DTR v[150:151],v192 offset:6560
M16 v[44:47],v[156:159],a[60:63],v[44:47]
s_waitcnt lgkmcnt(9)
DR a[16:19],v13 offset:4096
M16 v[48:51],a[32:35],v[160:163],v[48:51]
DTR v[152:153],v193 offset:5120
M16 v[48:51],a[48:51],v[164:167],v[48:51]
DR a[4:7],v12 offset:6144
M16 v[52:55],a[36:39],v[160:163],v[52:55]
DTR v[154:155],v193 offset:5280
M16 v[52:55],a[52:55],v[164:167],v[52:55]
DR a[20:23],v13 offset:6144
s_waitcnt vmcnt(4)
M16 v[56:59],a[40:43],v[160:163],v[56:59]
DTR v[156:157],v193 offset:6400
M16 v[56:59],a[56:59],v[164:167],v[56:59]
DR a[8:11],v12 offset:8192
M16 v[60:63],a[44:47],v[160:163],v[60:63]
DTR v[158:159],v193 offset:6560
M16 v[60:63],a[60:63],v[164:167],v[60:63]
s_waitcnt lgkmcnt(13)
DR a[24:27],v13 offset:8192
M16 v[64:67],a[32:35],v[168:171],v[64:67]
DTR v[160:161],v194 offset:5120
M16 v[64:67],a[48:51],v[172:175],v[64:67]
DR a[12:15],v12 offset:10240
M16 v[68:71],a[36:39],v[168:171],v[68:71]
DTR v[162:163],v194 offset:5280
M16 v[68:71],a[52:55],v[172:175],v[68:71]
DR a[28:31],v13 offset:10240
s_waitcnt lgkmcnt(8)
M16 v[72:75],a[40:43],v[168:171],v[72:75]
DTR v[164:165],v194 offset:6400
s_add_u32 m0, s32, 4096
M16 v[72:75],a[56:59],v[172:175],v[72:75]
M16 v[76:79],a[44:47],v[168:171],v[76:79]
DTR v[166:167],v194 offset:6560
M16 v[76:79],a[60:63],v[172:175],v[76:79]
s_waitcnt lgkmcnt(2)
BL4 v204,s[12:15],s33 offen lds
BL4 v205,s[12:15],s33 offen offset:1024 lds
BL4 v206,s[12:15],s33 offen offset:2048 lds
BL4 v207,s[12:15],s33 offen offset:3072 lds
M16 v[16:19],v[144:147],a[0:3],v[16:19]
DTR v[168:169],v195 offset:5120
s_add_u32 m0, s32, 8192
M16 v[16:19],v[148:151],a[16:19],v[16:19]
s_mov_b32 s33, 512
M16 v[20:23],v[144:147],a[4:7],v[20:23]
DTR v[170:171],v195 offset:5280
M16 v[20:23],v[148:151],a[20:23],v[20:23]
BL4 v200,s[12:15],s33 offen lds
M16 v[24:27],v[144:147],a[8:11],v[24:27]
DTR v[172:173],v195 offset:6400
M16 v[24:27],v[148:151],a[24:27],v[24:27]
M16 v[28:31],v[144:147],a[12:15],v[28:31]
DTR v[174:175],v195 offset:6560
M16 v[28:31],v[148:151],a[28:31],v[28:31]
BL4 v201,s[12:15],s33 offen offset:1024 lds
M16 v[32:35],v[152:155],a[0:3],v[32:35]
DTR v[144:145],v192 offset:7680
M16 v[32:35],v[156:159],a[16:19],v[32:35]
BL4 v202,s[12:15],s33 offen offset:2048 lds
M16 v[36:39],v[152:155],a[4:7],v[36:39]
DTR v[146:147],v192 offset:7840
M16 v[36:39],v[156:159],a[20:23],v[36:39]
BL4 v203,s[12:15],s33 offen offset:3072 lds
M16 v[40:43],v[152:155],a[8:11],v[40:43]
DTR v[148:149],v192 offset:8960
s_waitcnt vmcnt(8)
M16 v[40:43],v[156:159],a[24:27],v[40:43]
DR a[32:35],v12 offset:0
M16 v[44:47],v[152:155],a[12:15],v[44:47]
DTR v[150:151],v192 offset:9120
M16 v[44:47],v[156:159],a[28:31],v[44:47]
s_waitcnt lgkmcnt(9)
DR a[48:51],v13 offset:0
M16 v[48:51],a[0:3],v[160:163],v[48:51]
DTR v[152:153],v193 offset:7680
M16 v[48:51],a[16:19],v[164:167],v[48:51]
DR a[36:39],v12 offset:2048
M16 v[52:55],a[4:7],v[160:163],v[52:55]
DTR v[154:155],v193 offset:7840
M16 v[52:55],a[20:23],v[164:167],v[52:55]
DR a[52:55],v13 offset:2048
s_waitcnt vmcnt(4)
M16 v[56:59],a[8:11],v[160:163],v[56:59]
DTR v[156:157],v193 offset:8960
M16 v[56:59],a[24:27],v[164:167],v[56:59]
DR a[40:43],v12 offset:4096
M16 v[60:63],a[12:15],v[160:163],v[60:63]
DTR v[158:159],v193 offset:9120
M16 v[60:63],a[28:31],v[164:167],v[60:63]
s_waitcnt lgkmcnt(13)
DR a[56:59],v13 offset:4096
M16 v[64:67],a[0:3],v[168:171],v[64:67]
DTR v[160:161],v194 offset:7680
M16 v[64:67],a[16:19],v[172:175],v[64:67]
DR a[44:47],v12 offset:6144
M16 v[68:71],a[4:7],v[168:171],v[68:71]
DTR v[162:163],v194 offset:7840
M16 v[68:71],a[20:23],v[172:175],v[68:71]
DR a[60:63],v13 offset:6144
s_waitcnt lgkmcnt(8)
M16 v[72:75],a[8:11],v[168:171],v[72:75]
DTR v[164:165],v194 offset:8960
s_add_u32 m0, s32, 0
M16 v[72:75],a[24:27],v[172:175],v[72:75]
M16 v[76:79],a[12:15],v[168:171],v[76:79]
DTR v[166:167],v194 offset:9120
M16 v[76:79],a[28:31],v[172:175],v[76:79]
s_waitcnt lgkmcnt(2)
BL4 v204,s[12:15],s33 offen lds
BL4 v205,s[12:15],s33 offen offset:1024 lds
BL4 v206,s[12:15],s33 offen offset:2048 lds
BL4 v207,s[12:15],s33 offen offset:3072 lds
M16 v[16:19],v[144:147],a[32:35],v[16:19]
DTR v[168:169],v195 offset:7680
s_add_u32 m0, s32, 4096
M16 v[16:19],v[148:151],a[48:51],v[16:19]
s_mov_b32 s33, 640
M16 v[20:23],v[144:147],a[36:39],v[20:23]
DTR v[170:171],v195 offset:7840
M16 v[20:23],v[148:151],a[52:55],v[20:23]
BL4 v200,s[12:15],s33 offen lds
M16 v[24:27],v[144:147],a[40:43],v[24:27]
DTR v[172:173],v195 offset:8960
M16 v[24:27],v[148:151],a[56:59],v[24:27]
M16 v[28:31],v[144:147],a[44:47],v[28:31]
DTR v[174:175],v195 offset:9120
M16 v[28:31],v[148:151],a[60:63],v[28:31]
BL4 v201,s[12:15],s33 offen offset:1024 lds
M16 v[32:35],v[152:155],a[32:35],v[32:35]
DTR v[144:145],v192 offset:10240
M16 v[32:35],v[156:159],a[48:51],v[32:35]
BL4 v202,s[12:15],s33 offen offset:2048 lds
M16 v[36:39],v[152:155],a[36:39],v[36:39]
DTR v[146:147],v192 offset:10400
M16 v[36:39],v[156:159],a[52:55],v[36:39]
BL4 v203,s[12:15],s33 offen offset:3072 lds
M16 v[40:43],v[152:155],a[40:43],v[40:43]
DTR v[148:149],v192 offset:11520
s_waitcnt vmcnt(8)
M16 v[40:43],v[156:159],a[56:59],v[40:43]
DR a[0:3],v12 offset:8192
M16 v[44:47],v[152:155],a[44:47],v[44:47]
DTR v[150:151],v192 offset:11680
M16 v[44:47],v[156:159],a[60:63],v[44:47]
s_waitcnt lgkmcnt(9)
DR a[16:19],v13 offset:8192
M16 v[48:51],a[32:35],v[160:163],v[48:51]
DTR v[152:153],v193 offset:10240
M16 v[48:51],a[48:51],v[164:167],v[48:51]
DR a[4:7],v12 offset:10240
M16 v[52:55],a[36:39],v[160:163],v[52:55]
DTR v[154:155],v193 offset:10400
M16 v[52:55],a[52:55],v[164:167],v[52:55]
DR a[20:23],v13 offset:10240
s_waitcnt vmcnt(4)
M16 v[56:59],a[40:43],v[160:163],v[56:59]
DTR v[156:157],v193 offset:11520
M16 v[56:59],a[56:59],v[164:167],v[56:59]
DR a[8:11],v12 offset:0
M16 v[60:63],a[44:47],v[160:163],v[60:63]
DTR v[158:159],v193 offset:11680
M16 v[60:63],a[60:63],v[164:167],v[60:63]
s_waitcnt lgkmcnt(13)
DR a[24:27],v13 offset:0
M16 v[64:67],a[32:35],v[168:171],v[64:67]
DTR v[160:161],v194 offset:10240
M16 v[64:67],a[48:51],v[172:175],v[64:67]
DR a[12:15],v12 offset:2048
M16 v[68:71],a[36:39],v[168:171],v[68:71]
DTR v[162:163],v194 offset:10400
M16 v[68:71],a[52:55],v[172:175],v[68:71]
DR a[28:31],v13 offset:2048
s_waitcnt lgkmcnt(8)
M16 v[72:75],a[40:43],v[168:171],v[72:75]
DTR v[164:165],v194 offset:11520
s_add_u32 m0, s32, 8192
M16 v[72:75],a[56:59],v[172:175],v[72:75]
M16 v[76:79],a[44:47],v[168:171],v[76:79]
DTR v[166:167],v194 offset:11680
M16 v[76:79],a[60:63],v[172:175],v[76:79]
s_waitcnt lgkmcnt(2)
BL4 v204,s[12:15],s33 offen lds
BL4 v205,s[12:15],s33 offen offset:1024 lds
BL4 v206,s[12:15],s33 offen offset:2048 lds
BL4 v207,s[12:15],s33 offen offset:3072 lds
M16 v[16:19],v[144:147],a[0:3],v[16:19]
DTR v[168:169],v195 offset:10240
s_add_u32 m0, s32, 0
M16 v[16:19],v[148:151],a[16:19],v[16:19]
s_mov_b32 s33, 768
M16 v[20:23],v[144:147],a[4:7],v[20:23]
DTR v[170:171],v195 offset:10400
M16 v[20:23],v[148:151],a[20:23],v[20:23]
BL4 v200,s[12:15],s33 offen lds
M16 v[24:27],v[144:147],a[8:11],v[24:27]
DTR v[172:173],v195 offset:11520
M16 v[24:27],v[148:151],a[24:27],v[24:27]
M16 v[28:31],v[144:147],a[12:15],v[28:31]
DTR v[174:175],v195 offset:11680
M16 v[28:31],v[148:151],a[28:31],v[28:31]
BL4 v201,s[12:15],s33 offen offset:1024 lds
M16 v[32:35],v[152:155],a[0:3],v[32:35]
DTR v[144:145],v192 offset:12800
M16 v[32:35],v[156:159],a[16:19],v[32:35]
BL4 v202,s[12:15],s33 offen offset:2048 lds
M16 v[36:39],v[152:155],a[4:7],v[36:39]
DTR v[146:147],v192 offset:12960
M16 v[36:39],v[156:159],a[20:23],v[36:39]
BL4 v203,s[12:15],s33 offen offset:3072 lds
M16 v[40:43],v[152:155],a[8:11],v[40:43]
DTR v[148:149],v192 offset:14080
s_waitcnt vmcnt(8)
M16 v[40:43],v[156:159],a[24:27],v[40:43]
DR a[32:35],v12 offset:4096
M16 v[44:47],v[152:155],a[12:15],v[44:47]
DTR v[150:151],v192 offset:14240
M16 v[44:47],v[156:159],a[28:31],v[44:47]
s_waitcnt lgkmcnt(9)
DR a[48:51],v13 offset:4096
M16 v[48:51],a[0:3],v[160:163],v[48:51]
DTR v[152:153],v193 offset:12800
M16 v[48:51],a[16:19],v[164:167],v[48:51]
DR a[36:39],v12 offset:6144
M16 v[52:55],a[4:7],v[160:163],v[52:55]
DTR v[154:155],v193 offset:12960
M16 v[52:55],a[20:23],v[164:167],v[52:55]
DR a[52:55],v13 offset:6144
s_waitcnt vmcnt(4)
M16 v[56:59],a[8:11],v[160:163],v[56:59]
DTR v[156:157],v193 offset:14080
M16 v[56:59],a[24:27],v[164:167],v[56:59]
DR a[40:43],v12 offset:8192
M16 v[60:63],a[12:15],v[160:163],v[60:63]
DTR v[158:159],v193 offset:14240
M16 v[60:63],a[28:31],v[164:167],v[60:63]
s_waitcnt lgkmcnt(13)
DR a[56:59],v13 offset:8192
M16 v[64:67],a[0:3],v[168:171],v[64:67]
DTR v[160:161],v194 offset:12800
M16 v[64:67],a[16:19],v[172:175],v[64:67]
DR a[44:47],v12 offset:10240
M16 v[68:71],a[4:7],v[168:171],v[68:71]
DTR v[162:163],v194 offset:12960
M16 v[68:71],a[20:23],v[172:175],v[68:71]
DR a[60:63],v13 offset:10240
s_waitcnt lgkmcnt(8)
M16 v[72:75],a[8:11],v[168:171],v[72:75]
DTR v[164:165],v194 offset:14080
s_add_u32 m0, s32, 4096
M16 v[72:75],a[24:27],v[172:175],v[72:75]
M16 v[76:79],a[12:15],v[168:171],v[76:79]
DTR v[166:167],v194 offset:14240
M16 v[76:79],a[28:31],v[172:175],v[76:79]
s_waitcnt lgkmcnt(2)
BL4 v204,s[12:15],s33 offen lds
BL4 v205,s[12:15],s33 offen offset:1024 lds
BL4 v206,s[12:15],s33 offen offset:2048 lds
BL4 v207,s[12:15],s33 offen offset:3072 lds
M16 v[16:19],v[144:147],a[32:35],v[16:19]
DTR v[168:169],v195 offset:12800
s_add_u32 m0, s32, 8192
M16 v[16:19],v[148:151],a[48:51],v[16:19]
s_mov_b32 s33, 896
M16 v[20:23],v[144:147],a[36:39],v[20:23]
DTR v[170:171],v195 offset:12960
M16 v[20:23],v[148:151],a[52:55],v[20:23]
BL4 v200,s[12:15],s33 offen lds
M16 v[24:27],v[144:147],a[40:43],v[24:27]
DTR v[172:173],v195 offset:14080
M16 v[24:27],v[148:151],a[56:59],v[24:27]
M16 v[28:31],v[144:147],a[44:47],v[28:31]
DTR v[174:175],v195 offset:14240
M16 v[28:31],v[148:151],a[60:63],v[28:31]
BL4 v201,s[12:15],s33 offen offset:1024 lds
M16 v[32:35],v[152:155],a[32:35],v[32:35]
DTR v[144:145],v192 offset:15360
M16 v[32:35],v[156:159],a[48:51],v[32:35]
BL4 v202,s[12:15],s33 offen offset:2048 lds
M16 v[36:39],v[152:155],a[36:39],v[36:39]
DTR v[146:147],v192 offset:15520
M16 v[36:39],v[156:159],a[52:55],v[36:39]
BL4 v203,s[12:15],s33 offen offset:3072 lds
M16 v[40:43],v[152:155],a[40:43],v[40:43]
DTR v[148:149],v192 offset:16640
s_waitcnt vmcnt(8)
M16 v[40:43],v[156:159],a[56:59],v[40:43]
DR a[0:3],v12 offset:0
M16 v[44:47],v[152:155],a[44:47],v[44:47]
DTR v[150:151],v192 offset:16800
M16 v[44:47],v[156:159],a[60:63],v[44:47]
s_waitcnt lgkmcnt(9)
DR a[16:19],v13 offset:0
M16 v[48:51],a[32:35],v[160:163],v[48:51]
DTR v[152:153],v193 offset:15360
M16 v[48:51],a[48:51],v[164:167],v[48:51]
DR a[4:7],v12 offset:2048
M16 v[52:55],a[36:39],v[160:163],v[52:55]
DTR v[154:155],v193 offset:15520
M16 v[52:55],a[52:55],v[164:167],v[52:55]
DR a[20:23],v13 offset:2048
s_waitcnt vmcnt(4)
M16 v[56:59],a[40:43],v[160:163],v[56:59]
DTR v[156:157],v193 offset:16640
M16 v[56:59],a[56:59],v[164:167],v[56:59]
DR a[8:11],v12 offset:4096
M16 v[60:63],a[44:47],v[160:163],v[60:63]
DTR v[158:159],v193 offset:16800
M16 v[60:63],a[60:63],v[164:167],v[60:63]
s_waitcnt lgkmcnt(13)
DR a[24:27],v13 offset:4096
M16 v[64:67],a[32:35],v[168:171],v[64:67]
DTR v[160:161],v194 offset:15360
M16 v[64:67],a[48:51],v[172:175],v[64:67]
DR a[12:15],v12 offset:6144
M16 v[68:71],a[36:39],v[168:171],v[68:71]
DTR v[162:163],v194 offset:15520
M16 v[68:71],a[52:55],v[172:175],v[68:71]
DR a[28:31],v13 offset:6144
s_waitcnt lgkmcnt(8)
M16 v[72:75],a[40:43],v[168:171],v[72:75]
DTR v[164:165],v194 offset:16640
s_add_u32 m0, s32, 0
M16 v[72:75],a[56:59],v[172:175],v[72:75]
M16 v[76:79],a[44:47],v[168:171],v[76:79]
DTR v[166:167],v194 offset:16800
M16 v[76:79],a[60:63],v[172:175],v[76:79]
s_waitcnt lgkmcnt(2)
BL4 v204,s[12:15],s33 offen lds
BL4 v205,s[12:15],s33 offen offset:1024 lds
BL4 v206,s[12:15],s33 offen offset:2048 lds
BL4 v207,s[12:15],s33 offen offset:3072 lds
M16 v[16:19],v[144:147],a[0:3],v[16:19]
DTR v[168:169],v195 offset:15360
s_add_u32 m0, s32, 4096
M16 v[16:19],v[148:151],a[16:19],v[16:19]
s_mov_b32 s33, 1024
M16 v[20:23],v[144:147],a[4:7],v[20:23]
DTR v[170:171],v195 offset:15520
M16 v[20:23],v[148:151],a[20:23],v[20:23]
BL4 v200,s[12:15],s33 offen lds
M16 v[24:27],v[144:147],a[8:11],v[24:27]
DTR v[172:173],v195 offset:16640
M16 v[24:27],v[148:151],a[24:27],v[24:27]
M16 v[28:31],v[144:147],a[12:15],v[28:31]
DTR v[174:175],v195 offset:16800
M16 v[28:31],v[148:151],a[28:31],v[28:31]
BL4 v201,s[12:15],s33 offen offset:1024 lds
M16 v[32:35],v[152:155],a[0:3],v[32:35]
DTR v[144:145],v192 offset:17920
M16 v[32:35],v[156:159],a[16:19],v[32:35]
BL4 v202,s[12:15],s33 offen offset:2048 lds
M16 v[36:39],v[152:155],a[4:7],v[36:39]
DTR v[146:147],v192 offset:18080
M16 v[36:39],v[156:159],a[20:23],v[36:39]
BL4 v203,s[12:15],s33 offen offset:3072 lds
M16 v[40:43],v[152:155],a[8:11],v[40:43]
DTR v[148:149],v192 offset:19200
s_waitcnt vmcnt(8)
M16 v[40:43],v[156:159],a[24:27],v[40:43]
DR a[32:35],v12 offset:8192
M16 v[44:47],v[152:155],a[12:15],v[44:47]
DTR v[150:151],v192 offset:19360
M16 v[44:47],v[156:159],a[28:31],v[44:47]
s_waitcnt lgkmcnt(9)
DR a[48:51],v13 offset:8192
M16 v[48:51],a[0:3],v[160:163],v[48:51]
DTR v[152:153],v193 offset:17920
M16 v[48:51],a[16:19],v[164:167],v[48:51]
DR a[36:39],v12 offset:10240
M16 v[52:55],a[4:7],v[160:163],v[52:55]
DTR v[154:155],v193 offset:18080
M16 v[52:55],a[20:23],v[164:167],v[52:55]
DR a[52:55],v13 offset:10240
s_waitcnt vmcnt(4)
M16 v[56:59],a[8:11],v[160:163],v[56:59]
DTR v[156:157],v193 offset:19200
M16 v[56:59],a[24:27],v[164:167],v[56:59]
DR a[40:43],v12 offset:0
M16 v[60:63],a[12:15],v[160:163],v[60:63]
DTR v[158:159],v193 offset:19360
M16 v[60:63],a[28:31],v[164:167],v[60:63]
s_waitcnt lgkmcnt(13)
DR a[56:59],v13 offset:0
M16 v[64:67],a[0:3],v[168:171],v[64:67]
DTR v[160:161],v194 offset:17920
M16 v[64:67],a[16:19],v[172:175],v[64:67]
DR a[44:47],v12 offset:2048
M16 v[68:71],a[4:7],v[168:171],v[68:71]
DTR v[162:163],v194 offset:18080
M16 v[68:71],a[20:23],v[172:175],v[68:71]
DR a[60:63],v13 offset:2048
s_waitcnt lgkmcnt(8)
M16 v[72:75],a[8:11],v[168:171],v[72:75]
DTR v[164:165],v194 offset:19200
s_add_u32 m0, s32, 8192
M16 v[72:75],a[24:27],v[172:175],v[72:75]
M16 v[76:79],a[12:15],v[168:171],v[76:79]
DTR v[166:167],v194 offset:19360
M16 v[76:79],a[28:31],v[172:175],v[76:79]
s_waitcnt lgkmcnt(2)
BL4 v204,s[12:15],s33 offen lds
BL4 v205,s[12:15],s33 offen offset:1024 lds
BL4 v206,s[12:15],s33 offen offset:2048 lds
BL4 v207,s[12:15],s33 offen offset:3072 lds
M16 v[16:19],v[144:147],a[32:35],v[16:19]
DTR v[168:169],v195 offset:17920
s_add_u32 m0, s32, 0
M16 v[16:19],v[148:151],a[48:51],v[16:19]
s_mov_b32 s33, 1152
M16 v[20:23],v[144:147],a[36:39],v[20:23]
DTR v[170:171],v195 offset:18080
M16 v[20:23],v[148:151],a[52:55],v[20:23]
BL4 v200,s[12:15],s33 offen lds
M16 v[24:27],v[144:147],a[40:43],v[24:27]
DTR v[172:173],v195 offset:19200
M16 v[24:27],v[148:151],a[56:59],v[24:27]
M16 v[28:31],v[144:147],a[44:47],v[28:31]
DTR v[174:175],v195 offset:19360
M16 v[28:31],v[148:151],a[60:63],v[28:31]
BL4 v201,s[12:15],s33 offen offset:1024 lds
M16 v[32:35],v[152:155],a[32:35],v[32:35]
DTR v[144:145],v192 offset:20480
M16 v[32:35],v[156:159],a[48:51],v[32:35]
BL4 v202,s[12:15],s33 offen offset:2048 lds
M16 v[36:39],v[152:155],a[36:39],v[36:39]
DTR v[146:147],v192 offset:20640
M16 v[36:39],v[156:159],a[52:55],v[36:39]
BL4 v203,s[12:15],s33 offen offset:3072 lds
M16 v[40:43],v[152:155],a[40:43],v[40:43]
DTR v[148:149],v192 offset:21760
s_waitcnt vmcnt(8)
M16 v[40:43],v[156:159],a[56:59],v[40:43]
DR a[0:3],v12 offset:4096
M16 v[44:47],v[152:155],a[44:47],v[44:47]
DTR v[150:151],v192 offset:21920
M16 v[44:47],v[156:159],a[60:63],v[44:47]
s_waitcnt lgkmcnt(9)
DR a[16:19],v13 offset:4096
M16 v[48:51],a[32:35],v[160:163],v[48:51]
DTR v[152:153],v193 offset:20480
M16 v[48:51],a[48:51],v[164:167],v[48:51]
DR a[4:7],v12 offset:6144
M16 v[52:55],a[36:39],v[160:163],v[52:55]
DTR v[154:155],v193 offset:20640
M16 v[52:55],a[52:55],v[164:167],v[52:55]
DR a[20:23],v13 offset:6144
s_waitcnt vmcnt(4)
M16 v[56:59],a[40:43],v[160:163],v[56:59]
DTR v[156:157],v193 offset:21760
M16 v[56:59],a[56:59],v[164:167],v[56:59]
DR a[8:11],v12 offset:8192
M16 v[60:63],a[44:47],v[160:163],v[60:63]
DTR v[158:159],v193 offset:21920
M16 v[60:63],a[60:63],v[164:167],v[60:63]
s_waitcnt lgkmcnt(13)
DR a[24:27],v13 offset:8192
M16 v[64:67],a[32:35],v[168:171],v[64:67]
DTR v[160:161],v194 offset:20480
M16 v[64:67],a[48:51],v[172:175],v[64:67]
DR a[12:15],v12 offset:10240
M16 v[68:71],a[36:39],v[168:171],v[68:71]
DTR v[162:163],v194 offset:20640
M16 v[68:71],a[52:55],v[172:175],v[68:71]
DR a[28:31],v13 offset:10240
s_waitcnt lgkmcnt(8)
M16 v[72:75],a[40:43],v[168:171],v[72:75]
DTR v[164:165],v194 offset:21760
s_add_u32 m0, s32, 4096
M16 v[72:75],a[56:59],v[172:175],v[72:75]
M16 v[76:79],a[44:47],v[168:171],v[76:79]
DTR v[166:167],v194 offset:21920
M16 v[76:79],a[60:63],v[172:175],v[76:79]
s_waitcnt lgkmcnt(2)
BL4 v204,s[12:15],s33 offen lds
BL4 v205,s[12:15],s33 offen offset:1024 lds
BL4 v206,s[12:15],s33 offen offset:2048 lds
BL4 v207,s[12:15],s33 offen offset:3072 lds
M16 v[16:19],v[144:147],a[0:3],v[16:19]
DTR v[168:169],v195 offset:20480
s_waitcnt vmcnt(4)
M16 v[16:19],v[148:151],a[16:19],v[16:19]
DR a[32:35],v12 offset:0
M16 v[20:23],v[144:147],a[4:7],v[20:23]
DTR v[170:171],v195 offset:20640
M16 v[20:23],v[148:151],a[20:23],v[20:23]
DR a[48:51],v13 offset:0
M16 v[24:27],v[144:147],a[8:11],v[24:27]
DTR v[172:173],v195 offset:21760
M16 v[24:27],v[148:151],a[24:27],v[24:27]
DR a[36:39],v12 offset:2048
M16 v[28:31],v[144:147],a[12:15],v[28:31]
DTR v[174:175],v195 offset:21920
M16 v[28:31],v[148:151],a[28:31],v[28:31]
DR a[52:55],v13 offset:2048
M16 v[32:35],v[152:155],a[0:3],v[32:35]
DTR v[144:145],v192 offset:23040
s_waitcnt vmcnt(0)
M16 v[32:35],v[156:159],a[16:19],v[32:35]
DR a[40:43],v12 offset:4096
M16 v[36:39],v[152:155],a[4:7],v[36:39]
DTR v[146:147],v192 offset:23200
M16 v[36:39],v[156:159],a[20:23],v[36:39]
DR a[56:59],v13 offset:4096
M16 v[40:43],v[152:155],a[8:11],v[40:43]
DTR v[148:149],v192 offset:24320
M16 v[40:43],v[156:159],a[24:27],v[40:43]
DR a[44:47],v12 offset:6144
M16 v[44:47],v[152:155],a[12:15],v[44:47]
DTR v[150:151],v192 offset:24480
M16 v[44:47],v[156:159],a[28:31],v[44:47]
s_waitcnt lgkmcnt(15)
DR a[60:63],v13 offset:6144
M16 v[48:51],a[0:3],v[160:163],v[48:51]
DTR v[152:153],v193 offset:23040
s_waitcnt lgkmcnt(9)
M16 v[48:51],a[16:19],v[164:167],v[48:51]
M16 v[52:55],a[4:7],v[160:163],v[52:55]
DTR v[154:155],v193 offset:23200
M16 v[52:55],a[20:23],v[164:167],v[52:55]
M16 v[56:59],a[8:11],v[160:163],v[56:59]
DTR v[156:157],v193 offset:24320
M16 v[56:59],a[24:27],v[164:167],v[56:59]
M16 v[60:63],a[12:15],v[160:163],v[60:63]
DTR v[158:159],v193 offset:24480
M16 v[60:63],a[28:31],v[164:167],v[60:63]
M16 v[64:67],a[0:3],v[168:171],v[64:67]
DTR v[160:161],v194 offset:23040
M16 v[64:67],a[16:19],v[172:175],v[64:67]
M16 v[68:71],a[4:7],v[168:171],v[68:71]
DTR v[162:163],v194 offset:23200
M16 v[68:71],a[20:23],v[172:175],v[68:71]
M16 v[72:75],a[8:11],v[168:171],v[72:75]
DTR v[164:165],v194 offset:24320
M16 v[72:75],a[24:27],v[172:175],v[72:75]
M16 v[76:79],a[12:15],v[168:171],v[76:79]
DTR v[166:167],v194 offset:24480
M16 v[76:79],a[28:31],v[172:175],v[76:79]
s_waitcnt lgkmcnt(8)
M16 v[16:19],v[144:147],a[32:35],v[16:19]
DTR v[168:169],v195 offset:23040
M16 v[16:19],v[148:151],a[48:51],v[16:19]
M16 v[20:23],v[144:147],a[36:39],v[20:23]
DTR v[170:171],v195 offset:23200
M16 v[20:23],v[148:151],a[52:55],v[20:23]
M16 v[24:27],v[144:147],a[40:43],v[24:27]
DTR v[172:173],v195 offset:24320
M16 v[24:27],v[148:151],a[56:59],v[24:27]
s_waitcnt lgkmcnt(7)
M16 v[28:31],v[144:147],a[44:47],v[28:31]
DTR v[174:175],v195 offset:24480
M16 v[28:31],v[148:151],a[60:63],v[28:31]
M16 v[32:35],v[152:155],a[32:35],v[32:35]
M16 v[32:35],v[156:159],a[48:51],v[32:35]
M16 v[36:39],v[152:155],a[36:39],v[36:39]
M16 v[36:39],v[156:159],a[52:55],v[36:39]
M16 v[40:43],v[152:155],a[40:43],v[40:43]
M16 v[40:43],v[156:159],a[56:59],v[40:43]
M16 v[44:47],v[152:155],a[44:47],v[44:47]
M16 v[44:47],v[156:159],a[60:63],v[44:47]
s_waitcnt lgkmcnt(4)
M16 v[48:51],a[32:35],v[160:163],v[48:51]
M16 v[48:51],a[48:51],v[164:167],v[48:51]
M16 v[52:55],a[36:39],v[160:163],v[52:55]
M16 v[52:55],a[52:55],v[164:167],v[52:55]
M16 v[56:59],a[40:43],v[160:163],v[56:59]
M16 v[56:59],a[56:59],v[164:167],v[56:59]
M16 v[60:63],a[44:47],v[160:163],v[60:63]
M16 v[60:63],a[60:63],v[164:167],v[60:63]
s_waitcnt lgkmcnt(0)
M16 v[64:67],a[32:35],v[168:171],v[64:67]
M16 v[64:67],a[48:51],v[172:175],v[64:67]
M16 v[68:71],a[36:39],v[168:171],v[68:71]
M16 v[68:71],a[52:55],v[172:175],v[68:71]
M16 v[72:75],a[40:43],v[168:171],v[72:75]
M16 v[72:75],a[56:59],v[172:175],v[72:75]
M16 v[76:79],a[44:47],v[168:171],v[76:79]
M16 v[76:79],a[60:63],v[172:175],v[76:79]
s_nop 7
CVT v224,v16,v17
CVT v225,v18,v19
CVT v226,v20,v21
CVT v227,v22,v23
CVT v228,v24,v25
CVT v229,v26,v27
CVT v230,v28,v29
CVT v231,v30,v31
CVT v232,v32,v33
CVT v233,v34,v35
CVT v234,v36,v37
CVT v235,v38,v39
CVT v236,v40,v41
CVT v237,v42,v43
CVT v238,v44,v45
CVT v239,v46,v47
CVT v240,v48,v49
CVT v241,v50,v51
CVT v242,v52,v53
CVT v243,v54,v55
CVT v244,v56,v57
CVT v245,v58,v59
CVT v246,v60,v61
CVT v247,v62,v63
CVT v248,v64,v65
CVT v249,v66,v67
CVT v250,v68,v69
CVT v251,v70,v71
CVT v252,v72,v73
CVT v253,v74,v75
CVT v254,v76,v77
CVT v255,v78,v79
s_lshl_b32 s44, s21, 2
s_add_u32 s44, s44, s20
v_and_b32 v12, 15, v1
v_lshlrev_b32 v13, 3, v12
v_lshlrev_b32 v12, 4, v12
v_mov_b32 v2, v12
v_lshrrev_b32 v3, 5, v1
v_lshl_add_u32 v12, v3, 9, v12
v_lshl_add_u32 v2, v3, 3, v2
v_bfe_u32 v3, v1, 4, 1
v_lshl_add_u32 v12, v3, 3, v12
v_lshl_add_u32 v2, v3, 9, v2
s_lshl_b32 s45, s44, 11
s_add_u32 s45, s45, 71303168
s_lshl_b32 s43, s44, 12
s_add_u32 s43, s43, 72351744
s_lshl_b32 s44, s44, 10
s_add_u32 s44, s44, 71827456
buffer_store_dwordx2 v[224:225], v12, s[16:19], s45 offen sc1
buffer_store_dwordx2 v[226:227], v12, s[16:19], s45 offen offset:256 sc1
buffer_store_dwordx2 v[228:229], v12, s[16:19], s45 offen offset:1024 sc1
buffer_store_dwordx2 v[230:231], v12, s[16:19], s45 offen offset:1280 sc1
buffer_store_dwordx2 v[240:241], v2, s[16:19], s43 offen sc1
buffer_store_dwordx2 v[242:243], v2, s[16:19], s43 offen offset:1024 sc1
buffer_store_dwordx2 v[244:245], v2, s[16:19], s43 offen offset:2048 sc1
buffer_store_dwordx2 v[246:247], v2, s[16:19], s43 offen offset:3072 sc1
v_cmp_gt_u32 vcc, 16, v1
v_mov_b32 v4, 0x3f803f80
v_mov_b32 v5, 0x00003f80
v_lshrrev_b32 v3, 4, v1
v_lshl_add_u32 v13, v3, 8, v13
v_cndmask_b32 v232, v4, v232, vcc
v_cndmask_b32 v233, v5, v233, vcc
v_cndmask_b32 v234, v4, v234, vcc
v_cndmask_b32 v235, v5, v235, vcc
v_cndmask_b32 v236, v4, v236, vcc
v_cndmask_b32 v237, v5, v237, vcc
v_cndmask_b32 v238, v4, v238, vcc
v_cndmask_b32 v239, v5, v239, vcc
v_and_b32 v3, 15, v1
v_cmp_eq_u32 vcc, 4, v3
s_mov_b32 exec_hi, 0
buffer_store_dwordx2 v[232:233], v13, s[16:19], s44 offen sc1
buffer_store_dwordx2 v[234:235], v13, s[16:19], s44 offen offset:128 sc1
buffer_store_dwordx2 v[236:237], v13, s[16:19], s44 offen offset:512 sc1
buffer_store_dwordx2 v[238:239], v13, s[16:19], s44 offen offset:640 sc1
s_mov_b64 exec, -1
v_cndmask_b32 v4, 0, v4, vcc
v_cmp_gt_u32 vcc, 4, v3
s_nop 1
v_cndmask_b32 v248, v4, v248, vcc
v_cndmask_b32 v249, v4, v249, vcc
v_cndmask_b32 v250, v4, v250, vcc
v_cndmask_b32 v251, v4, v251, vcc
v_cndmask_b32 v252, v4, v252, vcc
v_cndmask_b32 v253, v4, v253, vcc
v_cndmask_b32 v254, v4, v254, vcc
v_cndmask_b32 v255, v4, v255, vcc
buffer_store_dwordx2 v[248:249], v2, s[16:19], s43 offen offset:256 sc1
buffer_store_dwordx2 v[250:251], v2, s[16:19], s43 offen offset:1280 sc1
buffer_store_dwordx2 v[252:253], v2, s[16:19], s43 offen offset:2304 sc1
buffer_store_dwordx2 v[254:255], v2, s[16:19], s43 offen offset:3328 sc1
L_p1_B_end:
s_lshl_b32 s97, s21, 2
s_add_u32 s97, s97, 128
s_waitcnt vmcnt(0)
s_barrier
s_lshr_b32 s98, s97, 31
s_or_b32 s98, s98, s20
s_cbranch_scc1 L_sg1
v_mov_b32 v12, s97
v_mov_b32 v13, 1
s_mov_b64 exec, 1
global_atomic_add v12, v13, s[88:89]
s_mov_b64 exec, -1
L_sg1:
s_mov_b32 s97, -1
s_mul_i32 s41, s21, 6
s_add_u32 s41, s41, s22
s_sub_u32 s41, s41, 26
s_lshl_b32 s41, s41, 2
s_add_u32 s41, s41, s20
s_mul_i32 s40, s41, 107
v_min_u32 v212, 63, v1
v_add_u32 v212, s40, v212
v_min_u32 v212, 20479, v212
v_mov_b32 v214, s64
v_mov_b32 v215, s65
v_mov_b32 v213, v212
v_lshlrev_b32 v213, 7, v213
v_add_co_u32 v214, vcc, v214, v213
s_nop 1
v_addc_co_u32 v215, vcc, 0, v215, vcc
global_load_dword v116, v[214:215], off
v_min_u32 v212, 42, v1
v_add_u32 v212, s40, v212
v_add_u32 v212, 64, v212
v_min_u32 v212, 20479, v212
v_mov_b32 v214, s64
v_mov_b32 v215, s65
v_mov_b32 v213, v212
v_lshlrev_b32 v213, 7, v213
v_add_co_u32 v214, vcc, v214, v213
s_nop 1
v_addc_co_u32 v215, vcc, 0, v215, vcc
global_load_dword v116, v[214:215], off
L_p2_entry:
s_and_b32 s12, s2, 7
s_lshl_b32 s12, s12, 2
s_bfe_u32 s13, s2, 0x20003
s_add_u32 s21, s12, s13
s_lshr_b32 s22, s2, 5
s_mov_b32 s4, s68
s_mov_b32 s5, s69
s_mov_b32 s6, 5242880
s_mov_b32 s7, 0x00020000
s_mov_b32 s92, s64
s_mov_b32 s93, s65
s_mov_b32 s94, 2621440
s_mov_b32 s95, 0x00020000
s_lshl_b32 s70, s21, 8
s_mov_b32 s71, 524288
s_lshl_b32 s73, s20, 12
s_lshl_b32 s66, s20, 13
s_add_u32 s66, s66, 131072
s_add_u32 s72, s73, 49152
s_lshr_b32 s12, s71, 6
v_lshrrev_b32 v8, 4, v1
s_lshl_b32 s13, s20, 4
v_add_u32 v9, s13, v8
v_mul_lo_u32 v9, v9, s12
v_lshlrev_b32 v8, 1, v8
v_and_b32 v10, 15, v1
v_xor_b32 v8, v8, v10
s_lshl_b32 s12, s12, 2
s_sub_u32 s12, s12, 1024
v_lshl_add_u32 v208, v8, 4, v9
v_add_u32 v209, s12, v208
v_xor_b32 v8, 8, v8
v_lshl_add_u32 v210, v8, 4, v9
s_lshl_b32 s13, s12, 1
v_add_u32 v210, s13, v210
v_add_u32 v211, s12, v210
s_lshl_b32 s12, s22, 3
s_add_u32 s12, s12, s20
s_mul_i32 s12, s12, 20480
s_lshl_b32 s13, s22, 2
s_sub_u32 s13, 30, s13
s_mul_i32 s13, s13, 81920
v_lshrrev_b32 v8, 3, v1
v_mul_u32_u24 v8, 1280, v8
v_add_u32 v8, s12, v8
v_and_b32 v9, 7, v1
v_lshrrev_b32 v10, 4, v1
v_xor_b32 v9, v9, v10
v_xor_b32 v10, 4, v9
v_lshl_add_u32 v9, v9, 4, v8
v_lshl_add_u32 v10, v10, 4, v8
v_add_u32 v220, 0, v9
v_add_u32 v221, 9216, v10
v_add_u32 v222, 79872, v9
v_add_u32 v223, 89088, v10
v_add_u32 v9, s13, v9
v_add_u32 v10, s13, v10
v_add_u32 v224, 0, v9
v_add_u32 v225, 9216, v10
v_add_u32 v226, 79872, v9
v_add_u32 v227, 89088, v10
v_and_b32 v8, 15, v1
v_lshrrev_b32 v9, 1, v8
v_lshrrev_b32 v10, 4, v1
v_xor_b32 v9, v9, v10
v_lshlrev_b32 v9, 4, v9
v_lshl_add_u32 v212, v8, 7, v9
v_add_u32 v212, s66, v212
v_xor_b32 v213, 64, v212
v_lshrrev_b32 v8, 4, v1
v_bfe_u32 v9, v1, 2, 2
v_lshl_add_u32 v10, v8, 3, v9
v_lshlrev_b32 v10, 8, v10
v_and_b32 v8, 1, v8
v_lshl_add_u32 v9, v8, 2, v9
v_lshl_add_u32 v10, v9, 5, v10
v_and_b32 v8, 3, v1
v_lshl_add_u32 v10, v8, 3, v10
v_add_u32 v228, 81920, v10
v_xor_b32 v229, 32, v228
v_xor_b32 v230, 64, v228
v_xor_b32 v231, 96, v228
v_xor_b32 v232, 128, v228
v_xor_b32 v233, 160, v228
v_xor_b32 v234, 192, v228
v_xor_b32 v235, 224, v228
s_sub_u32 s12, s72, s66
v_add_u32 v214, s12, v212
v_add_u32 v215, s12, v213
s_add_u32 m0, s73, 81920
s_nop 0
BL4 v208,s[4:7],s70 offen lds
BL4 v209,s[4:7],s70 offen offset:1024 lds
BL4 v210,s[4:7],s70 offen offset:2048 lds
BL4 v211,s[4:7],s70 offen offset:3072 lds
s_add_u32 s70, s70, s71
s_add_u32 m0, s66, 0
s_mov_b32 s67, 0
BL4 v220,s[92:95],s67 offen lds
BL4 v221,s[92:95],s67 offen offset:1024 lds
BL4 v222,s[92:95],s67 offen offset:2048 lds
BL4 v223,s[92:95],s67 offen offset:3072 lds
s_add_u32 m0, s66, 4096
s_nop 0
BL4 v224,s[92:95],s67 offen lds
BL4 v225,s[92:95],s67 offen offset:1024 lds
BL4 v226,s[92:95],s67 offen offset:2048 lds
BL4 v227,s[92:95],s67 offen offset:3072 lds
s_add_u32 m0, s73, 98304
s_nop 0
BL4 v208,s[4:7],s70 offen lds
BL4 v209,s[4:7],s70 offen offset:1024 lds
BL4 v210,s[4:7],s70 offen offset:2048 lds
BL4 v211,s[4:7],s70 offen offset:3072 lds
s_add_u32 s70, s70, s71
L_p2_entry_early:
s_mov_b32 s67, 128
s_mov_b32 m0, s72
s_nop 0
BL4 v220,s[92:95],s67 offen lds
BL4 v221,s[92:95],s67 offen offset:1024 lds
BL4 v222,s[92:95],s67 offen offset:2048 lds
BL4 v223,s[92:95],s67 offen offset:3072 lds
v_lshlrev_b32 v2, 4, v1
s_lshl_b32 s30, s20, 12
v_add_u32 v3, s30, v2
s_add_u32 s31, s30, 65536
v_add_u32 v7, 65536, v2
s_mov_b32 s8, s90
s_mov_b32 s9, s91
s_mov_b32 s10, 268435456
s_mov_b32 s11, 0x00020000
s_lshr_b32 s12, s2, 3
s_lshl_b32 s12, s12, 2
s_add_u32 s12, s12, s20
s_getpc_b64 s[56:57]
L_pc_2:
s_add_u32 s56, s56, L_p2_entry-L_pc_2
s_addc_u32 s57, s57, 0-(((L_p2_entry-L_pc_2)>>63)&1)
s_mul_i32 s58, s12, (((L_p2_end-L_p2_entry)/128+128)/128)
v_min_u32 v170, (((L_p2_end-L_p2_entry)/128+128)/128)-1, v1
v_add_u32 v170, s58, v170
v_min_u32 v170, (L_p2_end-L_p2_entry)/128, v170
v_lshlrev_b32 v170, 7, v170
global_load_dword v175, v170, s[56:57]
s_lshl_b32 s24, s21, 20
s_add_u32 s25, s24, 16384
s_mov_b32 s26, 0
s_mov_b32 s27, 0
v_lshlrev_b32 v168, 2, v1
s_waitcnt vmcnt(8)
s_barrier
DR a[192:195],v212 offset:0
DR a[208:211],v213 offset:0
DR a[196:199],v212 offset:2048
DR a[212:215],v213 offset:2048
DR a[200:203],v212 offset:4096
DR a[216:219],v213 offset:4096
DR a[204:207],v212 offset:6144
DR a[220:223],v213 offset:6144
s_waitcnt lgkmcnt(4)
s_add_u32 m0, s66, 0
s_nop 0
BL4 v224,s[92:95],s67 offen lds
BL4 v225,s[92:95],s67 offen offset:1024 lds
BL4 v226,s[92:95],s67 offen offset:2048 lds
BL4 v227,s[92:95],s67 offen offset:3072 lds
DTR a[128:129],v228 offset:0
DTR a[130:131],v228 offset:1024
DTR a[132:133],v228 offset:8192
DTR a[134:135],v228 offset:9216
DTR a[136:137],v229 offset:0
DTR a[138:139],v229 offset:1024
DTR a[140:141],v229 offset:8192
DTR a[142:143],v229 offset:9216
DTR a[144:145],v230 offset:0
DTR a[146:147],v230 offset:1024
DTR a[148:149],v230 offset:8192
DTR a[150:151],v230 offset:9216
DTR a[152:153],v231 offset:0
DTR a[154:155],v231 offset:1024
DTR a[156:157],v231 offset:8192
DTR a[158:159],v231 offset:9216
DTR a[160:161],v232 offset:0
DTR a[162:163],v232 offset:1024
DTR a[164:165],v232 offset:8192
DTR a[166:167],v232 offset:9216
s_waitcnt lgkmcnt(15)
M16 v[16:19],a[128:131],a[192:195],0
DTR a[168:169],v233 offset:0
s_add_u32 m0, s66, 4096
M16 v[16:19],a[132:135],a[208:211],v[16:19]
s_mov_b32 s67, 256
M16 v[20:23],a[128:131],a[196:199],0
DTR a[170:171],v233 offset:1024
M16 v[20:23],a[132:135],a[212:215],v[20:23]
BL4 v220,s[92:95],s67 offen lds
M16 v[24:27],a[128:131],a[200:203],0
DTR a[172:173],v233 offset:8192
M16 v[24:27],a[132:135],a[216:219],v[24:27]
BL4 v221,s[92:95],s67 offen offset:1024 lds
M16 v[28:31],a[128:131],a[204:207],0
DTR a[174:175],v233 offset:9216
M16 v[28:31],a[132:135],a[220:223],v[28:31]
s_waitcnt lgkmcnt(15)
M16 v[32:35],a[136:139],a[192:195],0
DTR a[128:129],v234 offset:0
M16 v[32:35],a[140:143],a[208:211],v[32:35]
BL4 v222,s[92:95],s67 offen offset:2048 lds
M16 v[36:39],a[136:139],a[196:199],0
DTR a[130:131],v234 offset:1024
M16 v[36:39],a[140:143],a[212:215],v[36:39]
BL4 v223,s[92:95],s67 offen offset:3072 lds
M16 v[40:43],a[136:139],a[200:203],0
DTR a[132:133],v234 offset:8192
s_waitcnt vmcnt(8)
M16 v[40:43],a[140:143],a[216:219],v[40:43]
DR a[224:227],v214 offset:0
M16 v[44:47],a[136:139],a[204:207],0
DTR a[134:135],v234 offset:9216
M16 v[44:47],a[140:143],a[220:223],v[44:47]
s_waitcnt lgkmcnt(15)
DR a[240:243],v215 offset:0
M16 v[48:51],a[144:147],a[192:195],0
DTR a[136:137],v235 offset:0
M16 v[48:51],a[148:151],a[208:211],v[48:51]
DR a[228:231],v214 offset:2048
M16 v[52:55],a[144:147],a[196:199],0
DTR a[138:139],v235 offset:1024
M16 v[52:55],a[148:151],a[212:215],v[52:55]
DR a[244:247],v215 offset:2048
s_waitcnt vmcnt(4)
M16 v[56:59],a[144:147],a[200:203],0
DTR a[140:141],v235 offset:8192
M16 v[56:59],a[148:151],a[216:219],v[56:59]
s_waitcnt lgkmcnt(15)
DR a[232:235],v212 offset:0
M16 v[60:63],a[144:147],a[204:207],0
DTR a[142:143],v235 offset:9216
M16 v[60:63],a[148:151],a[220:223],v[60:63]
s_barrier
s_lshr_b32 s98, s97, 31
s_or_b32 s98, s98, s20
s_cbranch_scc1 L_sg2
v_mov_b32 v170, s97
v_mov_b32 v171, 1
s_mov_b64 exec, 1
global_atomic_add v170, v171, s[88:89]
s_mov_b64 exec, -1
L_sg2:
M16 v[64:67],a[152:155],a[192:195],0
DTR a[144:145],v228 offset:16384
M16 v[64:67],a[156:159],a[208:211],v[64:67]
DR a[248:251],v213 offset:0
M16 v[68:71],a[152:155],a[196:199],0
DTR a[146:147],v228 offset:17408
M16 v[68:71],a[156:159],a[212:215],v[68:71]
DR a[236:239],v212 offset:2048
M16 v[72:75],a[152:155],a[200:203],0
DTR a[148:149],v228 offset:24576
M16 v[72:75],a[156:159],a[216:219],v[72:75]
DR a[252:255],v213 offset:2048
s_waitcnt lgkmcnt(9)
M16 v[76:79],a[152:155],a[204:207],0
DTR a[150:151],v228 offset:25600
s_mov_b32 m0, s72
M16 v[76:79],a[156:159],a[220:223],v[76:79]
M16 v[80:83],a[160:163],a[192:195],0
DTR a[152:153],v229 offset:16384
M16 v[80:83],a[164:167],a[208:211],v[80:83]
BL4 v224,s[92:95],s67 offen lds
M16 v[84:87],a[160:163],a[196:199],0
DTR a[154:155],v229 offset:17408
M16 v[84:87],a[164:167],a[212:215],v[84:87]
BL4 v225,s[92:95],s67 offen offset:1024 lds
M16 v[88:91],a[160:163],a[200:203],0
DTR a[156:157],v229 offset:24576
M16 v[88:91],a[164:167],a[216:219],v[88:91]
BL4 v226,s[92:95],s67 offen offset:2048 lds
M16 v[92:95],a[160:163],a[204:207],0
DTR a[158:159],v229 offset:25600
M16 v[92:95],a[164:167],a[220:223],v[92:95]
M16 v[96:99],a[168:171],a[192:195],0
DTR a[160:161],v230 offset:16384
M16 v[96:99],a[172:175],a[208:211],v[96:99]
BL4 v227,s[92:95],s67 offen offset:3072 lds
M16 v[100:103],a[168:171],a[196:199],0
DTR a[162:163],v230 offset:17408
s_add_u32 m0, s73, 114688
M16 v[100:103],a[172:175],a[212:215],v[100:103]
BL4 v208,s[4:7],s70 offen lds
M16 v[104:107],a[168:171],a[200:203],0
DTR a[164:165],v230 offset:24576
M16 v[104:107],a[172:175],a[216:219],v[104:107]
BL4 v209,s[4:7],s70 offen offset:1024 lds
M16 v[108:111],a[168:171],a[204:207],0
DTR a[166:167],v230 offset:25600
M16 v[108:111],a[172:175],a[220:223],v[108:111]
M16 v[112:115],a[128:131],a[192:195],0
DTR a[168:169],v231 offset:16384
M16 v[112:115],a[132:135],a[208:211],v[112:115]
BL4 v210,s[4:7],s70 offen offset:2048 lds
M16 v[116:119],a[128:131],a[196:199],0
DTR a[170:171],v231 offset:17408
M16 v[116:119],a[132:135],a[212:215],v[116:119]
BL4 v211,s[4:7],s70 offen offset:3072 lds
M16 v[120:123],a[128:131],a[200:203],0
DTR a[172:173],v231 offset:24576
s_add_u32 s70, s70, s71
M16 v[120:123],a[132:135],a[216:219],v[120:123]
AW a0,0
AW a1,0
M16 v[124:127],a[128:131],a[204:207],0
DTR a[174:175],v231 offset:25600
AW a2,0
M16 v[124:127],a[132:135],a[220:223],v[124:127]
s_waitcnt lgkmcnt(15)
AW a3,0
AW a4,0
M16 v[128:131],a[136:139],a[192:195],0
DTR a[128:129],v232 offset:16384
AW a5,0
M16 v[128:131],a[140:143],a[208:211],v[128:131]
AW a6,0
AW a7,0
M16 v[132:135],a[136:139],a[196:199],0
DTR a[130:131],v232 offset:17408
AW a8,0
M16 v[132:135],a[140:143],a[212:215],v[132:135]
AW a9,0
AW a10,0
M16 v[136:139],a[136:139],a[200:203],0
DTR a[132:133],v232 offset:24576
AW a11,0
M16 v[136:139],a[140:143],a[216:219],v[136:139]
AW a12,0
AW a13,0
M16 v[140:143],a[136:139],a[204:207],0
DTR a[134:135],v232 offset:25600
AW a14,0
M16 v[140:143],a[140:143],a[220:223],v[140:143]
s_waitcnt lgkmcnt(15)
AW a15,0
M16 v[16:19],a[144:147],a[224:227],v[16:19]
DTR a[136:137],v233 offset:16384
s_add_u32 m0, s66, 0
M16 v[16:19],a[148:151],a[240:243],v[16:19]
s_mov_b32 s67, 384
M16 v[20:23],a[144:147],a[228:231],v[20:23]
DTR a[138:139],v233 offset:17408
M16 v[20:23],a[148:151],a[244:247],v[20:23]
BL4 v220,s[92:95],s67 offen lds
M16 v[24:27],a[144:147],a[232:235],v[24:27]
DTR a[140:141],v233 offset:24576
M16 v[24:27],a[148:151],a[248:251],v[24:27]
BL4 v221,s[92:95],s67 offen offset:1024 lds
M16 v[28:31],a[144:147],a[236:239],v[28:31]
DTR a[142:143],v233 offset:25600
M16 v[28:31],a[148:151],a[252:255],v[28:31]
s_waitcnt lgkmcnt(15)
M16 v[32:35],a[152:155],a[224:227],v[32:35]
DTR a[144:145],v234 offset:16384
M16 v[32:35],a[156:159],a[240:243],v[32:35]
BL4 v222,s[92:95],s67 offen offset:2048 lds
M16 v[36:39],a[152:155],a[228:231],v[36:39]
DTR a[146:147],v234 offset:17408
M16 v[36:39],a[156:159],a[244:247],v[36:39]
BL4 v223,s[92:95],s67 offen offset:3072 lds
M16 v[40:43],a[152:155],a[232:235],v[40:43]
DTR a[148:149],v234 offset:24576
s_waitcnt vmcnt(12)
M16 v[40:43],a[156:159],a[248:251],v[40:43]
DR a[192:195],v212 offset:4096
M16 v[44:47],a[152:155],a[236:239],v[44:47]
DTR a[150:151],v234 offset:25600
M16 v[44:47],a[156:159],a[252:255],v[44:47]
s_waitcnt lgkmcnt(15)
DR a[208:211],v213 offset:4096
M16 v[48:51],a[160:163],a[224:227],v[48:51]
DTR a[152:153],v235 offset:16384
M16 v[48:51],a[164:167],a[240:243],v[48:51]
DR a[196:199],v212 offset:6144
M16 v[52:55],a[160:163],a[228:231],v[52:55]
DTR a[154:155],v235 offset:17408
M16 v[52:55],a[164:167],a[244:247],v[52:55]
DR a[212:215],v213 offset:6144
s_waitcnt vmcnt(8)
M16 v[56:59],a[160:163],a[232:235],v[56:59]
DTR a[156:157],v235 offset:24576
M16 v[56:59],a[164:167],a[248:251],v[56:59]
s_waitcnt lgkmcnt(15)
DR a[200:203],v214 offset:0
M16 v[60:63],a[160:163],a[236:239],v[60:63]
DTR a[158:159],v235 offset:25600
s_waitcnt vmcnt(4)
M16 v[60:63],a[164:167],a[252:255],v[60:63]
s_barrier
DR a[216:219],v215 offset:0
M16 v[64:67],a[168:171],a[224:227],v[64:67]
DTR a[160:161],v228 offset:32768
M16 v[64:67],a[172:175],a[240:243],v[64:67]
DR a[204:207],v214 offset:2048
M16 v[68:71],a[168:171],a[228:231],v[68:71]
DTR a[162:163],v228 offset:33792
M16 v[68:71],a[172:175],a[244:247],v[68:71]
DR a[220:223],v215 offset:2048
s_waitcnt lgkmcnt(8)
M16 v[72:75],a[168:171],a[232:235],v[72:75]
DTR a[164:165],v228 offset:40960
s_add_u32 m0, s66, 4096
M16 v[72:75],a[172:175],a[248:251],v[72:75]
M16 v[76:79],a[168:171],a[236:239],v[76:79]
DTR a[166:167],v228 offset:41984
M16 v[76:79],a[172:175],a[252:255],v[76:79]
M16 v[80:83],a[128:131],a[224:227],v[80:83]
DTR a[168:169],v229 offset:32768
M16 v[80:83],a[132:135],a[240:243],v[80:83]
BL4 v224,s[92:95],s67 offen lds
M16 v[84:87],a[128:131],a[228:231],v[84:87]
DTR a[170:171],v229 offset:33792
M16 v[84:87],a[132:135],a[244:247],v[84:87]
BL4 v225,s[92:95],s67 offen offset:1024 lds
M16 v[88:91],a[128:131],a[232:235],v[88:91]
DTR a[172:173],v229 offset:40960
M16 v[88:91],a[132:135],a[248:251],v[88:91]
BL4 v226,s[92:95],s67 offen offset:2048 lds
M16 v[92:95],a[128:131],a[236:239],v[92:95]
DTR a[174:175],v229 offset:41984
M16 v[92:95],a[132:135],a[252:255],v[92:95]
M16 v[96:99],a[136:139],a[224:227],v[96:99]
DTR a[128:129],v230 offset:32768
M16 v[96:99],a[140:143],a[240:243],v[96:99]
BL4 v227,s[92:95],s67 offen offset:3072 lds
M16 v[100:103],a[136:139],a[228:231],v[100:103]
DTR a[130:131],v230 offset:33792
s_add_u32 m0, s73, 81920
M16 v[100:103],a[140:143],a[244:247],v[100:103]
BL4 v208,s[4:7],s70 offen lds
M16 v[104:107],a[136:139],a[232:235],v[104:107]
DTR a[132:133],v230 offset:40960
M16 v[104:107],a[140:143],a[248:251],v[104:107]
BL4 v209,s[4:7],s70 offen offset:1024 lds
M16 v[108:111],a[136:139],a[236:239],v[108:111]
DTR a[134:135],v230 offset:41984
M16 v[108:111],a[140:143],a[252:255],v[108:111]
M16 v[112:115],a[144:147],a[224:227],v[112:115]
DTR a[136:137],v231 offset:32768
M16 v[112:115],a[148:151],a[240:243],v[112:115]
BL4 v210,s[4:7],s70 offen offset:2048 lds
M16 v[116:119],a[144:147],a[228:231],v[116:119]
DTR a[138:139],v231 offset:33792
M16 v[116:119],a[148:151],a[244:247],v[116:119]
BL4 v211,s[4:7],s70 offen offset:3072 lds
M16 v[120:123],a[144:147],a[232:235],v[120:123]
DTR a[140:141],v231 offset:40960
s_add_u32 s70, s70, s71
M16 v[120:123],a[148:151],a[248:251],v[120:123]
AW a16,0
AW a17,0
M16 v[124:127],a[144:147],a[236:239],v[124:127]
DTR a[142:143],v231 offset:41984
AW a18,0
M16 v[124:127],a[148:151],a[252:255],v[124:127]
s_waitcnt lgkmcnt(15)
AW a19,0
AW a20,0
M16 v[128:131],a[152:155],a[224:227],v[128:131]
DTR a[144:145],v232 offset:32768
AW a21,0
M16 v[128:131],a[156:159],a[240:243],v[128:131]
AW a22,0
AW a23,0
M16 v[132:135],a[152:155],a[228:231],v[132:135]
DTR a[146:147],v232 offset:33792
AW a24,0
M16 v[132:135],a[156:159],a[244:247],v[132:135]
AW a25,0
AW a26,0
M16 v[136:139],a[152:155],a[232:235],v[136:139]
DTR a[148:149],v232 offset:40960
AW a27,0
M16 v[136:139],a[156:159],a[248:251],v[136:139]
AW a28,0
AW a29,0
M16 v[140:143],a[152:155],a[236:239],v[140:143]
DTR a[150:151],v232 offset:41984
AW a30,0
M16 v[140:143],a[156:159],a[252:255],v[140:143]
s_waitcnt lgkmcnt(15)
AW a31,0
M16 v[16:19],a[160:163],a[192:195],v[16:19]
DTR a[152:153],v233 offset:32768
s_mov_b32 m0, s72
M16 v[16:19],a[164:167],a[208:211],v[16:19]
s_mov_b32 s67, 512
M16 v[20:23],a[160:163],a[196:199],v[20:23]
DTR a[154:155],v233 offset:33792
M16 v[20:23],a[164:167],a[212:215],v[20:23]
BL4 v220,s[92:95],s67 offen lds
M16 v[24:27],a[160:163],a[200:203],v[24:27]
DTR a[156:157],v233 offset:40960
M16 v[24:27],a[164:167],a[216:219],v[24:27]
BL4 v221,s[92:95],s67 offen offset:1024 lds
M16 v[28:31],a[160:163],a[204:207],v[28:31]
DTR a[158:159],v233 offset:41984
M16 v[28:31],a[164:167],a[220:223],v[28:31]
s_waitcnt lgkmcnt(15)
M16 v[32:35],a[168:171],a[192:195],v[32:35]
DTR a[160:161],v234 offset:32768
M16 v[32:35],a[172:175],a[208:211],v[32:35]
BL4 v222,s[92:95],s67 offen offset:2048 lds
M16 v[36:39],a[168:171],a[196:199],v[36:39]
DTR a[162:163],v234 offset:33792
M16 v[36:39],a[172:175],a[212:215],v[36:39]
BL4 v223,s[92:95],s67 offen offset:3072 lds
M16 v[40:43],a[168:171],a[200:203],v[40:43]
DTR a[164:165],v234 offset:40960
s_waitcnt vmcnt(12)
M16 v[40:43],a[172:175],a[216:219],v[40:43]
DR a[224:227],v212 offset:0
M16 v[44:47],a[168:171],a[204:207],v[44:47]
DTR a[166:167],v234 offset:41984
M16 v[44:47],a[172:175],a[220:223],v[44:47]
s_waitcnt lgkmcnt(15)
DR a[240:243],v213 offset:0
M16 v[48:51],a[128:131],a[192:195],v[48:51]
DTR a[168:169],v235 offset:32768
M16 v[48:51],a[132:135],a[208:211],v[48:51]
DR a[228:231],v212 offset:2048
M16 v[52:55],a[128:131],a[196:199],v[52:55]
DTR a[170:171],v235 offset:33792
M16 v[52:55],a[132:135],a[212:215],v[52:55]
DR a[244:247],v213 offset:2048
s_waitcnt vmcnt(8)
M16 v[56:59],a[128:131],a[200:203],v[56:59]
DTR a[172:173],v235 offset:40960
M16 v[56:59],a[132:135],a[216:219],v[56:59]
s_waitcnt lgkmcnt(15)
DR a[232:235],v212 offset:4096
M16 v[60:63],a[128:131],a[204:207],v[60:63]
DTR a[174:175],v235 offset:41984
s_waitcnt vmcnt(4)
M16 v[60:63],a[132:135],a[220:223],v[60:63]
s_barrier
DR a[248:251],v213 offset:4096
M16 v[64:67],a[136:139],a[192:195],v[64:67]
DTR a[128:129],v228 offset:0
M16 v[64:67],a[140:143],a[208:211],v[64:67]
DR a[236:239],v212 offset:6144
M16 v[68:71],a[136:139],a[196:199],v[68:71]
DTR a[130:131],v228 offset:1024
M16 v[68:71],a[140:143],a[212:215],v[68:71]
DR a[252:255],v213 offset:6144
s_waitcnt lgkmcnt(8)
M16 v[72:75],a[136:139],a[200:203],v[72:75]
DTR a[132:133],v228 offset:8192
s_add_u32 m0, s66, 0
M16 v[72:75],a[140:143],a[216:219],v[72:75]
M16 v[76:79],a[136:139],a[204:207],v[76:79]
DTR a[134:135],v228 offset:9216
M16 v[76:79],a[140:143],a[220:223],v[76:79]
M16 v[80:83],a[144:147],a[192:195],v[80:83]
DTR a[136:137],v229 offset:0
M16 v[80:83],a[148:151],a[208:211],v[80:83]
BL4 v224,s[92:95],s67 offen lds
M16 v[84:87],a[144:147],a[196:199],v[84:87]
DTR a[138:139],v229 offset:1024
M16 v[84:87],a[148:151],a[212:215],v[84:87]
BL4 v225,s[92:95],s67 offen offset:1024 lds
M16 v[88:91],a[144:147],a[200:203],v[88:91]
DTR a[140:141],v229 offset:8192
M16 v[88:91],a[148:151],a[216:219],v[88:91]
BL4 v226,s[92:95],s67 offen offset:2048 lds
M16 v[92:95],a[144:147],a[204:207],v[92:95]
DTR a[142:143],v229 offset:9216
M16 v[92:95],a[148:151],a[220:223],v[92:95]
M16 v[96:99],a[152:155],a[192:195],v[96:99]
DTR a[144:145],v230 offset:0
M16 v[96:99],a[156:159],a[208:211],v[96:99]
BL4 v227,s[92:95],s67 offen offset:3072 lds
M16 v[100:103],a[152:155],a[196:199],v[100:103]
DTR a[146:147],v230 offset:1024
s_add_u32 m0, s73, 98304
M16 v[100:103],a[156:159],a[212:215],v[100:103]
BL4 v208,s[4:7],s70 offen lds
M16 v[104:107],a[152:155],a[200:203],v[104:107]
DTR a[148:149],v230 offset:8192
M16 v[104:107],a[156:159],a[216:219],v[104:107]
BL4 v209,s[4:7],s70 offen offset:1024 lds
M16 v[108:111],a[152:155],a[204:207],v[108:111]
DTR a[150:151],v230 offset:9216
M16 v[108:111],a[156:159],a[220:223],v[108:111]
M16 v[112:115],a[160:163],a[192:195],v[112:115]
DTR a[152:153],v231 offset:0
M16 v[112:115],a[164:167],a[208:211],v[112:115]
BL4 v210,s[4:7],s70 offen offset:2048 lds
M16 v[116:119],a[160:163],a[196:199],v[116:119]
DTR a[154:155],v231 offset:1024
M16 v[116:119],a[164:167],a[212:215],v[116:119]
BL4 v211,s[4:7],s70 offen offset:3072 lds
M16 v[120:123],a[160:163],a[200:203],v[120:123]
DTR a[156:157],v231 offset:8192
s_add_u32 s70, s70, s71
M16 v[120:123],a[164:167],a[216:219],v[120:123]
AW a32,0
AW a33,0
M16 v[124:127],a[160:163],a[204:207],v[124:127]
DTR a[158:159],v231 offset:9216
AW a34,0
M16 v[124:127],a[164:167],a[220:223],v[124:127]
s_waitcnt lgkmcnt(15)
AW a35,0
AW a36,0
M16 v[128:131],a[168:171],a[192:195],v[128:131]
DTR a[160:161],v232 offset:0
AW a37,0
M16 v[128:131],a[172:175],a[208:211],v[128:131]
AW a38,0
AW a39,0
M16 v[132:135],a[168:171],a[196:199],v[132:135]
DTR a[162:163],v232 offset:1024
AW a40,0
M16 v[132:135],a[172:175],a[212:215],v[132:135]
AW a41,0
AW a42,0
M16 v[136:139],a[168:171],a[200:203],v[136:139]
DTR a[164:165],v232 offset:8192
AW a43,0
M16 v[136:139],a[172:175],a[216:219],v[136:139]
AW a44,0
AW a45,0
M16 v[140:143],a[168:171],a[204:207],v[140:143]
DTR a[166:167],v232 offset:9216
AW a46,0
M16 v[140:143],a[172:175],a[220:223],v[140:143]
s_waitcnt lgkmcnt(15)
AW a47,0
M16 v[16:19],a[128:131],a[224:227],v[16:19]
DTR a[168:169],v233 offset:0
s_add_u32 m0, s66, 4096
M16 v[16:19],a[132:135],a[240:243],v[16:19]
s_mov_b32 s67, 640
M16 v[20:23],a[128:131],a[228:231],v[20:23]
DTR a[170:171],v233 offset:1024
M16 v[20:23],a[132:135],a[244:247],v[20:23]
BL4 v220,s[92:95],s67 offen lds
M16 v[24:27],a[128:131],a[232:235],v[24:27]
DTR a[172:173],v233 offset:8192
M16 v[24:27],a[132:135],a[248:251],v[24:27]
BL4 v221,s[92:95],s67 offen offset:1024 lds
M16 v[28:31],a[128:131],a[236:239],v[28:31]
DTR a[174:175],v233 offset:9216
M16 v[28:31],a[132:135],a[252:255],v[28:31]
s_waitcnt lgkmcnt(15)
M16 v[32:35],a[136:139],a[224:227],v[32:35]
DTR a[128:129],v234 offset:0
M16 v[32:35],a[140:143],a[240:243],v[32:35]
BL4 v222,s[92:95],s67 offen offset:2048 lds
M16 v[36:39],a[136:139],a[228:231],v[36:39]
DTR a[130:131],v234 offset:1024
M16 v[36:39],a[140:143],a[244:247],v[36:39]
BL4 v223,s[92:95],s67 offen offset:3072 lds
M16 v[40:43],a[136:139],a[232:235],v[40:43]
DTR a[132:133],v234 offset:8192
s_waitcnt vmcnt(12)
M16 v[40:43],a[140:143],a[248:251],v[40:43]
DR a[192:195],v214 offset:0
M16 v[44:47],a[136:139],a[236:239],v[44:47]
DTR a[134:135],v234 offset:9216
M16 v[44:47],a[140:143],a[252:255],v[44:47]
s_waitcnt lgkmcnt(15)
DR a[208:211],v215 offset:0
M16 v[48:51],a[144:147],a[224:227],v[48:51]
DTR a[136:137],v235 offset:0
M16 v[48:51],a[148:151],a[240:243],v[48:51]
DR a[196:199],v214 offset:2048
M16 v[52:55],a[144:147],a[228:231],v[52:55]
DTR a[138:139],v235 offset:1024
M16 v[52:55],a[148:151],a[244:247],v[52:55]
DR a[212:215],v215 offset:2048
s_waitcnt vmcnt(8)
M16 v[56:59],a[144:147],a[232:235],v[56:59]
DTR a[140:141],v235 offset:8192
M16 v[56:59],a[148:151],a[248:251],v[56:59]
s_waitcnt lgkmcnt(15)
DR a[200:203],v212 offset:0
M16 v[60:63],a[144:147],a[236:239],v[60:63]
DTR a[142:143],v235 offset:9216
s_waitcnt vmcnt(4)
M16 v[60:63],a[148:151],a[252:255],v[60:63]
s_barrier
DR a[216:219],v213 offset:0
M16 v[64:67],a[152:155],a[224:227],v[64:67]
DTR a[144:145],v228 offset:16384
M16 v[64:67],a[156:159],a[240:243],v[64:67]
DR a[204:207],v212 offset:2048
M16 v[68:71],a[152:155],a[228:231],v[68:71]
DTR a[146:147],v228 offset:17408
M16 v[68:71],a[156:159],a[244:247],v[68:71]
DR a[220:223],v213 offset:2048
s_waitcnt lgkmcnt(8)
M16 v[72:75],a[152:155],a[232:235],v[72:75]
DTR a[148:149],v228 offset:24576
s_mov_b32 m0, s72
M16 v[72:75],a[156:159],a[248:251],v[72:75]
BL4 v224,s[92:95],s67 offen lds
M16 v[76:79],a[152:155],a[236:239],v[76:79]
DTR a[150:151],v228 offset:25600
M16 v[76:79],a[156:159],a[252:255],v[76:79]
M16 v[80:83],a[160:163],a[224:227],v[80:83]
DTR a[152:153],v229 offset:16384
M16 v[80:83],a[164:167],a[240:243],v[80:83]
BL4 v225,s[92:95],s67 offen offset:1024 lds
M16 v[84:87],a[160:163],a[228:231],v[84:87]
DTR a[154:155],v229 offset:17408
M16 v[84:87],a[164:167],a[244:247],v[84:87]
BL4 v226,s[92:95],s67 offen offset:2048 lds
M16 v[88:91],a[160:163],a[232:235],v[88:91]
DTR a[156:157],v229 offset:24576
M16 v[88:91],a[164:167],a[248:251],v[88:91]
BL4 v227,s[92:95],s67 offen offset:3072 lds
M16 v[92:95],a[160:163],a[236:239],v[92:95]
DTR a[158:159],v229 offset:25600
s_add_u32 m0, s73, 114688
M16 v[92:95],a[164:167],a[252:255],v[92:95]
M16 v[96:99],a[168:171],a[224:227],v[96:99]
DTR a[160:161],v230 offset:16384
M16 v[96:99],a[172:175],a[240:243],v[96:99]
BL4 v208,s[4:7],s70 offen lds
M16 v[100:103],a[168:171],a[228:231],v[100:103]
DTR a[162:163],v230 offset:17408
M16 v[100:103],a[172:175],a[244:247],v[100:103]
BL4 v209,s[4:7],s70 offen offset:1024 lds
M16 v[104:107],a[168:171],a[232:235],v[104:107]
DTR a[164:165],v230 offset:24576
M16 v[104:107],a[172:175],a[248:251],v[104:107]
BL4 v210,s[4:7],s70 offen offset:2048 lds
M16 v[108:111],a[168:171],a[236:239],v[108:111]
DTR a[166:167],v230 offset:25600
M16 v[108:111],a[172:175],a[252:255],v[108:111]
M16 v[112:115],a[128:131],a[224:227],v[112:115]
DTR a[168:169],v231 offset:16384
M16 v[112:115],a[132:135],a[240:243],v[112:115]
BL4 v211,s[4:7],s70 offen offset:3072 lds
M16 v[116:119],a[128:131],a[228:231],v[116:119]
DTR a[170:171],v231 offset:17408
s_add_u32 s70, s70, s71
M16 v[116:119],a[132:135],a[244:247],v[116:119]
AW a48,0
AW a49,0
M16 v[120:123],a[128:131],a[232:235],v[120:123]
DTR a[172:173],v231 offset:24576
AW a50,0
M16 v[120:123],a[132:135],a[248:251],v[120:123]
AW a51,0
AW a52,0
M16 v[124:127],a[128:131],a[236:239],v[124:127]
DTR a[174:175],v231 offset:25600
AW a53,0
M16 v[124:127],a[132:135],a[252:255],v[124:127]
s_waitcnt lgkmcnt(15)
AW a54,0
AW a55,0
M16 v[128:131],a[136:139],a[224:227],v[128:131]
DTR a[128:129],v232 offset:16384
AW a56,0
M16 v[128:131],a[140:143],a[240:243],v[128:131]
AW a57,0
AW a58,0
M16 v[132:135],a[136:139],a[228:231],v[132:135]
DTR a[130:131],v232 offset:17408
AW a59,0
M16 v[132:135],a[140:143],a[244:247],v[132:135]
AW a60,0
AW a61,0
M16 v[136:139],a[136:139],a[232:235],v[136:139]
DTR a[132:133],v232 offset:24576
AW a62,0
M16 v[136:139],a[140:143],a[248:251],v[136:139]
AW a63,0
M16 v[140:143],a[136:139],a[236:239],v[140:143]
DTR a[134:135],v232 offset:25600
M16 v[140:143],a[140:143],a[252:255],v[140:143]
s_waitcnt lgkmcnt(15)
M16 v[16:19],a[144:147],a[192:195],v[16:19]
DTR a[136:137],v233 offset:16384
s_add_u32 m0, s66, 0
M16 v[16:19],a[148:151],a[208:211],v[16:19]
s_mov_b32 s67, 768
M16 v[20:23],a[144:147],a[196:199],v[20:23]
DTR a[138:139],v233 offset:17408
M16 v[20:23],a[148:151],a[212:215],v[20:23]
BL4 v220,s[92:95],s67 offen lds
M16 v[24:27],a[144:147],a[200:203],v[24:27]
DTR a[140:141],v233 offset:24576
M16 v[24:27],a[148:151],a[216:219],v[24:27]
BL4 v221,s[92:95],s67 offen offset:1024 lds
M16 v[28:31],a[144:147],a[204:207],v[28:31]
DTR a[142:143],v233 offset:25600
M16 v[28:31],a[148:151],a[220:223],v[28:31]
s_waitcnt lgkmcnt(15)
M16 v[32:35],a[152:155],a[192:195],v[32:35]
DTR a[144:145],v234 offset:16384
M16 v[32:35],a[156:159],a[208:211],v[32:35]
BL4 v222,s[92:95],s67 offen offset:2048 lds
M16 v[36:39],a[152:155],a[196:199],v[36:39]
DTR a[146:147],v234 offset:17408
M16 v[36:39],a[156:159],a[212:215],v[36:39]
BL4 v223,s[92:95],s67 offen offset:3072 lds
M16 v[40:43],a[152:155],a[200:203],v[40:43]
DTR a[148:149],v234 offset:24576
s_waitcnt vmcnt(12)
M16 v[40:43],a[156:159],a[216:219],v[40:43]
DR a[224:227],v212 offset:4096
M16 v[44:47],a[152:155],a[204:207],v[44:47]
DTR a[150:151],v234 offset:25600
M16 v[44:47],a[156:159],a[220:223],v[44:47]
s_waitcnt lgkmcnt(15)
DR a[240:243],v213 offset:4096
M16 v[48:51],a[160:163],a[192:195],v[48:51]
DTR a[152:153],v235 offset:16384
M16 v[48:51],a[164:167],a[208:211],v[48:51]
DR a[228:231],v212 offset:6144
M16 v[52:55],a[160:163],a[196:199],v[52:55]
DTR a[154:155],v235 offset:17408
M16 v[52:55],a[164:167],a[212:215],v[52:55]
DR a[244:247],v213 offset:6144
s_waitcnt vmcnt(8)
M16 v[56:59],a[160:163],a[200:203],v[56:59]
DTR a[156:157],v235 offset:24576
M16 v[56:59],a[164:167],a[216:219],v[56:59]
s_waitcnt lgkmcnt(15)
DR a[232:235],v214 offset:0
M16 v[60:63],a[160:163],a[204:207],v[60:63]
DTR a[158:159],v235 offset:25600
s_waitcnt vmcnt(4)
M16 v[60:63],a[164:167],a[220:223],v[60:63]
s_barrier
DR a[248:251],v215 offset:0
M16 v[64:67],a[168:171],a[192:195],v[64:67]
DTR a[160:161],v228 offset:32768
M16 v[64:67],a[172:175],a[208:211],v[64:67]
DR a[236:239],v214 offset:2048
M16 v[68:71],a[168:171],a[196:199],v[68:71]
DTR a[162:163],v228 offset:33792
M16 v[68:71],a[172:175],a[212:215],v[68:71]
DR a[252:255],v215 offset:2048
s_waitcnt lgkmcnt(8)
M16 v[72:75],a[168:171],a[200:203],v[72:75]
DTR a[164:165],v228 offset:40960
s_add_u32 m0, s66, 4096
M16 v[72:75],a[172:175],a[216:219],v[72:75]
M16 v[76:79],a[168:171],a[204:207],v[76:79]
DTR a[166:167],v228 offset:41984
M16 v[76:79],a[172:175],a[220:223],v[76:79]
M16 v[80:83],a[128:131],a[192:195],v[80:83]
DTR a[168:169],v229 offset:32768
M16 v[80:83],a[132:135],a[208:211],v[80:83]
BL4 v224,s[92:95],s67 offen lds
M16 v[84:87],a[128:131],a[196:199],v[84:87]
DTR a[170:171],v229 offset:33792
M16 v[84:87],a[132:135],a[212:215],v[84:87]
BL4 v225,s[92:95],s67 offen offset:1024 lds
M16 v[88:91],a[128:131],a[200:203],v[88:91]
DTR a[172:173],v229 offset:40960
M16 v[88:91],a[132:135],a[216:219],v[88:91]
BL4 v226,s[92:95],s67 offen offset:2048 lds
M16 v[92:95],a[128:131],a[204:207],v[92:95]
DTR a[174:175],v229 offset:41984
M16 v[92:95],a[132:135],a[220:223],v[92:95]
M16 v[96:99],a[136:139],a[192:195],v[96:99]
DTR a[128:129],v230 offset:32768
M16 v[96:99],a[140:143],a[208:211],v[96:99]
BL4 v227,s[92:95],s67 offen offset:3072 lds
M16 v[100:103],a[136:139],a[196:199],v[100:103]
DTR a[130:131],v230 offset:33792
s_add_u32 m0, s73, 81920
M16 v[100:103],a[140:143],a[212:215],v[100:103]
BL4 v208,s[4:7],s70 offen lds
M16 v[104:107],a[136:139],a[200:203],v[104:107]
DTR a[132:133],v230 offset:40960
M16 v[104:107],a[140:143],a[216:219],v[104:107]
BL4 v209,s[4:7],s70 offen offset:1024 lds
M16 v[108:111],a[136:139],a[204:207],v[108:111]
DTR a[134:135],v230 offset:41984
M16 v[108:111],a[140:143],a[220:223],v[108:111]
M16 v[112:115],a[144:147],a[192:195],v[112:115]
DTR a[136:137],v231 offset:32768
M16 v[112:115],a[148:151],a[208:211],v[112:115]
BL4 v210,s[4:7],s70 offen offset:2048 lds
M16 v[116:119],a[144:147],a[196:199],v[116:119]
DTR a[138:139],v231 offset:33792
M16 v[116:119],a[148:151],a[212:215],v[116:119]
BL4 v211,s[4:7],s70 offen offset:3072 lds
M16 v[120:123],a[144:147],a[200:203],v[120:123]
DTR a[140:141],v231 offset:40960
s_add_u32 s70, s70, s71
M16 v[120:123],a[148:151],a[216:219],v[120:123]
AW a64,0
AW a65,0
M16 v[124:127],a[144:147],a[204:207],v[124:127]
DTR a[142:143],v231 offset:41984
AW a66,0
M16 v[124:127],a[148:151],a[220:223],v[124:127]
s_waitcnt lgkmcnt(15)
AW a67,0
AW a68,0
M16 v[128:131],a[152:155],a[192:195],v[128:131]
DTR a[144:145],v232 offset:32768
AW a69,0
M16 v[128:131],a[156:159],a[208:211],v[128:131]
AW a70,0
AW a71,0
M16 v[132:135],a[152:155],a[196:199],v[132:135]
DTR a[146:147],v232 offset:33792
AW a72,0
M16 v[132:135],a[156:159],a[212:215],v[132:135]
AW a73,0
AW a74,0
M16 v[136:139],a[152:155],a[200:203],v[136:139]
DTR a[148:149],v232 offset:40960
AW a75,0
M16 v[136:139],a[156:159],a[216:219],v[136:139]
AW a76,0
AW a77,0
M16 v[140:143],a[152:155],a[204:207],v[140:143]
DTR a[150:151],v232 offset:41984
AW a78,0
M16 v[140:143],a[156:159],a[220:223],v[140:143]
s_waitcnt lgkmcnt(15)
AW a79,0
M16 v[16:19],a[160:163],a[224:227],v[16:19]
DTR a[152:153],v233 offset:32768
s_mov_b32 m0, s72
M16 v[16:19],a[164:167],a[240:243],v[16:19]
s_mov_b32 s67, 896
M16 v[20:23],a[160:163],a[228:231],v[20:23]
DTR a[154:155],v233 offset:33792
M16 v[20:23],a[164:167],a[244:247],v[20:23]
BL4 v220,s[92:95],s67 offen lds
M16 v[24:27],a[160:163],a[232:235],v[24:27]
DTR a[156:157],v233 offset:40960
M16 v[24:27],a[164:167],a[248:251],v[24:27]
BL4 v221,s[92:95],s67 offen offset:1024 lds
M16 v[28:31],a[160:163],a[236:239],v[28:31]
DTR a[158:159],v233 offset:41984
M16 v[28:31],a[164:167],a[252:255],v[28:31]
s_waitcnt lgkmcnt(15)
M16 v[32:35],a[168:171],a[224:227],v[32:35]
DTR a[160:161],v234 offset:32768
M16 v[32:35],a[172:175],a[240:243],v[32:35]
BL4 v222,s[92:95],s67 offen offset:2048 lds
M16 v[36:39],a[168:171],a[228:231],v[36:39]
DTR a[162:163],v234 offset:33792
M16 v[36:39],a[172:175],a[244:247],v[36:39]
BL4 v223,s[92:95],s67 offen offset:3072 lds
M16 v[40:43],a[168:171],a[232:235],v[40:43]
DTR a[164:165],v234 offset:40960
s_waitcnt vmcnt(12)
M16 v[40:43],a[172:175],a[248:251],v[40:43]
DR a[192:195],v212 offset:0
M16 v[44:47],a[168:171],a[236:239],v[44:47]
DTR a[166:167],v234 offset:41984
M16 v[44:47],a[172:175],a[252:255],v[44:47]
s_waitcnt lgkmcnt(15)
DR a[208:211],v213 offset:0
M16 v[48:51],a[128:131],a[224:227],v[48:51]
DTR a[168:169],v235 offset:32768
M16 v[48:51],a[132:135],a[240:243],v[48:51]
DR a[196:199],v212 offset:2048
M16 v[52:55],a[128:131],a[228:231],v[52:55]
DTR a[170:171],v235 offset:33792
M16 v[52:55],a[132:135],a[244:247],v[52:55]
DR a[212:215],v213 offset:2048
s_waitcnt vmcnt(8)
M16 v[56:59],a[128:131],a[232:235],v[56:59]
DTR a[172:173],v235 offset:40960
M16 v[56:59],a[132:135],a[248:251],v[56:59]
s_waitcnt lgkmcnt(15)
DR a[200:203],v212 offset:4096
M16 v[60:63],a[128:131],a[236:239],v[60:63]
DTR a[174:175],v235 offset:41984
s_waitcnt vmcnt(4)
M16 v[60:63],a[132:135],a[252:255],v[60:63]
s_barrier
DR a[216:219],v213 offset:4096
M16 v[64:67],a[136:139],a[224:227],v[64:67]
DTR a[128:129],v228 offset:0
M16 v[64:67],a[140:143],a[240:243],v[64:67]
DR a[204:207],v212 offset:6144
M16 v[68:71],a[136:139],a[228:231],v[68:71]
DTR a[130:131],v228 offset:1024
M16 v[68:71],a[140:143],a[244:247],v[68:71]
DR a[220:223],v213 offset:6144
s_waitcnt lgkmcnt(8)
M16 v[72:75],a[136:139],a[232:235],v[72:75]
DTR a[132:133],v228 offset:8192
s_add_u32 m0, s66, 0
M16 v[72:75],a[140:143],a[248:251],v[72:75]
M16 v[76:79],a[136:139],a[236:239],v[76:79]
DTR a[134:135],v228 offset:9216
M16 v[76:79],a[140:143],a[252:255],v[76:79]
M16 v[80:83],a[144:147],a[224:227],v[80:83]
DTR a[136:137],v229 offset:0
M16 v[80:83],a[148:151],a[240:243],v[80:83]
BL4 v224,s[92:95],s67 offen lds
M16 v[84:87],a[144:147],a[228:231],v[84:87]
DTR a[138:139],v229 offset:1024
M16 v[84:87],a[148:151],a[244:247],v[84:87]
BL4 v225,s[92:95],s67 offen offset:1024 lds
M16 v[88:91],a[144:147],a[232:235],v[88:91]
DTR a[140:141],v229 offset:8192
M16 v[88:91],a[148:151],a[248:251],v[88:91]
BL4 v226,s[92:95],s67 offen offset:2048 lds
M16 v[92:95],a[144:147],a[236:239],v[92:95]
DTR a[142:143],v229 offset:9216
M16 v[92:95],a[148:151],a[252:255],v[92:95]
M16 v[96:99],a[152:155],a[224:227],v[96:99]
DTR a[144:145],v230 offset:0
M16 v[96:99],a[156:159],a[240:243],v[96:99]
BL4 v227,s[92:95],s67 offen offset:3072 lds
M16 v[100:103],a[152:155],a[228:231],v[100:103]
DTR a[146:147],v230 offset:1024
s_add_u32 m0, s73, 98304
M16 v[100:103],a[156:159],a[244:247],v[100:103]
BL4 v208,s[4:7],s70 offen lds
M16 v[104:107],a[152:155],a[232:235],v[104:107]
DTR a[148:149],v230 offset:8192
M16 v[104:107],a[156:159],a[248:251],v[104:107]
BL4 v209,s[4:7],s70 offen offset:1024 lds
M16 v[108:111],a[152:155],a[236:239],v[108:111]
DTR a[150:151],v230 offset:9216
M16 v[108:111],a[156:159],a[252:255],v[108:111]
M16 v[112:115],a[160:163],a[224:227],v[112:115]
DTR a[152:153],v231 offset:0
M16 v[112:115],a[164:167],a[240:243],v[112:115]
BL4 v210,s[4:7],s70 offen offset:2048 lds
M16 v[116:119],a[160:163],a[228:231],v[116:119]
DTR a[154:155],v231 offset:1024
M16 v[116:119],a[164:167],a[244:247],v[116:119]
BL4 v211,s[4:7],s70 offen offset:3072 lds
M16 v[120:123],a[160:163],a[232:235],v[120:123]
DTR a[156:157],v231 offset:8192
s_add_u32 s70, s70, s71
M16 v[120:123],a[164:167],a[248:251],v[120:123]
AW a80,0
AW a81,0
M16 v[124:127],a[160:163],a[236:239],v[124:127]
DTR a[158:159],v231 offset:9216
AW a82,0
M16 v[124:127],a[164:167],a[252:255],v[124:127]
s_waitcnt lgkmcnt(15)
AW a83,0
AW a84,0
M16 v[128:131],a[168:171],a[224:227],v[128:131]
DTR a[160:161],v232 offset:0
AW a85,0
M16 v[128:131],a[172:175],a[240:243],v[128:131]
AW a86,0
AW a87,0
M16 v[132:135],a[168:171],a[228:231],v[132:135]
DTR a[162:163],v232 offset:1024
AW a88,0
M16 v[132:135],a[172:175],a[244:247],v[132:135]
AW a89,0
AW a90,0
M16 v[136:139],a[168:171],a[232:235],v[136:139]
DTR a[164:165],v232 offset:8192
AW a91,0
M16 v[136:139],a[172:175],a[248:251],v[136:139]
AW a92,0
AW a93,0
M16 v[140:143],a[168:171],a[236:239],v[140:143]
DTR a[166:167],v232 offset:9216
AW a94,0
M16 v[140:143],a[172:175],a[252:255],v[140:143]
s_waitcnt lgkmcnt(15)
AW a95,0
v_and_b32 v8, 15, v1
v_lshrrev_b32 v9, 4, v1
v_lshlrev_b32 v9, 2, v9
v_sub_u32 v8, v8, v9
s_lshl_b32 s12, s20, 4
v_add_u32 v8, s12, v8
v_cmp_le_i32 s[32:33], 0, v8
v_cmp_le_i32 s[34:35], 1, v8
v_cmp_le_i32 s[36:37], 2, v8
v_cmp_le_i32 s[38:39], 3, v8
v_cmp_le_i32 s[40:41], 16, v8
v_cmp_le_i32 s[42:43], 17, v8
v_cmp_le_i32 s[44:45], 18, v8
v_cmp_le_i32 s[46:47], 19, v8
v_cmp_le_i32 s[48:49], 32, v8
v_cmp_le_i32 s[50:51], 33, v8
v_cmp_le_i32 s[52:53], 34, v8
v_cmp_le_i32 s[54:55], 35, v8
v_cmp_le_i32 s[56:57], 48, v8
v_cmp_le_i32 s[58:59], 49, v8
v_cmp_le_i32 s[60:61], 50, v8
v_cmp_le_i32 s[62:63], 51, v8
v_mov_b32 v6, 0xff800000
v_mov_b32 v8, 0
v_mov_b32 v240, 0
v_mov_b32 v241, 0
v_mov_b32 v242, 0
v_mov_b32 v243, 0
v_mov_b32 v244, 0
v_mov_b32 v245, 0
v_mov_b32 v246, 0
v_mov_b32 v247, 0
v_mov_b32 v248, 0
v_mov_b32 v249, 0
v_mov_b32 v250, 0
v_mov_b32 v251, 0
v_mov_b32 v252, 0
v_mov_b32 v253, 0
v_mov_b32 v254, 0
v_mov_b32 v255, 0
v_mov_b32 v4, v2
v_mov_b32 v5, v7
s_mov_b32 s28, 16384
s_mov_b32 s29, 0
M16 v[16:19],a[128:131],a[192:195],v[16:19]
DTR a[168:169],v233 offset:0
s_add_u32 m0, s66, 4096
M16 v[16:19],a[132:135],a[208:211],v[16:19]
s_mov_b32 s67, 1024
M16 v[20:23],a[128:131],a[196:199],v[20:23]
DTR a[170:171],v233 offset:1024
M16 v[20:23],a[132:135],a[212:215],v[20:23]
BL4 v220,s[92:95],s67 offen lds
M16 v[24:27],a[128:131],a[200:203],v[24:27]
DTR a[172:173],v233 offset:8192
M16 v[24:27],a[132:135],a[216:219],v[24:27]
BL4 v221,s[92:95],s67 offen offset:1024 lds
M16 v[28:31],a[128:131],a[204:207],v[28:31]
DTR a[174:175],v233 offset:9216
M16 v[28:31],a[132:135],a[220:223],v[28:31]
s_waitcnt lgkmcnt(15)
M16 v[32:35],a[136:139],a[192:195],v[32:35]
DTR a[128:129],v234 offset:0
M16 v[32:35],a[140:143],a[208:211],v[32:35]
BL4 v222,s[92:95],s67 offen offset:2048 lds
M16 v[36:39],a[136:139],a[196:199],v[36:39]
DTR a[130:131],v234 offset:1024
M16 v[36:39],a[140:143],a[212:215],v[36:39]
BL4 v223,s[92:95],s67 offen offset:3072 lds
M16 v[40:43],a[136:139],a[200:203],v[40:43]
DTR a[132:133],v234 offset:8192
s_waitcnt vmcnt(12)
M16 v[40:43],a[140:143],a[216:219],v[40:43]
DR a[224:227],v214 offset:0
M16 v[44:47],a[136:139],a[204:207],v[44:47]
DTR a[134:135],v234 offset:9216
M16 v[44:47],a[140:143],a[220:223],v[44:47]
s_waitcnt lgkmcnt(15)
DR a[240:243],v215 offset:0
M16 v[48:51],a[144:147],a[192:195],v[48:51]
DTR a[136:137],v235 offset:0
M16 v[48:51],a[148:151],a[208:211],v[48:51]
DR a[228:231],v214 offset:2048
M16 v[52:55],a[144:147],a[196:199],v[52:55]
DTR a[138:139],v235 offset:1024
M16 v[52:55],a[148:151],a[212:215],v[52:55]
DR a[244:247],v215 offset:2048
s_waitcnt vmcnt(8)
M16 v[56:59],a[144:147],a[200:203],v[56:59]
DTR a[140:141],v235 offset:8192
M16 v[56:59],a[148:151],a[216:219],v[56:59]
s_waitcnt lgkmcnt(15)
DR a[232:235],v212 offset:0
M16 v[60:63],a[144:147],a[204:207],v[60:63]
DTR a[142:143],v235 offset:9216
s_waitcnt vmcnt(4)
M16 v[60:63],a[148:151],a[220:223],v[60:63]
s_barrier
DR a[248:251],v213 offset:0
M16 v[64:67],a[152:155],a[192:195],v[64:67]
DTR a[144:145],v228 offset:16384
M16 v[64:67],a[156:159],a[208:211],v[64:67]
DR a[236:239],v212 offset:2048
M16 v[68:71],a[152:155],a[196:199],v[68:71]
DTR a[146:147],v228 offset:17408
M16 v[68:71],a[156:159],a[212:215],v[68:71]
DR a[252:255],v213 offset:2048
s_waitcnt lgkmcnt(8)
M16 v[72:75],a[152:155],a[200:203],v[72:75]
DTR a[148:149],v228 offset:24576
s_mov_b32 m0, s72
M16 v[72:75],a[156:159],a[216:219],v[72:75]
BL4 v224,s[92:95],s67 offen lds
M16 v[76:79],a[152:155],a[204:207],v[76:79]
DTR a[150:151],v228 offset:25600
M16 v[76:79],a[156:159],a[220:223],v[76:79]
M16 v[80:83],a[160:163],a[192:195],v[80:83]
DTR a[152:153],v229 offset:16384
M16 v[80:83],a[164:167],a[208:211],v[80:83]
BL4 v225,s[92:95],s67 offen offset:1024 lds
M16 v[84:87],a[160:163],a[196:199],v[84:87]
DTR a[154:155],v229 offset:17408
M16 v[84:87],a[164:167],a[212:215],v[84:87]
BL4 v226,s[92:95],s67 offen offset:2048 lds
M16 v[88:91],a[160:163],a[200:203],v[88:91]
DTR a[156:157],v229 offset:24576
M16 v[88:91],a[164:167],a[216:219],v[88:91]
BL4 v227,s[92:95],s67 offen offset:3072 lds
M16 v[92:95],a[160:163],a[204:207],v[92:95]
DTR a[158:159],v229 offset:25600
s_add_u32 m0, s73, 114688
M16 v[92:95],a[164:167],a[220:223],v[92:95]
M16 v[96:99],a[168:171],a[192:195],v[96:99]
DTR a[160:161],v230 offset:16384
M16 v[96:99],a[172:175],a[208:211],v[96:99]
BL4 v208,s[4:7],s70 offen lds
M16 v[100:103],a[168:171],a[196:199],v[100:103]
DTR a[162:163],v230 offset:17408
M16 v[100:103],a[172:175],a[212:215],v[100:103]
BL4 v209,s[4:7],s70 offen offset:1024 lds
M16 v[104:107],a[168:171],a[200:203],v[104:107]
DTR a[164:165],v230 offset:24576
M16 v[104:107],a[172:175],a[216:219],v[104:107]
BL4 v210,s[4:7],s70 offen offset:2048 lds
M16 v[108:111],a[168:171],a[204:207],v[108:111]
DTR a[166:167],v230 offset:25600
M16 v[108:111],a[172:175],a[220:223],v[108:111]
M16 v[112:115],a[128:131],a[192:195],v[112:115]
DTR a[168:169],v231 offset:16384
M16 v[112:115],a[132:135],a[208:211],v[112:115]
BL4 v211,s[4:7],s70 offen offset:3072 lds
M16 v[116:119],a[128:131],a[196:199],v[116:119]
DTR a[170:171],v231 offset:17408
s_add_u32 s70, s70, s71
M16 v[116:119],a[132:135],a[212:215],v[116:119]
global_load_dword v169, v168, s[88:89] sc1
AW a96,0
AW a97,0
M16 v[120:123],a[128:131],a[200:203],v[120:123]
DTR a[172:173],v231 offset:24576
AW a98,0
M16 v[120:123],a[132:135],a[216:219],v[120:123]
AW a99,0
AW a100,0
M16 v[124:127],a[128:131],a[204:207],v[124:127]
DTR a[174:175],v231 offset:25600
AW a101,0
M16 v[124:127],a[132:135],a[220:223],v[124:127]
s_waitcnt lgkmcnt(15)
AW a102,0
AW a103,0
M16 v[128:131],a[136:139],a[192:195],v[128:131]
DTR a[128:129],v232 offset:16384
AW a104,0
M16 v[128:131],a[140:143],a[208:211],v[128:131]
AW a105,0
AW a106,0
M16 v[132:135],a[136:139],a[196:199],v[132:135]
DTR a[130:131],v232 offset:17408
AW a107,0
M16 v[132:135],a[140:143],a[212:215],v[132:135]
AW a108,0
AW a109,0
M16 v[136:139],a[136:139],a[200:203],v[136:139]
DTR a[132:133],v232 offset:24576
AW a110,0
M16 v[136:139],a[140:143],a[216:219],v[136:139]
AW a111,0
M16 v[140:143],a[136:139],a[204:207],v[140:143]
DTR a[134:135],v232 offset:25600
M16 v[140:143],a[140:143],a[220:223],v[140:143]
s_waitcnt lgkmcnt(15)
M16 v[16:19],a[144:147],a[224:227],v[16:19]
DTR a[136:137],v233 offset:16384
s_add_u32 m0, s66, 0
M16 v[16:19],a[148:151],a[240:243],v[16:19]
s_mov_b32 s67, 1152
M16 v[20:23],a[144:147],a[228:231],v[20:23]
DTR a[138:139],v233 offset:17408
M16 v[20:23],a[148:151],a[244:247],v[20:23]
BL4 v220,s[92:95],s67 offen lds
M16 v[24:27],a[144:147],a[232:235],v[24:27]
DTR a[140:141],v233 offset:24576
M16 v[24:27],a[148:151],a[248:251],v[24:27]
BL4 v221,s[92:95],s67 offen offset:1024 lds
M16 v[28:31],a[144:147],a[236:239],v[28:31]
DTR a[142:143],v233 offset:25600
M16 v[28:31],a[148:151],a[252:255],v[28:31]
s_waitcnt lgkmcnt(15)
M16 v[32:35],a[152:155],a[224:227],v[32:35]
DTR a[144:145],v234 offset:16384
M16 v[32:35],a[156:159],a[240:243],v[32:35]
BL4 v222,s[92:95],s67 offen offset:2048 lds
M16 v[36:39],a[152:155],a[228:231],v[36:39]
DTR a[146:147],v234 offset:17408
M16 v[36:39],a[156:159],a[244:247],v[36:39]
BL4 v223,s[92:95],s67 offen offset:3072 lds
M16 v[40:43],a[152:155],a[232:235],v[40:43]
DTR a[148:149],v234 offset:24576
s_waitcnt vmcnt(13)
M16 v[40:43],a[156:159],a[248:251],v[40:43]
DR a[192:195],v212 offset:4096
M16 v[44:47],a[152:155],a[236:239],v[44:47]
DTR a[150:151],v234 offset:25600
M16 v[44:47],a[156:159],a[252:255],v[44:47]
s_waitcnt lgkmcnt(15)
DR a[208:211],v213 offset:4096
M16 v[48:51],a[160:163],a[224:227],v[48:51]
DTR a[152:153],v235 offset:16384
M16 v[48:51],a[164:167],a[240:243],v[48:51]
DR a[196:199],v212 offset:6144
M16 v[52:55],a[160:163],a[228:231],v[52:55]
DTR a[154:155],v235 offset:17408
M16 v[52:55],a[164:167],a[244:247],v[52:55]
DR a[212:215],v213 offset:6144
s_waitcnt vmcnt(9)
M16 v[56:59],a[160:163],a[232:235],v[56:59]
DTR a[156:157],v235 offset:24576
M16 v[56:59],a[164:167],a[248:251],v[56:59]
s_waitcnt lgkmcnt(15)
DR a[200:203],v214 offset:0
M16 v[60:63],a[160:163],a[236:239],v[60:63]
DTR a[158:159],v235 offset:25600
s_waitcnt vmcnt(5)
M16 v[60:63],a[164:167],a[252:255],v[60:63]
s_barrier
DR a[216:219],v215 offset:0
M16 v[64:67],a[168:171],a[224:227],v[64:67]
DTR a[160:161],v228 offset:32768
M16 v[64:67],a[172:175],a[240:243],v[64:67]
DR a[204:207],v214 offset:2048
M16 v[68:71],a[168:171],a[228:231],v[68:71]
DTR a[162:163],v228 offset:33792
M16 v[68:71],a[172:175],a[244:247],v[68:71]
DR a[220:223],v215 offset:2048
s_waitcnt lgkmcnt(8)
M16 v[72:75],a[168:171],a[232:235],v[72:75]
DTR a[164:165],v228 offset:40960
s_add_u32 m0, s66, 4096
M16 v[72:75],a[172:175],a[248:251],v[72:75]
M16 v[76:79],a[168:171],a[236:239],v[76:79]
DTR a[166:167],v228 offset:41984
M16 v[76:79],a[172:175],a[252:255],v[76:79]
M16 v[80:83],a[128:131],a[224:227],v[80:83]
DTR a[168:169],v229 offset:32768
M16 v[80:83],a[132:135],a[240:243],v[80:83]
BL4 v224,s[92:95],s67 offen lds
M16 v[84:87],a[128:131],a[228:231],v[84:87]
DTR a[170:171],v229 offset:33792
M16 v[84:87],a[132:135],a[244:247],v[84:87]
BL4 v225,s[92:95],s67 offen offset:1024 lds
M16 v[88:91],a[128:131],a[232:235],v[88:91]
DTR a[172:173],v229 offset:40960
M16 v[88:91],a[132:135],a[248:251],v[88:91]
BL4 v226,s[92:95],s67 offen offset:2048 lds
M16 v[92:95],a[128:131],a[236:239],v[92:95]
DTR a[174:175],v229 offset:41984
M16 v[92:95],a[132:135],a[252:255],v[92:95]
M16 v[96:99],a[136:139],a[224:227],v[96:99]
DTR a[128:129],v230 offset:32768
M16 v[96:99],a[140:143],a[240:243],v[96:99]
BL4 v227,s[92:95],s67 offen offset:3072 lds
M16 v[100:103],a[136:139],a[228:231],v[100:103]
DTR a[130:131],v230 offset:33792
s_add_u32 m0, s73, 81920
M16 v[100:103],a[140:143],a[244:247],v[100:103]
BL4 v208,s[4:7],s70 offen lds
M16 v[104:107],a[136:139],a[232:235],v[104:107]
DTR a[132:133],v230 offset:40960
M16 v[104:107],a[140:143],a[248:251],v[104:107]
BL4 v209,s[4:7],s70 offen offset:1024 lds
M16 v[108:111],a[136:139],a[236:239],v[108:111]
DTR a[134:135],v230 offset:41984
M16 v[108:111],a[140:143],a[252:255],v[108:111]
M16 v[112:115],a[144:147],a[224:227],v[112:115]
DTR a[136:137],v231 offset:32768
M16 v[112:115],a[148:151],a[240:243],v[112:115]
BL4 v210,s[4:7],s70 offen offset:2048 lds
M16 v[116:119],a[144:147],a[228:231],v[116:119]
DTR a[138:139],v231 offset:33792
M16 v[116:119],a[148:151],a[244:247],v[116:119]
BL4 v211,s[4:7],s70 offen offset:3072 lds
M16 v[120:123],a[144:147],a[232:235],v[120:123]
DTR a[140:141],v231 offset:40960
s_add_u32 s70, s70, s71
M16 v[120:123],a[148:151],a[248:251],v[120:123]
s_waitcnt vmcnt(12)
L_pl3:
v_cmp_le_u32 s[12:13], 6, v169
v_cmp_le_u32 s[14:15], 26, v169
s_nop 3
s_and_b32 s13, s13, s14
s_and_b32 s13, s13, 0xff
s_cmp_eq_u32 s13, 0xff
s_cbranch_scc1 L_pk3
s_cmp_eq_u32 s3, 0
s_cbranch_scc1 L_pk3
s_sub_u32 s3, s3, 1
s_sleep 8
global_load_dword v169, v168, s[88:89] sc1
s_waitcnt vmcnt(0)
s_branch L_pl3
L_pk3:
M16 v[124:127],a[144:147],a[236:239],v[124:127]
DTR a[142:143],v231 offset:41984
AW a112,0
M16 v[124:127],a[148:151],a[252:255],v[124:127]
s_waitcnt lgkmcnt(15)
AW a113,0
AW a114,0
M16 v[128:131],a[152:155],a[224:227],v[128:131]
DTR a[144:145],v232 offset:32768
AW a115,0
M16 v[128:131],a[156:159],a[240:243],v[128:131]
AW a116,0
AW a117,0
M16 v[132:135],a[152:155],a[228:231],v[132:135]
DTR a[146:147],v232 offset:33792
AW a118,0
M16 v[132:135],a[156:159],a[244:247],v[132:135]
AW a119,0
AW a120,0
M16 v[136:139],a[152:155],a[232:235],v[136:139]
DTR a[148:149],v232 offset:40960
AW a121,0
M16 v[136:139],a[156:159],a[248:251],v[136:139]
AW a122,0
AW a123,0
M16 v[140:143],a[152:155],a[236:239],v[140:143]
DTR a[150:151],v232 offset:41984
AW a124,0
M16 v[140:143],a[156:159],a[252:255],v[140:143]
s_waitcnt lgkmcnt(15)
AW a125,0
AW a126,0
AW a127,0
M16 v[16:19],a[160:163],a[192:195],v[16:19]
DTR a[152:153],v233 offset:32768
s_waitcnt vmcnt(8)
M16 v[16:19],a[164:167],a[208:211],v[16:19]
DR a[224:227],v212 offset:0
M16 v[20:23],a[160:163],a[196:199],v[20:23]
DTR a[154:155],v233 offset:33792
M16 v[20:23],a[164:167],a[212:215],v[20:23]
DR a[240:243],v213 offset:0
M16 v[24:27],a[160:163],a[200:203],v[24:27]
DTR a[156:157],v233 offset:40960
M16 v[24:27],a[164:167],a[216:219],v[24:27]
DR a[228:231],v212 offset:2048
M16 v[28:31],a[160:163],a[204:207],v[28:31]
DTR a[158:159],v233 offset:41984
M16 v[28:31],a[164:167],a[220:223],v[28:31]
s_waitcnt lgkmcnt(15)
DR a[244:247],v213 offset:2048
M16 v[32:35],a[168:171],a[192:195],v[32:35]
DTR a[160:161],v234 offset:32768
M16 v[32:35],a[172:175],a[208:211],v[32:35]
M16 v[36:39],a[168:171],a[196:199],v[36:39]
DTR a[162:163],v234 offset:33792
M16 v[36:39],a[172:175],a[212:215],v[36:39]
M16 v[40:43],a[168:171],a[200:203],v[40:43]
DTR a[164:165],v234 offset:40960
M16 v[40:43],a[172:175],a[216:219],v[40:43]
M16 v[44:47],a[168:171],a[204:207],v[44:47]
DTR a[166:167],v234 offset:41984
M16 v[44:47],a[172:175],a[220:223],v[44:47]
M16 v[48:51],a[128:131],a[192:195],v[48:51]
DTR a[168:169],v235 offset:32768
M16 v[48:51],a[132:135],a[208:211],v[48:51]
M16 v[52:55],a[128:131],a[196:199],v[52:55]
DTR a[170:171],v235 offset:33792
s_waitcnt vmcnt(4)
M16 v[52:55],a[132:135],a[212:215],v[52:55]
DR a[232:235],v212 offset:4096
M16 v[56:59],a[128:131],a[200:203],v[56:59]
DTR a[172:173],v235 offset:40960
M16 v[56:59],a[132:135],a[216:219],v[56:59]
s_waitcnt lgkmcnt(15)
DR a[248:251],v213 offset:4096
M16 v[60:63],a[128:131],a[204:207],v[60:63]
DTR a[174:175],v235 offset:41984
s_waitcnt vmcnt(0)
M16 v[60:63],a[132:135],a[220:223],v[60:63]
s_barrier
DR a[236:239],v212 offset:6144
M16 v[64:67],a[136:139],a[192:195],v[64:67]
DTR a[128:129],v228 offset:0
M16 v[64:67],a[140:143],a[208:211],v[64:67]
DR a[252:255],v213 offset:6144
s_waitcnt lgkmcnt(13)
M16 v[68:71],a[136:139],a[196:199],v[68:71]
DTR a[130:131],v228 offset:1024
s_add_u32 m0, s26, s30
M16 v[68:71],a[140:143],a[212:215],v[68:71]
BL4 v3,s[8:11],s24 offen lds
M16 v[72:75],a[136:139],a[200:203],v[72:75]
DTR a[132:133],v228 offset:8192
M16 v[72:75],a[140:143],a[216:219],v[72:75]
BL4 v3,s[8:11],s24 offen offset:1024 lds
M16 v[76:79],a[136:139],a[204:207],v[76:79]
DTR a[134:135],v228 offset:9216
M16 v[76:79],a[140:143],a[220:223],v[76:79]
M16 v[80:83],a[144:147],a[192:195],v[80:83]
DTR a[136:137],v229 offset:0
M16 v[80:83],a[148:151],a[208:211],v[80:83]
BL4 v3,s[8:11],s24 offen offset:2048 lds
M16 v[84:87],a[144:147],a[196:199],v[84:87]
DTR a[138:139],v229 offset:1024
M16 v[84:87],a[148:151],a[212:215],v[84:87]
BL4 v3,s[8:11],s24 offen offset:3072 lds
M16 v[88:91],a[144:147],a[200:203],v[88:91]
DTR a[140:141],v229 offset:8192
s_add_u32 s24, s24, 32768
M16 v[88:91],a[148:151],a[216:219],v[88:91]
s_add_u32 s26, s26, 16384
s_and_b32 s26, s26, 0xffff
s_add_u32 m0, s26, s30
M16 v[92:95],a[144:147],a[204:207],v[92:95]
DTR a[142:143],v229 offset:9216
M16 v[92:95],a[148:151],a[220:223],v[92:95]
M16 v[96:99],a[152:155],a[192:195],v[96:99]
DTR a[144:145],v230 offset:0
M16 v[96:99],a[156:159],a[208:211],v[96:99]
BL4 v3,s[8:11],s24 offen lds
M16 v[100:103],a[152:155],a[196:199],v[100:103]
DTR a[146:147],v230 offset:1024
M16 v[100:103],a[156:159],a[212:215],v[100:103]
BL4 v3,s[8:11],s24 offen offset:1024 lds
M16 v[104:107],a[152:155],a[200:203],v[104:107]
DTR a[148:149],v230 offset:8192
M16 v[104:107],a[156:159],a[216:219],v[104:107]
BL4 v3,s[8:11],s24 offen offset:2048 lds
M16 v[108:111],a[152:155],a[204:207],v[108:111]
DTR a[150:151],v230 offset:9216
M16 v[108:111],a[156:159],a[220:223],v[108:111]
s_waitcnt lgkmcnt(15)
M16 v[112:115],a[160:163],a[192:195],v[112:115]
DTR a[152:153],v231 offset:0
M16 v[112:115],a[164:167],a[208:211],v[112:115]
BL4 v3,s[8:11],s24 offen offset:3072 lds
M16 v[116:119],a[160:163],a[196:199],v[116:119]
DTR a[154:155],v231 offset:1024
s_add_u32 s24, s24, 32768
M16 v[116:119],a[164:167],a[212:215],v[116:119]
s_add_u32 s26, s26, 16384
s_and_b32 s26, s26, 0xffff
M16 v[120:123],a[160:163],a[200:203],v[120:123]
DTR a[156:157],v231 offset:8192
M16 v[120:123],a[164:167],a[216:219],v[120:123]
M16 v[124:127],a[160:163],a[204:207],v[124:127]
DTR a[158:159],v231 offset:9216
M16 v[124:127],a[164:167],a[220:223],v[124:127]
s_waitcnt lgkmcnt(15)
M16 v[128:131],a[168:171],a[192:195],v[128:131]
DTR a[160:161],v232 offset:0
M16 v[128:131],a[172:175],a[208:211],v[128:131]
M16 v[132:135],a[168:171],a[196:199],v[132:135]
DTR a[162:163],v232 offset:1024
M16 v[132:135],a[172:175],a[212:215],v[132:135]
M16 v[136:139],a[168:171],a[200:203],v[136:139]
DTR a[164:165],v232 offset:8192
M16 v[136:139],a[172:175],a[216:219],v[136:139]
M16 v[140:143],a[168:171],a[204:207],v[140:143]
DTR a[166:167],v232 offset:9216
M16 v[140:143],a[172:175],a[220:223],v[140:143]
s_waitcnt lgkmcnt(15)
M16 v[16:19],a[128:131],a[224:227],v[16:19]
DTR a[168:169],v233 offset:0
M16 v[16:19],a[132:135],a[240:243],v[16:19]
M16 v[20:23],a[128:131],a[228:231],v[20:23]
DTR a[170:171],v233 offset:1024
M16 v[20:23],a[132:135],a[244:247],v[20:23]
M16 v[24:27],a[128:131],a[232:235],v[24:27]
DTR a[172:173],v233 offset:8192
M16 v[24:27],a[132:135],a[248:251],v[24:27]
M16 v[28:31],a[128:131],a[236:239],v[28:31]
DTR a[174:175],v233 offset:9216
M16 v[28:31],a[132:135],a[252:255],v[28:31]
s_waitcnt lgkmcnt(15)
M16 v[32:35],a[136:139],a[224:227],v[32:35]
DTR a[128:129],v234 offset:0
M16 v[32:35],a[140:143],a[240:243],v[32:35]
CVT v16,v16,v17
CVT v17,v18,v19
M16 v[36:39],a[136:139],a[228:231],v[36:39]
DTR a[130:131],v234 offset:1024
M16 v[36:39],a[140:143],a[244:247],v[36:39]
CVT v20,v20,v21
CVT v21,v22,v23
M16 v[40:43],a[136:139],a[232:235],v[40:43]
DTR a[132:133],v234 offset:8192
M16 v[40:43],a[140:143],a[248:251],v[40:43]
CVT v24,v24,v25
CVT v25,v26,v27
M16 v[44:47],a[136:139],a[236:239],v[44:47]
DTR a[134:135],v234 offset:9216
M16 v[44:47],a[140:143],a[252:255],v[44:47]
s_waitcnt lgkmcnt(15)
CVT v28,v28,v29
CVT v29,v30,v31
M16 v[48:51],a[144:147],a[224:227],v[48:51]
DTR a[136:137],v235 offset:0
M16 v[48:51],a[148:151],a[240:243],v[48:51]
CVT v32,v32,v33
CVT v33,v34,v35
M16 v[52:55],a[144:147],a[228:231],v[52:55]
DTR a[138:139],v235 offset:1024
M16 v[52:55],a[148:151],a[244:247],v[52:55]
CVT v36,v36,v37
CVT v37,v38,v39
M16 v[56:59],a[144:147],a[232:235],v[56:59]
DTR a[140:141],v235 offset:8192
M16 v[56:59],a[148:151],a[248:251],v[56:59]
s_waitcnt lgkmcnt(15)
CVT v40,v40,v41
CVT v41,v42,v43
M16 v[60:63],a[144:147],a[236:239],v[60:63]
DTR a[142:143],v235 offset:9216
M16 v[60:63],a[148:151],a[252:255],v[60:63]
CVT v44,v44,v45
CVT v45,v46,v47
M16 v[64:67],a[152:155],a[224:227],v[64:67]
s_add_u32 m0, s26, s30
M16 v[64:67],a[156:159],a[240:243],v[64:67]
BL4 v3,s[8:11],s24 offen lds
M16 v[68:71],a[152:155],a[228:231],v[68:71]
BL4 v3,s[8:11],s24 offen offset:1024 lds
M16 v[68:71],a[156:159],a[244:247],v[68:71]
BL4 v3,s[8:11],s24 offen offset:2048 lds
M16 v[72:75],a[152:155],a[232:235],v[72:75]
BL4 v3,s[8:11],s24 offen offset:3072 lds
M16 v[72:75],a[156:159],a[248:251],v[72:75]
s_add_u32 s24, s24, 32768
s_add_u32 s26, s26, 16384
s_and_b32 s26, s26, 0xffff
M16 v[76:79],a[152:155],a[236:239],v[76:79]
s_add_u32 m0, s27, s31
CVT v48,v48,v49
CVT v49,v50,v51
M16 v[76:79],a[156:159],a[252:255],v[76:79]
s_waitcnt lgkmcnt(12)
CVT v52,v52,v53
CVT v53,v54,v55
M16 v[80:83],a[160:163],a[224:227],v[80:83]
BL4 v3,s[8:11],s25 offen lds
M16 v[80:83],a[164:167],a[240:243],v[80:83]
BL4 v3,s[8:11],s25 offen offset:1024 lds
M16 v[84:87],a[160:163],a[228:231],v[84:87]
BL4 v3,s[8:11],s25 offen offset:2048 lds
M16 v[84:87],a[164:167],a[244:247],v[84:87]
BL4 v3,s[8:11],s25 offen offset:3072 lds
M16 v[88:91],a[160:163],a[232:235],v[88:91]
s_add_u32 s25, s25, 32768
s_add_u32 s27, s27, 16384
s_and_b32 s27, s27, 0xffff
M16 v[88:91],a[164:167],a[248:251],v[88:91]
CVT v56,v56,v57
CVT v57,v58,v59
M16 v[92:95],a[160:163],a[236:239],v[92:95]
CVT v60,v60,v61
CVT v61,v62,v63
M16 v[92:95],a[164:167],a[252:255],v[92:95]
s_waitcnt lgkmcnt(8)
CVT v64,v64,v65
CVT v65,v66,v67
M16 v[96:99],a[168:171],a[224:227],v[96:99]
CVT v68,v68,v69
CVT v69,v70,v71
M16 v[96:99],a[172:175],a[240:243],v[96:99]
CVT v72,v72,v73
CVT v73,v74,v75
M16 v[100:103],a[168:171],a[228:231],v[100:103]
CVT v76,v76,v77
CVT v77,v78,v79
M16 v[100:103],a[172:175],a[244:247],v[100:103]
CVT v80,v80,v81
CVT v81,v82,v83
M16 v[104:107],a[168:171],a[232:235],v[104:107]
CVT v84,v84,v85
CVT v85,v86,v87
M16 v[104:107],a[172:175],a[248:251],v[104:107]
CVT v88,v88,v89
CVT v89,v90,v91
M16 v[108:111],a[168:171],a[236:239],v[108:111]
M16 v[108:111],a[172:175],a[252:255],v[108:111]
s_waitcnt lgkmcnt(4)
CVT v92,v92,v93
CVT v93,v94,v95
M16 v[112:115],a[128:131],a[224:227],v[112:115]
M16 v[112:115],a[132:135],a[240:243],v[112:115]
CVT v96,v96,v97
CVT v97,v98,v99
M16 v[116:119],a[128:131],a[228:231],v[116:119]
M16 v[116:119],a[132:135],a[244:247],v[116:119]
CVT v100,v100,v101
CVT v101,v102,v103
M16 v[120:123],a[128:131],a[232:235],v[120:123]
M16 v[120:123],a[132:135],a[248:251],v[120:123]
CVT v104,v104,v105
CVT v105,v106,v107
M16 v[124:127],a[128:131],a[236:239],v[124:127]
M16 v[124:127],a[132:135],a[252:255],v[124:127]
s_waitcnt lgkmcnt(0)
CVT v108,v108,v109
CVT v109,v110,v111
M16 v[128:131],a[136:139],a[224:227],v[128:131]
M16 v[128:131],a[140:143],a[240:243],v[128:131]
CVT v112,v112,v113
CVT v113,v114,v115
M16 v[132:135],a[136:139],a[228:231],v[132:135]
M16 v[132:135],a[140:143],a[244:247],v[132:135]
CVT v116,v116,v117
CVT v117,v118,v119
M16 v[136:139],a[136:139],a[232:235],v[136:139]
M16 v[136:139],a[140:143],a[248:251],v[136:139]
CVT v120,v120,v121
CVT v121,v122,v123
M16 v[140:143],a[136:139],a[236:239],v[140:143]
M16 v[140:143],a[140:143],a[252:255],v[140:143]
CVT v124,v124,v125
CVT v125,v126,v127
s_waitcnt vmcnt(8)
s_barrier
DR a[192:195],v4 offset:0
DR a[196:199],v4 offset:1024
DR a[200:203],v4 offset:2048
DR a[204:207],v4 offset:3072
DR a[208:211],v4 offset:4096
DR a[212:215],v4 offset:5120
DR a[216:219],v4 offset:6144
DR a[220:223],v4 offset:7168
DR a[224:227],v4 offset:8192
DR a[228:231],v4 offset:9216
DR a[232:235],v4 offset:10240
DR a[236:239],v4 offset:11264
DR a[240:243],v4 offset:12288
DR a[244:247],v4 offset:13312
DR a[248:251],v4 offset:14336
DR a[252:255],v4 offset:15360
v_mov_b32 v224, 0
v_mov_b32 v225, 0
v_mov_b32 v226, 0
v_mov_b32 v227, 0
v_mov_b32 v228, 0
v_mov_b32 v229, 0
v_mov_b32 v230, 0
v_mov_b32 v231, 0
v_mov_b32 v232, 0
v_mov_b32 v233, 0
v_mov_b32 v234, 0
v_mov_b32 v235, 0
v_mov_b32 v236, 0
v_mov_b32 v237, 0
v_mov_b32 v238, 0
v_mov_b32 v239, 0
s_cmp_lg_u32 s22, 0
s_cbranch_scc1 L_a_nomask0
v_cndmask_b32 v240, v6, v8, s[32:33]
v_cndmask_b32 v241, v6, v8, s[34:35]
v_cndmask_b32 v242, v6, v8, s[36:37]
v_cndmask_b32 v243, v6, v8, s[38:39]
v_cndmask_b32 v244, v6, v8, s[40:41]
v_cndmask_b32 v245, v6, v8, s[42:43]
v_cndmask_b32 v246, v6, v8, s[44:45]
v_cndmask_b32 v247, v6, v8, s[46:47]
v_cndmask_b32 v248, v6, v8, s[48:49]
v_cndmask_b32 v249, v6, v8, s[50:51]
v_cndmask_b32 v250, v6, v8, s[52:53]
v_cndmask_b32 v251, v6, v8, s[54:55]
v_cndmask_b32 v252, v6, v8, s[56:57]
v_cndmask_b32 v253, v6, v8, s[58:59]
v_cndmask_b32 v254, v6, v8, s[60:61]
v_cndmask_b32 v255, v6, v8, s[62:63]
L_a_nomask0:
v_add_u32 v4, s28, v2
CVT v128,v128,v129
CVT v129,v130,v131
CVT v132,v132,v133
CVT v133,v134,v135
CVT v136,v136,v137
CVT v137,v138,v139
CVT v140,v140,v141
CVT v141,v142,v143
s_add_u32 m0, s26, s30
s_nop 0
BL4 v3,s[8:11],s24 offen lds
BL4 v3,s[8:11],s24 offen offset:1024 lds
BL4 v3,s[8:11],s24 offen offset:2048 lds
BL4 v3,s[8:11],s24 offen offset:3072 lds
s_add_u32 s24, s24, 32768
s_add_u32 s26, s26, 16384
s_and_b32 s26, s26, 0xffff
s_add_u32 m0, s27, s31
s_nop 0
BL4 v3,s[8:11],s25 offen lds
BL4 v3,s[8:11],s25 offen offset:1024 lds
BL4 v3,s[8:11],s25 offen offset:2048 lds
BL4 v3,s[8:11],s25 offen offset:3072 lds
s_add_u32 s25, s25, 32768
s_add_u32 s27, s27, 16384
s_and_b32 s27, s27, 0xffff
AW a128,v16
AW a129,v17
AW a130,v32
AW a131,v33
AW a132,v48
AW a133,v49
AW a134,v64
AW a135,v65
AW a136,v80
AW a137,v81
AW a138,v96
AW a139,v97
AW a140,v112
AW a141,v113
AW a142,v128
AW a143,v129
s_waitcnt lgkmcnt(0)
M16 v[144:147],a[192:195],a[128:131],v[240:243]
AW a144,v20
AW a145,v21
M16 v[144:147],a[196:199],a[132:135],v[144:147]
AW a146,v36
AW a147,v37
M16 v[144:147],a[200:203],a[136:139],v[144:147]
AW a148,v52
AW a149,v53
M16 v[144:147],a[204:207],a[140:143],v[144:147]
AW a150,v68
AW a151,v69
M16 v[148:151],a[208:211],a[128:131],v[244:247]
AW a152,v84
AW a153,v85
M16 v[148:151],a[212:215],a[132:135],v[148:151]
AW a154,v100
AW a155,v101
M16 v[148:151],a[216:219],a[136:139],v[148:151]
AW a156,v116
AW a157,v117
M16 v[148:151],a[220:223],a[140:143],v[148:151]
AW a158,v132
AW a159,v133
M16 v[152:155],a[224:227],a[128:131],v[248:251]
M16 v[152:155],a[228:231],a[132:135],v[152:155]
M16 v[152:155],a[232:235],a[136:139],v[152:155]
M16 v[152:155],a[236:239],a[140:143],v[152:155]
M16 v[156:159],a[240:243],a[128:131],v[252:255]
M16 v[156:159],a[244:247],a[132:135],v[156:159]
M16 v[156:159],a[248:251],a[136:139],v[156:159]
M16 v[156:159],a[252:255],a[140:143],v[156:159]
M16 v[160:163],a[192:195],a[144:147],0
AW a160,v24
AW a161,v25
M16 v[160:163],a[196:199],a[148:151],v[160:163]
AW a162,v40
AW a163,v41
M16 v[160:163],a[200:203],a[152:155],v[160:163]
AW a164,v56
AW a165,v57
M16 v[160:163],a[204:207],a[156:159],v[160:163]
AW a166,v72
AW a167,v73
M16 v[164:167],a[208:211],a[144:147],0
AW a168,v88
AW a169,v89
M16 v[164:167],a[212:215],a[148:151],v[164:167]
AW a170,v104
AW a171,v105
M16 v[164:167],a[216:219],a[152:155],v[164:167]
AW a172,v120
AW a173,v121
M16 v[164:167],a[220:223],a[156:159],v[164:167]
AW a174,v136
AW a175,v137
M16 v[168:171],a[224:227],a[144:147],0
v_max3_f32 v8, v144, v145, v146
v_max3_f32 v8, v147, v148, v8
M16 v[168:171],a[228:231],a[148:151],v[168:171]
v_max3_f32 v8, v149, v150, v8
v_max3_f32 v8, v151, v152, v8
M16 v[168:171],a[232:235],a[152:155],v[168:171]
v_max3_f32 v8, v153, v154, v8
v_max3_f32 v8, v155, v156, v8
M16 v[168:171],a[236:239],a[156:159],v[168:171]
v_max3_f32 v8, v157, v158, v8
v_max_f32 v8, v159, v8
M16 v[172:175],a[240:243],a[144:147],0
v_mov_b32 v9, v8
M16 v[172:175],a[244:247],a[148:151],v[172:175]
M16 v[172:175],a[248:251],a[152:155],v[172:175]
v_permlane16_swap_b32 v8, v9
M16 v[172:175],a[252:255],a[156:159],v[172:175]
M16 v[176:179],a[192:195],a[160:163],0
AW a176,v28
AW a177,v29
M16 v[176:179],a[196:199],a[164:167],v[176:179]
AW a178,v44
AW a179,v45
M16 v[176:179],a[200:203],a[168:171],v[176:179]
AW a180,v60
AW a181,v61
M16 v[176:179],a[204:207],a[172:175],v[176:179]
AW a182,v76
AW a183,v77
M16 v[180:183],a[208:211],a[160:163],0
AW a184,v92
AW a185,v93
M16 v[180:183],a[212:215],a[164:167],v[180:183]
AW a186,v108
AW a187,v109
M16 v[180:183],a[216:219],a[168:171],v[180:183]
AW a188,v124
AW a189,v125
M16 v[180:183],a[220:223],a[172:175],v[180:183]
AW a190,v140
AW a191,v141
M16 v[184:187],a[224:227],a[160:163],0
v_max_f32 v8, v8, v9
v_mov_b32 v9, v8
M16 v[184:187],a[228:231],a[164:167],v[184:187]
M16 v[184:187],a[232:235],a[168:171],v[184:187]
v_permlane32_swap_b32 v8, v9
M16 v[184:187],a[236:239],a[172:175],v[184:187]
M16 v[188:191],a[240:243],a[160:163],0
v_max_f32 v8, v8, v9
v_sub_f32 v208, 0, v8
M16 v[188:191],a[244:247],a[164:167],v[188:191]
v_sub_f32 v209, 0, v8
v_sub_f32 v210, 0, v8
M16 v[188:191],a[248:251],a[168:171],v[188:191]
v_sub_f32 v211, 0, v8
v_max3_f32 v10, v160, v161, v162
M16 v[188:191],a[252:255],a[172:175],v[188:191]
v_max3_f32 v10, v163, v164, v10
v_max3_f32 v10, v165, v166, v10
M16 v[192:195],a[192:195],a[176:179],0
v_max3_f32 v10, v167, v168, v10
v_max3_f32 v10, v169, v170, v10
M16 v[192:195],a[196:199],a[180:183],v[192:195]
v_max3_f32 v10, v171, v172, v10
v_max3_f32 v10, v173, v174, v10
M16 v[192:195],a[200:203],a[184:187],v[192:195]
v_max_f32 v10, v175, v10
v_mov_b32 v11, v10
M16 v[192:195],a[204:207],a[188:191],v[192:195]
DR a[192:195],v4 offset:0
M16 v[196:199],a[208:211],a[176:179],0
DR a[196:199],v4 offset:1024
v_permlane16_swap_b32 v10, v11
M16 v[196:199],a[212:215],a[180:183],v[196:199]
DR a[200:203],v4 offset:2048
M16 v[196:199],a[216:219],a[184:187],v[196:199]
DR a[204:207],v4 offset:3072
v_max_f32 v10, v10, v11
M16 v[196:199],a[220:223],a[188:191],v[196:199]
DR a[208:211],v4 offset:4096
v_mov_b32 v11, v10
M16 v[200:203],a[224:227],a[176:179],0
DR a[212:215],v4 offset:5120
M16 v[200:203],a[228:231],a[180:183],v[200:203]
DR a[216:219],v4 offset:6144
v_permlane32_swap_b32 v10, v11
M16 v[200:203],a[232:235],a[184:187],v[200:203]
DR a[220:223],v4 offset:7168
M16 v[200:203],a[236:239],a[188:191],v[200:203]
DR a[224:227],v4 offset:8192
v_max_f32 v10, v10, v11
M16 v[204:207],a[240:243],a[176:179],0
DR a[228:231],v4 offset:9216
v_sub_f32 v212, 0, v10
M16 v[204:207],a[244:247],a[180:183],v[204:207]
DR a[232:235],v4 offset:10240
v_sub_f32 v213, 0, v10
M16 v[204:207],a[248:251],a[184:187],v[204:207]
DR a[236:239],v4 offset:11264
v_sub_f32 v214, 0, v10
M16 v[204:207],a[252:255],a[188:191],v[204:207]
v_sub_f32 v215, 0, v10
v_max3_f32 v12, v176, v177, v178
v_max3_f32 v12, v179, v180, v12
v_max3_f32 v12, v181, v182, v12
v_max3_f32 v12, v183, v184, v12
v_max3_f32 v12, v185, v186, v12
v_max3_f32 v12, v187, v188, v12
v_max3_f32 v12, v189, v190, v12
v_max_f32 v12, v191, v12
v_max3_f32 v14, v192, v193, v194
v_max3_f32 v14, v195, v196, v14
v_max3_f32 v14, v197, v198, v14
v_max3_f32 v14, v199, v200, v14
v_max3_f32 v14, v201, v202, v14
v_max3_f32 v14, v203, v204, v14
v_max3_f32 v14, v205, v206, v14
v_max_f32 v14, v207, v14
v_mov_b32 v15, v14
v_mov_b32 v13, v12
s_nop 0
v_permlane16_swap_b32 v14, v15
s_nop 0
s_nop 0
v_max_f32 v14, v14, v15
v_mov_b32 v15, v14
s_nop 0
s_nop 0
v_permlane32_swap_b32 v14, v15
s_nop 0
s_nop 0
v_max_f32 v14, v14, v15
v_sub_f32 v220, 0, v14
v_sub_f32 v221, 0, v14
v_sub_f32 v222, 0, v14
v_sub_f32 v223, 0, v14
s_nop 0
s_nop 0
v_permlane16_swap_b32 v12, v13
s_nop 0
s_nop 0
v_max_f32 v12, v12, v13
v_mov_b32 v13, v12
s_nop 0
s_nop 0
v_permlane32_swap_b32 v12, v13
s_nop 0
s_nop 0
v_max_f32 v12, v12, v13
v_sub_f32 v216, 0, v12
v_sub_f32 v217, 0, v12
v_sub_f32 v218, 0, v12
v_sub_f32 v219, 0, v12
v_sub_f32 v16, v144, v8
v_sub_f32 v17, v145, v8
v_sub_f32 v18, v146, v8
v_sub_f32 v19, v147, v8
v_sub_f32 v20, v148, v8
v_sub_f32 v21, v149, v8
v_sub_f32 v22, v150, v8
v_sub_f32 v23, v151, v8
v_sub_f32 v24, v152, v8
v_sub_f32 v25, v153, v8
v_sub_f32 v26, v154, v8
v_sub_f32 v27, v155, v8
v_sub_f32 v28, v156, v8
v_sub_f32 v29, v157, v8
v_sub_f32 v30, v158, v8
v_sub_f32 v31, v159, v8
v_sub_f32 v32, v160, v10
v_sub_f32 v33, v161, v10
v_sub_f32 v34, v162, v10
v_sub_f32 v35, v163, v10
v_sub_f32 v36, v164, v10
v_sub_f32 v37, v165, v10
v_sub_f32 v38, v166, v10
v_sub_f32 v39, v167, v10
v_sub_f32 v40, v168, v10
v_sub_f32 v41, v169, v10
v_sub_f32 v42, v170, v10
v_sub_f32 v43, v171, v10
v_sub_f32 v44, v172, v10
v_sub_f32 v45, v173, v10
v_sub_f32 v46, v174, v10
v_sub_f32 v47, v175, v10
v_sub_f32 v48, v176, v12
v_sub_f32 v49, v177, v12
v_sub_f32 v50, v178, v12
v_sub_f32 v51, v179, v12
v_sub_f32 v52, v180, v12
v_sub_f32 v53, v181, v12
v_sub_f32 v54, v182, v12
v_sub_f32 v55, v183, v12
v_sub_f32 v56, v184, v12
v_sub_f32 v57, v185, v12
v_sub_f32 v58, v186, v12
v_sub_f32 v59, v187, v12
v_sub_f32 v60, v188, v12
v_sub_f32 v61, v189, v12
v_sub_f32 v62, v190, v12
v_sub_f32 v63, v191, v12
v_sub_f32 v64, v192, v14
v_sub_f32 v65, v193, v14
v_sub_f32 v66, v194, v14
v_sub_f32 v67, v195, v14
v_sub_f32 v68, v196, v14
v_sub_f32 v69, v197, v14
v_sub_f32 v70, v198, v14
v_sub_f32 v71, v199, v14
v_sub_f32 v72, v200, v14
v_sub_f32 v73, v201, v14
v_sub_f32 v74, v202, v14
v_sub_f32 v75, v203, v14
v_sub_f32 v76, v204, v14
v_sub_f32 v77, v205, v14
v_sub_f32 v78, v206, v14
v_sub_f32 v79, v207, v14
s_waitcnt lgkmcnt(8)
v_mov_b32 v12, 0x3f803f80
v_mov_b32 v13, 0x3f803f80
v_mov_b32 v14, 0x3f803f80
v_mov_b32 v15, 0x3f803f80
s_mov_b32 s15, 6554
v_add_u32 v181, 0, v1
v_mul_u32_u24 v182, s15, v181
v_lshrrev_b32 v182, 16, v182
v_mul_u32_u24 v182, 1120, v182
v_lshl_add_u32 v176, v181, 4, v182
v_add_u32 v181, 64, v1
v_mul_u32_u24 v182, s15, v181
v_lshrrev_b32 v182, 16, v182
v_mul_u32_u24 v182, 1120, v182
v_lshl_add_u32 v177, v181, 4, v182
v_subrev_u32 v177, 1024, v177
v_add_u32 v181, 128, v1
v_mul_u32_u24 v182, s15, v181
v_lshrrev_b32 v182, 16, v182
v_mul_u32_u24 v182, 1120, v182
v_lshl_add_u32 v178, v181, 4, v182
v_subrev_u32 v178, 2048, v178
v_add_u32 v181, 192, v1
v_mul_u32_u24 v182, s15, v181
v_lshrrev_b32 v182, 16, v182
v_mul_u32_u24 v182, 1120, v182
v_lshl_add_u32 v179, v181, 4, v182
v_subrev_u32 v179, 3072, v179
v_add_u32 v181, 256, v1
v_mul_u32_u24 v182, s15, v181
v_lshrrev_b32 v182, 16, v182
v_mul_u32_u24 v182, 1120, v182
v_lshl_add_u32 v180, v181, 4, v182
s_sub_u32 s12, 223, s2
s_min_u32 s12, s12, 300
s_mul_i32 s12, s12, 6
s_add_u32 s12, s12, s20
s_lshr_b32 s13, s12, 3
s_and_b32 s14, s12, 7
s_cmp_lt_u32 s13, 128
s_cselect_b32 s4, s74, s84
s_cselect_b32 s5, s75, s85
s_mov_b32 s6, 819200
s_cselect_b32 s6, 5242880, s6
s_mov_b32 s7, 0x00020000
s_mul_i32 s0, s12, 5120
s_add_u32 s0, s0, 109051904
s_and_b32 s13, s13, 127
s_mul_i32 s16, s13, 40960
s_mul_i32 s14, s14, 160
s_add_u32 s16, s16, s14
s_cmp_lt_u32 s12, 1184
s_cselect_b32 s0, s0, 1073741824
s_cselect_b32 s16, s16, 1073741824
s_sub_u32 s12, 223, s2
s_min_u32 s12, s12, 300
s_mul_i32 s12, s12, 6
s_add_u32 s12, s12, s20
s_add_u32 s12, s12, 4
s_cmp_lt_u32 s20, 2
s_cselect_b32 s12, s12, 2000
s_lshr_b32 s13, s12, 3
s_and_b32 s14, s12, 7
s_cmp_lt_u32 s13, 128
s_cselect_b32 s92, s74, s84
s_cselect_b32 s93, s75, s85
s_mov_b32 s94, 819200
s_cselect_b32 s94, 5242880, s94
s_mov_b32 s95, 0x00020000
s_mul_i32 s1, s12, 5120
s_add_u32 s1, s1, 109051904
s_and_b32 s13, s13, 127
s_mul_i32 s17, s13, 40960
s_mul_i32 s14, s14, 160
s_add_u32 s17, s17, s14
s_cmp_lt_u32 s12, 1184
s_cselect_b32 s1, s1, 1073741824
s_cselect_b32 s17, s17, 1073741824
s_mul_i32 s18, s20, 5120
s_add_u32 s18, s18, 131072
s_cmp_eq_u32 s22, 0
s_cbranch_scc1 L_a_qb0
s_sub_u32 s23, s22, 1
M16 v[80:83],a[192:195],a[128:131],v[208:211]
DR a[240:243],v4 offset:12288
EXP v16,v16
M16 v[80:83],a[196:199],a[132:135],v[80:83]
EXP v17,v17
EXP v18,v18
M16 v[80:83],a[200:203],a[136:139],v[80:83]
s_waitcnt vmcnt(8)
EXP v19,v19
CVT v144,v16,v17
M16 v[80:83],a[204:207],a[140:143],v[80:83]
s_barrier
EXP v20,v20
EXP v21,v21
M16 v[96:99],a[192:195],a[144:147],v[212:215]
DR a[244:247],v4 offset:13312
EXP v22,v22
CVT v145,v18,v19
M16 v[96:99],a[196:199],a[148:151],v[96:99]
s_add_u32 m0, s26, s30
EXP v23,v23
EXP v24,v24
M16 v[96:99],a[200:203],a[152:155],v[96:99]
DR a[248:251],v4 offset:14336
CVT v146,v20,v21
CVT v147,v22,v23
M16 v[96:99],a[204:207],a[156:159],v[96:99]
BL4 v3,s[8:11],s24 offen lds
EXP v25,v25
M16 v[112:115],a[192:195],a[160:163],v[216:219]
DR a[252:255],v4 offset:15360
EXP v26,v26
CVT v148,v24,v25
M16 v[112:115],a[196:199],a[164:167],v[112:115]
s_add_u32 s28, s28, 16384
EXP v27,v27
EXP v28,v28
M16 v[112:115],a[200:203],a[168:171],v[112:115]
s_and_b32 s28, s28, 0xffff
EXP v29,v29
CVT v149,v26,v27
M16 v[112:115],a[204:207],a[172:175],v[112:115]
BL4 v3,s[8:11],s24 offen offset:1024 lds
v_add_u32 v4, s28, v2
CVT v150,v28,v29
M16 v[128:131],a[192:195],a[176:179],v[220:223]
EXP v30,v30
EXP v31,v31
M16 v[128:131],a[196:199],a[180:183],v[128:131]
EXP v32,v32
CVT v151,v30,v31
M16 v[128:131],a[200:203],a[184:187],v[128:131]
s_waitcnt lgkmcnt(8)
EXP v33,v33
EXP v34,v34
M16 v[128:131],a[204:207],a[188:191],v[128:131]
DR a[192:195],v4 offset:0
v_add_f32 v228, v32, v228
v_add_f32 v229, v33, v229
CVT v152,v32,v33
M16 v[84:87],a[208:211],a[128:131],v[208:211]
BL4 v3,s[8:11],s24 offen offset:2048 lds
EXP v35,v35
M16 v[84:87],a[212:215],a[132:135],v[84:87]
DR a[196:199],v4 offset:1024
v_add_f32 v230, v34, v230
v_add_f32 v231, v35, v231
CVT v153,v34,v35
M16 v[84:87],a[216:219],a[136:139],v[84:87]
EXP v36,v36
EXP v37,v37
M16 v[84:87],a[220:223],a[140:143],v[84:87]
DR a[200:203],v4 offset:2048
v_add_f32 v228, v36, v228
v_add_f32 v229, v37, v229
CVT v154,v36,v37
M16 v[100:103],a[208:211],a[144:147],v[212:215]
BL4 v3,s[8:11],s24 offen offset:3072 lds
EXP v38,v38
M16 v[100:103],a[212:215],a[148:151],v[100:103]
DR a[204:207],v4 offset:3072
EXP v39,v39
v_add_f32 v230, v38, v230
M16 v[100:103],a[216:219],a[152:155],v[100:103]
s_add_u32 s24, s24, 32768
v_add_f32 v231, v39, v231
CVT v155,v38,v39
M16 v[100:103],a[220:223],a[156:159],v[100:103]
s_add_u32 s26, s26, 16384
EXP v40,v40
EXP v41,v41
M16 v[116:119],a[208:211],a[160:163],v[216:219]
s_and_b32 s26, s26, 0xffff
v_add_f32 v228, v40, v228
v_add_f32 v229, v41, v229
CVT v156,v40,v41
M16 v[116:119],a[212:215],a[164:167],v[116:119]
s_add_u32 m0, s27, s31
EXP v42,v42
EXP v43,v43
M16 v[116:119],a[216:219],a[168:171],v[116:119]
BL4 v3,s[8:11],s25 offen lds
v_add_f32 v230, v42, v230
M16 v[116:119],a[220:223],a[172:175],v[116:119]
v_add_f32 v231, v43, v231
CVT v157,v42,v43
M16 v[132:135],a[208:211],a[176:179],v[220:223]
EXP v44,v44
M16 v[132:135],a[212:215],a[180:183],v[132:135]
EXP v45,v45
EXP v46,v46
M16 v[132:135],a[216:219],a[184:187],v[132:135]
s_waitcnt lgkmcnt(8)
v_add_f32 v228, v44, v228
v_add_f32 v229, v45, v229
CVT v158,v44,v45
M16 v[132:135],a[220:223],a[188:191],v[132:135]
DR a[208:211],v4 offset:4096
EXP v47,v47
v_add_f32 v230, v46, v230
M16 v[88:91],a[224:227],a[128:131],v[208:211]
BL4 v3,s[8:11],s25 offen offset:1024 lds
v_add_f32 v231, v47, v231
CVT v159,v46,v47
M16 v[88:91],a[228:231],a[132:135],v[88:91]
DR a[212:215],v4 offset:5120
EXP v48,v48
M16 v[88:91],a[232:235],a[136:139],v[88:91]
EXP v49,v49
EXP v50,v50
M16 v[88:91],a[236:239],a[140:143],v[88:91]
DR a[216:219],v4 offset:6144
v_add_f32 v232, v48, v232
v_add_f32 v233, v49, v233
CVT v160,v48,v49
M16 v[104:107],a[224:227],a[144:147],v[212:215]
BL4 v3,s[8:11],s25 offen offset:2048 lds
EXP v51,v51
M16 v[104:107],a[228:231],a[148:151],v[104:107]
DR a[220:223],v4 offset:7168
EXP v52,v52
v_add_f32 v234, v50, v234
M16 v[104:107],a[232:235],a[152:155],v[104:107]
EXP v53,v53
v_add_f32 v235, v51, v235
CVT v161,v50,v51
M16 v[104:107],a[236:239],a[156:159],v[104:107]
EXP v54,v54
v_add_f32 v232, v52, v232
M16 v[120:123],a[224:227],a[160:163],v[216:219]
BL4 v3,s[8:11],s25 offen offset:3072 lds
EXP v55,v55
M16 v[120:123],a[228:231],a[164:167],v[120:123]
s_add_u32 s25, s25, 32768
EXP v56,v56
v_add_f32 v233, v53, v233
M16 v[120:123],a[232:235],a[168:171],v[120:123]
s_add_u32 s27, s27, 16384
CVT v162,v52,v53
v_add_f32 v234, v54, v234
v_add_f32 v235, v55, v235
M16 v[120:123],a[236:239],a[172:175],v[120:123]
s_and_b32 s27, s27, 0xffff
EXP v57,v57
EXP v58,v58
M16 v[136:139],a[224:227],a[176:179],v[220:223]
EXP v59,v59
CVT v163,v54,v55
M16 v[136:139],a[228:231],a[180:183],v[136:139]
v_add_f32 v232, v56, v232
v_add_f32 v233, v57, v233
CVT v164,v56,v57
v_add_f32 v234, v58, v234
M16 v[136:139],a[232:235],a[184:187],v[136:139]
s_waitcnt lgkmcnt(8)
EXP v60,v60
v_add_f32 v235, v59, v235
M16 v[136:139],a[236:239],a[188:191],v[136:139]
DR a[224:227],v4 offset:8192
EXP v61,v61
EXP v62,v62
M16 v[92:95],a[240:243],a[128:131],v[208:211]
CVT v165,v58,v59
v_add_f32 v232, v60, v232
v_add_f32 v233, v61, v233
M16 v[92:95],a[244:247],a[132:135],v[92:95]
DR a[228:231],v4 offset:9216
EXP v63,v63
EXP v64,v64
M16 v[92:95],a[248:251],a[136:139],v[92:95]
EXP v65,v65
CVT v166,v60,v61
M16 v[92:95],a[252:255],a[140:143],v[92:95]
DR a[232:235],v4 offset:10240
v_add_f32 v234, v62, v234
v_add_f32 v235, v63, v235
CVT v167,v62,v63
v_add_f32 v236, v64, v236
M16 v[108:111],a[240:243],a[144:147],v[212:215]
EXP v66,v66
v_add_f32 v237, v65, v237
M16 v[108:111],a[244:247],a[148:151],v[108:111]
DR a[236:239],v4 offset:11264
EXP v67,v67
CVT v168,v64,v65
M16 v[108:111],a[248:251],a[152:155],v[108:111]
EXP v68,v68
v_add_f32 v238, v66, v238
v_add_f32 v239, v67, v239
M16 v[108:111],a[252:255],a[156:159],v[108:111]
EXP v69,v69
CVT v169,v66,v67
M16 v[124:127],a[240:243],a[160:163],v[216:219]
EXP v70,v70
EXP v71,v71
M16 v[124:127],a[244:247],a[164:167],v[124:127]
v_add_f32 v236, v68, v236
v_add_f32 v237, v69, v237
CVT v170,v68,v69
M16 v[124:127],a[248:251],a[168:171],v[124:127]
EXP v72,v72
EXP v73,v73
M16 v[124:127],a[252:255],a[172:175],v[124:127]
EXP v74,v74
v_add_f32 v238, v70, v238
M16 v[140:143],a[240:243],a[176:179],v[220:223]
v_add_f32 v239, v71, v239
CVT v171,v70,v71
v_add_f32 v236, v72, v236
v_add_f32 v237, v73, v237
M16 v[140:143],a[244:247],a[180:183],v[140:143]
EXP v75,v75
CVT v172,v72,v73
M16 v[140:143],a[248:251],a[184:187],v[140:143]
EXP v76,v76
EXP v77,v77
M16 v[140:143],a[252:255],a[188:191],v[140:143]
s_waitcnt lgkmcnt(8)
EXP v78,v78
v_add_f32 v238, v74, v238
EXP v79,v79
s_nop 0
v_add_f32 v239, v75, v239
CVT v173,v74,v75
v_add_f32 v236, v76, v236
v_add_f32 v237, v77, v237
CVT v174,v76,v77
s_add_u32 m0, s18, 0
s_nop 0
BL4 v176,s[4:7],s16 offen lds
BL4 v177,s[4:7],s16 offen offset:1024 lds
BL4 v178,s[4:7],s16 offen offset:2048 lds
BL4 v179,s[4:7],s16 offen offset:3072 lds
s_add_u32 m0, s18, 4096
s_nop 0
BL4 v180,s[4:7],s16 offen lds
s_cmp_ge_u32 s20, 2
s_cbranch_scc1 L_wt_onea
s_add_u32 m0, s18, 20480
s_nop 0
BL4 v176,s[92:95],s17 offen lds
BL4 v177,s[92:95],s17 offen offset:1024 lds
BL4 v178,s[92:95],s17 offen offset:2048 lds
BL4 v179,s[92:95],s17 offen offset:3072 lds
s_add_u32 m0, s18, 24576
s_nop 0
BL4 v180,s[92:95],s17 offen lds
L_wt_onea:
s_cmp_eq_u32 s23, 0
s_cbranch_scc1 L_a_loop_done
L_a_loop:
M16 v[16:19],a[192:195],a[128:131],v[208:211]
DR a[240:243],v4 offset:12288
v_add_f32 v238, v78, v238
M16 v[16:19],a[196:199],a[132:135],v[16:19]
EXP v80,v80
M16 v[16:19],a[200:203],a[136:139],v[16:19]
s_waitcnt vmcnt(8)
EXP v81,v81
M16 v[16:19],a[204:207],a[140:143],v[16:19]
s_barrier
EXP v82,v82
M16 v[32:35],a[192:195],a[144:147],v[212:215]
DR a[244:247],v4 offset:13312
v_add_f32 v239, v79, v239
M16 v[32:35],a[196:199],a[148:151],v[32:35]
s_add_u32 m0, s26, s30
EXP v83,v83
M16 v[32:35],a[200:203],a[152:155],v[32:35]
BL4 v3,s[8:11],s24 offen lds
M16 v[32:35],a[204:207],a[156:159],v[32:35]
EXP v84,v84
M16 v[48:51],a[192:195],a[160:163],v[216:219]
DR a[248:251],v4 offset:14336
CVT v175,v78,v79
M16 v[48:51],a[196:199],a[164:167],v[48:51]
EXP v85,v85
M16 v[48:51],a[200:203],a[168:171],v[48:51]
EXP v86,v86
M16 v[48:51],a[204:207],a[172:175],v[48:51]
s_waitcnt lgkmcnt(7)
CVT v176,v80,v81
CVT v177,v82,v83
M16 v[64:67],a[192:195],a[176:179],v[220:223]
DR a[252:255],v4 offset:15360
CVT v178,v84,v85
M16 v[64:67],a[196:199],a[180:183],v[64:67]
s_add_u32 s28, s28, 16384
EXP v87,v87
M16 v[64:67],a[200:203],a[184:187],v[64:67]
s_and_b32 s28, s28, 0xffff
EXP v88,v88
M16 v[64:67],a[204:207],a[188:191],v[64:67]
DR a[192:195],v5 offset:0
v_add_u32 v4, s28, v2
M16 v[20:23],a[208:211],a[128:131],v[208:211]
BL4 v3,s[8:11],s24 offen offset:1024 lds
M16 v[20:23],a[212:215],a[132:135],v[20:23]
EXP v89,v89
M16 v[20:23],a[216:219],a[136:139],v[20:23]
CVT v179,v86,v87
CVT v180,v88,v89
M16 v[20:23],a[220:223],a[140:143],v[20:23]
DR a[196:199],v5 offset:1024
M16 v[36:39],a[208:211],a[144:147],v[212:215]
EXP v90,v90
M16 v[36:39],a[212:215],a[148:151],v[36:39]
EXP v91,v91
M16 v[36:39],a[216:219],a[152:155],v[36:39]
EXP v92,v92
M16 v[36:39],a[220:223],a[156:159],v[36:39]
DR a[200:203],v5 offset:2048
CVT v181,v90,v91
M16 v[52:55],a[208:211],a[160:163],v[216:219]
EXP v93,v93
M16 v[52:55],a[212:215],a[164:167],v[52:55]
EXP v94,v94
M16 v[52:55],a[216:219],a[168:171],v[52:55]
BL4 v3,s[8:11],s24 offen offset:2048 lds
M16 v[52:55],a[220:223],a[172:175],v[52:55]
DR a[204:207],v5 offset:3072
CVT v182,v92,v93
M16 v[68:71],a[208:211],a[176:179],v[220:223]
EXP v95,v95
M16 v[68:71],a[212:215],a[180:183],v[68:71]
EXP v96,v96
M16 v[68:71],a[216:219],a[184:187],v[68:71]
s_waitcnt lgkmcnt(8)
CVT v183,v94,v95
v_add_f32 v228, v96, v228
M16 v[68:71],a[220:223],a[188:191],v[68:71]
DR a[208:211],v5 offset:4096
M16 v[24:27],a[224:227],a[128:131],v[208:211]
EXP v97,v97
M16 v[24:27],a[228:231],a[132:135],v[24:27]
v_add_f32 v229, v97, v229
CVT v184,v96,v97
M16 v[24:27],a[232:235],a[136:139],v[24:27]
EXP v98,v98
M16 v[24:27],a[236:239],a[140:143],v[24:27]
DR a[212:215],v5 offset:5120
v_add_f32 v230, v98, v230
M16 v[40:43],a[224:227],a[144:147],v[212:215]
BL4 v3,s[8:11],s24 offen offset:3072 lds
M16 v[40:43],a[228:231],a[148:151],v[40:43]
s_add_u32 s24, s24, 32768
EXP v99,v99
M16 v[40:43],a[232:235],a[152:155],v[40:43]
s_add_u32 s26, s26, 16384
v_add_f32 v231, v99, v231
CVT v185,v98,v99
M16 v[40:43],a[236:239],a[156:159],v[40:43]
DR a[216:219],v5 offset:6144
M16 v[56:59],a[224:227],a[160:163],v[216:219]
s_and_b32 s26, s26, 0xffff
EXP v100,v100
M16 v[56:59],a[228:231],a[164:167],v[56:59]
EXP v101,v101
M16 v[56:59],a[232:235],a[168:171],v[56:59]
v_add_f32 v228, v100, v228
v_add_f32 v229, v101, v229
M16 v[56:59],a[236:239],a[172:175],v[56:59]
DR a[220:223],v5 offset:7168
CVT v186,v100,v101
M16 v[72:75],a[224:227],a[176:179],v[220:223]
EXP v102,v102
M16 v[72:75],a[228:231],a[180:183],v[72:75]
EXP v103,v103
M16 v[72:75],a[232:235],a[184:187],v[72:75]
s_waitcnt lgkmcnt(8)
v_add_f32 v230, v102, v230
v_add_f32 v231, v103, v231
M16 v[72:75],a[236:239],a[188:191],v[72:75]
DR a[224:227],v5 offset:8192
CVT v187,v102,v103
M16 v[28:31],a[240:243],a[128:131],v[208:211]
s_add_u32 m0, s27, s31
EXP v104,v104
M16 v[28:31],a[244:247],a[132:135],v[28:31]
BL4 v3,s[8:11],s25 offen lds
M16 v[28:31],a[248:251],a[136:139],v[28:31]
EXP v105,v105
M16 v[28:31],a[252:255],a[140:143],v[28:31]
DR a[228:231],v5 offset:9216
v_add_f32 v228, v104, v228
M16 v[44:47],a[240:243],a[144:147],v[212:215]
v_add_f32 v229, v105, v229
CVT v188,v104,v105
M16 v[44:47],a[244:247],a[148:151],v[44:47]
EXP v106,v106
M16 v[44:47],a[248:251],a[152:155],v[44:47]
EXP v107,v107
M16 v[44:47],a[252:255],a[156:159],v[44:47]
DR a[232:235],v5 offset:10240
v_add_f32 v230, v106, v230
M16 v[60:63],a[240:243],a[160:163],v[216:219]
v_add_f32 v231, v107, v231
CVT v189,v106,v107
M16 v[60:63],a[244:247],a[164:167],v[60:63]
EXP v108,v108
M16 v[60:63],a[248:251],a[168:171],v[60:63]
EXP v109,v109
M16 v[60:63],a[252:255],a[172:175],v[60:63]
DR a[236:239],v5 offset:11264
v_add_f32 v228, v108, v228
M16 v[76:79],a[240:243],a[176:179],v[220:223]
BL4 v3,s[8:11],s25 offen offset:1024 lds
M16 v[76:79],a[244:247],a[180:183],v[76:79]
v_add_f32 v229, v109, v229
CVT v190,v108,v109
M16 v[76:79],a[248:251],a[184:187],v[76:79]
s_waitcnt lgkmcnt(8)
EXP v110,v110
M16 v[76:79],a[252:255],a[188:191],v[76:79]
DR a[240:243],v5 offset:12288
v_add_f32 v230, v110, v230
M16 a[0:3],a[192:195],v[144:147],a[0:3]
EXP v111,v111
M16 a[0:3],a[196:199],v[148:151],a[0:3]
v_add_f32 v231, v111, v231
CVT v191,v110,v111
M16 a[32:35],a[192:195],v[152:155],a[32:35]
EXP v112,v112
M16 a[32:35],a[196:199],v[156:159],a[32:35]
DR a[244:247],v5 offset:13312
v_add_f32 v232, v112, v232
M16 a[64:67],a[192:195],v[160:163],a[64:67]
EXP v113,v113
M16 a[64:67],a[196:199],v[164:167],a[64:67]
EXP v114,v114
M16 a[96:99],a[192:195],v[168:171],a[96:99]
BL4 v3,s[8:11],s25 offen offset:2048 lds
M16 a[96:99],a[196:199],v[172:175],a[96:99]
DR a[248:251],v5 offset:14336
v_add_f32 v233, v113, v233
M16 a[4:7],a[200:203],v[144:147],a[4:7]
CVT v192,v112,v113
v_add_f32 v234, v114, v234
M16 a[4:7],a[204:207],v[148:151],a[4:7]
EXP v115,v115
M16 a[36:39],a[200:203],v[152:155],a[36:39]
EXP v116,v116
M16 a[36:39],a[204:207],v[156:159],a[36:39]
DR a[252:255],v5 offset:15360
v_add_f32 v235, v115, v235
M16 a[68:71],a[200:203],v[160:163],a[68:71]
s_add_u32 s29, s29, 16384
CVT v193,v114,v115
v_add_f32 v232, v116, v232
M16 a[68:71],a[204:207],v[164:167],a[68:71]
s_and_b32 s29, s29, 0xffff
EXP v117,v117
M16 a[100:103],a[200:203],v[168:171],a[100:103]
s_waitcnt lgkmcnt(8)
v_add_u32 v5, s29, v7
v_add_f32 v233, v117, v233
M16 a[100:103],a[204:207],v[172:175],a[100:103]
DR a[192:195],v4 offset:0
CVT v194,v116,v117
M16 a[8:11],a[208:211],v[144:147],a[8:11]
BL4 v3,s[8:11],s25 offen offset:3072 lds
M16 a[8:11],a[212:215],v[148:151],a[8:11]
s_add_u32 s25, s25, 32768
EXP v118,v118
M16 a[40:43],a[208:211],v[152:155],a[40:43]
s_add_u32 s27, s27, 16384
EXP v119,v119
M16 a[40:43],a[212:215],v[156:159],a[40:43]
DR a[196:199],v4 offset:1024
v_add_f32 v234, v118, v234
M16 a[72:75],a[208:211],v[160:163],a[72:75]
s_and_b32 s27, s27, 0xffff
v_add_f32 v235, v119, v235
CVT v195,v118,v119
M16 a[72:75],a[212:215],v[164:167],a[72:75]
EXP v120,v120
M16 a[104:107],a[208:211],v[168:171],a[104:107]
EXP v121,v121
M16 a[104:107],a[212:215],v[172:175],a[104:107]
DR a[200:203],v4 offset:2048
v_add_f32 v232, v120, v232
M16 a[12:15],a[216:219],v[144:147],a[12:15]
v_add_f32 v233, v121, v233
CVT v196,v120,v121
M16 a[12:15],a[220:223],v[148:151],a[12:15]
EXP v122,v122
M16 a[44:47],a[216:219],v[152:155],a[44:47]
EXP v123,v123
M16 a[44:47],a[220:223],v[156:159],a[44:47]
DR a[204:207],v4 offset:3072
v_add_f32 v234, v122, v234
M16 a[76:79],a[216:219],v[160:163],a[76:79]
EXP v124,v124
M16 a[76:79],a[220:223],v[164:167],a[76:79]
v_add_f32 v235, v123, v235
CVT v197,v122,v123
M16 a[108:111],a[216:219],v[168:171],a[108:111]
EXP v125,v125
M16 a[108:111],a[220:223],v[172:175],a[108:111]
EXP v126,v126
M16 v[224:227],v[12:15],v[144:147],v[224:227]
s_waitcnt lgkmcnt(8)
EXP v127,v127
M16 v[224:227],v[12:15],v[148:151],v[224:227]
DR a[208:211],v4 offset:4096
v_add_f32 v232, v124, v232
M16 a[16:19],a[224:227],v[144:147],a[16:19]
v_add_f32 v233, v125, v233
CVT v198,v124,v125
M16 a[16:19],a[228:231],v[148:151],a[16:19]
EXP v128,v128
M16 a[48:51],a[224:227],v[152:155],a[48:51]
EXP v129,v129
M16 a[48:51],a[228:231],v[156:159],a[48:51]
DR a[212:215],v4 offset:5120
v_add_f32 v234, v126, v234
M16 a[80:83],a[224:227],v[160:163],a[80:83]
v_add_f32 v235, v127, v235
CVT v199,v126,v127
M16 a[80:83],a[228:231],v[164:167],a[80:83]
EXP v130,v130
M16 a[112:115],a[224:227],v[168:171],a[112:115]
EXP v131,v131
M16 a[112:115],a[228:231],v[172:175],a[112:115]
DR a[216:219],v4 offset:6144
v_add_f32 v236, v128, v236
M16 a[20:23],a[232:235],v[144:147],a[20:23]
EXP v132,v132
M16 a[20:23],a[236:239],v[148:151],a[20:23]
v_add_f32 v237, v129, v237
CVT v200,v128,v129
M16 a[52:55],a[232:235],v[152:155],a[52:55]
EXP v133,v133
M16 a[52:55],a[236:239],v[156:159],a[52:55]
DR a[220:223],v4 offset:7168
v_add_f32 v238, v130, v238
M16 a[84:87],a[232:235],v[160:163],a[84:87]
EXP v134,v134
M16 a[84:87],a[236:239],v[164:167],a[84:87]
v_add_f32 v239, v131, v239
CVT v201,v130,v131
M16 a[116:119],a[232:235],v[168:171],a[116:119]
s_waitcnt lgkmcnt(8)
EXP v135,v135
M16 a[116:119],a[236:239],v[172:175],a[116:119]
DR a[224:227],v4 offset:8192
v_add_f32 v236, v132, v236
M16 a[24:27],a[240:243],v[144:147],a[24:27]
EXP v136,v136
M16 a[24:27],a[244:247],v[148:151],a[24:27]
EXP v137,v137
M16 a[56:59],a[240:243],v[152:155],a[56:59]
v_add_f32 v237, v133, v237
CVT v202,v132,v133
M16 a[56:59],a[244:247],v[156:159],a[56:59]
DR a[228:231],v4 offset:9216
v_add_f32 v238, v134, v238
M16 a[88:91],a[240:243],v[160:163],a[88:91]
EXP v138,v138
M16 a[88:91],a[244:247],v[164:167],a[88:91]
EXP v139,v139
M16 a[120:123],a[240:243],v[168:171],a[120:123]
v_add_f32 v239, v135, v239
CVT v203,v134,v135
M16 a[120:123],a[244:247],v[172:175],a[120:123]
DR a[232:235],v4 offset:10240
v_add_f32 v236, v136, v236
M16 a[28:31],a[248:251],v[144:147],a[28:31]
EXP v140,v140
M16 a[28:31],a[252:255],v[148:151],a[28:31]
EXP v141,v141
M16 a[60:63],a[248:251],v[152:155],a[60:63]
EXP v142,v142
M16 a[60:63],a[252:255],v[156:159],a[60:63]
DR a[236:239],v4 offset:11264
v_add_f32 v237, v137, v237
M16 a[92:95],a[248:251],v[160:163],a[92:95]
CVT v204,v136,v137
v_add_f32 v238, v138, v238
M16 a[92:95],a[252:255],v[164:167],a[92:95]
EXP v143,v143
M16 a[124:127],a[248:251],v[168:171],a[124:127]
v_add_f32 v239, v139, v239
CVT v205,v138,v139
M16 a[124:127],a[252:255],v[172:175],a[124:127]
s_waitcnt lgkmcnt(8)
v_add_f32 v236, v140, v236
v_add_f32 v237, v141, v237
CVT v206,v140,v141
M16 v[80:83],a[192:195],a[128:131],v[208:211]
DR a[240:243],v4 offset:12288
v_add_f32 v238, v142, v238
M16 v[80:83],a[196:199],a[132:135],v[80:83]
EXP v16,v16
M16 v[80:83],a[200:203],a[136:139],v[80:83]
s_waitcnt vmcnt(8)
EXP v17,v17
M16 v[80:83],a[204:207],a[140:143],v[80:83]
s_barrier
EXP v18,v18
M16 v[96:99],a[192:195],a[144:147],v[212:215]
DR a[244:247],v4 offset:13312
v_add_f32 v239, v143, v239
M16 v[96:99],a[196:199],a[148:151],v[96:99]
s_add_u32 m0, s26, s30
EXP v19,v19
M16 v[96:99],a[200:203],a[152:155],v[96:99]
BL4 v3,s[8:11],s24 offen lds
M16 v[96:99],a[204:207],a[156:159],v[96:99]
EXP v20,v20
M16 v[112:115],a[192:195],a[160:163],v[216:219]
DR a[248:251],v4 offset:14336
CVT v207,v142,v143
M16 v[112:115],a[196:199],a[164:167],v[112:115]
EXP v21,v21
M16 v[112:115],a[200:203],a[168:171],v[112:115]
EXP v22,v22
M16 v[112:115],a[204:207],a[172:175],v[112:115]
s_waitcnt lgkmcnt(7)
CVT v144,v16,v17
CVT v145,v18,v19
M16 v[128:131],a[192:195],a[176:179],v[220:223]
DR a[252:255],v4 offset:15360
CVT v146,v20,v21
M16 v[128:131],a[196:199],a[180:183],v[128:131]
s_add_u32 s28, s28, 16384
EXP v23,v23
M16 v[128:131],a[200:203],a[184:187],v[128:131]
s_and_b32 s28, s28, 0xffff
EXP v24,v24
M16 v[128:131],a[204:207],a[188:191],v[128:131]
DR a[192:195],v5 offset:0
v_add_u32 v4, s28, v2
M16 v[84:87],a[208:211],a[128:131],v[208:211]
BL4 v3,s[8:11],s24 offen offset:1024 lds
M16 v[84:87],a[212:215],a[132:135],v[84:87]
EXP v25,v25
M16 v[84:87],a[216:219],a[136:139],v[84:87]
CVT v147,v22,v23
CVT v148,v24,v25
M16 v[84:87],a[220:223],a[140:143],v[84:87]
DR a[196:199],v5 offset:1024
M16 v[100:103],a[208:211],a[144:147],v[212:215]
EXP v26,v26
M16 v[100:103],a[212:215],a[148:151],v[100:103]
EXP v27,v27
M16 v[100:103],a[216:219],a[152:155],v[100:103]
EXP v28,v28
M16 v[100:103],a[220:223],a[156:159],v[100:103]
DR a[200:203],v5 offset:2048
CVT v149,v26,v27
M16 v[116:119],a[208:211],a[160:163],v[216:219]
EXP v29,v29
M16 v[116:119],a[212:215],a[164:167],v[116:119]
EXP v30,v30
M16 v[116:119],a[216:219],a[168:171],v[116:119]
BL4 v3,s[8:11],s24 offen offset:2048 lds
M16 v[116:119],a[220:223],a[172:175],v[116:119]
DR a[204:207],v5 offset:3072
CVT v150,v28,v29
M16 v[132:135],a[208:211],a[176:179],v[220:223]
EXP v31,v31
M16 v[132:135],a[212:215],a[180:183],v[132:135]
EXP v32,v32
M16 v[132:135],a[216:219],a[184:187],v[132:135]
s_waitcnt lgkmcnt(8)
CVT v151,v30,v31
v_add_f32 v228, v32, v228
M16 v[132:135],a[220:223],a[188:191],v[132:135]
DR a[208:211],v5 offset:4096
M16 v[88:91],a[224:227],a[128:131],v[208:211]
EXP v33,v33
M16 v[88:91],a[228:231],a[132:135],v[88:91]
v_add_f32 v229, v33, v229
CVT v152,v32,v33
M16 v[88:91],a[232:235],a[136:139],v[88:91]
EXP v34,v34
M16 v[88:91],a[236:239],a[140:143],v[88:91]
DR a[212:215],v5 offset:5120
v_add_f32 v230, v34, v230
M16 v[104:107],a[224:227],a[144:147],v[212:215]
BL4 v3,s[8:11],s24 offen offset:3072 lds
M16 v[104:107],a[228:231],a[148:151],v[104:107]
s_add_u32 s24, s24, 32768
EXP v35,v35
M16 v[104:107],a[232:235],a[152:155],v[104:107]
s_add_u32 s26, s26, 16384
v_add_f32 v231, v35, v231
CVT v153,v34,v35
M16 v[104:107],a[236:239],a[156:159],v[104:107]
DR a[216:219],v5 offset:6144
M16 v[120:123],a[224:227],a[160:163],v[216:219]
s_and_b32 s26, s26, 0xffff
EXP v36,v36
M16 v[120:123],a[228:231],a[164:167],v[120:123]
EXP v37,v37
M16 v[120:123],a[232:235],a[168:171],v[120:123]
v_add_f32 v228, v36, v228
v_add_f32 v229, v37, v229
M16 v[120:123],a[236:239],a[172:175],v[120:123]
DR a[220:223],v5 offset:7168
CVT v154,v36,v37
M16 v[136:139],a[224:227],a[176:179],v[220:223]
EXP v38,v38
M16 v[136:139],a[228:231],a[180:183],v[136:139]
EXP v39,v39
M16 v[136:139],a[232:235],a[184:187],v[136:139]
s_waitcnt lgkmcnt(8)
v_add_f32 v230, v38, v230
v_add_f32 v231, v39, v231
M16 v[136:139],a[236:239],a[188:191],v[136:139]
DR a[224:227],v5 offset:8192
CVT v155,v38,v39
M16 v[92:95],a[240:243],a[128:131],v[208:211]
s_add_u32 m0, s27, s31
EXP v40,v40
M16 v[92:95],a[244:247],a[132:135],v[92:95]
BL4 v3,s[8:11],s25 offen lds
M16 v[92:95],a[248:251],a[136:139],v[92:95]
EXP v41,v41
M16 v[92:95],a[252:255],a[140:143],v[92:95]
DR a[228:231],v5 offset:9216
v_add_f32 v228, v40, v228
M16 v[108:111],a[240:243],a[144:147],v[212:215]
v_add_f32 v229, v41, v229
CVT v156,v40,v41
M16 v[108:111],a[244:247],a[148:151],v[108:111]
EXP v42,v42
M16 v[108:111],a[248:251],a[152:155],v[108:111]
EXP v43,v43
M16 v[108:111],a[252:255],a[156:159],v[108:111]
DR a[232:235],v5 offset:10240
v_add_f32 v230, v42, v230
M16 v[124:127],a[240:243],a[160:163],v[216:219]
v_add_f32 v231, v43, v231
CVT v157,v42,v43
M16 v[124:127],a[244:247],a[164:167],v[124:127]
EXP v44,v44
M16 v[124:127],a[248:251],a[168:171],v[124:127]
EXP v45,v45
M16 v[124:127],a[252:255],a[172:175],v[124:127]
DR a[236:239],v5 offset:11264
v_add_f32 v228, v44, v228
M16 v[140:143],a[240:243],a[176:179],v[220:223]
BL4 v3,s[8:11],s25 offen offset:1024 lds
M16 v[140:143],a[244:247],a[180:183],v[140:143]
v_add_f32 v229, v45, v229
CVT v158,v44,v45
M16 v[140:143],a[248:251],a[184:187],v[140:143]
s_waitcnt lgkmcnt(8)
EXP v46,v46
M16 v[140:143],a[252:255],a[188:191],v[140:143]
DR a[240:243],v5 offset:12288
v_add_f32 v230, v46, v230
M16 a[0:3],a[192:195],v[176:179],a[0:3]
EXP v47,v47
M16 a[0:3],a[196:199],v[180:183],a[0:3]
v_add_f32 v231, v47, v231
CVT v159,v46,v47
M16 a[32:35],a[192:195],v[184:187],a[32:35]
EXP v48,v48
M16 a[32:35],a[196:199],v[188:191],a[32:35]
DR a[244:247],v5 offset:13312
v_add_f32 v232, v48, v232
M16 a[64:67],a[192:195],v[192:195],a[64:67]
EXP v49,v49
M16 a[64:67],a[196:199],v[196:199],a[64:67]
EXP v50,v50
M16 a[96:99],a[192:195],v[200:203],a[96:99]
BL4 v3,s[8:11],s25 offen offset:2048 lds
M16 a[96:99],a[196:199],v[204:207],a[96:99]
DR a[248:251],v5 offset:14336
v_add_f32 v233, v49, v233
M16 a[4:7],a[200:203],v[176:179],a[4:7]
CVT v160,v48,v49
v_add_f32 v234, v50, v234
M16 a[4:7],a[204:207],v[180:183],a[4:7]
EXP v51,v51
M16 a[36:39],a[200:203],v[184:187],a[36:39]
EXP v52,v52
M16 a[36:39],a[204:207],v[188:191],a[36:39]
DR a[252:255],v5 offset:15360
v_add_f32 v235, v51, v235
M16 a[68:71],a[200:203],v[192:195],a[68:71]
s_add_u32 s29, s29, 16384
CVT v161,v50,v51
v_add_f32 v232, v52, v232
M16 a[68:71],a[204:207],v[196:199],a[68:71]
s_and_b32 s29, s29, 0xffff
EXP v53,v53
M16 a[100:103],a[200:203],v[200:203],a[100:103]
s_waitcnt lgkmcnt(8)
v_add_u32 v5, s29, v7
v_add_f32 v233, v53, v233
M16 a[100:103],a[204:207],v[204:207],a[100:103]
DR a[192:195],v4 offset:0
CVT v162,v52,v53
M16 a[8:11],a[208:211],v[176:179],a[8:11]
BL4 v3,s[8:11],s25 offen offset:3072 lds
M16 a[8:11],a[212:215],v[180:183],a[8:11]
s_add_u32 s25, s25, 32768
EXP v54,v54
M16 a[40:43],a[208:211],v[184:187],a[40:43]
s_add_u32 s27, s27, 16384
EXP v55,v55
M16 a[40:43],a[212:215],v[188:191],a[40:43]
DR a[196:199],v4 offset:1024
v_add_f32 v234, v54, v234
M16 a[72:75],a[208:211],v[192:195],a[72:75]
s_and_b32 s27, s27, 0xffff
v_add_f32 v235, v55, v235
CVT v163,v54,v55
M16 a[72:75],a[212:215],v[196:199],a[72:75]
EXP v56,v56
M16 a[104:107],a[208:211],v[200:203],a[104:107]
EXP v57,v57
M16 a[104:107],a[212:215],v[204:207],a[104:107]
DR a[200:203],v4 offset:2048
v_add_f32 v232, v56, v232
M16 a[12:15],a[216:219],v[176:179],a[12:15]
v_add_f32 v233, v57, v233
CVT v164,v56,v57
M16 a[12:15],a[220:223],v[180:183],a[12:15]
EXP v58,v58
M16 a[44:47],a[216:219],v[184:187],a[44:47]
EXP v59,v59
M16 a[44:47],a[220:223],v[188:191],a[44:47]
DR a[204:207],v4 offset:3072
v_add_f32 v234, v58, v234
M16 a[76:79],a[216:219],v[192:195],a[76:79]
EXP v60,v60
M16 a[76:79],a[220:223],v[196:199],a[76:79]
v_add_f32 v235, v59, v235
CVT v165,v58,v59
M16 a[108:111],a[216:219],v[200:203],a[108:111]
EXP v61,v61
M16 a[108:111],a[220:223],v[204:207],a[108:111]
EXP v62,v62
M16 v[224:227],v[12:15],v[176:179],v[224:227]
s_waitcnt lgkmcnt(8)
EXP v63,v63
M16 v[224:227],v[12:15],v[180:183],v[224:227]
DR a[208:211],v4 offset:4096
v_add_f32 v232, v60, v232
M16 a[16:19],a[224:227],v[176:179],a[16:19]
v_add_f32 v233, v61, v233
CVT v166,v60,v61
M16 a[16:19],a[228:231],v[180:183],a[16:19]
EXP v64,v64
M16 a[48:51],a[224:227],v[184:187],a[48:51]
EXP v65,v65
M16 a[48:51],a[228:231],v[188:191],a[48:51]
DR a[212:215],v4 offset:5120
v_add_f32 v234, v62, v234
M16 a[80:83],a[224:227],v[192:195],a[80:83]
v_add_f32 v235, v63, v235
CVT v167,v62,v63
M16 a[80:83],a[228:231],v[196:199],a[80:83]
EXP v66,v66
M16 a[112:115],a[224:227],v[200:203],a[112:115]
EXP v67,v67
M16 a[112:115],a[228:231],v[204:207],a[112:115]
DR a[216:219],v4 offset:6144
v_add_f32 v236, v64, v236
M16 a[20:23],a[232:235],v[176:179],a[20:23]
EXP v68,v68
M16 a[20:23],a[236:239],v[180:183],a[20:23]
v_add_f32 v237, v65, v237
CVT v168,v64,v65
M16 a[52:55],a[232:235],v[184:187],a[52:55]
EXP v69,v69
M16 a[52:55],a[236:239],v[188:191],a[52:55]
DR a[220:223],v4 offset:7168
v_add_f32 v238, v66, v238
M16 a[84:87],a[232:235],v[192:195],a[84:87]
EXP v70,v70
M16 a[84:87],a[236:239],v[196:199],a[84:87]
v_add_f32 v239, v67, v239
CVT v169,v66,v67
M16 a[116:119],a[232:235],v[200:203],a[116:119]
s_waitcnt lgkmcnt(8)
EXP v71,v71
M16 a[116:119],a[236:239],v[204:207],a[116:119]
DR a[224:227],v4 offset:8192
v_add_f32 v236, v68, v236
M16 a[24:27],a[240:243],v[176:179],a[24:27]
EXP v72,v72
M16 a[24:27],a[244:247],v[180:183],a[24:27]
EXP v73,v73
M16 a[56:59],a[240:243],v[184:187],a[56:59]
v_add_f32 v237, v69, v237
CVT v170,v68,v69
M16 a[56:59],a[244:247],v[188:191],a[56:59]
DR a[228:231],v4 offset:9216
v_add_f32 v238, v70, v238
M16 a[88:91],a[240:243],v[192:195],a[88:91]
EXP v74,v74
M16 a[88:91],a[244:247],v[196:199],a[88:91]
EXP v75,v75
M16 a[120:123],a[240:243],v[200:203],a[120:123]
v_add_f32 v239, v71, v239
CVT v171,v70,v71
M16 a[120:123],a[244:247],v[204:207],a[120:123]
DR a[232:235],v4 offset:10240
v_add_f32 v236, v72, v236
M16 a[28:31],a[248:251],v[176:179],a[28:31]
EXP v76,v76
M16 a[28:31],a[252:255],v[180:183],a[28:31]
EXP v77,v77
M16 a[60:63],a[248:251],v[184:187],a[60:63]
EXP v78,v78
M16 a[60:63],a[252:255],v[188:191],a[60:63]
DR a[236:239],v4 offset:11264
v_add_f32 v237, v73, v237
M16 a[92:95],a[248:251],v[192:195],a[92:95]
s_sub_u32 s23, s23, 1
CVT v172,v72,v73
v_add_f32 v238, v74, v238
M16 a[92:95],a[252:255],v[196:199],a[92:95]
EXP v79,v79
M16 a[124:127],a[248:251],v[200:203],a[124:127]
v_add_f32 v239, v75, v239
CVT v173,v74,v75
M16 a[124:127],a[252:255],v[204:207],a[124:127]
s_waitcnt lgkmcnt(8)
v_add_f32 v236, v76, v236
v_add_f32 v237, v77, v237
CVT v174,v76,v77
s_cmp_lg_u32 s23, 0
s_cbranch_scc1 L_a_loop
L_a_loop_done:
v_cndmask_b32 v240, v6, v208, s[32:33]
v_cndmask_b32 v241, v6, v208, s[34:35]
v_cndmask_b32 v242, v6, v208, s[36:37]
v_cndmask_b32 v243, v6, v208, s[38:39]
v_cndmask_b32 v244, v6, v208, s[40:41]
v_cndmask_b32 v245, v6, v208, s[42:43]
v_cndmask_b32 v246, v6, v208, s[44:45]
v_cndmask_b32 v247, v6, v208, s[46:47]
v_cndmask_b32 v248, v6, v208, s[48:49]
v_cndmask_b32 v249, v6, v208, s[50:51]
v_cndmask_b32 v250, v6, v208, s[52:53]
v_cndmask_b32 v251, v6, v208, s[54:55]
v_cndmask_b32 v252, v6, v208, s[56:57]
v_cndmask_b32 v253, v6, v208, s[58:59]
v_cndmask_b32 v254, v6, v208, s[60:61]
v_cndmask_b32 v255, v6, v208, s[62:63]
s_nop 1
M16 v[16:19],a[192:195],a[128:131],v[240:243]
DR a[240:243],v4 offset:12288
v_add_f32 v238, v78, v238
M16 v[16:19],a[196:199],a[132:135],v[16:19]
EXP v80,v80
M16 v[16:19],a[200:203],a[136:139],v[16:19]
s_waitcnt vmcnt(8)
EXP v81,v81
M16 v[16:19],a[204:207],a[140:143],v[16:19]
s_barrier
EXP v82,v82
M16 v[32:35],a[192:195],a[144:147],v[212:215]
DR a[244:247],v4 offset:13312
v_add_f32 v239, v79, v239
M16 v[32:35],a[196:199],a[148:151],v[32:35]
s_add_u32 m0, s26, s30
EXP v83,v83
M16 v[32:35],a[200:203],a[152:155],v[32:35]
BL4 v3,s[8:11],s24 offen lds
M16 v[32:35],a[204:207],a[156:159],v[32:35]
EXP v84,v84
M16 v[48:51],a[192:195],a[160:163],v[216:219]
DR a[248:251],v4 offset:14336
CVT v175,v78,v79
M16 v[48:51],a[196:199],a[164:167],v[48:51]
EXP v85,v85
M16 v[48:51],a[200:203],a[168:171],v[48:51]
EXP v86,v86
M16 v[48:51],a[204:207],a[172:175],v[48:51]
s_waitcnt lgkmcnt(7)
CVT v176,v80,v81
CVT v177,v82,v83
M16 v[64:67],a[192:195],a[176:179],v[220:223]
DR a[252:255],v4 offset:15360
CVT v178,v84,v85
M16 v[64:67],a[196:199],a[180:183],v[64:67]
s_add_u32 s28, s28, 16384
EXP v87,v87
M16 v[64:67],a[200:203],a[184:187],v[64:67]
s_and_b32 s28, s28, 0xffff
EXP v88,v88
M16 v[64:67],a[204:207],a[188:191],v[64:67]
DR a[192:195],v5 offset:0
v_add_u32 v4, s28, v2
M16 v[20:23],a[208:211],a[128:131],v[244:247]
BL4 v3,s[8:11],s24 offen offset:1024 lds
M16 v[20:23],a[212:215],a[132:135],v[20:23]
EXP v89,v89
M16 v[20:23],a[216:219],a[136:139],v[20:23]
CVT v179,v86,v87
CVT v180,v88,v89
M16 v[20:23],a[220:223],a[140:143],v[20:23]
DR a[196:199],v5 offset:1024
M16 v[36:39],a[208:211],a[144:147],v[212:215]
EXP v90,v90
M16 v[36:39],a[212:215],a[148:151],v[36:39]
EXP v91,v91
M16 v[36:39],a[216:219],a[152:155],v[36:39]
EXP v92,v92
M16 v[36:39],a[220:223],a[156:159],v[36:39]
DR a[200:203],v5 offset:2048
CVT v181,v90,v91
M16 v[52:55],a[208:211],a[160:163],v[216:219]
EXP v93,v93
M16 v[52:55],a[212:215],a[164:167],v[52:55]
EXP v94,v94
M16 v[52:55],a[216:219],a[168:171],v[52:55]
BL4 v3,s[8:11],s24 offen offset:2048 lds
M16 v[52:55],a[220:223],a[172:175],v[52:55]
DR a[204:207],v5 offset:3072
CVT v182,v92,v93
M16 v[68:71],a[208:211],a[176:179],v[220:223]
EXP v95,v95
M16 v[68:71],a[212:215],a[180:183],v[68:71]
EXP v96,v96
M16 v[68:71],a[216:219],a[184:187],v[68:71]
s_waitcnt lgkmcnt(8)
CVT v183,v94,v95
v_add_f32 v228, v96, v228
M16 v[68:71],a[220:223],a[188:191],v[68:71]
DR a[208:211],v5 offset:4096
M16 v[24:27],a[224:227],a[128:131],v[248:251]
EXP v97,v97
M16 v[24:27],a[228:231],a[132:135],v[24:27]
v_add_f32 v229, v97, v229
CVT v184,v96,v97
M16 v[24:27],a[232:235],a[136:139],v[24:27]
EXP v98,v98
M16 v[24:27],a[236:239],a[140:143],v[24:27]
DR a[212:215],v5 offset:5120
v_add_f32 v230, v98, v230
M16 v[40:43],a[224:227],a[144:147],v[212:215]
BL4 v3,s[8:11],s24 offen offset:3072 lds
M16 v[40:43],a[228:231],a[148:151],v[40:43]
s_add_u32 s24, s24, 32768
EXP v99,v99
M16 v[40:43],a[232:235],a[152:155],v[40:43]
s_add_u32 s26, s26, 16384
v_add_f32 v231, v99, v231
CVT v185,v98,v99
M16 v[40:43],a[236:239],a[156:159],v[40:43]
DR a[216:219],v5 offset:6144
M16 v[56:59],a[224:227],a[160:163],v[216:219]
s_and_b32 s26, s26, 0xffff
EXP v100,v100
M16 v[56:59],a[228:231],a[164:167],v[56:59]
EXP v101,v101
M16 v[56:59],a[232:235],a[168:171],v[56:59]
v_add_f32 v228, v100, v228
v_add_f32 v229, v101, v229
M16 v[56:59],a[236:239],a[172:175],v[56:59]
DR a[220:223],v5 offset:7168
CVT v186,v100,v101
M16 v[72:75],a[224:227],a[176:179],v[220:223]
EXP v102,v102
M16 v[72:75],a[228:231],a[180:183],v[72:75]
EXP v103,v103
M16 v[72:75],a[232:235],a[184:187],v[72:75]
s_waitcnt lgkmcnt(8)
v_add_f32 v230, v102, v230
v_add_f32 v231, v103, v231
M16 v[72:75],a[236:239],a[188:191],v[72:75]
DR a[224:227],v5 offset:8192
CVT v187,v102,v103
M16 v[28:31],a[240:243],a[128:131],v[252:255]
s_add_u32 m0, s27, s31
EXP v104,v104
M16 v[28:31],a[244:247],a[132:135],v[28:31]
BL4 v3,s[8:11],s25 offen lds
M16 v[28:31],a[248:251],a[136:139],v[28:31]
EXP v105,v105
M16 v[28:31],a[252:255],a[140:143],v[28:31]
DR a[228:231],v5 offset:9216
v_add_f32 v228, v104, v228
M16 v[44:47],a[240:243],a[144:147],v[212:215]
v_add_f32 v229, v105, v229
CVT v188,v104,v105
M16 v[44:47],a[244:247],a[148:151],v[44:47]
EXP v106,v106
M16 v[44:47],a[248:251],a[152:155],v[44:47]
EXP v107,v107
M16 v[44:47],a[252:255],a[156:159],v[44:47]
DR a[232:235],v5 offset:10240
v_add_f32 v230, v106, v230
M16 v[60:63],a[240:243],a[160:163],v[216:219]
v_add_f32 v231, v107, v231
CVT v189,v106,v107
M16 v[60:63],a[244:247],a[164:167],v[60:63]
EXP v108,v108
M16 v[60:63],a[248:251],a[168:171],v[60:63]
EXP v109,v109
M16 v[60:63],a[252:255],a[172:175],v[60:63]
DR a[236:239],v5 offset:11264
v_add_f32 v228, v108, v228
M16 v[76:79],a[240:243],a[176:179],v[220:223]
BL4 v3,s[8:11],s25 offen offset:1024 lds
M16 v[76:79],a[244:247],a[180:183],v[76:79]
v_add_f32 v229, v109, v229
CVT v190,v108,v109
M16 v[76:79],a[248:251],a[184:187],v[76:79]
s_waitcnt lgkmcnt(8)
EXP v110,v110
M16 v[76:79],a[252:255],a[188:191],v[76:79]
DR a[240:243],v5 offset:12288
v_add_f32 v230, v110, v230
M16 a[0:3],a[192:195],v[144:147],a[0:3]
EXP v111,v111
M16 a[0:3],a[196:199],v[148:151],a[0:3]
v_add_f32 v231, v111, v231
CVT v191,v110,v111
M16 a[32:35],a[192:195],v[152:155],a[32:35]
EXP v112,v112
M16 a[32:35],a[196:199],v[156:159],a[32:35]
DR a[244:247],v5 offset:13312
v_add_f32 v232, v112, v232
M16 a[64:67],a[192:195],v[160:163],a[64:67]
EXP v113,v113
M16 a[64:67],a[196:199],v[164:167],a[64:67]
EXP v114,v114
M16 a[96:99],a[192:195],v[168:171],a[96:99]
BL4 v3,s[8:11],s25 offen offset:2048 lds
M16 a[96:99],a[196:199],v[172:175],a[96:99]
DR a[248:251],v5 offset:14336
v_add_f32 v233, v113, v233
M16 a[4:7],a[200:203],v[144:147],a[4:7]
CVT v192,v112,v113
v_add_f32 v234, v114, v234
M16 a[4:7],a[204:207],v[148:151],a[4:7]
EXP v115,v115
M16 a[36:39],a[200:203],v[152:155],a[36:39]
EXP v116,v116
M16 a[36:39],a[204:207],v[156:159],a[36:39]
DR a[252:255],v5 offset:15360
v_add_f32 v235, v115, v235
M16 a[68:71],a[200:203],v[160:163],a[68:71]
s_add_u32 s29, s29, 16384
CVT v193,v114,v115
v_add_f32 v232, v116, v232
M16 a[68:71],a[204:207],v[164:167],a[68:71]
s_and_b32 s29, s29, 0xffff
EXP v117,v117
M16 a[100:103],a[200:203],v[168:171],a[100:103]
s_waitcnt lgkmcnt(8)
v_add_u32 v5, s29, v7
v_add_f32 v233, v117, v233
M16 a[100:103],a[204:207],v[172:175],a[100:103]
DR a[192:195],v4 offset:0
CVT v194,v116,v117
M16 a[8:11],a[208:211],v[144:147],a[8:11]
BL4 v3,s[8:11],s25 offen offset:3072 lds
M16 a[8:11],a[212:215],v[148:151],a[8:11]
s_add_u32 s25, s25, 32768
EXP v118,v118
M16 a[40:43],a[208:211],v[152:155],a[40:43]
s_add_u32 s27, s27, 16384
EXP v119,v119
M16 a[40:43],a[212:215],v[156:159],a[40:43]
DR a[196:199],v4 offset:1024
v_add_f32 v234, v118, v234
M16 a[72:75],a[208:211],v[160:163],a[72:75]
s_and_b32 s27, s27, 0xffff
v_add_f32 v235, v119, v235
CVT v195,v118,v119
M16 a[72:75],a[212:215],v[164:167],a[72:75]
EXP v120,v120
M16 a[104:107],a[208:211],v[168:171],a[104:107]
EXP v121,v121
M16 a[104:107],a[212:215],v[172:175],a[104:107]
DR a[200:203],v4 offset:2048
v_add_f32 v232, v120, v232
M16 a[12:15],a[216:219],v[144:147],a[12:15]
v_add_f32 v233, v121, v233
CVT v196,v120,v121
M16 a[12:15],a[220:223],v[148:151],a[12:15]
EXP v122,v122
M16 a[44:47],a[216:219],v[152:155],a[44:47]
EXP v123,v123
M16 a[44:47],a[220:223],v[156:159],a[44:47]
DR a[204:207],v4 offset:3072
v_add_f32 v234, v122, v234
M16 a[76:79],a[216:219],v[160:163],a[76:79]
EXP v124,v124
M16 a[76:79],a[220:223],v[164:167],a[76:79]
v_add_f32 v235, v123, v235
CVT v197,v122,v123
M16 a[108:111],a[216:219],v[168:171],a[108:111]
EXP v125,v125
M16 a[108:111],a[220:223],v[172:175],a[108:111]
EXP v126,v126
M16 v[224:227],v[12:15],v[144:147],v[224:227]
s_waitcnt lgkmcnt(8)
EXP v127,v127
M16 v[224:227],v[12:15],v[148:151],v[224:227]
DR a[208:211],v4 offset:4096
v_add_f32 v232, v124, v232
M16 a[16:19],a[224:227],v[144:147],a[16:19]
v_add_f32 v233, v125, v233
CVT v198,v124,v125
M16 a[16:19],a[228:231],v[148:151],a[16:19]
EXP v128,v128
M16 a[48:51],a[224:227],v[152:155],a[48:51]
EXP v129,v129
M16 a[48:51],a[228:231],v[156:159],a[48:51]
DR a[212:215],v4 offset:5120
v_add_f32 v234, v126, v234
M16 a[80:83],a[224:227],v[160:163],a[80:83]
v_add_f32 v235, v127, v235
CVT v199,v126,v127
M16 a[80:83],a[228:231],v[164:167],a[80:83]
EXP v130,v130
M16 a[112:115],a[224:227],v[168:171],a[112:115]
EXP v131,v131
M16 a[112:115],a[228:231],v[172:175],a[112:115]
DR a[216:219],v4 offset:6144
v_add_f32 v236, v128, v236
M16 a[20:23],a[232:235],v[144:147],a[20:23]
EXP v132,v132
M16 a[20:23],a[236:239],v[148:151],a[20:23]
v_add_f32 v237, v129, v237
CVT v200,v128,v129
M16 a[52:55],a[232:235],v[152:155],a[52:55]
EXP v133,v133
M16 a[52:55],a[236:239],v[156:159],a[52:55]
DR a[220:223],v4 offset:7168
v_add_f32 v238, v130, v238
M16 a[84:87],a[232:235],v[160:163],a[84:87]
EXP v134,v134
M16 a[84:87],a[236:239],v[164:167],a[84:87]
v_add_f32 v239, v131, v239
CVT v201,v130,v131
M16 a[116:119],a[232:235],v[168:171],a[116:119]
s_waitcnt lgkmcnt(8)
EXP v135,v135
M16 a[116:119],a[236:239],v[172:175],a[116:119]
DR a[224:227],v4 offset:8192
v_add_f32 v236, v132, v236
M16 a[24:27],a[240:243],v[144:147],a[24:27]
EXP v136,v136
M16 a[24:27],a[244:247],v[148:151],a[24:27]
EXP v137,v137
M16 a[56:59],a[240:243],v[152:155],a[56:59]
v_add_f32 v237, v133, v237
CVT v202,v132,v133
M16 a[56:59],a[244:247],v[156:159],a[56:59]
DR a[228:231],v4 offset:9216
v_add_f32 v238, v134, v238
M16 a[88:91],a[240:243],v[160:163],a[88:91]
EXP v138,v138
M16 a[88:91],a[244:247],v[164:167],a[88:91]
EXP v139,v139
M16 a[120:123],a[240:243],v[168:171],a[120:123]
v_add_f32 v239, v135, v239
CVT v203,v134,v135
M16 a[120:123],a[244:247],v[172:175],a[120:123]
DR a[232:235],v4 offset:10240
v_add_f32 v236, v136, v236
M16 a[28:31],a[248:251],v[144:147],a[28:31]
EXP v140,v140
M16 a[28:31],a[252:255],v[148:151],a[28:31]
EXP v141,v141
M16 a[60:63],a[248:251],v[152:155],a[60:63]
EXP v142,v142
M16 a[60:63],a[252:255],v[156:159],a[60:63]
DR a[236:239],v4 offset:11264
v_add_f32 v237, v137, v237
M16 a[92:95],a[248:251],v[160:163],a[92:95]
CVT v204,v136,v137
v_add_f32 v238, v138, v238
M16 a[92:95],a[252:255],v[164:167],a[92:95]
EXP v143,v143
M16 a[124:127],a[248:251],v[168:171],a[124:127]
v_add_f32 v239, v139, v239
CVT v205,v138,v139
M16 a[124:127],a[252:255],v[172:175],a[124:127]
s_waitcnt lgkmcnt(8)
v_add_f32 v236, v140, v236
v_add_f32 v237, v141, v237
CVT v206,v140,v141
v_cndmask_b32 v240, v6, v212, s[32:33]
v_cndmask_b32 v241, v6, v212, s[34:35]
v_cndmask_b32 v242, v6, v212, s[36:37]
v_cndmask_b32 v243, v6, v212, s[38:39]
v_cndmask_b32 v244, v6, v212, s[40:41]
v_cndmask_b32 v245, v6, v212, s[42:43]
v_cndmask_b32 v246, v6, v212, s[44:45]
v_cndmask_b32 v247, v6, v212, s[46:47]
v_cndmask_b32 v248, v6, v212, s[48:49]
v_cndmask_b32 v249, v6, v212, s[50:51]
v_cndmask_b32 v250, v6, v212, s[52:53]
v_cndmask_b32 v251, v6, v212, s[54:55]
v_cndmask_b32 v252, v6, v212, s[56:57]
v_cndmask_b32 v253, v6, v212, s[58:59]
v_cndmask_b32 v254, v6, v212, s[60:61]
v_cndmask_b32 v255, v6, v212, s[62:63]
s_nop 1
M16 v[96:99],a[192:195],a[144:147],v[240:243]
DR a[240:243],v4 offset:12288
v_add_f32 v238, v142, v238
M16 v[96:99],a[196:199],a[148:151],v[96:99]
EXP v16,v16
v_add_f32 v239, v143, v239
M16 v[96:99],a[200:203],a[152:155],v[96:99]
s_waitcnt vmcnt(8)
EXP v17,v17
M16 v[96:99],a[204:207],a[156:159],v[96:99]
s_barrier
EXP v18,v18
M16 v[112:115],a[192:195],a[160:163],v[216:219]
DR a[244:247],v4 offset:13312
CVT v207,v142,v143
M16 v[112:115],a[196:199],a[164:167],v[112:115]
s_add_u32 m0, s26, s30
EXP v19,v19
CVT v144,v16,v17
M16 v[112:115],a[200:203],a[168:171],v[112:115]
BL4 v3,s[8:11],s24 offen lds
M16 v[112:115],a[204:207],a[172:175],v[112:115]
DR a[248:251],v4 offset:14336
CVT v145,v18,v19
M16 v[128:131],a[192:195],a[176:179],v[220:223]
EXP v20,v20
M16 v[128:131],a[196:199],a[180:183],v[128:131]
s_waitcnt lgkmcnt(7)
EXP v21,v21
M16 v[128:131],a[200:203],a[184:187],v[128:131]
DR a[252:255],v4 offset:15360
CVT v146,v20,v21
M16 v[128:131],a[204:207],a[188:191],v[128:131]
DR a[192:195],v5 offset:0
M16 v[100:103],a[208:211],a[144:147],v[244:247]
s_add_u32 s28, s28, 16384
EXP v22,v22
M16 v[100:103],a[212:215],a[148:151],v[100:103]
s_and_b32 s28, s28, 0xffff
EXP v23,v23
M16 v[100:103],a[216:219],a[152:155],v[100:103]
DR a[196:199],v5 offset:1024
v_add_u32 v4, s28, v2
M16 v[100:103],a[220:223],a[156:159],v[100:103]
BL4 v3,s[8:11],s24 offen offset:1024 lds
M16 v[116:119],a[208:211],a[160:163],v[216:219]
EXP v24,v24
M16 v[116:119],a[212:215],a[164:167],v[116:119]
DR a[200:203],v5 offset:2048
EXP v25,v25
M16 v[116:119],a[216:219],a[168:171],v[116:119]
CVT v147,v22,v23
CVT v148,v24,v25
M16 v[116:119],a[220:223],a[172:175],v[116:119]
EXP v26,v26
M16 v[132:135],a[208:211],a[176:179],v[220:223]
DR a[204:207],v5 offset:3072
M16 v[132:135],a[212:215],a[180:183],v[132:135]
EXP v27,v27
M16 v[132:135],a[216:219],a[184:187],v[132:135]
s_waitcnt lgkmcnt(8)
EXP v28,v28
M16 v[132:135],a[220:223],a[188:191],v[132:135]
DR a[208:211],v5 offset:4096
CVT v149,v26,v27
M16 v[104:107],a[224:227],a[144:147],v[248:251]
BL4 v3,s[8:11],s24 offen offset:2048 lds
M16 v[104:107],a[228:231],a[148:151],v[104:107]
EXP v29,v29
M16 v[104:107],a[232:235],a[152:155],v[104:107]
DR a[212:215],v5 offset:5120
CVT v150,v28,v29
M16 v[104:107],a[236:239],a[156:159],v[104:107]
EXP v30,v30
M16 v[120:123],a[224:227],a[160:163],v[216:219]
EXP v31,v31
M16 v[120:123],a[228:231],a[164:167],v[120:123]
DR a[216:219],v5 offset:6144
EXP v32,v32
M16 v[120:123],a[232:235],a[168:171],v[120:123]
CVT v151,v30,v31
v_add_f32 v228, v32, v228
M16 v[120:123],a[236:239],a[172:175],v[120:123]
EXP v33,v33
M16 v[136:139],a[224:227],a[176:179],v[220:223]
DR a[220:223],v5 offset:7168
v_add_f32 v229, v33, v229
M16 v[136:139],a[228:231],a[180:183],v[136:139]
BL4 v3,s[8:11],s24 offen offset:3072 lds
CVT v152,v32,v33
M16 v[136:139],a[232:235],a[184:187],v[136:139]
s_waitcnt lgkmcnt(8)
EXP v34,v34
M16 v[136:139],a[236:239],a[188:191],v[136:139]
DR a[224:227],v5 offset:8192
v_add_f32 v230, v34, v230
M16 v[108:111],a[240:243],a[144:147],v[252:255]
s_add_u32 s24, s24, 32768
EXP v35,v35
M16 v[108:111],a[244:247],a[148:151],v[108:111]
s_add_u32 s26, s26, 16384
v_add_f32 v231, v35, v231
CVT v153,v34,v35
M16 v[108:111],a[248:251],a[152:155],v[108:111]
DR a[228:231],v5 offset:9216
M16 v[108:111],a[252:255],a[156:159],v[108:111]
s_and_b32 s26, s26, 0xffff
EXP v36,v36
M16 v[124:127],a[240:243],a[160:163],v[216:219]
EXP v37,v37
M16 v[124:127],a[244:247],a[164:167],v[124:127]
DR a[232:235],v5 offset:10240
v_add_f32 v228, v36, v228
v_add_f32 v229, v37, v229
M16 v[124:127],a[248:251],a[168:171],v[124:127]
s_add_u32 m0, s27, s31
EXP v38,v38
M16 v[124:127],a[252:255],a[172:175],v[124:127]
BL4 v3,s[8:11],s25 offen lds
M16 v[140:143],a[240:243],a[176:179],v[220:223]
DR a[236:239],v5 offset:11264
CVT v154,v36,v37
M16 v[140:143],a[244:247],a[180:183],v[140:143]
EXP v39,v39
v_add_f32 v230, v38, v230
M16 v[140:143],a[248:251],a[184:187],v[140:143]
s_waitcnt lgkmcnt(8)
v_add_f32 v231, v39, v231
CVT v155,v38,v39
M16 v[140:143],a[252:255],a[188:191],v[140:143]
DR a[240:243],v5 offset:12288
M16 a[0:3],a[192:195],v[176:179],a[0:3]
EXP v40,v40
M16 a[0:3],a[196:199],v[180:183],a[0:3]
EXP v41,v41
v_add_f32 v228, v40, v228
M16 a[32:35],a[192:195],v[184:187],a[32:35]
DR a[244:247],v5 offset:13312
v_add_f32 v229, v41, v229
M16 a[32:35],a[196:199],v[188:191],a[32:35]
BL4 v3,s[8:11],s25 offen offset:1024 lds
M16 a[64:67],a[192:195],v[192:195],a[64:67]
EXP v42,v42
M16 a[64:67],a[196:199],v[196:199],a[64:67]
DR a[248:251],v5 offset:14336
EXP v43,v43
M16 a[96:99],a[192:195],v[200:203],a[96:99]
CVT v156,v40,v41
v_add_f32 v230, v42, v230
M16 a[96:99],a[196:199],v[204:207],a[96:99]
EXP v44,v44
M16 a[4:7],a[200:203],v[176:179],a[4:7]
DR a[252:255],v5 offset:15360
v_add_f32 v231, v43, v231
M16 a[4:7],a[204:207],v[180:183],a[4:7]
s_add_u32 s29, s29, 16384
EXP v45,v45
CVT v157,v42,v43
M16 a[36:39],a[200:203],v[184:187],a[36:39]
s_and_b32 s29, s29, 0xffff
EXP v46,v46
M16 a[36:39],a[204:207],v[188:191],a[36:39]
BL4 v3,s[8:11],s25 offen offset:2048 lds
v_add_u32 v5, s29, v7
M16 a[68:71],a[200:203],v[192:195],a[68:71]
EXP v47,v47
v_add_f32 v228, v44, v228
M16 a[68:71],a[204:207],v[196:199],a[68:71]
v_add_f32 v229, v45, v229
CVT v158,v44,v45
M16 a[100:103],a[200:203],v[200:203],a[100:103]
s_waitcnt lgkmcnt(8)
EXP v48,v48
M16 a[100:103],a[204:207],v[204:207],a[100:103]
DR a[192:195],v4 offset:0
v_add_f32 v230, v46, v230
M16 a[8:11],a[208:211],v[176:179],a[8:11]
EXP v49,v49
v_add_f32 v231, v47, v231
M16 a[8:11],a[212:215],v[180:183],a[8:11]
EXP v50,v50
M16 a[40:43],a[208:211],v[184:187],a[40:43]
DR a[196:199],v4 offset:1024
CVT v159,v46,v47
M16 a[40:43],a[212:215],v[188:191],a[40:43]
BL4 v3,s[8:11],s25 offen offset:3072 lds
M16 a[72:75],a[208:211],v[192:195],a[72:75]
s_add_u32 s25, s25, 32768
v_add_f32 v232, v48, v232
v_add_f32 v233, v49, v233
CVT v160,v48,v49
M16 a[72:75],a[212:215],v[196:199],a[72:75]
DR a[200:203],v4 offset:2048
v_add_f32 v234, v50, v234
M16 a[104:107],a[208:211],v[200:203],a[104:107]
s_add_u32 s27, s27, 16384
EXP v51,v51
M16 a[104:107],a[212:215],v[204:207],a[104:107]
s_and_b32 s27, s27, 0xffff
EXP v52,v52
M16 a[12:15],a[216:219],v[176:179],a[12:15]
DR a[204:207],v4 offset:3072
EXP v53,v53
M16 a[12:15],a[220:223],v[180:183],a[12:15]
EXP v54,v54
M16 a[44:47],a[216:219],v[184:187],a[44:47]
v_add_f32 v235, v51, v235
CVT v161,v50,v51
M16 a[44:47],a[220:223],v[188:191],a[44:47]
EXP v55,v55
M16 a[76:79],a[216:219],v[192:195],a[76:79]
EXP v56,v56
v_add_f32 v232, v52, v232
M16 a[76:79],a[220:223],v[196:199],a[76:79]
EXP v57,v57
M16 a[108:111],a[216:219],v[200:203],a[108:111]
EXP v58,v58
M16 a[108:111],a[220:223],v[204:207],a[108:111]
v_add_f32 v233, v53, v233
CVT v162,v52,v53
M16 v[224:227],v[12:15],v[176:179],v[224:227]
s_waitcnt lgkmcnt(8)
EXP v59,v59
v_add_f32 v234, v54, v234
M16 v[224:227],v[12:15],v[180:183],v[224:227]
DR a[208:211],v4 offset:4096
v_add_f32 v235, v55, v235
M16 a[16:19],a[224:227],v[176:179],a[16:19]
EXP v60,v60
M16 a[16:19],a[228:231],v[180:183],a[16:19]
EXP v61,v61
M16 a[48:51],a[224:227],v[184:187],a[48:51]
DR a[212:215],v4 offset:5120
EXP v62,v62
M16 a[48:51],a[228:231],v[188:191],a[48:51]
CVT v163,v54,v55
v_add_f32 v232, v56, v232
M16 a[80:83],a[224:227],v[192:195],a[80:83]
EXP v63,v63
M16 a[80:83],a[228:231],v[196:199],a[80:83]
DR a[216:219],v4 offset:6144
v_add_f32 v233, v57, v233
M16 a[112:115],a[224:227],v[200:203],a[112:115]
EXP v64,v64
CVT v164,v56,v57
M16 a[112:115],a[228:231],v[204:207],a[112:115]
EXP v65,v65
M16 a[20:23],a[232:235],v[176:179],a[20:23]
DR a[220:223],v4 offset:7168
v_add_f32 v234, v58, v234
M16 a[20:23],a[236:239],v[180:183],a[20:23]
v_add_f32 v235, v59, v235
CVT v165,v58,v59
M16 a[52:55],a[232:235],v[184:187],a[52:55]
EXP v66,v66
v_add_f32 v232, v60, v232
M16 a[52:55],a[236:239],v[188:191],a[52:55]
EXP v67,v67
M16 a[84:87],a[232:235],v[192:195],a[84:87]
EXP v68,v68
M16 a[84:87],a[236:239],v[196:199],a[84:87]
EXP v69,v69
M16 a[116:119],a[232:235],v[200:203],a[116:119]
s_waitcnt lgkmcnt(8)
v_add_f32 v233, v61, v233
CVT v166,v60,v61
v_add_f32 v234, v62, v234
M16 a[116:119],a[236:239],v[204:207],a[116:119]
DR a[224:227],v4 offset:8192
v_add_f32 v235, v63, v235
M16 a[24:27],a[240:243],v[176:179],a[24:27]
EXP v70,v70
M16 a[24:27],a[244:247],v[180:183],a[24:27]
EXP v71,v71
M16 a[56:59],a[240:243],v[184:187],a[56:59]
DR a[228:231],v4 offset:9216
EXP v72,v72
M16 a[56:59],a[244:247],v[188:191],a[56:59]
EXP v73,v73
M16 a[88:91],a[240:243],v[192:195],a[88:91]
CVT v167,v62,v63
v_add_f32 v236, v64, v236
M16 a[88:91],a[244:247],v[196:199],a[88:91]
DR a[232:235],v4 offset:10240
v_add_f32 v237, v65, v237
M16 a[120:123],a[240:243],v[200:203],a[120:123]
EXP v74,v74
CVT v168,v64,v65
M16 a[120:123],a[244:247],v[204:207],a[120:123]
EXP v75,v75
M16 a[28:31],a[248:251],v[176:179],a[28:31]
DR a[236:239],v4 offset:11264
v_add_f32 v238, v66, v238
M16 a[28:31],a[252:255],v[180:183],a[28:31]
EXP v76,v76
M16 a[60:63],a[248:251],v[184:187],a[60:63]
EXP v77,v77
v_add_f32 v239, v67, v239
M16 a[60:63],a[252:255],v[188:191],a[60:63]
CVT v169,v66,v67
v_add_f32 v236, v68, v236
M16 a[92:95],a[248:251],v[192:195],a[92:95]
EXP v78,v78
M16 a[92:95],a[252:255],v[196:199],a[92:95]
EXP v79,v79
M16 a[124:127],a[248:251],v[200:203],a[124:127]
v_add_f32 v237, v69, v237
CVT v170,v68,v69
v_add_f32 v238, v70, v238
M16 a[124:127],a[252:255],v[204:207],a[124:127]
s_waitcnt lgkmcnt(8)
v_add_f32 v239, v71, v239
CVT v171,v70,v71
v_add_f32 v236, v72, v236
v_add_f32 v237, v73, v237
CVT v172,v72,v73
v_add_f32 v238, v74, v238
v_add_f32 v239, v75, v239
CVT v173,v74,v75
v_add_f32 v236, v76, v236
v_add_f32 v237, v77, v237
CVT v174,v76,v77
s_cmp_lg_u32 s22, 7
s_cbranch_scc1 L_a_x1
v_cndmask_b32 v240, v6, v216, s[32:33]
v_cndmask_b32 v241, v6, v216, s[34:35]
v_cndmask_b32 v242, v6, v216, s[36:37]
v_cndmask_b32 v243, v6, v216, s[38:39]
v_cndmask_b32 v244, v6, v216, s[40:41]
v_cndmask_b32 v245, v6, v216, s[42:43]
v_cndmask_b32 v246, v6, v216, s[44:45]
v_cndmask_b32 v247, v6, v216, s[46:47]
v_cndmask_b32 v248, v6, v216, s[48:49]
v_cndmask_b32 v249, v6, v216, s[50:51]
v_cndmask_b32 v250, v6, v216, s[52:53]
v_cndmask_b32 v251, v6, v216, s[54:55]
v_cndmask_b32 v252, v6, v216, s[56:57]
v_cndmask_b32 v253, v6, v216, s[58:59]
v_cndmask_b32 v254, v6, v216, s[60:61]
v_cndmask_b32 v255, v6, v216, s[62:63]
s_nop 1
M16 v[48:51],a[192:195],a[160:163],v[240:243]
DR a[240:243],v4 offset:12288
v_add_f32 v238, v78, v238
M16 v[48:51],a[196:199],a[164:167],v[48:51]
EXP v96,v96
M16 v[48:51],a[200:203],a[168:171],v[48:51]
s_waitcnt vmcnt(8)
EXP v97,v97
M16 v[48:51],a[204:207],a[172:175],v[48:51]
s_barrier
s_lshr_b32 s12, s2, 3
s_lshl_b32 s12, s12, 2
s_add_u32 s12, s12, s20
v_min_u32 v10, 13, v1
s_mul_i32 s13, s12, 14
v_add_u32 v10, s13, v10
v_lshlrev_b32 v11, 7, v10
v_add_u32 v9, 458752, v11
v_add_u32 v8, 950272, v11
v_cmp_le_u32 vcc, 512, v10
s_nop 1
v_cndmask_b32 v11, v11, v9, vcc
v_cmp_le_u32 vcc, 768, v10
s_mov_b32 s14, 71303168
s_nop 0
v_cndmask_b32 v11, v11, v8, vcc
buffer_load_dword v8, v11, s[8:11], s14 offen
s_getpc_b64 s[16:17]
L_pc_3:
s_add_u32 s16, s16, L_p2_end-L_pc_3
s_addc_u32 s17, s17, 0-(((L_p2_end-L_pc_3)>>63)&1)
s_mul_i32 s18, s12, (((L_p3_end-L_p2_end)/128+128)/128)
v_min_u32 v10, (((L_p3_end-L_p2_end)/128+128)/128)-1, v1
v_add_u32 v10, s18, v10
v_min_u32 v10, (L_p3_end-L_p2_end)/128, v10
v_lshlrev_b32 v10, 7, v10
global_load_dword v8, v10, s[16:17]
v_add_f32 v239, v79, v239
M16 v[64:67],a[192:195],a[176:179],v[220:223]
DR a[244:247],v4 offset:13312
CVT v175,v78,v79
M16 v[64:67],a[196:199],a[180:183],v[64:67]
s_add_u32 m0, s27, s31
EXP v98,v98
M16 v[64:67],a[200:203],a[184:187],v[64:67]
s_waitcnt lgkmcnt(6)
EXP v99,v99
M16 v[64:67],a[204:207],a[188:191],v[64:67]
DR a[248:251],v4 offset:14336
v_add_f32 v228, v96, v228
M16 v[52:55],a[208:211],a[160:163],v[244:247]
BL4 v3,s[8:11],s25 offen lds
M16 v[52:55],a[212:215],a[164:167],v[52:55]
EXP v100,v100
v_add_f32 v229, v97, v229
M16 v[52:55],a[216:219],a[168:171],v[52:55]
DR a[252:255],v4 offset:15360
CVT v184,v96,v97
M16 v[52:55],a[220:223],a[172:175],v[52:55]
DR a[192:195],v5 offset:0
v_add_f32 v230, v98, v230
M16 v[68:71],a[208:211],a[176:179],v[220:223]
s_add_u32 s28, s28, 16384
EXP v101,v101
M16 v[68:71],a[212:215],a[180:183],v[68:71]
s_and_b32 s28, s28, 0xffff
EXP v102,v102
M16 v[68:71],a[216:219],a[184:187],v[68:71]
DR a[196:199],v5 offset:1024
v_add_u32 v4, s28, v2
M16 v[68:71],a[220:223],a[188:191],v[68:71]
s_waitcnt lgkmcnt(6)
EXP v103,v103
v_add_f32 v231, v99, v231
M16 v[56:59],a[224:227],a[160:163],v[248:251]
CVT v185,v98,v99
v_add_f32 v228, v100, v228
M16 v[56:59],a[228:231],a[164:167],v[56:59]
DR a[200:203],v5 offset:2048
v_add_f32 v229, v101, v229
M16 v[56:59],a[232:235],a[168:171],v[56:59]
EXP v104,v104
M16 v[56:59],a[236:239],a[172:175],v[56:59]
EXP v105,v105
M16 v[72:75],a[224:227],a[176:179],v[220:223]
DR a[204:207],v5 offset:3072
CVT v186,v100,v101
M16 v[72:75],a[228:231],a[180:183],v[72:75]
DR a[208:211],v5 offset:4096
EXP v106,v106
M16 v[72:75],a[232:235],a[184:187],v[72:75]
v_add_f32 v230, v102, v230
v_add_f32 v231, v103, v231
M16 v[72:75],a[236:239],a[188:191],v[72:75]
s_waitcnt lgkmcnt(5)
EXP v107,v107
M16 v[60:63],a[240:243],a[160:163],v[252:255]
DR a[212:215],v5 offset:5120
CVT v187,v102,v103
M16 v[60:63],a[244:247],a[164:167],v[60:63]
BL4 v3,s[8:11],s25 offen offset:1024 lds
M16 v[60:63],a[248:251],a[168:171],v[60:63]
EXP v108,v108
M16 v[60:63],a[252:255],a[172:175],v[60:63]
DR a[216:219],v5 offset:6144
EXP v109,v109
M16 v[76:79],a[240:243],a[176:179],v[220:223]
v_add_f32 v228, v104, v228
v_add_f32 v229, v105, v229
M16 v[76:79],a[244:247],a[180:183],v[76:79]
s_waitcnt lgkmcnt(3)
EXP v110,v110
M16 v[76:79],a[248:251],a[184:187],v[76:79]
DR a[220:223],v5 offset:7168
CVT v188,v104,v105
M16 v[76:79],a[252:255],a[188:191],v[76:79]
DR a[224:227],v5 offset:8192
v_add_f32 v230, v106, v230
M16 a[0:3],a[192:195],v[144:147],a[0:3]
EXP v111,v111
M16 a[0:3],a[196:199],v[148:151],a[0:3]
EXP v112,v112
v_add_f32 v231, v107, v231
M16 a[32:35],a[192:195],v[152:155],a[32:35]
DR a[228:231],v5 offset:9216
CVT v189,v106,v107
M16 a[32:35],a[196:199],v[156:159],a[32:35]
v_add_f32 v228, v108, v228
v_add_f32 v229, v109, v229
M16 a[64:67],a[192:195],v[160:163],a[64:67]
EXP v113,v113
M16 a[64:67],a[196:199],v[164:167],a[64:67]
DR a[232:235],v5 offset:10240
CVT v190,v108,v109
M16 a[96:99],a[192:195],v[168:171],a[96:99]
EXP v114,v114
M16 a[96:99],a[196:199],v[172:175],a[96:99]
EXP v115,v115
v_add_f32 v230, v110, v230
M16 a[4:7],a[200:203],v[144:147],a[4:7]
DR a[236:239],v5 offset:11264
v_add_f32 v231, v111, v231
M16 a[4:7],a[204:207],v[148:151],a[4:7]
DR a[240:243],v5 offset:12288
CVT v191,v110,v111
M16 a[36:39],a[200:203],v[152:155],a[36:39]
BL4 v3,s[8:11],s25 offen offset:2048 lds
M16 a[36:39],a[204:207],v[156:159],a[36:39]
EXP v116,v116
M16 a[68:71],a[200:203],v[160:163],a[68:71]
DR a[244:247],v5 offset:13312
v_add_f32 v232, v112, v232
M16 a[68:71],a[204:207],v[164:167],a[68:71]
v_add_f32 v233, v113, v233
CVT v192,v112,v113
v_add_f32 v234, v114, v234
M16 a[100:103],a[200:203],v[168:171],a[100:103]
s_waitcnt lgkmcnt(6)
EXP v117,v117
M16 a[100:103],a[204:207],v[172:175],a[100:103]
DR a[248:251],v5 offset:14336
v_add_f32 v235, v115, v235
M16 a[8:11],a[208:211],v[144:147],a[8:11]
EXP v118,v118
M16 a[8:11],a[212:215],v[148:151],a[8:11]
EXP v119,v119
M16 a[40:43],a[208:211],v[152:155],a[40:43]
DR a[252:255],v5 offset:15360
CVT v193,v114,v115
M16 a[40:43],a[212:215],v[156:159],a[40:43]
DR a[192:195],v4 offset:0
v_add_f32 v232, v116, v232
M16 a[72:75],a[208:211],v[160:163],a[72:75]
s_add_u32 s29, s29, 16384
v_add_f32 v233, v117, v233
CVT v194,v116,v117
v_add_f32 v234, v118, v234
M16 a[72:75],a[212:215],v[164:167],a[72:75]
s_and_b32 s29, s29, 0xffff
EXP v120,v120
M16 a[104:107],a[208:211],v[168:171],a[104:107]
DR a[196:199],v4 offset:1024
v_add_u32 v5, s29, v7
M16 a[104:107],a[212:215],v[172:175],a[104:107]
EXP v121,v121
M16 a[12:15],a[216:219],v[144:147],a[12:15]
EXP v122,v122
M16 a[12:15],a[220:223],v[148:151],a[12:15]
DR a[200:203],v4 offset:2048
v_add_f32 v235, v119, v235
M16 a[44:47],a[216:219],v[152:155],a[44:47]
BL4 v3,s[8:11],s25 offen offset:3072 lds
CVT v195,v118,v119
M16 a[44:47],a[220:223],v[156:159],a[44:47]
s_add_u32 s25, s25, 32768
v_add_f32 v232, v120, v232
v_add_f32 v233, v121, v233
M16 a[76:79],a[216:219],v[160:163],a[76:79]
DR a[204:207],v4 offset:3072
CVT v196,v120,v121
M16 a[76:79],a[220:223],v[164:167],a[76:79]
s_add_u32 s27, s27, 16384
EXP v123,v123
M16 a[108:111],a[216:219],v[168:171],a[108:111]
s_and_b32 s27, s27, 0xffff
EXP v124,v124
M16 a[108:111],a[220:223],v[172:175],a[108:111]
EXP v125,v125
M16 v[224:227],v[12:15],v[144:147],v[224:227]
s_waitcnt lgkmcnt(8)
v_add_f32 v234, v122, v234
v_add_f32 v235, v123, v235
CVT v197,v122,v123
M16 v[224:227],v[12:15],v[148:151],v[224:227]
DR a[208:211],v4 offset:4096
v_add_f32 v232, v124, v232
M16 a[16:19],a[224:227],v[144:147],a[16:19]
EXP v126,v126
M16 a[16:19],a[228:231],v[148:151],a[16:19]
EXP v127,v127
M16 a[48:51],a[224:227],v[152:155],a[48:51]
DR a[212:215],v4 offset:5120
v_add_f32 v233, v125, v233
M16 a[48:51],a[228:231],v[156:159],a[48:51]
EXP v128,v128
M16 a[80:83],a[224:227],v[160:163],a[80:83]
CVT v198,v124,v125
v_add_f32 v234, v126, v234
v_add_f32 v235, v127, v235
M16 a[80:83],a[228:231],v[164:167],a[80:83]
DR a[216:219],v4 offset:6144
CVT v199,v126,v127
M16 a[112:115],a[224:227],v[168:171],a[112:115]
EXP v129,v129
M16 a[112:115],a[228:231],v[172:175],a[112:115]
EXP v130,v130
M16 a[20:23],a[232:235],v[144:147],a[20:23]
DR a[220:223],v4 offset:7168
v_add_f32 v236, v128, v236
M16 a[20:23],a[236:239],v[148:151],a[20:23]
EXP v131,v131
M16 a[52:55],a[232:235],v[152:155],a[52:55]
EXP v132,v132
v_add_f32 v237, v129, v237
M16 a[52:55],a[236:239],v[156:159],a[52:55]
CVT v200,v128,v129
v_add_f32 v238, v130, v238
M16 a[84:87],a[232:235],v[160:163],a[84:87]
EXP v133,v133
M16 a[84:87],a[236:239],v[164:167],a[84:87]
EXP v134,v134
M16 a[116:119],a[232:235],v[168:171],a[116:119]
s_waitcnt lgkmcnt(8)
EXP v135,v135
M16 a[116:119],a[236:239],v[172:175],a[116:119]
DR a[224:227],v4 offset:8192
v_add_f32 v239, v131, v239
M16 a[24:27],a[240:243],v[144:147],a[24:27]
CVT v201,v130,v131
v_add_f32 v236, v132, v236
v_add_f32 v237, v133, v237
M16 a[24:27],a[244:247],v[148:151],a[24:27]
EXP v136,v136
M16 a[56:59],a[240:243],v[152:155],a[56:59]
DR a[228:231],v4 offset:9216
CVT v202,v132,v133
M16 a[56:59],a[244:247],v[156:159],a[56:59]
EXP v137,v137
M16 a[88:91],a[240:243],v[160:163],a[88:91]
EXP v138,v138
M16 a[88:91],a[244:247],v[164:167],a[88:91]
DR a[232:235],v4 offset:10240
v_add_f32 v238, v134, v238
M16 a[120:123],a[240:243],v[168:171],a[120:123]
v_add_f32 v239, v135, v239
CVT v203,v134,v135
v_add_f32 v236, v136, v236
M16 a[120:123],a[244:247],v[172:175],a[120:123]
EXP v139,v139
M16 a[28:31],a[248:251],v[144:147],a[28:31]
DR a[236:239],v4 offset:11264
v_add_f32 v237, v137, v237
M16 a[28:31],a[252:255],v[148:151],a[28:31]
EXP v140,v140
M16 a[60:63],a[248:251],v[152:155],a[60:63]
EXP v141,v141
M16 a[60:63],a[252:255],v[156:159],a[60:63]
CVT v204,v136,v137
v_add_f32 v238, v138, v238
M16 a[92:95],a[248:251],v[160:163],a[92:95]
EXP v142,v142
v_add_f32 v239, v139, v239
M16 a[92:95],a[252:255],v[164:167],a[92:95]
EXP v143,v143
M16 a[124:127],a[248:251],v[168:171],a[124:127]
CVT v205,v138,v139
v_add_f32 v236, v140, v236
M16 a[124:127],a[252:255],v[172:175],a[124:127]
s_waitcnt lgkmcnt(8)
v_add_f32 v237, v141, v237
CVT v206,v140,v141
v_cndmask_b32 v240, v6, v220, s[32:33]
v_cndmask_b32 v241, v6, v220, s[34:35]
v_cndmask_b32 v242, v6, v220, s[36:37]
v_cndmask_b32 v243, v6, v220, s[38:39]
v_cndmask_b32 v244, v6, v220, s[40:41]
v_cndmask_b32 v245, v6, v220, s[42:43]
v_cndmask_b32 v246, v6, v220, s[44:45]
v_cndmask_b32 v247, v6, v220, s[46:47]
v_cndmask_b32 v248, v6, v220, s[48:49]
v_cndmask_b32 v249, v6, v220, s[50:51]
v_cndmask_b32 v250, v6, v220, s[52:53]
v_cndmask_b32 v251, v6, v220, s[54:55]
v_cndmask_b32 v252, v6, v220, s[56:57]
v_cndmask_b32 v253, v6, v220, s[58:59]
v_cndmask_b32 v254, v6, v220, s[60:61]
v_cndmask_b32 v255, v6, v220, s[62:63]
s_nop 1
M16 v[128:131],a[192:195],a[176:179],v[240:243]
DR a[240:243],v4 offset:12288
s_add_u32 s29, s29, 16384
s_and_b32 s29, s29, 0xffff
M16 v[128:131],a[196:199],a[180:183],v[128:131]
EXP v48,v48
M16 v[128:131],a[200:203],a[184:187],v[128:131]
s_waitcnt vmcnt(4)
EXP v49,v49
M16 v[128:131],a[204:207],a[188:191],v[128:131]
s_barrier
s_waitcnt lgkmcnt(5)
v_add_f32 v238, v142, v238
M16 v[132:135],a[208:211],a[176:179],v[244:247]
DR a[244:247],v4 offset:13312
v_add_f32 v239, v143, v239
M16 v[132:135],a[212:215],a[180:183],v[132:135]
EXP v50,v50
M16 v[132:135],a[216:219],a[184:187],v[132:135]
DR a[248:251],v4 offset:14336
CVT v207,v142,v143
M16 v[132:135],a[220:223],a[188:191],v[132:135]
s_waitcnt lgkmcnt(3)
EXP v51,v51
M16 v[136:139],a[224:227],a[176:179],v[248:251]
DR a[252:255],v4 offset:15360
CVT v160,v48,v49
M16 v[136:139],a[228:231],a[180:183],v[136:139]
DR a[192:195],v5 offset:0
CVT v161,v50,v51
M16 v[136:139],a[232:235],a[184:187],v[136:139]
EXP v52,v52
M16 v[136:139],a[236:239],a[188:191],v[136:139]
DR a[196:199],v5 offset:1024
s_waitcnt lgkmcnt(2)
M16 v[140:143],a[240:243],a[176:179],v[252:255]
EXP v53,v53
M16 v[140:143],a[244:247],a[180:183],v[140:143]
DR a[200:203],v5 offset:2048
CVT v162,v52,v53
M16 v[140:143],a[248:251],a[184:187],v[140:143]
EXP v54,v54
M16 v[140:143],a[252:255],a[188:191],v[140:143]
DR a[204:207],v5 offset:3072
s_waitcnt lgkmcnt(0)
M16 a[32:35],a[192:195],v[184:187],a[32:35]
DR a[208:211],v5 offset:4096
M16 a[32:35],a[196:199],v[188:191],a[32:35]
EXP v55,v55
M16 a[64:67],a[192:195],v[192:195],a[64:67]
DR a[212:215],v5 offset:5120
CVT v163,v54,v55
M16 a[64:67],a[196:199],v[196:199],a[64:67]
EXP v56,v56
M16 a[96:99],a[192:195],v[200:203],a[96:99]
DR a[216:219],v5 offset:6144
M16 a[96:99],a[196:199],v[204:207],a[96:99]
EXP v57,v57
M16 a[36:39],a[200:203],v[184:187],a[36:39]
DR a[220:223],v5 offset:7168
CVT v164,v56,v57
M16 a[36:39],a[204:207],v[188:191],a[36:39]
DR a[224:227],v5 offset:8192
M16 a[68:71],a[200:203],v[192:195],a[68:71]
EXP v58,v58
M16 a[68:71],a[204:207],v[196:199],a[68:71]
DR a[228:231],v5 offset:9216
M16 a[100:103],a[200:203],v[200:203],a[100:103]
s_waitcnt lgkmcnt(2)
EXP v59,v59
M16 a[100:103],a[204:207],v[204:207],a[100:103]
DR a[232:235],v5 offset:10240
CVT v165,v58,v59
M16 a[40:43],a[208:211],v[184:187],a[40:43]
EXP v60,v60
M16 a[40:43],a[212:215],v[188:191],a[40:43]
DR a[236:239],v5 offset:11264
M16 a[72:75],a[208:211],v[192:195],a[72:75]
DR a[240:243],v5 offset:12288
EXP v61,v61
M16 a[72:75],a[212:215],v[196:199],a[72:75]
EXP v62,v62
M16 a[104:107],a[208:211],v[200:203],a[104:107]
DR a[244:247],v5 offset:13312
CVT v166,v60,v61
M16 a[104:107],a[212:215],v[204:207],a[104:107]
EXP v63,v63
M16 a[44:47],a[216:219],v[184:187],a[44:47]
DR a[248:251],v5 offset:14336
CVT v167,v62,v63
M16 a[44:47],a[220:223],v[188:191],a[44:47]
EXP v64,v64
M16 a[76:79],a[216:219],v[192:195],a[76:79]
DR a[252:255],v5 offset:15360
v_add_u32 v5, s29, v7
M16 a[76:79],a[220:223],v[196:199],a[76:79]
DR a[192:195],v5 offset:0
M16 a[108:111],a[216:219],v[200:203],a[108:111]
s_waitcnt lgkmcnt(5)
EXP v65,v65
M16 a[108:111],a[220:223],v[204:207],a[108:111]
DR a[196:199],v5 offset:1024
CVT v168,v64,v65
M16 a[48:51],a[224:227],v[184:187],a[48:51]
EXP v66,v66
M16 a[48:51],a[228:231],v[188:191],a[48:51]
DR a[200:203],v5 offset:2048
M16 a[80:83],a[224:227],v[192:195],a[80:83]
EXP v67,v67
M16 a[80:83],a[228:231],v[196:199],a[80:83]
DR a[204:207],v5 offset:3072
CVT v169,v66,v67
M16 a[112:115],a[224:227],v[200:203],a[112:115]
DR a[208:211],v5 offset:4096
M16 a[112:115],a[228:231],v[204:207],a[112:115]
EXP v68,v68
M16 a[52:55],a[232:235],v[184:187],a[52:55]
DR a[212:215],v5 offset:5120
M16 a[52:55],a[236:239],v[188:191],a[52:55]
EXP v69,v69
M16 a[84:87],a[232:235],v[192:195],a[84:87]
DR a[216:219],v5 offset:6144
CVT v170,v68,v69
M16 a[84:87],a[236:239],v[196:199],a[84:87]
s_waitcnt lgkmcnt(7)
EXP v70,v70
M16 a[116:119],a[232:235],v[200:203],a[116:119]
DR a[220:223],v5 offset:7168
M16 a[116:119],a[236:239],v[204:207],a[116:119]
DR a[224:227],v5 offset:8192
M16 a[56:59],a[240:243],v[184:187],a[56:59]
EXP v71,v71
M16 a[56:59],a[244:247],v[188:191],a[56:59]
DR a[228:231],v5 offset:9216
CVT v171,v70,v71
M16 a[88:91],a[240:243],v[192:195],a[88:91]
EXP v72,v72
M16 a[88:91],a[244:247],v[196:199],a[88:91]
DR a[232:235],v5 offset:10240
M16 a[120:123],a[240:243],v[200:203],a[120:123]
EXP v73,v73
M16 a[120:123],a[244:247],v[204:207],a[120:123]
DR a[236:239],v5 offset:11264
CVT v172,v72,v73
M16 a[60:63],a[248:251],v[184:187],a[60:63]
EXP v74,v74
M16 a[60:63],a[252:255],v[188:191],a[60:63]
EXP v75,v75
M16 a[92:95],a[248:251],v[192:195],a[92:95]
EXP v76,v76
M16 a[92:95],a[252:255],v[196:199],a[92:95]
EXP v77,v77
M16 a[124:127],a[248:251],v[200:203],a[124:127]
EXP v78,v78
M16 a[124:127],a[252:255],v[204:207],a[124:127]
s_waitcnt lgkmcnt(8)
EXP v79,v79
CVT v173,v74,v75
s_branch L_a_e01
L_a_qb0:
v_cndmask_b32 v240, v6, v212, s[32:33]
v_cndmask_b32 v241, v6, v212, s[34:35]
v_cndmask_b32 v242, v6, v212, s[36:37]
v_cndmask_b32 v243, v6, v212, s[38:39]
v_cndmask_b32 v244, v6, v212, s[40:41]
v_cndmask_b32 v245, v6, v212, s[42:43]
v_cndmask_b32 v246, v6, v212, s[44:45]
v_cndmask_b32 v247, v6, v212, s[46:47]
v_cndmask_b32 v248, v6, v212, s[48:49]
v_cndmask_b32 v249, v6, v212, s[50:51]
v_cndmask_b32 v250, v6, v212, s[52:53]
v_cndmask_b32 v251, v6, v212, s[54:55]
v_cndmask_b32 v252, v6, v212, s[56:57]
v_cndmask_b32 v253, v6, v212, s[58:59]
v_cndmask_b32 v254, v6, v212, s[60:61]
v_cndmask_b32 v255, v6, v212, s[62:63]
s_nop 1
M16 v[96:99],a[192:195],a[144:147],v[240:243]
DR a[240:243],v4 offset:12288
EXP v16,v16
EXP v17,v17
M16 v[96:99],a[196:199],a[148:151],v[96:99]
DR a[244:247],v4 offset:13312
EXP v18,v18
EXP v19,v19
M16 v[96:99],a[200:203],a[152:155],v[96:99]
s_waitcnt vmcnt(8)
EXP v20,v20
EXP v21,v21
CVT v144,v16,v17
M16 v[96:99],a[204:207],a[156:159],v[96:99]
s_barrier
EXP v22,v22
CVT v145,v18,v19
CVT v146,v20,v21
M16 v[112:115],a[192:195],a[160:163],v[216:219]
DR a[248:251],v4 offset:14336
EXP v23,v23
EXP v24,v24
M16 v[112:115],a[196:199],a[164:167],v[112:115]
DR a[252:255],v4 offset:15360
EXP v25,v25
EXP v26,v26
CVT v147,v22,v23
M16 v[112:115],a[200:203],a[168:171],v[112:115]
s_add_u32 s28, s28, 16384
EXP v27,v27
EXP v28,v28
CVT v148,v24,v25
M16 v[112:115],a[204:207],a[172:175],v[112:115]
s_and_b32 s28, s28, 0xffff
EXP v29,v29
EXP v30,v30
M16 v[128:131],a[192:195],a[176:179],v[220:223]
s_add_u32 m0, s26, s30
v_add_u32 v4, s28, v2
CVT v149,v26,v27
CVT v150,v28,v29
M16 v[128:131],a[196:199],a[180:183],v[128:131]
BL4 v3,s[8:11],s24 offen lds
EXP v31,v31
M16 v[128:131],a[200:203],a[184:187],v[128:131]
s_waitcnt lgkmcnt(8)
EXP v32,v32
EXP v33,v33
CVT v151,v30,v31
M16 v[128:131],a[204:207],a[188:191],v[128:131]
DR a[192:195],v4 offset:0
v_add_f32 v228, v32, v228
v_add_f32 v229, v33, v229
CVT v152,v32,v33
M16 v[100:103],a[208:211],a[144:147],v[244:247]
DR a[196:199],v4 offset:1024
EXP v34,v34
EXP v35,v35
M16 v[100:103],a[212:215],a[148:151],v[100:103]
DR a[200:203],v4 offset:2048
v_add_f32 v230, v34, v230
v_add_f32 v231, v35, v231
CVT v153,v34,v35
M16 v[100:103],a[216:219],a[152:155],v[100:103]
DR a[204:207],v4 offset:3072
EXP v36,v36
EXP v37,v37
M16 v[100:103],a[220:223],a[156:159],v[100:103]
BL4 v3,s[8:11],s24 offen offset:1024 lds
v_add_f32 v228, v36, v228
v_add_f32 v229, v37, v229
M16 v[116:119],a[208:211],a[160:163],v[216:219]
EXP v38,v38
EXP v39,v39
CVT v154,v36,v37
M16 v[116:119],a[212:215],a[164:167],v[116:119]
v_add_f32 v230, v38, v230
v_add_f32 v231, v39, v231
CVT v155,v38,v39
M16 v[116:119],a[216:219],a[168:171],v[116:119]
BL4 v3,s[8:11],s24 offen offset:2048 lds
EXP v40,v40
M16 v[116:119],a[220:223],a[172:175],v[116:119]
EXP v41,v41
EXP v42,v42
v_add_f32 v228, v40, v228
M16 v[132:135],a[208:211],a[176:179],v[220:223]
v_add_f32 v229, v41, v229
CVT v156,v40,v41
v_add_f32 v230, v42, v230
M16 v[132:135],a[212:215],a[180:183],v[132:135]
BL4 v3,s[8:11],s24 offen offset:3072 lds
EXP v43,v43
M16 v[132:135],a[216:219],a[184:187],v[132:135]
s_waitcnt lgkmcnt(8)
v_add_f32 v231, v43, v231
CVT v157,v42,v43
M16 v[132:135],a[220:223],a[188:191],v[132:135]
DR a[208:211],v4 offset:4096
EXP v44,v44
EXP v45,v45
M16 v[104:107],a[224:227],a[144:147],v[248:251]
DR a[212:215],v4 offset:5120
v_add_f32 v228, v44, v228
v_add_f32 v229, v45, v229
CVT v158,v44,v45
M16 v[104:107],a[228:231],a[148:151],v[104:107]
DR a[216:219],v4 offset:6144
EXP v46,v46
EXP v47,v47
M16 v[104:107],a[232:235],a[152:155],v[104:107]
DR a[220:223],v4 offset:7168
v_add_f32 v230, v46, v230
v_add_f32 v231, v47, v231
CVT v159,v46,v47
M16 v[104:107],a[236:239],a[156:159],v[104:107]
s_add_u32 s24, s24, 32768
EXP v48,v48
EXP v49,v49
M16 v[120:123],a[224:227],a[160:163],v[216:219]
s_add_u32 s26, s26, 16384
EXP v50,v50
v_add_f32 v232, v48, v232
v_add_f32 v233, v49, v233
CVT v160,v48,v49
M16 v[120:123],a[228:231],a[164:167],v[120:123]
s_and_b32 s26, s26, 0xffff
EXP v51,v51
EXP v52,v52
M16 v[120:123],a[232:235],a[168:171],v[120:123]
s_add_u32 m0, s27, s31
EXP v53,v53
v_add_f32 v234, v50, v234
v_add_f32 v235, v51, v235
CVT v161,v50,v51
M16 v[120:123],a[236:239],a[172:175],v[120:123]
BL4 v3,s[8:11],s25 offen lds
EXP v54,v54
v_add_f32 v232, v52, v232
M16 v[136:139],a[224:227],a[176:179],v[220:223]
EXP v55,v55
v_add_f32 v233, v53, v233
CVT v162,v52,v53
M16 v[136:139],a[228:231],a[180:183],v[136:139]
EXP v56,v56
EXP v57,v57
v_add_f32 v234, v54, v234
M16 v[136:139],a[232:235],a[184:187],v[136:139]
s_waitcnt lgkmcnt(8)
EXP v58,v58
v_add_f32 v235, v55, v235
CVT v163,v54,v55
v_add_f32 v232, v56, v232
M16 v[136:139],a[236:239],a[188:191],v[136:139]
DR a[224:227],v4 offset:8192
EXP v59,v59
EXP v60,v60
M16 v[108:111],a[240:243],a[144:147],v[252:255]
DR a[228:231],v4 offset:9216
EXP v61,v61
v_add_f32 v233, v57, v233
CVT v164,v56,v57
v_add_f32 v234, v58, v234
M16 v[108:111],a[244:247],a[148:151],v[108:111]
DR a[232:235],v4 offset:10240
EXP v62,v62
EXP v63,v63
v_add_f32 v235, v59, v235
M16 v[108:111],a[248:251],a[152:155],v[108:111]
DR a[236:239],v4 offset:11264
EXP v64,v64
EXP v65,v65
M16 v[108:111],a[252:255],a[156:159],v[108:111]
BL4 v3,s[8:11],s25 offen offset:1024 lds
EXP v66,v66
CVT v165,v58,v59
M16 v[124:127],a[240:243],a[160:163],v[216:219]
EXP v67,v67
EXP v68,v68
M16 v[124:127],a[244:247],a[164:167],v[124:127]
EXP v69,v69
EXP v70,v70
v_add_f32 v232, v60, v232
M16 v[124:127],a[248:251],a[168:171],v[124:127]
BL4 v3,s[8:11],s25 offen offset:2048 lds
EXP v71,v71
v_add_f32 v233, v61, v233
M16 v[124:127],a[252:255],a[172:175],v[124:127]
EXP v72,v72
EXP v73,v73
M16 v[140:143],a[240:243],a[176:179],v[220:223]
EXP v74,v74
EXP v75,v75
CVT v166,v60,v61
M16 v[140:143],a[244:247],a[180:183],v[140:143]
BL4 v3,s[8:11],s25 offen offset:3072 lds
EXP v76,v76
v_add_f32 v234, v62, v234
M16 v[140:143],a[248:251],a[184:187],v[140:143]
s_add_u32 s25, s25, 32768
EXP v77,v77
EXP v78,v78
M16 v[140:143],a[252:255],a[188:191],v[140:143]
s_add_u32 s27, s27, 16384
s_and_b32 s27, s27, 0xffff
s_waitcnt lgkmcnt(8)
EXP v79,v79
v_add_f32 v235, v63, v235
CVT v167,v62,v63
v_add_f32 v236, v64, v236
v_add_f32 v237, v65, v237
CVT v168,v64,v65
v_add_f32 v238, v66, v238
v_add_f32 v239, v67, v239
CVT v169,v66,v67
v_add_f32 v236, v68, v236
v_add_f32 v237, v69, v237
CVT v170,v68,v69
v_add_f32 v238, v70, v238
v_add_f32 v239, v71, v239
CVT v171,v70,v71
v_add_f32 v236, v72, v236
v_add_f32 v237, v73, v237
CVT v172,v72,v73
v_add_f32 v238, v74, v238
v_add_f32 v239, v75, v239
CVT v173,v74,v75
v_add_f32 v236, v76, v236
v_add_f32 v237, v77, v237
CVT v174,v76,v77
s_add_u32 m0, s18, 0
s_nop 0
BL4 v176,s[4:7],s16 offen lds
BL4 v177,s[4:7],s16 offen offset:1024 lds
BL4 v178,s[4:7],s16 offen offset:2048 lds
BL4 v179,s[4:7],s16 offen offset:3072 lds
s_add_u32 m0, s18, 4096
s_nop 0
BL4 v180,s[4:7],s16 offen lds
s_cmp_ge_u32 s20, 2
s_cbranch_scc1 L_wt_oneb
s_add_u32 m0, s18, 20480
s_nop 0
BL4 v176,s[92:95],s17 offen lds
BL4 v177,s[92:95],s17 offen offset:1024 lds
BL4 v178,s[92:95],s17 offen offset:2048 lds
BL4 v179,s[92:95],s17 offen offset:3072 lds
s_add_u32 m0, s18, 24576
s_nop 0
BL4 v180,s[92:95],s17 offen lds
L_wt_oneb:
L_a_x1:
s_lshl_b32 s23, s22, 1
s_sub_u32 s23, 13, s23
M16 v[48:51],a[192:195],a[160:163],v[216:219]
DR a[240:243],v4 offset:12288
v_add_f32 v238, v78, v238
M16 v[48:51],a[196:199],a[164:167],v[48:51]
EXP v96,v96
M16 v[48:51],a[200:203],a[168:171],v[48:51]
s_waitcnt vmcnt(8)
EXP v97,v97
v_add_f32 v239, v79, v239
M16 v[48:51],a[204:207],a[172:175],v[48:51]
s_barrier
EXP v98,v98
M16 v[64:67],a[192:195],a[176:179],v[220:223]
DR a[244:247],v4 offset:13312
CVT v175,v78,v79
M16 v[64:67],a[196:199],a[180:183],v[64:67]
s_add_u32 m0, s26, s30
EXP v99,v99
M16 v[64:67],a[200:203],a[184:187],v[64:67]
s_waitcnt lgkmcnt(6)
EXP v100,v100
v_add_f32 v228, v96, v228
M16 v[64:67],a[204:207],a[188:191],v[64:67]
DR a[248:251],v4 offset:14336
v_add_f32 v229, v97, v229
M16 v[52:55],a[208:211],a[160:163],v[216:219]
BL4 v3,s[8:11],s24 offen lds
M16 v[52:55],a[212:215],a[164:167],v[52:55]
EXP v101,v101
M16 v[52:55],a[216:219],a[168:171],v[52:55]
DR a[252:255],v4 offset:15360
CVT v184,v96,v97
M16 v[52:55],a[220:223],a[172:175],v[52:55]
DR a[192:195],v5 offset:0
EXP v102,v102
M16 v[68:71],a[208:211],a[176:179],v[220:223]
s_add_u32 s28, s28, 16384
v_add_f32 v230, v98, v230
v_add_f32 v231, v99, v231
M16 v[68:71],a[212:215],a[180:183],v[68:71]
s_and_b32 s28, s28, 0xffff
EXP v103,v103
M16 v[68:71],a[216:219],a[184:187],v[68:71]
DR a[196:199],v5 offset:1024
v_add_u32 v4, s28, v2
M16 v[68:71],a[220:223],a[188:191],v[68:71]
s_waitcnt lgkmcnt(6)
EXP v104,v104
CVT v185,v98,v99
M16 v[56:59],a[224:227],a[160:163],v[216:219]
BL4 v3,s[8:11],s24 offen offset:1024 lds
M16 v[56:59],a[228:231],a[164:167],v[56:59]
DR a[200:203],v5 offset:2048
v_add_f32 v228, v100, v228
M16 v[56:59],a[232:235],a[168:171],v[56:59]
EXP v105,v105
M16 v[56:59],a[236:239],a[172:175],v[56:59]
v_add_f32 v229, v101, v229
CVT v186,v100,v101
M16 v[72:75],a[224:227],a[176:179],v[220:223]
DR a[204:207],v5 offset:3072
EXP v106,v106
M16 v[72:75],a[228:231],a[180:183],v[72:75]
DR a[208:211],v5 offset:4096
v_add_f32 v230, v102, v230
M16 v[72:75],a[232:235],a[184:187],v[72:75]
EXP v107,v107
M16 v[72:75],a[236:239],a[188:191],v[72:75]
s_waitcnt lgkmcnt(5)
EXP v108,v108
M16 v[60:63],a[240:243],a[160:163],v[216:219]
DR a[212:215],v5 offset:5120
v_add_f32 v231, v103, v231
CVT v187,v102,v103
M16 v[60:63],a[244:247],a[164:167],v[60:63]
BL4 v3,s[8:11],s24 offen offset:2048 lds
M16 v[60:63],a[248:251],a[168:171],v[60:63]
EXP v109,v109
M16 v[60:63],a[252:255],a[172:175],v[60:63]
DR a[216:219],v5 offset:6144
v_add_f32 v228, v104, v228
M16 v[76:79],a[240:243],a[176:179],v[220:223]
EXP v110,v110
v_add_f32 v229, v105, v229
M16 v[76:79],a[244:247],a[180:183],v[76:79]
s_waitcnt lgkmcnt(3)
EXP v111,v111
M16 v[76:79],a[248:251],a[184:187],v[76:79]
DR a[220:223],v5 offset:7168
CVT v188,v104,v105
M16 v[76:79],a[252:255],a[188:191],v[76:79]
DR a[224:227],v5 offset:8192
v_add_f32 v230, v106, v230
M16 a[0:3],a[192:195],v[144:147],a[0:3]
BL4 v3,s[8:11],s24 offen offset:3072 lds
M16 a[0:3],a[196:199],v[148:151],a[0:3]
s_add_u32 s24, s24, 32768
v_add_f32 v231, v107, v231
CVT v189,v106,v107
v_add_f32 v228, v108, v228
M16 a[32:35],a[192:195],v[152:155],a[32:35]
DR a[228:231],v5 offset:9216
v_add_f32 v229, v109, v229
M16 a[32:35],a[196:199],v[156:159],a[32:35]
s_add_u32 s26, s26, 16384
EXP v112,v112
M16 a[64:67],a[192:195],v[160:163],a[64:67]
s_and_b32 s26, s26, 0xffff
EXP v113,v113
M16 a[64:67],a[196:199],v[164:167],a[64:67]
DR a[232:235],v5 offset:10240
EXP v114,v114
M16 a[96:99],a[192:195],v[168:171],a[96:99]
CVT v190,v108,v109
v_add_f32 v230, v110, v230
M16 a[96:99],a[196:199],v[172:175],a[96:99]
s_add_u32 m0, s27, s31
EXP v115,v115
M16 a[4:7],a[200:203],v[144:147],a[4:7]
DR a[236:239],v5 offset:11264
v_add_f32 v231, v111, v231
M16 a[4:7],a[204:207],v[148:151],a[4:7]
DR a[240:243],v5 offset:12288
CVT v191,v110,v111
M16 a[36:39],a[200:203],v[152:155],a[36:39]
BL4 v3,s[8:11],s25 offen lds
v_add_f32 v232, v112, v232
M16 a[36:39],a[204:207],v[156:159],a[36:39]
EXP v116,v116
M16 a[68:71],a[200:203],v[160:163],a[68:71]
DR a[244:247],v5 offset:13312
v_add_f32 v233, v113, v233
M16 a[68:71],a[204:207],v[164:167],a[68:71]
EXP v117,v117
M16 a[100:103],a[200:203],v[168:171],a[100:103]
s_waitcnt lgkmcnt(6)
CVT v192,v112,v113
v_add_f32 v234, v114, v234
v_add_f32 v235, v115, v235
M16 a[100:103],a[204:207],v[172:175],a[100:103]
DR a[248:251],v5 offset:14336
CVT v193,v114,v115
M16 a[8:11],a[208:211],v[144:147],a[8:11]
EXP v118,v118
M16 a[8:11],a[212:215],v[148:151],a[8:11]
BL4 v3,s[8:11],s25 offen offset:1024 lds
M16 a[40:43],a[208:211],v[152:155],a[40:43]
DR a[252:255],v5 offset:15360
v_add_f32 v232, v116, v232
M16 a[40:43],a[212:215],v[156:159],a[40:43]
DR a[192:195],v4 offset:0
EXP v119,v119
M16 a[72:75],a[208:211],v[160:163],a[72:75]
s_add_u32 s29, s29, 16384
EXP v120,v120
M16 a[72:75],a[212:215],v[164:167],a[72:75]
s_and_b32 s29, s29, 0xffff
v_add_f32 v233, v117, v233
CVT v194,v116,v117
M16 a[104:107],a[208:211],v[168:171],a[104:107]
DR a[196:199],v4 offset:1024
v_add_u32 v5, s29, v7
M16 a[104:107],a[212:215],v[172:175],a[104:107]
EXP v121,v121
v_add_f32 v234, v118, v234
M16 a[12:15],a[216:219],v[144:147],a[12:15]
BL4 v3,s[8:11],s25 offen offset:2048 lds
M16 a[12:15],a[220:223],v[148:151],a[12:15]
DR a[200:203],v4 offset:2048
v_add_f32 v235, v119, v235
M16 a[44:47],a[216:219],v[152:155],a[44:47]
EXP v122,v122
M16 a[44:47],a[220:223],v[156:159],a[44:47]
EXP v123,v123
M16 a[76:79],a[216:219],v[160:163],a[76:79]
DR a[204:207],v4 offset:3072
CVT v195,v118,v119
v_add_f32 v232, v120, v232
M16 a[76:79],a[220:223],v[164:167],a[76:79]
EXP v124,v124
M16 a[108:111],a[216:219],v[168:171],a[108:111]
EXP v125,v125
M16 a[108:111],a[220:223],v[172:175],a[108:111]
BL4 v3,s[8:11],s25 offen offset:3072 lds
M16 v[224:227],v[12:15],v[144:147],v[224:227]
s_waitcnt lgkmcnt(8)
EXP v126,v126
v_add_f32 v233, v121, v233
M16 v[224:227],v[12:15],v[148:151],v[224:227]
DR a[208:211],v4 offset:4096
CVT v196,v120,v121
M16 a[16:19],a[224:227],v[144:147],a[16:19]
s_add_u32 s25, s25, 32768
v_add_f32 v234, v122, v234
v_add_f32 v235, v123, v235
M16 a[16:19],a[228:231],v[148:151],a[16:19]
s_add_u32 s27, s27, 16384
EXP v127,v127
M16 a[48:51],a[224:227],v[152:155],a[48:51]
DR a[212:215],v4 offset:5120
CVT v197,v122,v123
M16 a[48:51],a[228:231],v[156:159],a[48:51]
s_and_b32 s27, s27, 0xffff
EXP v128,v128
v_add_f32 v232, v124, v232
M16 a[80:83],a[224:227],v[160:163],a[80:83]
EXP v129,v129
M16 a[80:83],a[228:231],v[164:167],a[80:83]
DR a[216:219],v4 offset:6144
v_add_f32 v233, v125, v233
M16 a[112:115],a[224:227],v[168:171],a[112:115]
CVT v198,v124,v125
v_add_f32 v234, v126, v234
M16 a[112:115],a[228:231],v[172:175],a[112:115]
EXP v130,v130
v_add_f32 v235, v127, v235
M16 a[20:23],a[232:235],v[144:147],a[20:23]
DR a[220:223],v4 offset:7168
CVT v199,v126,v127
M16 a[20:23],a[236:239],v[148:151],a[20:23]
EXP v131,v131
M16 a[52:55],a[232:235],v[152:155],a[52:55]
EXP v132,v132
M16 a[52:55],a[236:239],v[156:159],a[52:55]
v_add_f32 v236, v128, v236
v_add_f32 v237, v129, v237
CVT v200,v128,v129
M16 a[84:87],a[232:235],v[160:163],a[84:87]
EXP v133,v133
M16 a[84:87],a[236:239],v[164:167],a[84:87]
EXP v134,v134
M16 a[116:119],a[232:235],v[168:171],a[116:119]
s_waitcnt lgkmcnt(8)
EXP v135,v135
M16 a[116:119],a[236:239],v[172:175],a[116:119]
DR a[224:227],v4 offset:8192
v_add_f32 v238, v130, v238
M16 a[24:27],a[240:243],v[144:147],a[24:27]
v_add_f32 v239, v131, v239
CVT v201,v130,v131
v_add_f32 v236, v132, v236
M16 a[24:27],a[244:247],v[148:151],a[24:27]
EXP v136,v136
M16 a[56:59],a[240:243],v[152:155],a[56:59]
DR a[228:231],v4 offset:9216
v_add_f32 v237, v133, v237
M16 a[56:59],a[244:247],v[156:159],a[56:59]
EXP v137,v137
M16 a[88:91],a[240:243],v[160:163],a[88:91]
EXP v138,v138
CVT v202,v132,v133
M16 a[88:91],a[244:247],v[164:167],a[88:91]
DR a[232:235],v4 offset:10240
v_add_f32 v238, v134, v238
M16 a[120:123],a[240:243],v[168:171],a[120:123]
v_add_f32 v239, v135, v239
CVT v203,v134,v135
M16 a[120:123],a[244:247],v[172:175],a[120:123]
EXP v139,v139
M16 a[28:31],a[248:251],v[144:147],a[28:31]
DR a[236:239],v4 offset:11264
v_add_f32 v236, v136, v236
M16 a[28:31],a[252:255],v[148:151],a[28:31]
EXP v140,v140
v_add_f32 v237, v137, v237
M16 a[60:63],a[248:251],v[152:155],a[60:63]
EXP v141,v141
M16 a[60:63],a[252:255],v[156:159],a[60:63]
CVT v204,v136,v137
v_add_f32 v238, v138, v238
M16 a[92:95],a[248:251],v[160:163],a[92:95]
EXP v142,v142
M16 a[92:95],a[252:255],v[164:167],a[92:95]
EXP v143,v143
v_add_f32 v239, v139, v239
M16 a[124:127],a[248:251],v[168:171],a[124:127]
CVT v205,v138,v139
v_add_f32 v236, v140, v236
M16 a[124:127],a[252:255],v[172:175],a[124:127]
s_waitcnt lgkmcnt(8)
v_add_f32 v237, v141, v237
CVT v206,v140,v141
M16 v[112:115],a[192:195],a[160:163],v[216:219]
DR a[240:243],v4 offset:12288
v_add_f32 v238, v142, v238
M16 v[112:115],a[196:199],a[164:167],v[112:115]
EXP v48,v48
M16 v[112:115],a[200:203],a[168:171],v[112:115]
s_waitcnt vmcnt(8)
EXP v49,v49
M16 v[112:115],a[204:207],a[172:175],v[112:115]
s_barrier
EXP v50,v50
M16 v[128:131],a[192:195],a[176:179],v[220:223]
DR a[244:247],v4 offset:13312
v_add_f32 v239, v143, v239
M16 v[128:131],a[196:199],a[180:183],v[128:131]
s_add_u32 m0, s26, s30
EXP v51,v51
M16 v[128:131],a[200:203],a[184:187],v[128:131]
DR a[248:251],v4 offset:14336
CVT v207,v142,v143
M16 v[128:131],a[204:207],a[188:191],v[128:131]
s_waitcnt lgkmcnt(7)
EXP v52,v52
M16 v[116:119],a[208:211],a[160:163],v[216:219]
DR a[252:255],v4 offset:15360
CVT v160,v48,v49
M16 v[116:119],a[212:215],a[164:167],v[116:119]
DR a[192:195],v5 offset:0
CVT v161,v50,v51
M16 v[116:119],a[216:219],a[168:171],v[116:119]
s_add_u32 s28, s28, 16384
EXP v53,v53
M16 v[116:119],a[220:223],a[172:175],v[116:119]
DR a[196:199],v5 offset:1024
CVT v162,v52,v53
M16 v[132:135],a[208:211],a[176:179],v[220:223]
s_and_b32 s28, s28, 0xffff
EXP v54,v54
M16 v[132:135],a[212:215],a[180:183],v[132:135]
DR a[200:203],v5 offset:2048
v_add_u32 v4, s28, v2
M16 v[132:135],a[216:219],a[184:187],v[132:135]
s_waitcnt lgkmcnt(7)
EXP v55,v55
M16 v[132:135],a[220:223],a[188:191],v[132:135]
DR a[204:207],v5 offset:3072
CVT v163,v54,v55
M16 v[120:123],a[224:227],a[160:163],v[216:219]
DR a[208:211],v5 offset:4096
M16 v[120:123],a[228:231],a[164:167],v[120:123]
BL4 v3,s[8:11],s24 offen lds
M16 v[120:123],a[232:235],a[168:171],v[120:123]
DR a[212:215],v5 offset:5120
M16 v[120:123],a[236:239],a[172:175],v[120:123]
EXP v56,v56
M16 v[136:139],a[224:227],a[176:179],v[220:223]
DR a[216:219],v5 offset:6144
M16 v[136:139],a[228:231],a[180:183],v[136:139]
s_waitcnt lgkmcnt(7)
EXP v57,v57
M16 v[136:139],a[232:235],a[184:187],v[136:139]
DR a[220:223],v5 offset:7168
CVT v164,v56,v57
M16 v[136:139],a[236:239],a[188:191],v[136:139]
DR a[224:227],v5 offset:8192
M16 v[124:127],a[240:243],a[160:163],v[216:219]
BL4 v3,s[8:11],s24 offen offset:1024 lds
M16 v[124:127],a[244:247],a[164:167],v[124:127]
DR a[228:231],v5 offset:9216
M16 v[124:127],a[248:251],a[168:171],v[124:127]
EXP v58,v58
M16 v[124:127],a[252:255],a[172:175],v[124:127]
DR a[232:235],v5 offset:10240
M16 v[140:143],a[240:243],a[176:179],v[220:223]
EXP v59,v59
M16 v[140:143],a[244:247],a[180:183],v[140:143]
DR a[236:239],v5 offset:11264
CVT v165,v58,v59
M16 v[140:143],a[248:251],a[184:187],v[140:143]
s_waitcnt lgkmcnt(8)
EXP v60,v60
M16 v[140:143],a[252:255],a[188:191],v[140:143]
DR a[240:243],v5 offset:12288
M16 a[32:35],a[192:195],v[184:187],a[32:35]
BL4 v3,s[8:11],s24 offen offset:2048 lds
M16 a[32:35],a[196:199],v[188:191],a[32:35]
DR a[244:247],v5 offset:13312
M16 a[64:67],a[192:195],v[192:195],a[64:67]
EXP v61,v61
M16 a[64:67],a[196:199],v[196:199],a[64:67]
DR a[248:251],v5 offset:14336
CVT v166,v60,v61
M16 a[96:99],a[192:195],v[200:203],a[96:99]
EXP v62,v62
M16 a[96:99],a[196:199],v[204:207],a[96:99]
DR a[252:255],v5 offset:15360
M16 a[36:39],a[200:203],v[184:187],a[36:39]
s_add_u32 s29, s29, 16384
EXP v63,v63
M16 a[36:39],a[204:207],v[188:191],a[36:39]
s_and_b32 s29, s29, 0xffff
EXP v64,v64
M16 a[68:71],a[200:203],v[192:195],a[68:71]
BL4 v3,s[8:11],s24 offen offset:3072 lds
v_add_u32 v5, s29, v7
M16 a[68:71],a[204:207],v[196:199],a[68:71]
s_add_u32 s24, s24, 32768
EXP v65,v65
M16 a[100:103],a[200:203],v[200:203],a[100:103]
s_waitcnt lgkmcnt(8)
CVT v167,v62,v63
CVT v168,v64,v65
M16 a[100:103],a[204:207],v[204:207],a[100:103]
DR a[192:195],v4 offset:0
M16 a[40:43],a[208:211],v[184:187],a[40:43]
s_add_u32 s26, s26, 16384
EXP v66,v66
M16 a[40:43],a[212:215],v[188:191],a[40:43]
DR a[196:199],v4 offset:1024
M16 a[72:75],a[208:211],v[192:195],a[72:75]
s_and_b32 s26, s26, 0xffff
EXP v67,v67
M16 a[72:75],a[212:215],v[196:199],a[72:75]
DR a[200:203],v4 offset:2048
CVT v169,v66,v67
M16 a[104:107],a[208:211],v[200:203],a[104:107]
s_add_u32 m0, s27, s31
EXP v68,v68
M16 a[104:107],a[212:215],v[204:207],a[104:107]
DR a[204:207],v4 offset:3072
M16 a[44:47],a[216:219],v[184:187],a[44:47]
BL4 v3,s[8:11],s25 offen lds
M16 a[44:47],a[220:223],v[188:191],a[44:47]
EXP v69,v69
M16 a[76:79],a[216:219],v[192:195],a[76:79]
EXP v70,v70
M16 a[76:79],a[220:223],v[196:199],a[76:79]
EXP v71,v71
M16 a[108:111],a[216:219],v[200:203],a[108:111]
s_waitcnt lgkmcnt(8)
CVT v170,v68,v69
CVT v171,v70,v71
M16 a[108:111],a[220:223],v[204:207],a[108:111]
DR a[208:211],v4 offset:4096
M16 a[48:51],a[224:227],v[184:187],a[48:51]
BL4 v3,s[8:11],s25 offen offset:1024 lds
M16 a[48:51],a[228:231],v[188:191],a[48:51]
DR a[212:215],v4 offset:5120
M16 a[80:83],a[224:227],v[192:195],a[80:83]
EXP v72,v72
M16 a[80:83],a[228:231],v[196:199],a[80:83]
DR a[216:219],v4 offset:6144
M16 a[112:115],a[224:227],v[200:203],a[112:115]
EXP v73,v73
M16 a[112:115],a[228:231],v[204:207],a[112:115]
DR a[220:223],v4 offset:7168
CVT v172,v72,v73
M16 a[52:55],a[232:235],v[184:187],a[52:55]
BL4 v3,s[8:11],s25 offen offset:2048 lds
M16 a[52:55],a[236:239],v[188:191],a[52:55]
EXP v74,v74
M16 a[84:87],a[232:235],v[192:195],a[84:87]
EXP v75,v75
M16 a[84:87],a[236:239],v[196:199],a[84:87]
EXP v76,v76
M16 a[116:119],a[232:235],v[200:203],a[116:119]
s_waitcnt lgkmcnt(8)
EXP v77,v77
M16 a[116:119],a[236:239],v[204:207],a[116:119]
DR a[224:227],v4 offset:8192
CVT v173,v74,v75
M16 a[56:59],a[240:243],v[184:187],a[56:59]
BL4 v3,s[8:11],s25 offen offset:3072 lds
M16 a[56:59],a[244:247],v[188:191],a[56:59]
DR a[228:231],v4 offset:9216
M16 a[88:91],a[240:243],v[192:195],a[88:91]
s_add_u32 s25, s25, 32768
EXP v78,v78
M16 a[88:91],a[244:247],v[196:199],a[88:91]
DR a[232:235],v4 offset:10240
M16 a[120:123],a[240:243],v[200:203],a[120:123]
s_add_u32 s27, s27, 16384
EXP v79,v79
M16 a[120:123],a[244:247],v[204:207],a[120:123]
DR a[236:239],v4 offset:11264
M16 a[60:63],a[248:251],v[184:187],a[60:63]
s_and_b32 s27, s27, 0xffff
M16 a[60:63],a[252:255],v[188:191],a[60:63]
M16 a[92:95],a[248:251],v[192:195],a[92:95]
M16 a[92:95],a[252:255],v[196:199],a[92:95]
M16 a[124:127],a[248:251],v[200:203],a[124:127]
M16 a[124:127],a[252:255],v[204:207],a[124:127]
s_waitcnt lgkmcnt(8)
L_a_e01:
s_mul_i32 s76, s22, 1212416
s_lshl_b32 s13, s21, 14
s_add_u32 s76, s76, s13
s_add_u32 s76, s76, 83886080
s_lshl_b32 s13, s20, 10
v_add_u32 v8, s13, v2
v_add_u32 v9, 8192, v8
s_mov_b32 s77, 0x5d800000
s_mov_b32 s78, 0x207
s_and_b32 s12, s20, 3
v_lshrrev_b32 v148, 2, v1
v_mul_u32_u24 v148, 160, v148
v_and_b32 v149, 3, v1
v_lshl_add_u32 v148, v149, 3, v148
s_mul_i32 s12, s12, 5120
s_add_u32 s12, s12, 131072
v_add_u32 v148, s12, v148
v_add_u32 v149, 4096, v2
DTR v[176:177],v148 offset:0
DTR v[178:179],v148 offset:2560
DTR v[180:181],v148 offset:32
DTR v[182:183],v148 offset:2592
DTR v[184:185],v148 offset:64
DTR v[186:187],v148 offset:2624
DTR v[188:189],v148 offset:96
DTR v[190:191],v148 offset:2656
DTR v[144:145],v148 offset:128
DTR v[146:147],v148 offset:2688
v_add_f32 v228, v228, v229
v_add_f32 v230, v230, v231
v_add_f32 v228, v228, v230
v_mov_b32 v229, v228
s_nop 1
v_permlane16_swap_b32 v228, v229
s_nop 1
v_add_f32 v228, v228, v229
v_mov_b32 v229, v228
s_nop 1
v_permlane32_swap_b32 v228, v229
s_nop 1
v_add_f32 v228, v228, v229
v_rcp_f32 v230, v228
s_nop 0
v_mov_b32 v231, v230
v_rcp_f32 v226, v224
s_nop 0
v_mov_b32 v227, v226
s_waitcnt lgkmcnt(0)
AR v16,a0
AR v17,a1
AR v18,a2
AR v19,a3
AR v20,a4
AR v21,a5
AR v22,a6
AR v23,a7
v_pk_mul_f32 v[16:17], v[16:17], v[226:227]
v_pk_mul_f32 v[18:19], v[18:19], v[226:227]
v_pk_mul_f32 v[20:21], v[20:21], v[226:227]
v_pk_mul_f32 v[22:23], v[22:23], v[226:227]
CVT v80,v16,v17
CVT v81,v18,v19
CVT v82,v20,v21
CVT v83,v22,v23
v_pk_add_f32 v[16:17], v[16:17], v[18:19]
v_pk_add_f32 v[20:21], v[20:21], v[22:23]
v_pk_add_f32 v[10:11], v[16:17], v[20:21]
BS4 v[176:179],v2,s[8:11],s0 offen sc1
AR v24,a8
AR v25,a9
AR v26,a10
AR v27,a11
AR v28,a12
AR v29,a13
AR v30,a14
AR v31,a15
v_pk_mul_f32 v[24:25], v[24:25], v[226:227]
v_pk_mul_f32 v[26:27], v[26:27], v[226:227]
v_pk_mul_f32 v[28:29], v[28:29], v[226:227]
v_pk_mul_f32 v[30:31], v[30:31], v[226:227]
CVT v84,v24,v25
CVT v85,v26,v27
CVT v86,v28,v29
CVT v87,v30,v31
v_pk_add_f32 v[24:25], v[24:25], v[26:27]
v_pk_add_f32 v[28:29], v[28:29], v[30:31]
v_pk_add_f32 v[10:11], v[10:11], v[24:25]
v_pk_add_f32 v[10:11], v[10:11], v[28:29]
BS4 v[180:183],v2,s[8:11],s0 offen offset:1024 sc1
AR v32,a16
AR v33,a17
AR v34,a18
AR v35,a19
AR v36,a20
AR v37,a21
AR v38,a22
AR v39,a23
v_pk_mul_f32 v[32:33], v[32:33], v[226:227]
v_pk_mul_f32 v[34:35], v[34:35], v[226:227]
v_pk_mul_f32 v[36:37], v[36:37], v[226:227]
v_pk_mul_f32 v[38:39], v[38:39], v[226:227]
CVT v88,v32,v33
CVT v89,v34,v35
CVT v90,v36,v37
CVT v91,v38,v39
v_pk_add_f32 v[32:33], v[32:33], v[34:35]
v_pk_add_f32 v[36:37], v[36:37], v[38:39]
v_pk_add_f32 v[10:11], v[10:11], v[32:33]
v_pk_add_f32 v[10:11], v[10:11], v[36:37]
BS4 v[184:187],v2,s[8:11],s0 offen offset:2048 sc1
BS4 v[188:191],v2,s[8:11],s0 offen offset:3072 sc1
AR v40,a24
AR v41,a25
AR v42,a26
AR v43,a27
AR v44,a28
AR v45,a29
AR v46,a30
AR v47,a31
v_pk_mul_f32 v[40:41], v[40:41], v[226:227]
v_pk_mul_f32 v[42:43], v[42:43], v[226:227]
v_pk_mul_f32 v[44:45], v[44:45], v[226:227]
v_pk_mul_f32 v[46:47], v[46:47], v[226:227]
CVT v92,v40,v41
CVT v93,v42,v43
CVT v94,v44,v45
CVT v95,v46,v47
v_pk_add_f32 v[40:41], v[40:41], v[42:43]
v_pk_add_f32 v[44:45], v[44:45], v[46:47]
v_pk_add_f32 v[10:11], v[10:11], v[40:41]
v_pk_add_f32 v[10:11], v[10:11], v[44:45]
BS4 v[144:147],v149,s[8:11],s0 offen sc1
v_add_f32 v10, v10, v11
v_cmp_nge_f32 s[12:13], s77, v224
v_cmp_class_f32 s[14:15], v10, s78
s_nop 1
s_or_b64 vcc, s[12:13], s[14:15]
s_cbranch_vccnz L_a_slow0
L_a_ok0:
s_and_b32 s12, s20, 1
v_lshrrev_b32 v148, 2, v1
v_mul_u32_u24 v148, 160, v148
v_and_b32 v149, 3, v1
v_lshl_add_u32 v148, v149, 3, v148
s_mul_i32 s12, s12, 5120
s_add_u32 s12, s12, 131072
v_add_u32 v148, s12, v148
v_add_u32 v149, 4096, v2
DTR v[176:177],v148 offset:20480
DTR v[178:179],v148 offset:23040
DTR v[180:181],v148 offset:20512
DTR v[182:183],v148 offset:23072
DTR v[184:185],v148 offset:20544
DTR v[186:187],v148 offset:23104
DTR v[188:189],v148 offset:20576
DTR v[190:191],v148 offset:23136
DTR v[144:145],v148 offset:20608
DTR v[146:147],v148 offset:23168
AR v16,a32
AR v17,a33
AR v18,a34
AR v19,a35
AR v20,a36
AR v21,a37
AR v22,a38
AR v23,a39
v_pk_mul_f32 v[16:17], v[16:17], v[230:231]
v_pk_mul_f32 v[18:19], v[18:19], v[230:231]
v_pk_mul_f32 v[20:21], v[20:21], v[230:231]
v_pk_mul_f32 v[22:23], v[22:23], v[230:231]
CVT v96,v16,v17
CVT v97,v18,v19
CVT v98,v20,v21
CVT v99,v22,v23
v_pk_add_f32 v[16:17], v[16:17], v[18:19]
v_pk_add_f32 v[20:21], v[20:21], v[22:23]
v_pk_add_f32 v[10:11], v[16:17], v[20:21]
BS4 v[80:83],v8,s[8:11],s76 offen sc1
s_add_u32 s76, s76, 4096
AR v24,a40
AR v25,a41
AR v26,a42
AR v27,a43
AR v28,a44
AR v29,a45
AR v30,a46
AR v31,a47
v_pk_mul_f32 v[24:25], v[24:25], v[230:231]
v_pk_mul_f32 v[26:27], v[26:27], v[230:231]
v_pk_mul_f32 v[28:29], v[28:29], v[230:231]
v_pk_mul_f32 v[30:31], v[30:31], v[230:231]
CVT v100,v24,v25
CVT v101,v26,v27
CVT v102,v28,v29
CVT v103,v30,v31
v_pk_add_f32 v[24:25], v[24:25], v[26:27]
v_pk_add_f32 v[28:29], v[28:29], v[30:31]
v_pk_add_f32 v[10:11], v[10:11], v[24:25]
v_pk_add_f32 v[10:11], v[10:11], v[28:29]
BS4 v[84:87],v8,s[8:11],s76 offen sc1
s_sub_u32 s76, s76, 4096
s_waitcnt lgkmcnt(0)
BS4 v[176:179],v2,s[8:11],s1 offen sc1
AR v32,a48
AR v33,a49
AR v34,a50
AR v35,a51
AR v36,a52
AR v37,a53
AR v38,a54
AR v39,a55
v_pk_mul_f32 v[32:33], v[32:33], v[230:231]
v_pk_mul_f32 v[34:35], v[34:35], v[230:231]
v_pk_mul_f32 v[36:37], v[36:37], v[230:231]
v_pk_mul_f32 v[38:39], v[38:39], v[230:231]
CVT v104,v32,v33
CVT v105,v34,v35
CVT v106,v36,v37
CVT v107,v38,v39
v_pk_add_f32 v[32:33], v[32:33], v[34:35]
v_pk_add_f32 v[36:37], v[36:37], v[38:39]
v_pk_add_f32 v[10:11], v[10:11], v[32:33]
v_pk_add_f32 v[10:11], v[10:11], v[36:37]
BS4 v[88:91],v9,s[8:11],s76 offen sc1
s_add_u32 s76, s76, 4096
BS4 v[180:183],v2,s[8:11],s1 offen offset:1024 sc1
BS4 v[184:187],v2,s[8:11],s1 offen offset:2048 sc1
AR v40,a56
AR v41,a57
AR v42,a58
AR v43,a59
AR v44,a60
AR v45,a61
AR v46,a62
AR v47,a63
v_pk_mul_f32 v[40:41], v[40:41], v[230:231]
v_pk_mul_f32 v[42:43], v[42:43], v[230:231]
v_pk_mul_f32 v[44:45], v[44:45], v[230:231]
v_pk_mul_f32 v[46:47], v[46:47], v[230:231]
CVT v108,v40,v41
CVT v109,v42,v43
CVT v110,v44,v45
CVT v111,v46,v47
v_pk_add_f32 v[40:41], v[40:41], v[42:43]
v_pk_add_f32 v[44:45], v[44:45], v[46:47]
v_pk_add_f32 v[10:11], v[10:11], v[40:41]
v_pk_add_f32 v[10:11], v[10:11], v[44:45]
BS4 v[92:95],v9,s[8:11],s76 offen sc1
s_add_u32 s76, s76, 602112
BS4 v[188:191],v2,s[8:11],s1 offen offset:3072 sc1
BS4 v[144:147],v149,s[8:11],s1 offen sc1
v_add_f32 v10, v10, v11
v_cmp_nge_f32 s[12:13], s77, v228
v_cmp_class_f32 s[14:15], v10, s78
s_nop 1
s_or_b64 vcc, s[12:13], s[14:15]
s_cbranch_vccnz L_a_slow1
L_a_ok1:
BS4 v[96:99],v8,s[8:11],s76 offen sc1
s_add_u32 s76, s76, 4096
BS4 v[100:103],v8,s[8:11],s76 offen sc1
s_sub_u32 s76, s76, 4096
s_mov_b32 s97, 64
v_mov_b32 v44, 0x3f803f80
v_mov_b32 v45, 0x3f803f80
v_mov_b32 v46, 0x3f803f80
v_mov_b32 v47, 0x3f803f80
v_mov_b32 v224, 0
v_mov_b32 v225, 0
v_mov_b32 v226, 0
v_mov_b32 v227, 0
v_mov_b32 v228, 0
v_mov_b32 v229, 0
v_mov_b32 v230, 0
v_mov_b32 v231, 0
s_and_b32 s14, s2, 3
s_lshl_b32 s14, s14, 3
s_bfe_u32 s15, s2, 0x30003
s_add_u32 s64, s14, s15
s_bfe_u32 s14, s2, 0x10002
s_lshl_b32 s14, s14, 2
s_lshr_b32 s15, s2, 6
s_add_u32 s65, s14, s15
s_lshl_b32 s66, s64, 3
s_add_u32 s66, s66, s65
s_lshl_b32 s66, s66, 3
s_add_u32 s66, s66, s20
s_mul_i32 s67, s66, 1280
s_add_u32 s67, s67, 67108864
v_and_b32 v12, 31, v1
v_lshrrev_b32 v14, 5, v1
v_mul_u32_u24 v12, 5, v12
v_lshl_add_u32 v12, v14, 1, v12
v_lshlrev_b32 v12, 3, v12
v_lshlrev_b32 v14, 3, v1
s_lshl_b32 s68, s20, 14
s_add_u32 s68, s68, 71303168
s_lshl_b32 s69, s20, 13
s_add_u32 s69, s69, 71827456
s_lshl_b32 s70, s20, 15
s_add_u32 s70, s70, 72351744
s_mov_b32 s72, 0xfffff
s_mov_b32 s73, 0xfffff
BS4 v[104:107],v9,s[8:11],s76 offen sc1
s_add_u32 s76, s76, 4096
BS4 v[108:111],v9,s[8:11],s76 offen sc1
s_add_u32 s76, s76, 602112
s_lshl_b32 s12, s22, 2
s_sub_u32 s12, 28, s12
s_mul_i32 s12, s12, 606208
s_add_u32 s76, s76, s12
s_cmp_eq_u32 s22, 7
s_cbranch_scc1 L_a_tail
L_a_loop2:
M16 v[48:51],a[192:195],a[160:163],v[216:219]
DR a[240:243],v4 offset:12288
CVT v174,v76,v77
M16 v[48:51],a[196:199],a[164:167],v[48:51]
EXP v112,v112
M16 v[48:51],a[200:203],a[168:171],v[48:51]
s_waitcnt vmcnt(8)
EXP v113,v113
M16 v[48:51],a[204:207],a[172:175],v[48:51]
s_barrier
EXP v114,v114
M16 v[64:67],a[192:195],a[176:179],v[220:223]
DR a[244:247],v4 offset:13312
CVT v175,v78,v79
M16 v[64:67],a[196:199],a[180:183],v[64:67]
s_add_u32 m0, s26, s30
EXP v115,v115
M16 v[64:67],a[200:203],a[184:187],v[64:67]
DR a[248:251],v4 offset:14336
CVT v192,v112,v113
M16 v[64:67],a[204:207],a[188:191],v[64:67]
s_waitcnt lgkmcnt(7)
EXP v116,v116
M16 v[52:55],a[208:211],a[160:163],v[216:219]
DR a[252:255],v4 offset:15360
EXP v117,v117
M16 v[52:55],a[212:215],a[164:167],v[52:55]
DR a[192:195],v5 offset:0
CVT v193,v114,v115
M16 v[52:55],a[216:219],a[168:171],v[52:55]
s_add_u32 s28, s28, 16384
EXP v118,v118
M16 v[52:55],a[220:223],a[172:175],v[52:55]
DR a[196:199],v5 offset:1024
CVT v194,v116,v117
M16 v[68:71],a[208:211],a[176:179],v[220:223]
s_and_b32 s28, s28, 0xffff
EXP v119,v119
M16 v[68:71],a[212:215],a[180:183],v[68:71]
DR a[200:203],v5 offset:2048
v_add_u32 v4, s28, v2
M16 v[68:71],a[216:219],a[184:187],v[68:71]
s_waitcnt lgkmcnt(7)
EXP v120,v120
M16 v[68:71],a[220:223],a[188:191],v[68:71]
DR a[204:207],v5 offset:3072
CVT v195,v118,v119
M16 v[56:59],a[224:227],a[160:163],v[216:219]
DR a[208:211],v5 offset:4096
M16 v[56:59],a[228:231],a[164:167],v[56:59]
BL4 v3,s[8:11],s24 offen lds
M16 v[56:59],a[232:235],a[168:171],v[56:59]
DR a[212:215],v5 offset:5120
M16 v[56:59],a[236:239],a[172:175],v[56:59]
EXP v121,v121
M16 v[72:75],a[224:227],a[176:179],v[220:223]
DR a[216:219],v5 offset:6144
EXP v122,v122
M16 v[72:75],a[228:231],a[180:183],v[72:75]
s_waitcnt lgkmcnt(7)
EXP v123,v123
M16 v[72:75],a[232:235],a[184:187],v[72:75]
DR a[220:223],v5 offset:7168
CVT v196,v120,v121
M16 v[72:75],a[236:239],a[188:191],v[72:75]
DR a[224:227],v5 offset:8192
CVT v197,v122,v123
M16 v[60:63],a[240:243],a[160:163],v[216:219]
BL4 v3,s[8:11],s24 offen offset:1024 lds
M16 v[60:63],a[244:247],a[164:167],v[60:63]
DR a[228:231],v5 offset:9216
M16 v[60:63],a[248:251],a[168:171],v[60:63]
EXP v124,v124
M16 v[60:63],a[252:255],a[172:175],v[60:63]
DR a[232:235],v5 offset:10240
M16 v[76:79],a[240:243],a[176:179],v[220:223]
EXP v125,v125
M16 v[76:79],a[244:247],a[180:183],v[76:79]
DR a[236:239],v5 offset:11264
CVT v198,v124,v125
M16 v[76:79],a[248:251],a[184:187],v[76:79]
s_waitcnt lgkmcnt(8)
EXP v126,v126
M16 v[76:79],a[252:255],a[188:191],v[76:79]
DR a[240:243],v5 offset:12288
M16 a[64:67],a[192:195],v[160:163],a[64:67]
BL4 v3,s[8:11],s24 offen offset:2048 lds
M16 a[64:67],a[196:199],v[164:167],a[64:67]
DR a[244:247],v5 offset:13312
EXP v127,v127
M16 a[96:99],a[192:195],v[168:171],a[96:99]
EXP v128,v128
M16 a[96:99],a[196:199],v[172:175],a[96:99]
DR a[248:251],v5 offset:14336
CVT v199,v126,v127
M16 a[68:71],a[200:203],v[160:163],a[68:71]
EXP v129,v129
M16 a[68:71],a[204:207],v[164:167],a[68:71]
DR a[252:255],v5 offset:15360
CVT v200,v128,v129
M16 a[100:103],a[200:203],v[168:171],a[100:103]
s_add_u32 s29, s29, 16384
EXP v130,v130
M16 a[100:103],a[204:207],v[172:175],a[100:103]
s_and_b32 s29, s29, 0xffff
EXP v131,v131
M16 v[224:227],v[44:47],v[160:163],v[224:227]
s_waitcnt lgkmcnt(8)
v_add_u32 v5, s29, v7
CVT v201,v130,v131
M16 v[224:227],v[44:47],v[164:167],v[224:227]
DR a[192:195],v4 offset:0
M16 a[72:75],a[208:211],v[160:163],a[72:75]
BL4 v3,s[8:11],s24 offen offset:3072 lds
M16 a[72:75],a[212:215],v[164:167],a[72:75]
DR a[196:199],v4 offset:1024
M16 a[104:107],a[208:211],v[168:171],a[104:107]
s_add_u32 s24, s24, 32768
EXP v132,v132
M16 a[104:107],a[212:215],v[172:175],a[104:107]
DR a[200:203],v4 offset:2048
EXP v133,v133
M16 a[76:79],a[216:219],v[160:163],a[76:79]
s_add_u32 s26, s26, 16384
EXP v134,v134
M16 a[76:79],a[220:223],v[164:167],a[76:79]
DR a[204:207],v4 offset:3072
CVT v202,v132,v133
M16 a[108:111],a[216:219],v[168:171],a[108:111]
s_waitcnt lgkmcnt(8)
EXP v135,v135
M16 a[108:111],a[220:223],v[172:175],a[108:111]
DR a[208:211],v4 offset:4096
CVT v203,v134,v135
M16 a[80:83],a[224:227],v[160:163],a[80:83]
s_and_b32 s26, s26, 0xffff
EXP v136,v136
M16 a[80:83],a[228:231],v[164:167],a[80:83]
DR a[212:215],v4 offset:5120
M16 a[112:115],a[224:227],v[168:171],a[112:115]
s_add_u32 m0, s27, s31
EXP v137,v137
M16 a[112:115],a[228:231],v[172:175],a[112:115]
DR a[216:219],v4 offset:6144
CVT v204,v136,v137
M16 a[84:87],a[232:235],v[160:163],a[84:87]
BL4 v3,s[8:11],s25 offen lds
M16 a[84:87],a[236:239],v[164:167],a[84:87]
DR a[220:223],v4 offset:7168
M16 a[116:119],a[232:235],v[168:171],a[116:119]
EXP v138,v138
M16 a[116:119],a[236:239],v[172:175],a[116:119]
EXP v139,v139
M16 v[228:231],v[44:47],v[168:171],v[228:231]
s_waitcnt lgkmcnt(8)
EXP v140,v140
M16 v[228:231],v[44:47],v[172:175],v[228:231]
DR a[224:227],v4 offset:8192
EXP v141,v141
M16 a[88:91],a[240:243],v[160:163],a[88:91]
BL4 v3,s[8:11],s25 offen offset:1024 lds
M16 a[88:91],a[244:247],v[164:167],a[88:91]
DR a[228:231],v4 offset:9216
CVT v205,v138,v139
M16 a[120:123],a[240:243],v[168:171],a[120:123]
EXP v142,v142
M16 a[120:123],a[244:247],v[172:175],a[120:123]
DR a[232:235],v4 offset:10240
M16 a[92:95],a[248:251],v[160:163],a[92:95]
EXP v143,v143
M16 a[92:95],a[252:255],v[164:167],a[92:95]
DR a[236:239],v4 offset:11264
M16 a[124:127],a[248:251],v[168:171],a[124:127]
BL4 v3,s[8:11],s25 offen offset:2048 lds
M16 a[124:127],a[252:255],v[172:175],a[124:127]
BL4 v3,s[8:11],s25 offen offset:3072 lds
s_add_u32 s25, s25, 32768
s_add_u32 s27, s27, 16384
s_and_b32 s27, s27, 0xffff
s_waitcnt lgkmcnt(8)
M16 v[112:115],a[192:195],a[160:163],v[216:219]
DR a[240:243],v4 offset:12288
CVT v206,v140,v141
M16 v[112:115],a[196:199],a[164:167],v[112:115]
EXP v48,v48
M16 v[112:115],a[200:203],a[168:171],v[112:115]
s_waitcnt vmcnt(8)
EXP v49,v49
M16 v[112:115],a[204:207],a[172:175],v[112:115]
s_barrier
EXP v50,v50
M16 v[128:131],a[192:195],a[176:179],v[220:223]
DR a[244:247],v4 offset:13312
CVT v207,v142,v143
M16 v[128:131],a[196:199],a[180:183],v[128:131]
s_add_u32 m0, s26, s30
EXP v51,v51
M16 v[128:131],a[200:203],a[184:187],v[128:131]
DR a[248:251],v4 offset:14336
CVT v160,v48,v49
M16 v[128:131],a[204:207],a[188:191],v[128:131]
s_waitcnt lgkmcnt(7)
EXP v52,v52
M16 v[116:119],a[208:211],a[160:163],v[216:219]
DR a[252:255],v4 offset:15360
EXP v53,v53
M16 v[116:119],a[212:215],a[164:167],v[116:119]
DR a[192:195],v5 offset:0
CVT v161,v50,v51
M16 v[116:119],a[216:219],a[168:171],v[116:119]
s_add_u32 s28, s28, 16384
EXP v54,v54
M16 v[116:119],a[220:223],a[172:175],v[116:119]
DR a[196:199],v5 offset:1024
CVT v162,v52,v53
M16 v[132:135],a[208:211],a[176:179],v[220:223]
s_and_b32 s28, s28, 0xffff
EXP v55,v55
M16 v[132:135],a[212:215],a[180:183],v[132:135]
DR a[200:203],v5 offset:2048
v_add_u32 v4, s28, v2
M16 v[132:135],a[216:219],a[184:187],v[132:135]
s_waitcnt lgkmcnt(7)
EXP v56,v56
M16 v[132:135],a[220:223],a[188:191],v[132:135]
DR a[204:207],v5 offset:3072
CVT v163,v54,v55
M16 v[120:123],a[224:227],a[160:163],v[216:219]
DR a[208:211],v5 offset:4096
M16 v[120:123],a[228:231],a[164:167],v[120:123]
BL4 v3,s[8:11],s24 offen lds
M16 v[120:123],a[232:235],a[168:171],v[120:123]
DR a[212:215],v5 offset:5120
M16 v[120:123],a[236:239],a[172:175],v[120:123]
EXP v57,v57
M16 v[136:139],a[224:227],a[176:179],v[220:223]
DR a[216:219],v5 offset:6144
EXP v58,v58
M16 v[136:139],a[228:231],a[180:183],v[136:139]
s_waitcnt lgkmcnt(7)
EXP v59,v59
M16 v[136:139],a[232:235],a[184:187],v[136:139]
DR a[220:223],v5 offset:7168
CVT v164,v56,v57
M16 v[136:139],a[236:239],a[188:191],v[136:139]
DR a[224:227],v5 offset:8192
CVT v165,v58,v59
M16 v[124:127],a[240:243],a[160:163],v[216:219]
BL4 v3,s[8:11],s24 offen offset:1024 lds
M16 v[124:127],a[244:247],a[164:167],v[124:127]
DR a[228:231],v5 offset:9216
M16 v[124:127],a[248:251],a[168:171],v[124:127]
EXP v60,v60
M16 v[124:127],a[252:255],a[172:175],v[124:127]
DR a[232:235],v5 offset:10240
M16 v[140:143],a[240:243],a[176:179],v[220:223]
EXP v61,v61
M16 v[140:143],a[244:247],a[180:183],v[140:143]
DR a[236:239],v5 offset:11264
CVT v166,v60,v61
M16 v[140:143],a[248:251],a[184:187],v[140:143]
s_waitcnt lgkmcnt(8)
EXP v62,v62
M16 v[140:143],a[252:255],a[188:191],v[140:143]
DR a[240:243],v5 offset:12288
M16 a[64:67],a[192:195],v[192:195],a[64:67]
BL4 v3,s[8:11],s24 offen offset:2048 lds
M16 a[64:67],a[196:199],v[196:199],a[64:67]
DR a[244:247],v5 offset:13312
EXP v63,v63
M16 a[96:99],a[192:195],v[200:203],a[96:99]
EXP v64,v64
M16 a[96:99],a[196:199],v[204:207],a[96:99]
DR a[248:251],v5 offset:14336
CVT v167,v62,v63
M16 a[68:71],a[200:203],v[192:195],a[68:71]
EXP v65,v65
M16 a[68:71],a[204:207],v[196:199],a[68:71]
DR a[252:255],v5 offset:15360
CVT v168,v64,v65
M16 a[100:103],a[200:203],v[200:203],a[100:103]
s_add_u32 s29, s29, 16384
EXP v66,v66
M16 a[100:103],a[204:207],v[204:207],a[100:103]
s_and_b32 s29, s29, 0xffff
EXP v67,v67
M16 v[224:227],v[44:47],v[192:195],v[224:227]
s_waitcnt lgkmcnt(8)
v_add_u32 v5, s29, v7
CVT v169,v66,v67
M16 v[224:227],v[44:47],v[196:199],v[224:227]
DR a[192:195],v4 offset:0
M16 a[72:75],a[208:211],v[192:195],a[72:75]
BL4 v3,s[8:11],s24 offen offset:3072 lds
M16 a[72:75],a[212:215],v[196:199],a[72:75]
DR a[196:199],v4 offset:1024
M16 a[104:107],a[208:211],v[200:203],a[104:107]
s_add_u32 s24, s24, 32768
EXP v68,v68
M16 a[104:107],a[212:215],v[204:207],a[104:107]
DR a[200:203],v4 offset:2048
EXP v69,v69
M16 a[76:79],a[216:219],v[192:195],a[76:79]
s_add_u32 s26, s26, 16384
EXP v70,v70
M16 a[76:79],a[220:223],v[196:199],a[76:79]
DR a[204:207],v4 offset:3072
CVT v170,v68,v69
M16 a[108:111],a[216:219],v[200:203],a[108:111]
s_waitcnt lgkmcnt(8)
EXP v71,v71
M16 a[108:111],a[220:223],v[204:207],a[108:111]
DR a[208:211],v4 offset:4096
CVT v171,v70,v71
M16 a[80:83],a[224:227],v[192:195],a[80:83]
s_and_b32 s26, s26, 0xffff
EXP v72,v72
M16 a[80:83],a[228:231],v[196:199],a[80:83]
DR a[212:215],v4 offset:5120
M16 a[112:115],a[224:227],v[200:203],a[112:115]
s_add_u32 m0, s27, s31
EXP v73,v73
M16 a[112:115],a[228:231],v[204:207],a[112:115]
DR a[216:219],v4 offset:6144
CVT v172,v72,v73
M16 a[84:87],a[232:235],v[192:195],a[84:87]
BL4 v3,s[8:11],s25 offen lds
M16 a[84:87],a[236:239],v[196:199],a[84:87]
DR a[220:223],v4 offset:7168
M16 a[116:119],a[232:235],v[200:203],a[116:119]
EXP v74,v74
M16 a[116:119],a[236:239],v[204:207],a[116:119]
EXP v75,v75
M16 v[228:231],v[44:47],v[200:203],v[228:231]
s_waitcnt lgkmcnt(8)
EXP v76,v76
M16 v[228:231],v[44:47],v[204:207],v[228:231]
DR a[224:227],v4 offset:8192
EXP v77,v77
M16 a[88:91],a[240:243],v[192:195],a[88:91]
BL4 v3,s[8:11],s25 offen offset:1024 lds
M16 a[88:91],a[244:247],v[196:199],a[88:91]
DR a[228:231],v4 offset:9216
CVT v173,v74,v75
M16 a[120:123],a[240:243],v[200:203],a[120:123]
EXP v78,v78
M16 a[120:123],a[244:247],v[204:207],a[120:123]
DR a[232:235],v4 offset:10240
M16 a[92:95],a[248:251],v[192:195],a[92:95]
s_sub_u32 s23, s23, 1
EXP v79,v79
M16 a[92:95],a[252:255],v[196:199],a[92:95]
DR a[236:239],v4 offset:11264
M16 a[124:127],a[248:251],v[200:203],a[124:127]
BL4 v3,s[8:11],s25 offen offset:2048 lds
M16 a[124:127],a[252:255],v[204:207],a[124:127]
BL4 v3,s[8:11],s25 offen offset:3072 lds
s_add_u32 s25, s25, 32768
s_add_u32 s27, s27, 16384
s_and_b32 s27, s27, 0xffff
s_waitcnt lgkmcnt(8)
s_cmp_lg_u32 s23, 0
s_cbranch_scc1 L_a_loop2
v_cndmask_b32 v240, v6, v216, s[32:33]
v_cndmask_b32 v241, v6, v216, s[34:35]
v_cndmask_b32 v242, v6, v216, s[36:37]
v_cndmask_b32 v243, v6, v216, s[38:39]
v_cndmask_b32 v244, v6, v216, s[40:41]
v_cndmask_b32 v245, v6, v216, s[42:43]
v_cndmask_b32 v246, v6, v216, s[44:45]
v_cndmask_b32 v247, v6, v216, s[46:47]
v_cndmask_b32 v248, v6, v216, s[48:49]
v_cndmask_b32 v249, v6, v216, s[50:51]
v_cndmask_b32 v250, v6, v216, s[52:53]
v_cndmask_b32 v251, v6, v216, s[54:55]
v_cndmask_b32 v252, v6, v216, s[56:57]
v_cndmask_b32 v253, v6, v216, s[58:59]
v_cndmask_b32 v254, v6, v216, s[60:61]
v_cndmask_b32 v255, v6, v216, s[62:63]
s_nop 1
M16 v[48:51],a[192:195],a[160:163],v[240:243]
DR a[240:243],v4 offset:12288
CVT v174,v76,v77
M16 v[48:51],a[196:199],a[164:167],v[48:51]
EXP v112,v112
M16 v[48:51],a[200:203],a[168:171],v[48:51]
s_waitcnt vmcnt(8)
EXP v113,v113
M16 v[48:51],a[204:207],a[172:175],v[48:51]
s_barrier
s_lshr_b32 s98, s97, 31
s_or_b32 s98, s98, s20
s_cbranch_scc1 L_sg4
v_mov_b32 v10, s97
v_mov_b32 v11, 1
s_mov_b64 exec, 1
global_atomic_add v10, v11, s[88:89]
s_mov_b64 exec, -1
L_sg4:
s_mov_b32 s97, -1
s_lshr_b32 s12, s2, 3
s_lshl_b32 s12, s12, 2
s_add_u32 s12, s12, s20
v_min_u32 v10, 13, v1
s_mul_i32 s13, s12, 14
v_add_u32 v10, s13, v10
v_lshlrev_b32 v11, 7, v10
v_add_u32 v15, 458752, v11
v_add_u32 v13, 950272, v11
v_cmp_le_u32 vcc, 512, v10
s_nop 1
v_cndmask_b32 v11, v11, v15, vcc
v_cmp_le_u32 vcc, 768, v10
s_mov_b32 s14, 71303168
s_nop 0
v_cndmask_b32 v11, v11, v13, vcc
buffer_load_dword v13, v11, s[8:11], s14 offen
s_getpc_b64 s[16:17]
L_pc_4:
s_add_u32 s16, s16, L_p2_end-L_pc_4
s_addc_u32 s17, s17, 0-(((L_p2_end-L_pc_4)>>63)&1)
s_mul_i32 s18, s12, (((L_p3_end-L_p2_end)/128+128)/128)
v_min_u32 v10, (((L_p3_end-L_p2_end)/128+128)/128)-1, v1
v_add_u32 v10, s18, v10
v_min_u32 v10, (L_p3_end-L_p2_end)/128, v10
v_lshlrev_b32 v10, 7, v10
global_load_dword v13, v10, s[16:17]
M16 v[64:67],a[192:195],a[176:179],v[220:223]
DR a[244:247],v4 offset:13312
CVT v175,v78,v79
M16 v[64:67],a[196:199],a[180:183],v[64:67]
s_add_u32 m0, s27, s31
EXP v114,v114
M16 v[64:67],a[200:203],a[184:187],v[64:67]
DR a[248:251],v4 offset:14336
CVT v192,v112,v113
M16 v[64:67],a[204:207],a[188:191],v[64:67]
s_waitcnt lgkmcnt(7)
EXP v115,v115
M16 v[52:55],a[208:211],a[160:163],v[244:247]
DR a[252:255],v4 offset:15360
CVT v193,v114,v115
M16 v[52:55],a[212:215],a[164:167],v[52:55]
DR a[192:195],v5 offset:0
M16 v[52:55],a[216:219],a[168:171],v[52:55]
s_add_u32 s28, s28, 16384
EXP v116,v116
M16 v[52:55],a[220:223],a[172:175],v[52:55]
DR a[196:199],v5 offset:1024
M16 v[68:71],a[208:211],a[176:179],v[220:223]
s_and_b32 s28, s28, 0xffff
EXP v117,v117
M16 v[68:71],a[212:215],a[180:183],v[68:71]
DR a[200:203],v5 offset:2048
v_add_u32 v4, s28, v2
M16 v[68:71],a[216:219],a[184:187],v[68:71]
s_waitcnt lgkmcnt(7)
EXP v118,v118
M16 v[68:71],a[220:223],a[188:191],v[68:71]
DR a[204:207],v5 offset:3072
CVT v194,v116,v117
M16 v[56:59],a[224:227],a[160:163],v[248:251]
DR a[208:211],v5 offset:4096
M16 v[56:59],a[228:231],a[164:167],v[56:59]
BL4 v3,s[8:11],s25 offen lds
M16 v[56:59],a[232:235],a[168:171],v[56:59]
DR a[212:215],v5 offset:5120
EXP v119,v119
M16 v[56:59],a[236:239],a[172:175],v[56:59]
EXP v120,v120
M16 v[72:75],a[224:227],a[176:179],v[220:223]
DR a[216:219],v5 offset:6144
CVT v195,v118,v119
M16 v[72:75],a[228:231],a[180:183],v[72:75]
s_waitcnt lgkmcnt(7)
EXP v121,v121
M16 v[72:75],a[232:235],a[184:187],v[72:75]
DR a[220:223],v5 offset:7168
CVT v196,v120,v121
M16 v[72:75],a[236:239],a[188:191],v[72:75]
DR a[224:227],v5 offset:8192
M16 v[60:63],a[240:243],a[160:163],v[252:255]
EXP v122,v122
M16 v[60:63],a[244:247],a[164:167],v[60:63]
DR a[228:231],v5 offset:9216
M16 v[60:63],a[248:251],a[168:171],v[60:63]
EXP v123,v123
M16 v[60:63],a[252:255],a[172:175],v[60:63]
DR a[232:235],v5 offset:10240
CVT v197,v122,v123
M16 v[76:79],a[240:243],a[176:179],v[220:223]
BL4 v3,s[8:11],s25 offen offset:1024 lds
M16 v[76:79],a[244:247],a[180:183],v[76:79]
DR a[236:239],v5 offset:11264
M16 v[76:79],a[248:251],a[184:187],v[76:79]
s_waitcnt lgkmcnt(8)
EXP v124,v124
M16 v[76:79],a[252:255],a[188:191],v[76:79]
DR a[240:243],v5 offset:12288
M16 a[64:67],a[192:195],v[160:163],a[64:67]
EXP v125,v125
M16 a[64:67],a[196:199],v[164:167],a[64:67]
DR a[244:247],v5 offset:13312
CVT v198,v124,v125
M16 a[96:99],a[192:195],v[168:171],a[96:99]
EXP v126,v126
M16 a[96:99],a[196:199],v[172:175],a[96:99]
DR a[248:251],v5 offset:14336
M16 a[68:71],a[200:203],v[160:163],a[68:71]
EXP v127,v127
M16 a[68:71],a[204:207],v[164:167],a[68:71]
DR a[252:255],v5 offset:15360
CVT v199,v126,v127
M16 a[100:103],a[200:203],v[168:171],a[100:103]
s_add_u32 s29, s29, 16384
EXP v128,v128
M16 a[100:103],a[204:207],v[172:175],a[100:103]
s_and_b32 s29, s29, 0xffff
EXP v129,v129
M16 v[224:227],v[44:47],v[160:163],v[224:227]
s_waitcnt lgkmcnt(8)
v_add_u32 v5, s29, v7
CVT v200,v128,v129
M16 v[224:227],v[44:47],v[164:167],v[224:227]
DR a[192:195],v4 offset:0
M16 a[72:75],a[208:211],v[160:163],a[72:75]
BL4 v3,s[8:11],s25 offen offset:2048 lds
M16 a[72:75],a[212:215],v[164:167],a[72:75]
DR a[196:199],v4 offset:1024
M16 a[104:107],a[208:211],v[168:171],a[104:107]
EXP v130,v130
M16 a[104:107],a[212:215],v[172:175],a[104:107]
DR a[200:203],v4 offset:2048
M16 a[76:79],a[216:219],v[160:163],a[76:79]
EXP v131,v131
M16 a[76:79],a[220:223],v[164:167],a[76:79]
DR a[204:207],v4 offset:3072
CVT v201,v130,v131
M16 a[108:111],a[216:219],v[168:171],a[108:111]
s_waitcnt lgkmcnt(8)
EXP v132,v132
M16 a[108:111],a[220:223],v[172:175],a[108:111]
DR a[208:211],v4 offset:4096
EXP v133,v133
M16 a[80:83],a[224:227],v[160:163],a[80:83]
EXP v134,v134
M16 a[80:83],a[228:231],v[164:167],a[80:83]
DR a[212:215],v4 offset:5120
CVT v202,v132,v133
M16 a[112:115],a[224:227],v[168:171],a[112:115]
BL4 v3,s[8:11],s25 offen offset:3072 lds
M16 a[112:115],a[228:231],v[172:175],a[112:115]
DR a[216:219],v4 offset:6144
M16 a[84:87],a[232:235],v[160:163],a[84:87]
s_add_u32 s25, s25, 32768
EXP v135,v135
M16 a[84:87],a[236:239],v[164:167],a[84:87]
DR a[220:223],v4 offset:7168
CVT v203,v134,v135
M16 a[116:119],a[232:235],v[168:171],a[116:119]
s_add_u32 s27, s27, 16384
EXP v136,v136
M16 a[116:119],a[236:239],v[172:175],a[116:119]
s_and_b32 s27, s27, 0xffff
EXP v137,v137
M16 v[228:231],v[44:47],v[168:171],v[228:231]
s_waitcnt lgkmcnt(8)
EXP v138,v138
M16 v[228:231],v[44:47],v[172:175],v[228:231]
DR a[224:227],v4 offset:8192
CVT v204,v136,v137
M16 a[88:91],a[240:243],v[160:163],a[88:91]
EXP v139,v139
M16 a[88:91],a[244:247],v[164:167],a[88:91]
DR a[228:231],v4 offset:9216
CVT v205,v138,v139
M16 a[120:123],a[240:243],v[168:171],a[120:123]
EXP v140,v140
M16 a[120:123],a[244:247],v[172:175],a[120:123]
DR a[232:235],v4 offset:10240
M16 a[92:95],a[248:251],v[160:163],a[92:95]
EXP v141,v141
M16 a[92:95],a[252:255],v[164:167],a[92:95]
DR a[236:239],v4 offset:11264
M16 a[124:127],a[248:251],v[168:171],a[124:127]
EXP v142,v142
M16 a[124:127],a[252:255],v[172:175],a[124:127]
s_waitcnt lgkmcnt(8)
EXP v143,v143
v_cndmask_b32 v240, v6, v220, s[32:33]
v_cndmask_b32 v241, v6, v220, s[34:35]
v_cndmask_b32 v242, v6, v220, s[36:37]
v_cndmask_b32 v243, v6, v220, s[38:39]
v_cndmask_b32 v244, v6, v220, s[40:41]
v_cndmask_b32 v245, v6, v220, s[42:43]
v_cndmask_b32 v246, v6, v220, s[44:45]
v_cndmask_b32 v247, v6, v220, s[46:47]
v_cndmask_b32 v248, v6, v220, s[48:49]
v_cndmask_b32 v249, v6, v220, s[50:51]
v_cndmask_b32 v250, v6, v220, s[52:53]
v_cndmask_b32 v251, v6, v220, s[54:55]
v_cndmask_b32 v252, v6, v220, s[56:57]
v_cndmask_b32 v253, v6, v220, s[58:59]
v_cndmask_b32 v254, v6, v220, s[60:61]
v_cndmask_b32 v255, v6, v220, s[62:63]
s_nop 1
M16 v[128:131],a[192:195],a[176:179],v[240:243]
DR a[240:243],v4 offset:12288
s_add_u32 s29, s29, 16384
s_and_b32 s29, s29, 0xffff
M16 v[128:131],a[196:199],a[180:183],v[128:131]
DR a[244:247],v4 offset:13312
CVT v206,v140,v141
M16 v[128:131],a[200:203],a[184:187],v[128:131]
s_waitcnt vmcnt(4)
EXP v48,v48
M16 v[128:131],a[204:207],a[188:191],v[128:131]
s_barrier
s_waitcnt lgkmcnt(6)
EXP v49,v49
M16 v[132:135],a[208:211],a[176:179],v[244:247]
DR a[248:251],v4 offset:14336
CVT v207,v142,v143
M16 v[132:135],a[212:215],a[180:183],v[132:135]
DR a[252:255],v4 offset:15360
EXP v50,v50
M16 v[132:135],a[216:219],a[184:187],v[132:135]
DR a[192:195],v5 offset:0
CVT v160,v48,v49
M16 v[132:135],a[220:223],a[188:191],v[132:135]
DR a[196:199],v5 offset:1024
s_waitcnt lgkmcnt(6)
M16 v[136:139],a[224:227],a[176:179],v[248:251]
DR a[200:203],v5 offset:2048
EXP v51,v51
M16 v[136:139],a[228:231],a[180:183],v[136:139]
DR a[204:207],v5 offset:3072
CVT v161,v50,v51
M16 v[136:139],a[232:235],a[184:187],v[136:139]
DR a[208:211],v5 offset:4096
EXP v52,v52
M16 v[136:139],a[236:239],a[188:191],v[136:139]
DR a[212:215],v5 offset:5120
s_waitcnt lgkmcnt(6)
M16 v[140:143],a[240:243],a[176:179],v[252:255]
DR a[216:219],v5 offset:6144
M16 v[140:143],a[244:247],a[180:183],v[140:143]
DR a[220:223],v5 offset:7168
EXP v53,v53
M16 v[140:143],a[248:251],a[184:187],v[140:143]
DR a[224:227],v5 offset:8192
CVT v162,v52,v53
M16 v[140:143],a[252:255],a[188:191],v[140:143]
DR a[228:231],v5 offset:9216
s_waitcnt lgkmcnt(6)
M16 a[64:67],a[192:195],v[192:195],a[64:67]
DR a[232:235],v5 offset:10240
EXP v54,v54
M16 a[64:67],a[196:199],v[196:199],a[64:67]
DR a[236:239],v5 offset:11264
M16 a[96:99],a[192:195],v[200:203],a[96:99]
DR a[240:243],v5 offset:12288
M16 a[96:99],a[196:199],v[204:207],a[96:99]
DR a[244:247],v5 offset:13312
EXP v55,v55
M16 a[68:71],a[200:203],v[192:195],a[68:71]
DR a[248:251],v5 offset:14336
CVT v163,v54,v55
M16 a[68:71],a[204:207],v[196:199],a[68:71]
DR a[252:255],v5 offset:15360
v_add_u32 v5, s29, v7
M16 a[100:103],a[200:203],v[200:203],a[100:103]
EXP v56,v56
M16 a[100:103],a[204:207],v[204:207],a[100:103]
EXP v57,v57
M16 v[224:227],v[44:47],v[192:195],v[224:227]
s_waitcnt lgkmcnt(8)
EXP v58,v58
M16 v[224:227],v[44:47],v[196:199],v[224:227]
DR a[192:195],v5 offset:0
EXP v59,v59
M16 a[72:75],a[208:211],v[192:195],a[72:75]
DR a[196:199],v5 offset:1024
EXP v60,v60
M16 a[72:75],a[212:215],v[196:199],a[72:75]
DR a[200:203],v5 offset:2048
EXP v61,v61
M16 a[104:107],a[208:211],v[200:203],a[104:107]
DR a[204:207],v5 offset:3072
CVT v164,v56,v57
M16 a[104:107],a[212:215],v[204:207],a[104:107]
EXP v62,v62
M16 a[76:79],a[216:219],v[192:195],a[76:79]
EXP v63,v63
M16 a[76:79],a[220:223],v[196:199],a[76:79]
EXP v64,v64
M16 a[108:111],a[216:219],v[200:203],a[108:111]
s_waitcnt lgkmcnt(8)
EXP v65,v65
M16 a[108:111],a[220:223],v[204:207],a[108:111]
DR a[208:211],v5 offset:4096
EXP v66,v66
M16 a[80:83],a[224:227],v[192:195],a[80:83]
DR a[212:215],v5 offset:5120
CVT v165,v58,v59
M16 a[80:83],a[228:231],v[196:199],a[80:83]
DR a[216:219],v5 offset:6144
EXP v67,v67
M16 a[112:115],a[224:227],v[200:203],a[112:115]
DR a[220:223],v5 offset:7168
CVT v166,v60,v61
M16 a[112:115],a[228:231],v[204:207],a[112:115]
EXP v68,v68
M16 a[84:87],a[232:235],v[192:195],a[84:87]
EXP v69,v69
M16 a[84:87],a[236:239],v[196:199],a[84:87]
EXP v70,v70
M16 a[116:119],a[232:235],v[200:203],a[116:119]
EXP v71,v71
M16 a[116:119],a[236:239],v[204:207],a[116:119]
EXP v72,v72
M16 v[228:231],v[44:47],v[200:203],v[228:231]
s_waitcnt lgkmcnt(8)
EXP v73,v73
M16 v[228:231],v[44:47],v[204:207],v[228:231]
DR a[224:227],v5 offset:8192
EXP v74,v74
M16 a[88:91],a[240:243],v[192:195],a[88:91]
DR a[228:231],v5 offset:9216
CVT v167,v62,v63
M16 a[88:91],a[244:247],v[196:199],a[88:91]
DR a[232:235],v5 offset:10240
EXP v75,v75
M16 a[120:123],a[240:243],v[200:203],a[120:123]
DR a[236:239],v5 offset:11264
CVT v168,v64,v65
M16 a[120:123],a[244:247],v[204:207],a[120:123]
EXP v76,v76
M16 a[92:95],a[248:251],v[192:195],a[92:95]
EXP v77,v77
M16 a[92:95],a[252:255],v[196:199],a[92:95]
EXP v78,v78
M16 a[124:127],a[248:251],v[200:203],a[124:127]
EXP v79,v79
M16 a[124:127],a[252:255],v[204:207],a[124:127]
s_waitcnt lgkmcnt(8)
CVT v169,v66,v67
CVT v170,v68,v69
CVT v171,v70,v71
CVT v172,v72,v73
CVT v173,v74,v75
L_a_tail:
s_nop 0
CVT v174,v76,v77
CVT v175,v78,v79
s_nop 1
M16 a[64:67],a[192:195],v[160:163],a[64:67]
DR a[240:243],v5 offset:12288
s_add_u32 s29, s29, 16384
s_and_b32 s29, s29, 0xffff
M16 a[64:67],a[196:199],v[164:167],a[64:67]
DR a[244:247],v5 offset:13312
EXP v128,v128
M16 a[96:99],a[192:195],v[168:171],a[96:99]
s_waitcnt vmcnt(0)
EXP v129,v129
M16 a[96:99],a[196:199],v[172:175],a[96:99]
s_barrier
EXP v130,v130
M16 a[68:71],a[200:203],v[160:163],a[68:71]
DR a[248:251],v5 offset:14336
CVT v200,v128,v129
M16 a[68:71],a[204:207],v[164:167],a[68:71]
DR a[252:255],v5 offset:15360
v_add_u32 v5, s29, v7
M16 a[100:103],a[200:203],v[168:171],a[100:103]
v_mov_b32 v100, 0
v_mov_b32 v101, 0
BL4 v[96:99],v12,s[8:11],s67 offen
M16 a[100:103],a[204:207],v[172:175],a[100:103]
s_mov_b32 exec_hi, 0
buffer_load_dwordx2 v[100:101], v12, s[8:11], s67 offen offset:32
s_mov_b32 exec_hi, -1
M16 v[224:227],v[44:47],v[160:163],v[224:227]
s_waitcnt lgkmcnt(8)
EXP v131,v131
M16 v[224:227],v[44:47],v[164:167],v[224:227]
DR a[192:195],v5 offset:0
EXP v132,v132
CVT v201,v130,v131
M16 a[72:75],a[208:211],v[160:163],a[72:75]
DR a[196:199],v5 offset:1024
EXP v133,v133
M16 a[72:75],a[212:215],v[164:167],a[72:75]
DR a[200:203],v5 offset:2048
EXP v134,v134
M16 a[104:107],a[208:211],v[168:171],a[104:107]
DR a[204:207],v5 offset:3072
CVT v202,v132,v133
M16 a[104:107],a[212:215],v[172:175],a[104:107]
BL4 a[0:3],v2,s[8:11],s68 offen offset:0
M16 a[76:79],a[216:219],v[160:163],a[76:79]
BL4 a[4:7],v2,s[8:11],s68 offen offset:1024
M16 a[76:79],a[220:223],v[164:167],a[76:79]
BL4 a[8:11],v2,s[8:11],s68 offen offset:2048
M16 a[108:111],a[216:219],v[168:171],a[108:111]
s_waitcnt lgkmcnt(8)
EXP v135,v135
M16 a[108:111],a[220:223],v[172:175],a[108:111]
DR a[208:211],v5 offset:4096
EXP v136,v136
M16 a[80:83],a[224:227],v[160:163],a[80:83]
DR a[212:215],v5 offset:5120
EXP v137,v137
M16 a[80:83],a[228:231],v[164:167],a[80:83]
DR a[216:219],v5 offset:6144
CVT v203,v134,v135
M16 a[112:115],a[224:227],v[168:171],a[112:115]
DR a[220:223],v5 offset:7168
EXP v138,v138
M16 a[112:115],a[228:231],v[172:175],a[112:115]
BL4 a[12:15],v2,s[8:11],s68 offen offset:3072
s_add_u32 s68, s68, 4096
M16 a[84:87],a[232:235],v[160:163],a[84:87]
BL4 a[16:19],v2,s[8:11],s68 offen offset:0
M16 a[84:87],a[236:239],v[164:167],a[84:87]
BL4 a[20:23],v2,s[8:11],s68 offen offset:1024
M16 a[116:119],a[232:235],v[168:171],a[116:119]
BL4 a[24:27],v2,s[8:11],s68 offen offset:2048
M16 a[116:119],a[236:239],v[172:175],a[116:119]
BL4 a[28:31],v2,s[8:11],s68 offen offset:3072
s_add_u32 s68, s68, 4096
M16 v[228:231],v[44:47],v[168:171],v[228:231]
s_waitcnt lgkmcnt(8)
EXP v139,v139
M16 v[228:231],v[44:47],v[172:175],v[228:231]
DR a[224:227],v5 offset:8192
EXP v140,v140
CVT v204,v136,v137
M16 a[88:91],a[240:243],v[160:163],a[88:91]
DR a[228:231],v5 offset:9216
EXP v141,v141
M16 a[88:91],a[244:247],v[164:167],a[88:91]
DR a[232:235],v5 offset:10240
CVT v205,v138,v139
M16 a[120:123],a[240:243],v[168:171],a[120:123]
DR a[236:239],v5 offset:11264
EXP v142,v142
M16 a[120:123],a[244:247],v[172:175],a[120:123]
buffer_load_dwordx2 a[32:33], v14, s[8:11], s69 offen offset:0
M16 a[92:95],a[248:251],v[160:163],a[92:95]
buffer_load_dwordx2 a[34:35], v14, s[8:11], s69 offen offset:512
M16 a[92:95],a[252:255],v[164:167],a[92:95]
buffer_load_dwordx2 a[36:37], v14, s[8:11], s69 offen offset:1024
M16 a[124:127],a[248:251],v[168:171],a[124:127]
buffer_load_dwordx2 a[38:39], v14, s[8:11], s69 offen offset:1536
M16 a[124:127],a[252:255],v[172:175],a[124:127]
s_waitcnt lgkmcnt(8)
EXP v143,v143
s_nop 0
CVT v206,v140,v141
CVT v207,v142,v143
s_nop 1
M16 a[96:99],a[192:195],v[200:203],a[96:99]
DR a[240:243],v5 offset:12288
M16 a[96:99],a[196:199],v[204:207],a[96:99]
DR a[244:247],v5 offset:13312
M16 a[100:103],a[200:203],v[200:203],a[100:103]
DR a[248:251],v5 offset:14336
M16 a[100:103],a[204:207],v[204:207],a[100:103]
DR a[252:255],v5 offset:15360
s_waitcnt lgkmcnt(8)
M16 a[104:107],a[208:211],v[200:203],a[104:107]
buffer_load_dwordx2 a[40:41], v14, s[8:11], s69 offen offset:2048
M16 a[104:107],a[212:215],v[204:207],a[104:107]
buffer_load_dwordx2 a[42:43], v14, s[8:11], s69 offen offset:2560
M16 a[108:111],a[216:219],v[200:203],a[108:111]
buffer_load_dwordx2 a[44:45], v14, s[8:11], s69 offen offset:3072
M16 a[108:111],a[220:223],v[204:207],a[108:111]
s_waitcnt lgkmcnt(4)
M16 a[112:115],a[224:227],v[200:203],a[112:115]
buffer_load_dwordx2 a[46:47], v14, s[8:11], s69 offen offset:3584
s_add_u32 s69, s69, 4096
M16 a[112:115],a[228:231],v[204:207],a[112:115]
buffer_load_dwordx2 a[48:49], v14, s[8:11], s69 offen offset:0
M16 a[116:119],a[232:235],v[200:203],a[116:119]
buffer_load_dwordx2 a[50:51], v14, s[8:11], s69 offen offset:512
M16 a[116:119],a[236:239],v[204:207],a[116:119]
buffer_load_dwordx2 a[52:53], v14, s[8:11], s69 offen offset:1024
M16 v[228:231],v[44:47],v[200:203],v[228:231]
buffer_load_dwordx2 a[54:55], v14, s[8:11], s69 offen offset:1536
M16 v[228:231],v[44:47],v[204:207],v[228:231]
s_waitcnt lgkmcnt(0)
M16 a[120:123],a[240:243],v[200:203],a[120:123]
buffer_load_dwordx2 a[56:57], v14, s[8:11], s69 offen offset:2048
M16 a[120:123],a[244:247],v[204:207],a[120:123]
buffer_load_dwordx2 a[58:59], v14, s[8:11], s69 offen offset:2560
M16 a[124:127],a[248:251],v[200:203],a[124:127]
buffer_load_dwordx2 a[60:61], v14, s[8:11], s69 offen offset:3072
M16 a[124:127],a[252:255],v[204:207],a[124:127]
buffer_load_dwordx2 a[62:63], v14, s[8:11], s69 offen offset:3584
BL4 a[192:195],v2,s[8:11],s70 offen offset:0
BL4 a[196:199],v2,s[8:11],s70 offen offset:1024
BL4 a[200:203],v2,s[8:11],s70 offen offset:2048
BL4 a[204:207],v2,s[8:11],s70 offen offset:3072
s_add_u32 s70, s70, 4096
BL4 a[208:211],v2,s[8:11],s70 offen offset:0
BL4 a[212:215],v2,s[8:11],s70 offen offset:1024
BL4 a[216:219],v2,s[8:11],s70 offen offset:2048
BL4 a[220:223],v2,s[8:11],s70 offen offset:3072
s_add_u32 s70, s70, 4096
v_add_f32 v232, v232, v233
v_add_f32 v234, v234, v235
v_add_f32 v232, v232, v234
v_mov_b32 v233, v232
v_add_f32 v236, v236, v237
v_add_f32 v238, v238, v239
v_add_f32 v236, v236, v238
v_mov_b32 v237, v236
s_nop 1
v_permlane16_swap_b32 v232, v233
v_permlane16_swap_b32 v236, v237
s_nop 1
v_add_f32 v232, v232, v233
v_add_f32 v236, v236, v237
v_mov_b32 v233, v232
v_mov_b32 v237, v236
s_nop 1
v_permlane32_swap_b32 v232, v233
v_permlane32_swap_b32 v236, v237
s_nop 1
v_add_f32 v232, v232, v233
v_add_f32 v236, v236, v237
v_add_f32 v232, v232, v224
v_add_f32 v236, v236, v228
v_rcp_f32 v234, v232
v_rcp_f32 v238, v236
s_nop 0
v_mov_b32 v235, v234
v_mov_b32 v239, v238
AR v16,a64
AR v17,a65
AR v18,a66
AR v19,a67
AR v20,a68
AR v21,a69
AR v22,a70
AR v23,a71
v_pk_mul_f32 v[16:17], v[16:17], v[234:235]
v_pk_mul_f32 v[18:19], v[18:19], v[234:235]
v_pk_mul_f32 v[20:21], v[20:21], v[234:235]
v_pk_mul_f32 v[22:23], v[22:23], v[234:235]
CVT v176,v16,v17
CVT v177,v18,v19
CVT v178,v20,v21
CVT v179,v22,v23
v_pk_add_f32 v[16:17], v[16:17], v[18:19]
v_pk_add_f32 v[20:21], v[20:21], v[22:23]
v_pk_add_f32 v[10:11], v[16:17], v[20:21]
BL4 a[224:227],v2,s[8:11],s70 offen offset:0
BL4 a[228:231],v2,s[8:11],s70 offen offset:1024
AR v24,a72
AR v25,a73
AR v26,a74
AR v27,a75
AR v28,a76
AR v29,a77
AR v30,a78
AR v31,a79
v_pk_mul_f32 v[24:25], v[24:25], v[234:235]
v_pk_mul_f32 v[26:27], v[26:27], v[234:235]
v_pk_mul_f32 v[28:29], v[28:29], v[234:235]
v_pk_mul_f32 v[30:31], v[30:31], v[234:235]
CVT v180,v24,v25
CVT v181,v26,v27
CVT v182,v28,v29
CVT v183,v30,v31
v_pk_add_f32 v[24:25], v[24:25], v[26:27]
v_pk_add_f32 v[28:29], v[28:29], v[30:31]
v_pk_add_f32 v[10:11], v[10:11], v[24:25]
v_pk_add_f32 v[10:11], v[10:11], v[28:29]
BL4 a[232:235],v2,s[8:11],s70 offen offset:2048
BL4 a[236:239],v2,s[8:11],s70 offen offset:3072
s_add_u32 s70, s70, 4096
AR v32,a80
AR v33,a81
AR v34,a82
AR v35,a83
AR v36,a84
AR v37,a85
AR v38,a86
AR v39,a87
v_pk_mul_f32 v[32:33], v[32:33], v[234:235]
v_pk_mul_f32 v[34:35], v[34:35], v[234:235]
v_pk_mul_f32 v[36:37], v[36:37], v[234:235]
v_pk_mul_f32 v[38:39], v[38:39], v[234:235]
CVT v184,v32,v33
CVT v185,v34,v35
CVT v186,v36,v37
CVT v187,v38,v39
v_pk_add_f32 v[32:33], v[32:33], v[34:35]
v_pk_add_f32 v[36:37], v[36:37], v[38:39]
v_pk_add_f32 v[10:11], v[10:11], v[32:33]
v_pk_add_f32 v[10:11], v[10:11], v[36:37]
BL4 a[240:243],v2,s[8:11],s70 offen offset:0
BL4 a[244:247],v2,s[8:11],s70 offen offset:1024
AR v40,a88
AR v41,a89
AR v42,a90
AR v43,a91
AR v44,a92
AR v45,a93
AR v46,a94
AR v47,a95
v_pk_mul_f32 v[40:41], v[40:41], v[234:235]
v_pk_mul_f32 v[42:43], v[42:43], v[234:235]
v_pk_mul_f32 v[44:45], v[44:45], v[234:235]
v_pk_mul_f32 v[46:47], v[46:47], v[234:235]
CVT v188,v40,v41
CVT v189,v42,v43
CVT v190,v44,v45
CVT v191,v46,v47
v_pk_add_f32 v[40:41], v[40:41], v[42:43]
v_pk_add_f32 v[44:45], v[44:45], v[46:47]
v_pk_add_f32 v[10:11], v[10:11], v[40:41]
v_pk_add_f32 v[10:11], v[10:11], v[44:45]
BL4 a[248:251],v2,s[8:11],s70 offen offset:2048
BL4 a[252:255],v2,s[8:11],s70 offen offset:3072
s_add_u32 s70, s70, 4096
v_add_f32 v10, v10, v11
v_cmp_nge_f32 s[12:13], s77, v232
v_cmp_class_f32 s[14:15], v10, s78
s_nop 1
s_or_b64 vcc, s[12:13], s[14:15]
s_cbranch_vccnz L_a_slow2
L_a_ok2:
AR v48,a96
AR v49,a97
AR v50,a98
AR v51,a99
AR v52,a100
AR v53,a101
AR v54,a102
AR v55,a103
v_pk_mul_f32 v[48:49], v[48:49], v[238:239]
v_pk_mul_f32 v[50:51], v[50:51], v[238:239]
v_pk_mul_f32 v[52:53], v[52:53], v[238:239]
v_pk_mul_f32 v[54:55], v[54:55], v[238:239]
CVT v192,v48,v49
CVT v193,v50,v51
CVT v194,v52,v53
CVT v195,v54,v55
v_pk_add_f32 v[48:49], v[48:49], v[50:51]
v_pk_add_f32 v[52:53], v[52:53], v[54:55]
v_pk_add_f32 v[10:11], v[48:49], v[52:53]
BS4 v[176:179],v8,s[8:11],s76 offen sc1
s_add_u32 s76, s76, 4096
AR v56,a104
AR v57,a105
AR v58,a106
AR v59,a107
AR v60,a108
AR v61,a109
AR v62,a110
AR v63,a111
v_pk_mul_f32 v[56:57], v[56:57], v[238:239]
v_pk_mul_f32 v[58:59], v[58:59], v[238:239]
v_pk_mul_f32 v[60:61], v[60:61], v[238:239]
v_pk_mul_f32 v[62:63], v[62:63], v[238:239]
CVT v196,v56,v57
CVT v197,v58,v59
CVT v198,v60,v61
CVT v199,v62,v63
v_pk_add_f32 v[56:57], v[56:57], v[58:59]
v_pk_add_f32 v[60:61], v[60:61], v[62:63]
v_pk_add_f32 v[10:11], v[10:11], v[56:57]
v_pk_add_f32 v[10:11], v[10:11], v[60:61]
BS4 v[180:183],v8,s[8:11],s76 offen sc1
s_sub_u32 s76, s76, 4096
AR v64,a112
AR v65,a113
AR v66,a114
AR v67,a115
AR v68,a116
AR v69,a117
AR v70,a118
AR v71,a119
v_pk_mul_f32 v[64:65], v[64:65], v[238:239]
v_pk_mul_f32 v[66:67], v[66:67], v[238:239]
v_pk_mul_f32 v[68:69], v[68:69], v[238:239]
v_pk_mul_f32 v[70:71], v[70:71], v[238:239]
CVT v200,v64,v65
CVT v201,v66,v67
CVT v202,v68,v69
CVT v203,v70,v71
v_pk_add_f32 v[64:65], v[64:65], v[66:67]
v_pk_add_f32 v[68:69], v[68:69], v[70:71]
v_pk_add_f32 v[10:11], v[10:11], v[64:65]
v_pk_add_f32 v[10:11], v[10:11], v[68:69]
BS4 v[184:187],v9,s[8:11],s76 offen sc1
s_add_u32 s76, s76, 4096
AR v72,a120
AR v73,a121
AR v74,a122
AR v75,a123
AR v76,a124
AR v77,a125
AR v78,a126
AR v79,a127
v_pk_mul_f32 v[72:73], v[72:73], v[238:239]
v_pk_mul_f32 v[74:75], v[74:75], v[238:239]
v_pk_mul_f32 v[76:77], v[76:77], v[238:239]
v_pk_mul_f32 v[78:79], v[78:79], v[238:239]
CVT v204,v72,v73
CVT v205,v74,v75
CVT v206,v76,v77
CVT v207,v78,v79
v_pk_add_f32 v[72:73], v[72:73], v[74:75]
v_pk_add_f32 v[76:77], v[76:77], v[78:79]
v_pk_add_f32 v[10:11], v[10:11], v[72:73]
v_pk_add_f32 v[10:11], v[10:11], v[76:77]
BS4 v[188:191],v9,s[8:11],s76 offen sc1
s_add_u32 s76, s76, 602112
v_add_f32 v10, v10, v11
v_cmp_nge_f32 s[12:13], s77, v236
v_cmp_class_f32 s[14:15], v10, s78
s_nop 1
s_or_b64 vcc, s[12:13], s[14:15]
s_cbranch_vccnz L_a_slow3
L_a_ok3:
s_branch L_a_done
L_a_slow0:
s_lshl_b32 s81, s22, 1
s_add_u32 s81, s81, 0
v_mov_b32 v184, v6
v_mov_b32 v208, 0
v_mov_b32 v209, 0
v_mov_b32 v210, 0
v_mov_b32 v211, 0
s_mov_b32 s80, 0
s_lshl_b32 s82, s21, 20
L_a_slow0_0:
BL4 v[16:19],v2,s[8:11],s82 offen offset:0
BL4 v[20:23],v2,s[8:11],s82 offen offset:1024
BL4 v[24:27],v2,s[8:11],s82 offen offset:2048
BL4 v[28:31],v2,s[8:11],s82 offen offset:3072
s_add_u32 s82, s82, 4096
BL4 v[32:35],v2,s[8:11],s82 offen offset:0
BL4 v[36:39],v2,s[8:11],s82 offen offset:1024
BL4 v[40:43],v2,s[8:11],s82 offen offset:2048
BL4 v[44:47],v2,s[8:11],s82 offen offset:3072
s_add_u32 s82, s82, 4096
BL4 v[80:83],v2,s[8:11],s82 offen offset:0
BL4 v[84:87],v2,s[8:11],s82 offen offset:1024
BL4 v[88:91],v2,s[8:11],s82 offen offset:2048
BL4 v[92:95],v2,s[8:11],s82 offen offset:3072
s_add_u32 s82, s82, 4096
BL4 v[96:99],v2,s[8:11],s82 offen offset:0
BL4 v[100:103],v2,s[8:11],s82 offen offset:1024
BL4 v[104:107],v2,s[8:11],s82 offen offset:2048
BL4 v[108:111],v2,s[8:11],s82 offen offset:3072
s_add_u32 s82, s82, 4096
v_mov_b32 v240, v208
v_mov_b32 v241, v208
v_mov_b32 v242, v208
v_mov_b32 v243, v208
v_mov_b32 v244, v208
v_mov_b32 v245, v208
v_mov_b32 v246, v208
v_mov_b32 v247, v208
v_mov_b32 v248, v208
v_mov_b32 v249, v208
v_mov_b32 v250, v208
v_mov_b32 v251, v208
v_mov_b32 v252, v208
v_mov_b32 v253, v208
v_mov_b32 v254, v208
v_mov_b32 v255, v208
s_cmp_lg_u32 s80, s81
s_cbranch_scc1 L_a_slow0_0n
v_cndmask_b32 v240, v6, v208, s[32:33]
v_cndmask_b32 v241, v6, v208, s[34:35]
v_cndmask_b32 v242, v6, v208, s[36:37]
v_cndmask_b32 v243, v6, v208, s[38:39]
v_cndmask_b32 v244, v6, v208, s[40:41]
v_cndmask_b32 v245, v6, v208, s[42:43]
v_cndmask_b32 v246, v6, v208, s[44:45]
v_cndmask_b32 v247, v6, v208, s[46:47]
v_cndmask_b32 v248, v6, v208, s[48:49]
v_cndmask_b32 v249, v6, v208, s[50:51]
v_cndmask_b32 v250, v6, v208, s[52:53]
v_cndmask_b32 v251, v6, v208, s[54:55]
v_cndmask_b32 v252, v6, v208, s[56:57]
v_cndmask_b32 v253, v6, v208, s[58:59]
v_cndmask_b32 v254, v6, v208, s[60:61]
v_cndmask_b32 v255, v6, v208, s[62:63]
L_a_slow0_0n:
s_waitcnt vmcnt(0)
s_nop 1
M16 v[144:147],v[16:19],a[128:131],v[240:243]
M16 v[144:147],v[20:23],a[132:135],v[144:147]
M16 v[144:147],v[24:27],a[136:139],v[144:147]
M16 v[144:147],v[28:31],a[140:143],v[144:147]
M16 v[148:151],v[32:35],a[128:131],v[244:247]
M16 v[148:151],v[36:39],a[132:135],v[148:151]
M16 v[148:151],v[40:43],a[136:139],v[148:151]
M16 v[148:151],v[44:47],a[140:143],v[148:151]
M16 v[152:155],v[80:83],a[128:131],v[248:251]
M16 v[152:155],v[84:87],a[132:135],v[152:155]
M16 v[152:155],v[88:91],a[136:139],v[152:155]
M16 v[152:155],v[92:95],a[140:143],v[152:155]
M16 v[156:159],v[96:99],a[128:131],v[252:255]
M16 v[156:159],v[100:103],a[132:135],v[156:159]
M16 v[156:159],v[104:107],a[136:139],v[156:159]
M16 v[156:159],v[108:111],a[140:143],v[156:159]
s_nop 7
v_max3_f32 v184, v144, v145, v184
v_max3_f32 v184, v146, v147, v184
v_max3_f32 v184, v148, v149, v184
v_max3_f32 v184, v150, v151, v184
v_max3_f32 v184, v152, v153, v184
v_max3_f32 v184, v154, v155, v184
v_max3_f32 v184, v156, v157, v184
v_max3_f32 v184, v158, v159, v184
s_add_u32 s82, s82, 16384
s_add_u32 s80, s80, 1
s_cmp_le_u32 s80, s81
s_cbranch_scc1 L_a_slow0_0
v_mov_b32 v185, v184
s_nop 1
v_permlane16_swap_b32 v184, v185
s_nop 1
v_max_f32 v184, v184, v185
v_mov_b32 v185, v184
s_nop 1
v_permlane32_swap_b32 v184, v185
s_nop 1
v_max_f32 v184, v184, v185
v_sub_f32 v208, 0, v184
v_mov_b32 v224, 0
v_sub_f32 v209, 0, v184
v_mov_b32 v225, 0
v_sub_f32 v210, 0, v184
v_mov_b32 v226, 0
v_sub_f32 v211, 0, v184
v_mov_b32 v227, 0
AW a0,0
AW a1,0
AW a2,0
AW a3,0
AW a4,0
AW a5,0
AW a6,0
AW a7,0
AW a8,0
AW a9,0
AW a10,0
AW a11,0
AW a12,0
AW a13,0
AW a14,0
AW a15,0
AW a16,0
AW a17,0
AW a18,0
AW a19,0
AW a20,0
AW a21,0
AW a22,0
AW a23,0
AW a24,0
AW a25,0
AW a26,0
AW a27,0
AW a28,0
AW a29,0
AW a30,0
AW a31,0
s_mov_b32 s80, 0
s_lshl_b32 s82, s21, 20
L_a_slow0_1:
BL4 v[16:19],v2,s[8:11],s82 offen offset:0
BL4 v[20:23],v2,s[8:11],s82 offen offset:1024
BL4 v[24:27],v2,s[8:11],s82 offen offset:2048
BL4 v[28:31],v2,s[8:11],s82 offen offset:3072
s_add_u32 s82, s82, 4096
BL4 v[32:35],v2,s[8:11],s82 offen offset:0
BL4 v[36:39],v2,s[8:11],s82 offen offset:1024
BL4 v[40:43],v2,s[8:11],s82 offen offset:2048
BL4 v[44:47],v2,s[8:11],s82 offen offset:3072
s_add_u32 s82, s82, 4096
BL4 v[80:83],v2,s[8:11],s82 offen offset:0
BL4 v[84:87],v2,s[8:11],s82 offen offset:1024
BL4 v[88:91],v2,s[8:11],s82 offen offset:2048
BL4 v[92:95],v2,s[8:11],s82 offen offset:3072
s_add_u32 s82, s82, 4096
BL4 v[96:99],v2,s[8:11],s82 offen offset:0
BL4 v[100:103],v2,s[8:11],s82 offen offset:1024
BL4 v[104:107],v2,s[8:11],s82 offen offset:2048
BL4 v[108:111],v2,s[8:11],s82 offen offset:3072
s_add_u32 s82, s82, 4096
v_mov_b32 v240, v208
v_mov_b32 v241, v208
v_mov_b32 v242, v208
v_mov_b32 v243, v208
v_mov_b32 v244, v208
v_mov_b32 v245, v208
v_mov_b32 v246, v208
v_mov_b32 v247, v208
v_mov_b32 v248, v208
v_mov_b32 v249, v208
v_mov_b32 v250, v208
v_mov_b32 v251, v208
v_mov_b32 v252, v208
v_mov_b32 v253, v208
v_mov_b32 v254, v208
v_mov_b32 v255, v208
s_cmp_lg_u32 s80, s81
s_cbranch_scc1 L_a_slow0_1n
v_cndmask_b32 v240, v6, v208, s[32:33]
v_cndmask_b32 v241, v6, v208, s[34:35]
v_cndmask_b32 v242, v6, v208, s[36:37]
v_cndmask_b32 v243, v6, v208, s[38:39]
v_cndmask_b32 v244, v6, v208, s[40:41]
v_cndmask_b32 v245, v6, v208, s[42:43]
v_cndmask_b32 v246, v6, v208, s[44:45]
v_cndmask_b32 v247, v6, v208, s[46:47]
v_cndmask_b32 v248, v6, v208, s[48:49]
v_cndmask_b32 v249, v6, v208, s[50:51]
v_cndmask_b32 v250, v6, v208, s[52:53]
v_cndmask_b32 v251, v6, v208, s[54:55]
v_cndmask_b32 v252, v6, v208, s[56:57]
v_cndmask_b32 v253, v6, v208, s[58:59]
v_cndmask_b32 v254, v6, v208, s[60:61]
v_cndmask_b32 v255, v6, v208, s[62:63]
L_a_slow0_1n:
s_waitcnt vmcnt(0)
s_nop 1
M16 v[144:147],v[16:19],a[128:131],v[240:243]
M16 v[144:147],v[20:23],a[132:135],v[144:147]
M16 v[144:147],v[24:27],a[136:139],v[144:147]
M16 v[144:147],v[28:31],a[140:143],v[144:147]
M16 v[148:151],v[32:35],a[128:131],v[244:247]
M16 v[148:151],v[36:39],a[132:135],v[148:151]
M16 v[148:151],v[40:43],a[136:139],v[148:151]
M16 v[148:151],v[44:47],a[140:143],v[148:151]
M16 v[152:155],v[80:83],a[128:131],v[248:251]
M16 v[152:155],v[84:87],a[132:135],v[152:155]
M16 v[152:155],v[88:91],a[136:139],v[152:155]
M16 v[152:155],v[92:95],a[140:143],v[152:155]
M16 v[156:159],v[96:99],a[128:131],v[252:255]
M16 v[156:159],v[100:103],a[132:135],v[156:159]
M16 v[156:159],v[104:107],a[136:139],v[156:159]
M16 v[156:159],v[108:111],a[140:143],v[156:159]
BL4 v[16:19],v2,s[8:11],s82 offen offset:0
BL4 v[20:23],v2,s[8:11],s82 offen offset:1024
BL4 v[24:27],v2,s[8:11],s82 offen offset:2048
BL4 v[28:31],v2,s[8:11],s82 offen offset:3072
s_add_u32 s82, s82, 4096
BL4 v[32:35],v2,s[8:11],s82 offen offset:0
BL4 v[36:39],v2,s[8:11],s82 offen offset:1024
BL4 v[40:43],v2,s[8:11],s82 offen offset:2048
BL4 v[44:47],v2,s[8:11],s82 offen offset:3072
s_add_u32 s82, s82, 4096
BL4 v[80:83],v2,s[8:11],s82 offen offset:0
BL4 v[84:87],v2,s[8:11],s82 offen offset:1024
BL4 v[88:91],v2,s[8:11],s82 offen offset:2048
BL4 v[92:95],v2,s[8:11],s82 offen offset:3072
s_add_u32 s82, s82, 4096
BL4 v[96:99],v2,s[8:11],s82 offen offset:0
BL4 v[100:103],v2,s[8:11],s82 offen offset:1024
BL4 v[104:107],v2,s[8:11],s82 offen offset:2048
BL4 v[108:111],v2,s[8:11],s82 offen offset:3072
s_add_u32 s82, s82, 4096
EXP v144,v144
EXP v145,v145
EXP v146,v146
EXP v147,v147
EXP v148,v148
EXP v149,v149
EXP v150,v150
EXP v151,v151
EXP v152,v152
EXP v153,v153
EXP v154,v154
EXP v155,v155
EXP v156,v156
EXP v157,v157
EXP v158,v158
EXP v159,v159
s_nop 0
v_add_f32 v224, v144, v224
v_add_f32 v225, v145, v225
v_add_f32 v226, v146, v226
v_add_f32 v227, v147, v227
v_add_f32 v224, v148, v224
v_add_f32 v225, v149, v225
v_add_f32 v226, v150, v226
v_add_f32 v227, v151, v227
v_add_f32 v224, v152, v224
v_add_f32 v225, v153, v225
v_add_f32 v226, v154, v226
v_add_f32 v227, v155, v227
v_add_f32 v224, v156, v224
v_add_f32 v225, v157, v225
v_add_f32 v226, v158, v226
v_add_f32 v227, v159, v227
CVT v176,v144,v145
CVT v177,v146,v147
CVT v178,v148,v149
CVT v179,v150,v151
CVT v180,v152,v153
CVT v181,v154,v155
CVT v182,v156,v157
CVT v183,v158,v159
s_waitcnt vmcnt(0)
s_nop 1
M16 a[0:3],v[16:19],v[176:179],a[0:3]
M16 a[0:3],v[20:23],v[180:183],a[0:3]
M16 a[4:7],v[24:27],v[176:179],a[4:7]
M16 a[4:7],v[28:31],v[180:183],a[4:7]
M16 a[8:11],v[32:35],v[176:179],a[8:11]
M16 a[8:11],v[36:39],v[180:183],a[8:11]
M16 a[12:15],v[40:43],v[176:179],a[12:15]
M16 a[12:15],v[44:47],v[180:183],a[12:15]
M16 a[16:19],v[80:83],v[176:179],a[16:19]
M16 a[16:19],v[84:87],v[180:183],a[16:19]
M16 a[20:23],v[88:91],v[176:179],a[20:23]
M16 a[20:23],v[92:95],v[180:183],a[20:23]
M16 a[24:27],v[96:99],v[176:179],a[24:27]
M16 a[24:27],v[100:103],v[180:183],a[24:27]
M16 a[28:31],v[104:107],v[176:179],a[28:31]
M16 a[28:31],v[108:111],v[180:183],a[28:31]
s_nop 7
s_add_u32 s80, s80, 1
s_cmp_le_u32 s80, s81
s_cbranch_scc1 L_a_slow0_1
v_add_f32 v224, v224, v225
v_add_f32 v226, v226, v227
v_add_f32 v224, v224, v226
v_mov_b32 v225, v224
s_nop 1
v_permlane16_swap_b32 v224, v225
s_nop 1
v_add_f32 v224, v224, v225
v_mov_b32 v225, v224
s_nop 1
v_permlane32_swap_b32 v224, v225
s_nop 1
v_add_f32 v224, v224, v225
v_rcp_f32 v226, v224
s_nop 0
v_mov_b32 v227, v226
AR v16,a0
AR v17,a1
AR v18,a2
AR v19,a3
AR v20,a4
AR v21,a5
AR v22,a6
AR v23,a7
v_pk_mul_f32 v[16:17], v[16:17], v[226:227]
v_pk_mul_f32 v[18:19], v[18:19], v[226:227]
v_pk_mul_f32 v[20:21], v[20:21], v[226:227]
v_pk_mul_f32 v[22:23], v[22:23], v[226:227]
CVT v80,v16,v17
CVT v81,v18,v19
CVT v82,v20,v21
CVT v83,v22,v23
v_pk_add_f32 v[16:17], v[16:17], v[18:19]
v_pk_add_f32 v[20:21], v[20:21], v[22:23]
v_pk_add_f32 v[10:11], v[16:17], v[20:21]
AR v24,a8
AR v25,a9
AR v26,a10
AR v27,a11
AR v28,a12
AR v29,a13
AR v30,a14
AR v31,a15
v_pk_mul_f32 v[24:25], v[24:25], v[226:227]
v_pk_mul_f32 v[26:27], v[26:27], v[226:227]
v_pk_mul_f32 v[28:29], v[28:29], v[226:227]
v_pk_mul_f32 v[30:31], v[30:31], v[226:227]
CVT v84,v24,v25
CVT v85,v26,v27
CVT v86,v28,v29
CVT v87,v30,v31
v_pk_add_f32 v[24:25], v[24:25], v[26:27]
v_pk_add_f32 v[28:29], v[28:29], v[30:31]
v_pk_add_f32 v[10:11], v[10:11], v[24:25]
v_pk_add_f32 v[10:11], v[10:11], v[28:29]
AR v32,a16
AR v33,a17
AR v34,a18
AR v35,a19
AR v36,a20
AR v37,a21
AR v38,a22
AR v39,a23
v_pk_mul_f32 v[32:33], v[32:33], v[226:227]
v_pk_mul_f32 v[34:35], v[34:35], v[226:227]
v_pk_mul_f32 v[36:37], v[36:37], v[226:227]
v_pk_mul_f32 v[38:39], v[38:39], v[226:227]
CVT v88,v32,v33
CVT v89,v34,v35
CVT v90,v36,v37
CVT v91,v38,v39
v_pk_add_f32 v[32:33], v[32:33], v[34:35]
v_pk_add_f32 v[36:37], v[36:37], v[38:39]
v_pk_add_f32 v[10:11], v[10:11], v[32:33]
v_pk_add_f32 v[10:11], v[10:11], v[36:37]
AR v40,a24
AR v41,a25
AR v42,a26
AR v43,a27
AR v44,a28
AR v45,a29
AR v46,a30
AR v47,a31
v_pk_mul_f32 v[40:41], v[40:41], v[226:227]
v_pk_mul_f32 v[42:43], v[42:43], v[226:227]
v_pk_mul_f32 v[44:45], v[44:45], v[226:227]
v_pk_mul_f32 v[46:47], v[46:47], v[226:227]
CVT v92,v40,v41
CVT v93,v42,v43
CVT v94,v44,v45
CVT v95,v46,v47
v_pk_add_f32 v[40:41], v[40:41], v[42:43]
v_pk_add_f32 v[44:45], v[44:45], v[46:47]
v_pk_add_f32 v[10:11], v[10:11], v[40:41]
v_pk_add_f32 v[10:11], v[10:11], v[44:45]
s_branch L_a_ok0
L_a_slow1:
s_lshl_b32 s81, s22, 1
s_add_u32 s81, s81, 1
v_mov_b32 v184, v6
v_mov_b32 v212, 0
v_mov_b32 v213, 0
v_mov_b32 v214, 0
v_mov_b32 v215, 0
s_mov_b32 s80, 0
s_lshl_b32 s82, s21, 20
L_a_slow1_0:
BL4 v[16:19],v2,s[8:11],s82 offen offset:0
BL4 v[20:23],v2,s[8:11],s82 offen offset:1024
BL4 v[24:27],v2,s[8:11],s82 offen offset:2048
BL4 v[28:31],v2,s[8:11],s82 offen offset:3072
s_add_u32 s82, s82, 4096
BL4 v[32:35],v2,s[8:11],s82 offen offset:0
BL4 v[36:39],v2,s[8:11],s82 offen offset:1024
BL4 v[40:43],v2,s[8:11],s82 offen offset:2048
BL4 v[44:47],v2,s[8:11],s82 offen offset:3072
s_add_u32 s82, s82, 4096
BL4 v[80:83],v2,s[8:11],s82 offen offset:0
BL4 v[84:87],v2,s[8:11],s82 offen offset:1024
BL4 v[88:91],v2,s[8:11],s82 offen offset:2048
BL4 v[92:95],v2,s[8:11],s82 offen offset:3072
s_add_u32 s82, s82, 4096
BL4 v[96:99],v2,s[8:11],s82 offen offset:0
BL4 v[100:103],v2,s[8:11],s82 offen offset:1024
BL4 v[104:107],v2,s[8:11],s82 offen offset:2048
BL4 v[108:111],v2,s[8:11],s82 offen offset:3072
s_add_u32 s82, s82, 4096
v_mov_b32 v240, v212
v_mov_b32 v241, v212
v_mov_b32 v242, v212
v_mov_b32 v243, v212
v_mov_b32 v244, v212
v_mov_b32 v245, v212
v_mov_b32 v246, v212
v_mov_b32 v247, v212
v_mov_b32 v248, v212
v_mov_b32 v249, v212
v_mov_b32 v250, v212
v_mov_b32 v251, v212
v_mov_b32 v252, v212
v_mov_b32 v253, v212
v_mov_b32 v254, v212
v_mov_b32 v255, v212
s_cmp_lg_u32 s80, s81
s_cbranch_scc1 L_a_slow1_0n
v_cndmask_b32 v240, v6, v212, s[32:33]
v_cndmask_b32 v241, v6, v212, s[34:35]
v_cndmask_b32 v242, v6, v212, s[36:37]
v_cndmask_b32 v243, v6, v212, s[38:39]
v_cndmask_b32 v244, v6, v212, s[40:41]
v_cndmask_b32 v245, v6, v212, s[42:43]
v_cndmask_b32 v246, v6, v212, s[44:45]
v_cndmask_b32 v247, v6, v212, s[46:47]
v_cndmask_b32 v248, v6, v212, s[48:49]
v_cndmask_b32 v249, v6, v212, s[50:51]
v_cndmask_b32 v250, v6, v212, s[52:53]
v_cndmask_b32 v251, v6, v212, s[54:55]
v_cndmask_b32 v252, v6, v212, s[56:57]
v_cndmask_b32 v253, v6, v212, s[58:59]
v_cndmask_b32 v254, v6, v212, s[60:61]
v_cndmask_b32 v255, v6, v212, s[62:63]
L_a_slow1_0n:
s_waitcnt vmcnt(0)
s_nop 1
M16 v[144:147],v[16:19],a[144:147],v[240:243]
M16 v[144:147],v[20:23],a[148:151],v[144:147]
M16 v[144:147],v[24:27],a[152:155],v[144:147]
M16 v[144:147],v[28:31],a[156:159],v[144:147]
M16 v[148:151],v[32:35],a[144:147],v[244:247]
M16 v[148:151],v[36:39],a[148:151],v[148:151]
M16 v[148:151],v[40:43],a[152:155],v[148:151]
M16 v[148:151],v[44:47],a[156:159],v[148:151]
M16 v[152:155],v[80:83],a[144:147],v[248:251]
M16 v[152:155],v[84:87],a[148:151],v[152:155]
M16 v[152:155],v[88:91],a[152:155],v[152:155]
M16 v[152:155],v[92:95],a[156:159],v[152:155]
M16 v[156:159],v[96:99],a[144:147],v[252:255]
M16 v[156:159],v[100:103],a[148:151],v[156:159]
M16 v[156:159],v[104:107],a[152:155],v[156:159]
M16 v[156:159],v[108:111],a[156:159],v[156:159]
s_nop 7
v_max3_f32 v184, v144, v145, v184
v_max3_f32 v184, v146, v147, v184
v_max3_f32 v184, v148, v149, v184
v_max3_f32 v184, v150, v151, v184
v_max3_f32 v184, v152, v153, v184
v_max3_f32 v184, v154, v155, v184
v_max3_f32 v184, v156, v157, v184
v_max3_f32 v184, v158, v159, v184
s_add_u32 s82, s82, 16384
s_add_u32 s80, s80, 1
s_cmp_le_u32 s80, s81
s_cbranch_scc1 L_a_slow1_0
v_mov_b32 v185, v184
s_nop 1
v_permlane16_swap_b32 v184, v185
s_nop 1
v_max_f32 v184, v184, v185
v_mov_b32 v185, v184
s_nop 1
v_permlane32_swap_b32 v184, v185
s_nop 1
v_max_f32 v184, v184, v185
v_sub_f32 v212, 0, v184
v_mov_b32 v228, 0
v_sub_f32 v213, 0, v184
v_mov_b32 v229, 0
v_sub_f32 v214, 0, v184
v_mov_b32 v230, 0
v_sub_f32 v215, 0, v184
v_mov_b32 v231, 0
AW a32,0
AW a33,0
AW a34,0
AW a35,0
AW a36,0
AW a37,0
AW a38,0
AW a39,0
AW a40,0
AW a41,0
AW a42,0
AW a43,0
AW a44,0
AW a45,0
AW a46,0
AW a47,0
AW a48,0
AW a49,0
AW a50,0
AW a51,0
AW a52,0
AW a53,0
AW a54,0
AW a55,0
AW a56,0
AW a57,0
AW a58,0
AW a59,0
AW a60,0
AW a61,0
AW a62,0
AW a63,0
s_mov_b32 s80, 0
s_lshl_b32 s82, s21, 20
L_a_slow1_1:
BL4 v[16:19],v2,s[8:11],s82 offen offset:0
BL4 v[20:23],v2,s[8:11],s82 offen offset:1024
BL4 v[24:27],v2,s[8:11],s82 offen offset:2048
BL4 v[28:31],v2,s[8:11],s82 offen offset:3072
s_add_u32 s82, s82, 4096
BL4 v[32:35],v2,s[8:11],s82 offen offset:0
BL4 v[36:39],v2,s[8:11],s82 offen offset:1024
BL4 v[40:43],v2,s[8:11],s82 offen offset:2048
BL4 v[44:47],v2,s[8:11],s82 offen offset:3072
s_add_u32 s82, s82, 4096
BL4 v[80:83],v2,s[8:11],s82 offen offset:0
BL4 v[84:87],v2,s[8:11],s82 offen offset:1024
BL4 v[88:91],v2,s[8:11],s82 offen offset:2048
BL4 v[92:95],v2,s[8:11],s82 offen offset:3072
s_add_u32 s82, s82, 4096
BL4 v[96:99],v2,s[8:11],s82 offen offset:0
BL4 v[100:103],v2,s[8:11],s82 offen offset:1024
BL4 v[104:107],v2,s[8:11],s82 offen offset:2048
BL4 v[108:111],v2,s[8:11],s82 offen offset:3072
s_add_u32 s82, s82, 4096
v_mov_b32 v240, v212
v_mov_b32 v241, v212
v_mov_b32 v242, v212
v_mov_b32 v243, v212
v_mov_b32 v244, v212
v_mov_b32 v245, v212
v_mov_b32 v246, v212
v_mov_b32 v247, v212
v_mov_b32 v248, v212
v_mov_b32 v249, v212
v_mov_b32 v250, v212
v_mov_b32 v251, v212
v_mov_b32 v252, v212
v_mov_b32 v253, v212
v_mov_b32 v254, v212
v_mov_b32 v255, v212
s_cmp_lg_u32 s80, s81
s_cbranch_scc1 L_a_slow1_1n
v_cndmask_b32 v240, v6, v212, s[32:33]
v_cndmask_b32 v241, v6, v212, s[34:35]
v_cndmask_b32 v242, v6, v212, s[36:37]
v_cndmask_b32 v243, v6, v212, s[38:39]
v_cndmask_b32 v244, v6, v212, s[40:41]
v_cndmask_b32 v245, v6, v212, s[42:43]
v_cndmask_b32 v246, v6, v212, s[44:45]
v_cndmask_b32 v247, v6, v212, s[46:47]
v_cndmask_b32 v248, v6, v212, s[48:49]
v_cndmask_b32 v249, v6, v212, s[50:51]
v_cndmask_b32 v250, v6, v212, s[52:53]
v_cndmask_b32 v251, v6, v212, s[54:55]
v_cndmask_b32 v252, v6, v212, s[56:57]
v_cndmask_b32 v253, v6, v212, s[58:59]
v_cndmask_b32 v254, v6, v212, s[60:61]
v_cndmask_b32 v255, v6, v212, s[62:63]
L_a_slow1_1n:
s_waitcnt vmcnt(0)
s_nop 1
M16 v[144:147],v[16:19],a[144:147],v[240:243]
M16 v[144:147],v[20:23],a[148:151],v[144:147]
M16 v[144:147],v[24:27],a[152:155],v[144:147]
M16 v[144:147],v[28:31],a[156:159],v[144:147]
M16 v[148:151],v[32:35],a[144:147],v[244:247]
M16 v[148:151],v[36:39],a[148:151],v[148:151]
M16 v[148:151],v[40:43],a[152:155],v[148:151]
M16 v[148:151],v[44:47],a[156:159],v[148:151]
M16 v[152:155],v[80:83],a[144:147],v[248:251]
M16 v[152:155],v[84:87],a[148:151],v[152:155]
M16 v[152:155],v[88:91],a[152:155],v[152:155]
M16 v[152:155],v[92:95],a[156:159],v[152:155]
M16 v[156:159],v[96:99],a[144:147],v[252:255]
M16 v[156:159],v[100:103],a[148:151],v[156:159]
M16 v[156:159],v[104:107],a[152:155],v[156:159]
M16 v[156:159],v[108:111],a[156:159],v[156:159]
BL4 v[16:19],v2,s[8:11],s82 offen offset:0
BL4 v[20:23],v2,s[8:11],s82 offen offset:1024
BL4 v[24:27],v2,s[8:11],s82 offen offset:2048
BL4 v[28:31],v2,s[8:11],s82 offen offset:3072
s_add_u32 s82, s82, 4096
BL4 v[32:35],v2,s[8:11],s82 offen offset:0
BL4 v[36:39],v2,s[8:11],s82 offen offset:1024
BL4 v[40:43],v2,s[8:11],s82 offen offset:2048
BL4 v[44:47],v2,s[8:11],s82 offen offset:3072
s_add_u32 s82, s82, 4096
BL4 v[80:83],v2,s[8:11],s82 offen offset:0
BL4 v[84:87],v2,s[8:11],s82 offen offset:1024
BL4 v[88:91],v2,s[8:11],s82 offen offset:2048
BL4 v[92:95],v2,s[8:11],s82 offen offset:3072
s_add_u32 s82, s82, 4096
BL4 v[96:99],v2,s[8:11],s82 offen offset:0
BL4 v[100:103],v2,s[8:11],s82 offen offset:1024
BL4 v[104:107],v2,s[8:11],s82 offen offset:2048
BL4 v[108:111],v2,s[8:11],s82 offen offset:3072
s_add_u32 s82, s82, 4096
EXP v144,v144
EXP v145,v145
EXP v146,v146
EXP v147,v147
EXP v148,v148
EXP v149,v149
EXP v150,v150
EXP v151,v151
EXP v152,v152
EXP v153,v153
EXP v154,v154
EXP v155,v155
EXP v156,v156
EXP v157,v157
EXP v158,v158
EXP v159,v159
s_nop 0
v_add_f32 v228, v144, v228
v_add_f32 v229, v145, v229
v_add_f32 v230, v146, v230
v_add_f32 v231, v147, v231
v_add_f32 v228, v148, v228
v_add_f32 v229, v149, v229
v_add_f32 v230, v150, v230
v_add_f32 v231, v151, v231
v_add_f32 v228, v152, v228
v_add_f32 v229, v153, v229
v_add_f32 v230, v154, v230
v_add_f32 v231, v155, v231
v_add_f32 v228, v156, v228
v_add_f32 v229, v157, v229
v_add_f32 v230, v158, v230
v_add_f32 v231, v159, v231
CVT v176,v144,v145
CVT v177,v146,v147
CVT v178,v148,v149
CVT v179,v150,v151
CVT v180,v152,v153
CVT v181,v154,v155
CVT v182,v156,v157
CVT v183,v158,v159
s_waitcnt vmcnt(0)
s_nop 1
M16 a[32:35],v[16:19],v[176:179],a[32:35]
M16 a[32:35],v[20:23],v[180:183],a[32:35]
M16 a[36:39],v[24:27],v[176:179],a[36:39]
M16 a[36:39],v[28:31],v[180:183],a[36:39]
M16 a[40:43],v[32:35],v[176:179],a[40:43]
M16 a[40:43],v[36:39],v[180:183],a[40:43]
M16 a[44:47],v[40:43],v[176:179],a[44:47]
M16 a[44:47],v[44:47],v[180:183],a[44:47]
M16 a[48:51],v[80:83],v[176:179],a[48:51]
M16 a[48:51],v[84:87],v[180:183],a[48:51]
M16 a[52:55],v[88:91],v[176:179],a[52:55]
M16 a[52:55],v[92:95],v[180:183],a[52:55]
M16 a[56:59],v[96:99],v[176:179],a[56:59]
M16 a[56:59],v[100:103],v[180:183],a[56:59]
M16 a[60:63],v[104:107],v[176:179],a[60:63]
M16 a[60:63],v[108:111],v[180:183],a[60:63]
s_nop 7
s_add_u32 s80, s80, 1
s_cmp_le_u32 s80, s81
s_cbranch_scc1 L_a_slow1_1
v_add_f32 v228, v228, v229
v_add_f32 v230, v230, v231
v_add_f32 v228, v228, v230
v_mov_b32 v229, v228
s_nop 1
v_permlane16_swap_b32 v228, v229
s_nop 1
v_add_f32 v228, v228, v229
v_mov_b32 v229, v228
s_nop 1
v_permlane32_swap_b32 v228, v229
s_nop 1
v_add_f32 v228, v228, v229
v_rcp_f32 v230, v228
s_nop 0
v_mov_b32 v231, v230
AR v16,a32
AR v17,a33
AR v18,a34
AR v19,a35
AR v20,a36
AR v21,a37
AR v22,a38
AR v23,a39
v_pk_mul_f32 v[16:17], v[16:17], v[230:231]
v_pk_mul_f32 v[18:19], v[18:19], v[230:231]
v_pk_mul_f32 v[20:21], v[20:21], v[230:231]
v_pk_mul_f32 v[22:23], v[22:23], v[230:231]
CVT v96,v16,v17
CVT v97,v18,v19
CVT v98,v20,v21
CVT v99,v22,v23
v_pk_add_f32 v[16:17], v[16:17], v[18:19]
v_pk_add_f32 v[20:21], v[20:21], v[22:23]
v_pk_add_f32 v[10:11], v[16:17], v[20:21]
AR v24,a40
AR v25,a41
AR v26,a42
AR v27,a43
AR v28,a44
AR v29,a45
AR v30,a46
AR v31,a47
v_pk_mul_f32 v[24:25], v[24:25], v[230:231]
v_pk_mul_f32 v[26:27], v[26:27], v[230:231]
v_pk_mul_f32 v[28:29], v[28:29], v[230:231]
v_pk_mul_f32 v[30:31], v[30:31], v[230:231]
CVT v100,v24,v25
CVT v101,v26,v27
CVT v102,v28,v29
CVT v103,v30,v31
v_pk_add_f32 v[24:25], v[24:25], v[26:27]
v_pk_add_f32 v[28:29], v[28:29], v[30:31]
v_pk_add_f32 v[10:11], v[10:11], v[24:25]
v_pk_add_f32 v[10:11], v[10:11], v[28:29]
AR v32,a48
AR v33,a49
AR v34,a50
AR v35,a51
AR v36,a52
AR v37,a53
AR v38,a54
AR v39,a55
v_pk_mul_f32 v[32:33], v[32:33], v[230:231]
v_pk_mul_f32 v[34:35], v[34:35], v[230:231]
v_pk_mul_f32 v[36:37], v[36:37], v[230:231]
v_pk_mul_f32 v[38:39], v[38:39], v[230:231]
CVT v104,v32,v33
CVT v105,v34,v35
CVT v106,v36,v37
CVT v107,v38,v39
v_pk_add_f32 v[32:33], v[32:33], v[34:35]
v_pk_add_f32 v[36:37], v[36:37], v[38:39]
v_pk_add_f32 v[10:11], v[10:11], v[32:33]
v_pk_add_f32 v[10:11], v[10:11], v[36:37]
AR v40,a56
AR v41,a57
AR v42,a58
AR v43,a59
AR v44,a60
AR v45,a61
AR v46,a62
AR v47,a63
v_pk_mul_f32 v[40:41], v[40:41], v[230:231]
v_pk_mul_f32 v[42:43], v[42:43], v[230:231]
v_pk_mul_f32 v[44:45], v[44:45], v[230:231]
v_pk_mul_f32 v[46:47], v[46:47], v[230:231]
CVT v108,v40,v41
CVT v109,v42,v43
CVT v110,v44,v45
CVT v111,v46,v47
v_pk_add_f32 v[40:41], v[40:41], v[42:43]
v_pk_add_f32 v[44:45], v[44:45], v[46:47]
v_pk_add_f32 v[10:11], v[10:11], v[40:41]
v_pk_add_f32 v[10:11], v[10:11], v[44:45]
s_branch L_a_ok1
L_a_slow2:
s_lshl_b32 s81, s22, 1
s_sub_u32 s81, 30, s81
v_mov_b32 v136, v6
v_mov_b32 v216, 0
v_mov_b32 v217, 0
v_mov_b32 v218, 0
v_mov_b32 v219, 0
s_mov_b32 s80, 0
s_lshl_b32 s82, s21, 20
L_a_slow2_0:
BL4 v[16:19],v2,s[8:11],s82 offen offset:0
BL4 v[20:23],v2,s[8:11],s82 offen offset:1024
BL4 v[24:27],v2,s[8:11],s82 offen offset:2048
BL4 v[28:31],v2,s[8:11],s82 offen offset:3072
s_add_u32 s82, s82, 4096
BL4 v[32:35],v2,s[8:11],s82 offen offset:0
BL4 v[36:39],v2,s[8:11],s82 offen offset:1024
BL4 v[40:43],v2,s[8:11],s82 offen offset:2048
BL4 v[44:47],v2,s[8:11],s82 offen offset:3072
s_add_u32 s82, s82, 4096
BL4 v[48:51],v2,s[8:11],s82 offen offset:0
BL4 v[52:55],v2,s[8:11],s82 offen offset:1024
BL4 v[56:59],v2,s[8:11],s82 offen offset:2048
BL4 v[60:63],v2,s[8:11],s82 offen offset:3072
s_add_u32 s82, s82, 4096
BL4 v[64:67],v2,s[8:11],s82 offen offset:0
BL4 v[68:71],v2,s[8:11],s82 offen offset:1024
BL4 v[72:75],v2,s[8:11],s82 offen offset:2048
BL4 v[76:79],v2,s[8:11],s82 offen offset:3072
s_add_u32 s82, s82, 4096
v_mov_b32 v240, v216
v_mov_b32 v241, v216
v_mov_b32 v242, v216
v_mov_b32 v243, v216
v_mov_b32 v244, v216
v_mov_b32 v245, v216
v_mov_b32 v246, v216
v_mov_b32 v247, v216
v_mov_b32 v248, v216
v_mov_b32 v249, v216
v_mov_b32 v250, v216
v_mov_b32 v251, v216
v_mov_b32 v252, v216
v_mov_b32 v253, v216
v_mov_b32 v254, v216
v_mov_b32 v255, v216
s_cmp_lg_u32 s80, s81
s_cbranch_scc1 L_a_slow2_0n
v_cndmask_b32 v240, v6, v216, s[32:33]
v_cndmask_b32 v241, v6, v216, s[34:35]
v_cndmask_b32 v242, v6, v216, s[36:37]
v_cndmask_b32 v243, v6, v216, s[38:39]
v_cndmask_b32 v244, v6, v216, s[40:41]
v_cndmask_b32 v245, v6, v216, s[42:43]
v_cndmask_b32 v246, v6, v216, s[44:45]
v_cndmask_b32 v247, v6, v216, s[46:47]
v_cndmask_b32 v248, v6, v216, s[48:49]
v_cndmask_b32 v249, v6, v216, s[50:51]
v_cndmask_b32 v250, v6, v216, s[52:53]
v_cndmask_b32 v251, v6, v216, s[54:55]
v_cndmask_b32 v252, v6, v216, s[56:57]
v_cndmask_b32 v253, v6, v216, s[58:59]
v_cndmask_b32 v254, v6, v216, s[60:61]
v_cndmask_b32 v255, v6, v216, s[62:63]
L_a_slow2_0n:
s_waitcnt vmcnt(0)
s_nop 1
M16 v[112:115],v[16:19],a[160:163],v[240:243]
M16 v[112:115],v[20:23],a[164:167],v[112:115]
M16 v[112:115],v[24:27],a[168:171],v[112:115]
M16 v[112:115],v[28:31],a[172:175],v[112:115]
M16 v[116:119],v[32:35],a[160:163],v[244:247]
M16 v[116:119],v[36:39],a[164:167],v[116:119]
M16 v[116:119],v[40:43],a[168:171],v[116:119]
M16 v[116:119],v[44:47],a[172:175],v[116:119]
M16 v[120:123],v[48:51],a[160:163],v[248:251]
M16 v[120:123],v[52:55],a[164:167],v[120:123]
M16 v[120:123],v[56:59],a[168:171],v[120:123]
M16 v[120:123],v[60:63],a[172:175],v[120:123]
M16 v[124:127],v[64:67],a[160:163],v[252:255]
M16 v[124:127],v[68:71],a[164:167],v[124:127]
M16 v[124:127],v[72:75],a[168:171],v[124:127]
M16 v[124:127],v[76:79],a[172:175],v[124:127]
s_nop 7
v_max3_f32 v136, v112, v113, v136
v_max3_f32 v136, v114, v115, v136
v_max3_f32 v136, v116, v117, v136
v_max3_f32 v136, v118, v119, v136
v_max3_f32 v136, v120, v121, v136
v_max3_f32 v136, v122, v123, v136
v_max3_f32 v136, v124, v125, v136
v_max3_f32 v136, v126, v127, v136
s_add_u32 s82, s82, 16384
s_add_u32 s80, s80, 1
s_cmp_le_u32 s80, s81
s_cbranch_scc1 L_a_slow2_0
v_mov_b32 v137, v136
s_nop 1
v_permlane16_swap_b32 v136, v137
s_nop 1
v_max_f32 v136, v136, v137
v_mov_b32 v137, v136
s_nop 1
v_permlane32_swap_b32 v136, v137
s_nop 1
v_max_f32 v136, v136, v137
v_sub_f32 v216, 0, v136
v_mov_b32 v232, 0
v_sub_f32 v217, 0, v136
v_mov_b32 v233, 0
v_sub_f32 v218, 0, v136
v_mov_b32 v234, 0
v_sub_f32 v219, 0, v136
v_mov_b32 v235, 0
AW a64,0
AW a65,0
AW a66,0
AW a67,0
AW a68,0
AW a69,0
AW a70,0
AW a71,0
AW a72,0
AW a73,0
AW a74,0
AW a75,0
AW a76,0
AW a77,0
AW a78,0
AW a79,0
AW a80,0
AW a81,0
AW a82,0
AW a83,0
AW a84,0
AW a85,0
AW a86,0
AW a87,0
AW a88,0
AW a89,0
AW a90,0
AW a91,0
AW a92,0
AW a93,0
AW a94,0
AW a95,0
s_mov_b32 s80, 0
s_lshl_b32 s82, s21, 20
L_a_slow2_1:
BL4 v[16:19],v2,s[8:11],s82 offen offset:0
BL4 v[20:23],v2,s[8:11],s82 offen offset:1024
BL4 v[24:27],v2,s[8:11],s82 offen offset:2048
BL4 v[28:31],v2,s[8:11],s82 offen offset:3072
s_add_u32 s82, s82, 4096
BL4 v[32:35],v2,s[8:11],s82 offen offset:0
BL4 v[36:39],v2,s[8:11],s82 offen offset:1024
BL4 v[40:43],v2,s[8:11],s82 offen offset:2048
BL4 v[44:47],v2,s[8:11],s82 offen offset:3072
s_add_u32 s82, s82, 4096
BL4 v[48:51],v2,s[8:11],s82 offen offset:0
BL4 v[52:55],v2,s[8:11],s82 offen offset:1024
BL4 v[56:59],v2,s[8:11],s82 offen offset:2048
BL4 v[60:63],v2,s[8:11],s82 offen offset:3072
s_add_u32 s82, s82, 4096
BL4 v[64:67],v2,s[8:11],s82 offen offset:0
BL4 v[68:71],v2,s[8:11],s82 offen offset:1024
BL4 v[72:75],v2,s[8:11],s82 offen offset:2048
BL4 v[76:79],v2,s[8:11],s82 offen offset:3072
s_add_u32 s82, s82, 4096
v_mov_b32 v240, v216
v_mov_b32 v241, v216
v_mov_b32 v242, v216
v_mov_b32 v243, v216
v_mov_b32 v244, v216
v_mov_b32 v245, v216
v_mov_b32 v246, v216
v_mov_b32 v247, v216
v_mov_b32 v248, v216
v_mov_b32 v249, v216
v_mov_b32 v250, v216
v_mov_b32 v251, v216
v_mov_b32 v252, v216
v_mov_b32 v253, v216
v_mov_b32 v254, v216
v_mov_b32 v255, v216
s_cmp_lg_u32 s80, s81
s_cbranch_scc1 L_a_slow2_1n
v_cndmask_b32 v240, v6, v216, s[32:33]
v_cndmask_b32 v241, v6, v216, s[34:35]
v_cndmask_b32 v242, v6, v216, s[36:37]
v_cndmask_b32 v243, v6, v216, s[38:39]
v_cndmask_b32 v244, v6, v216, s[40:41]
v_cndmask_b32 v245, v6, v216, s[42:43]
v_cndmask_b32 v246, v6, v216, s[44:45]
v_cndmask_b32 v247, v6, v216, s[46:47]
v_cndmask_b32 v248, v6, v216, s[48:49]
v_cndmask_b32 v249, v6, v216, s[50:51]
v_cndmask_b32 v250, v6, v216, s[52:53]
v_cndmask_b32 v251, v6, v216, s[54:55]
v_cndmask_b32 v252, v6, v216, s[56:57]
v_cndmask_b32 v253, v6, v216, s[58:59]
v_cndmask_b32 v254, v6, v216, s[60:61]
v_cndmask_b32 v255, v6, v216, s[62:63]
L_a_slow2_1n:
s_waitcnt vmcnt(0)
s_nop 1
M16 v[112:115],v[16:19],a[160:163],v[240:243]
M16 v[112:115],v[20:23],a[164:167],v[112:115]
M16 v[112:115],v[24:27],a[168:171],v[112:115]
M16 v[112:115],v[28:31],a[172:175],v[112:115]
M16 v[116:119],v[32:35],a[160:163],v[244:247]
M16 v[116:119],v[36:39],a[164:167],v[116:119]
M16 v[116:119],v[40:43],a[168:171],v[116:119]
M16 v[116:119],v[44:47],a[172:175],v[116:119]
M16 v[120:123],v[48:51],a[160:163],v[248:251]
M16 v[120:123],v[52:55],a[164:167],v[120:123]
M16 v[120:123],v[56:59],a[168:171],v[120:123]
M16 v[120:123],v[60:63],a[172:175],v[120:123]
M16 v[124:127],v[64:67],a[160:163],v[252:255]
M16 v[124:127],v[68:71],a[164:167],v[124:127]
M16 v[124:127],v[72:75],a[168:171],v[124:127]
M16 v[124:127],v[76:79],a[172:175],v[124:127]
BL4 v[16:19],v2,s[8:11],s82 offen offset:0
BL4 v[20:23],v2,s[8:11],s82 offen offset:1024
BL4 v[24:27],v2,s[8:11],s82 offen offset:2048
BL4 v[28:31],v2,s[8:11],s82 offen offset:3072
s_add_u32 s82, s82, 4096
BL4 v[32:35],v2,s[8:11],s82 offen offset:0
BL4 v[36:39],v2,s[8:11],s82 offen offset:1024
BL4 v[40:43],v2,s[8:11],s82 offen offset:2048
BL4 v[44:47],v2,s[8:11],s82 offen offset:3072
s_add_u32 s82, s82, 4096
BL4 v[48:51],v2,s[8:11],s82 offen offset:0
BL4 v[52:55],v2,s[8:11],s82 offen offset:1024
BL4 v[56:59],v2,s[8:11],s82 offen offset:2048
BL4 v[60:63],v2,s[8:11],s82 offen offset:3072
s_add_u32 s82, s82, 4096
BL4 v[64:67],v2,s[8:11],s82 offen offset:0
BL4 v[68:71],v2,s[8:11],s82 offen offset:1024
BL4 v[72:75],v2,s[8:11],s82 offen offset:2048
BL4 v[76:79],v2,s[8:11],s82 offen offset:3072
s_add_u32 s82, s82, 4096
EXP v112,v112
EXP v113,v113
EXP v114,v114
EXP v115,v115
EXP v116,v116
EXP v117,v117
EXP v118,v118
EXP v119,v119
EXP v120,v120
EXP v121,v121
EXP v122,v122
EXP v123,v123
EXP v124,v124
EXP v125,v125
EXP v126,v126
EXP v127,v127
s_nop 0
v_add_f32 v232, v112, v232
v_add_f32 v233, v113, v233
v_add_f32 v234, v114, v234
v_add_f32 v235, v115, v235
v_add_f32 v232, v116, v232
v_add_f32 v233, v117, v233
v_add_f32 v234, v118, v234
v_add_f32 v235, v119, v235
v_add_f32 v232, v120, v232
v_add_f32 v233, v121, v233
v_add_f32 v234, v122, v234
v_add_f32 v235, v123, v235
v_add_f32 v232, v124, v232
v_add_f32 v233, v125, v233
v_add_f32 v234, v126, v234
v_add_f32 v235, v127, v235
CVT v128,v112,v113
CVT v129,v114,v115
CVT v130,v116,v117
CVT v131,v118,v119
CVT v132,v120,v121
CVT v133,v122,v123
CVT v134,v124,v125
CVT v135,v126,v127
s_waitcnt vmcnt(0)
s_nop 1
M16 a[64:67],v[16:19],v[128:131],a[64:67]
M16 a[64:67],v[20:23],v[132:135],a[64:67]
M16 a[68:71],v[24:27],v[128:131],a[68:71]
M16 a[68:71],v[28:31],v[132:135],a[68:71]
M16 a[72:75],v[32:35],v[128:131],a[72:75]
M16 a[72:75],v[36:39],v[132:135],a[72:75]
M16 a[76:79],v[40:43],v[128:131],a[76:79]
M16 a[76:79],v[44:47],v[132:135],a[76:79]
M16 a[80:83],v[48:51],v[128:131],a[80:83]
M16 a[80:83],v[52:55],v[132:135],a[80:83]
M16 a[84:87],v[56:59],v[128:131],a[84:87]
M16 a[84:87],v[60:63],v[132:135],a[84:87]
M16 a[88:91],v[64:67],v[128:131],a[88:91]
M16 a[88:91],v[68:71],v[132:135],a[88:91]
M16 a[92:95],v[72:75],v[128:131],a[92:95]
M16 a[92:95],v[76:79],v[132:135],a[92:95]
s_nop 7
s_add_u32 s80, s80, 1
s_cmp_le_u32 s80, s81
s_cbranch_scc1 L_a_slow2_1
v_add_f32 v232, v232, v233
v_add_f32 v234, v234, v235
v_add_f32 v232, v232, v234
v_mov_b32 v233, v232
s_nop 1
v_permlane16_swap_b32 v232, v233
s_nop 1
v_add_f32 v232, v232, v233
v_mov_b32 v233, v232
s_nop 1
v_permlane32_swap_b32 v232, v233
s_nop 1
v_add_f32 v232, v232, v233
v_rcp_f32 v234, v232
s_nop 0
v_mov_b32 v235, v234
AR v16,a64
AR v17,a65
AR v18,a66
AR v19,a67
AR v20,a68
AR v21,a69
AR v22,a70
AR v23,a71
v_pk_mul_f32 v[16:17], v[16:17], v[234:235]
v_pk_mul_f32 v[18:19], v[18:19], v[234:235]
v_pk_mul_f32 v[20:21], v[20:21], v[234:235]
v_pk_mul_f32 v[22:23], v[22:23], v[234:235]
CVT v176,v16,v17
CVT v177,v18,v19
CVT v178,v20,v21
CVT v179,v22,v23
v_pk_add_f32 v[16:17], v[16:17], v[18:19]
v_pk_add_f32 v[20:21], v[20:21], v[22:23]
v_pk_add_f32 v[10:11], v[16:17], v[20:21]
AR v24,a72
AR v25,a73
AR v26,a74
AR v27,a75
AR v28,a76
AR v29,a77
AR v30,a78
AR v31,a79
v_pk_mul_f32 v[24:25], v[24:25], v[234:235]
v_pk_mul_f32 v[26:27], v[26:27], v[234:235]
v_pk_mul_f32 v[28:29], v[28:29], v[234:235]
v_pk_mul_f32 v[30:31], v[30:31], v[234:235]
CVT v180,v24,v25
CVT v181,v26,v27
CVT v182,v28,v29
CVT v183,v30,v31
v_pk_add_f32 v[24:25], v[24:25], v[26:27]
v_pk_add_f32 v[28:29], v[28:29], v[30:31]
v_pk_add_f32 v[10:11], v[10:11], v[24:25]
v_pk_add_f32 v[10:11], v[10:11], v[28:29]
AR v32,a80
AR v33,a81
AR v34,a82
AR v35,a83
AR v36,a84
AR v37,a85
AR v38,a86
AR v39,a87
v_pk_mul_f32 v[32:33], v[32:33], v[234:235]
v_pk_mul_f32 v[34:35], v[34:35], v[234:235]
v_pk_mul_f32 v[36:37], v[36:37], v[234:235]
v_pk_mul_f32 v[38:39], v[38:39], v[234:235]
CVT v184,v32,v33
CVT v185,v34,v35
CVT v186,v36,v37
CVT v187,v38,v39
v_pk_add_f32 v[32:33], v[32:33], v[34:35]
v_pk_add_f32 v[36:37], v[36:37], v[38:39]
v_pk_add_f32 v[10:11], v[10:11], v[32:33]
v_pk_add_f32 v[10:11], v[10:11], v[36:37]
AR v40,a88
AR v41,a89
AR v42,a90
AR v43,a91
AR v44,a92
AR v45,a93
AR v46,a94
AR v47,a95
v_pk_mul_f32 v[40:41], v[40:41], v[234:235]
v_pk_mul_f32 v[42:43], v[42:43], v[234:235]
v_pk_mul_f32 v[44:45], v[44:45], v[234:235]
v_pk_mul_f32 v[46:47], v[46:47], v[234:235]
CVT v188,v40,v41
CVT v189,v42,v43
CVT v190,v44,v45
CVT v191,v46,v47
v_pk_add_f32 v[40:41], v[40:41], v[42:43]
v_pk_add_f32 v[44:45], v[44:45], v[46:47]
v_pk_add_f32 v[10:11], v[10:11], v[40:41]
v_pk_add_f32 v[10:11], v[10:11], v[44:45]
s_branch L_a_ok2
L_a_slow3:
s_lshl_b32 s81, s22, 1
s_sub_u32 s81, 31, s81
v_mov_b32 v136, v6
v_mov_b32 v220, 0
v_mov_b32 v221, 0
v_mov_b32 v222, 0
v_mov_b32 v223, 0
s_mov_b32 s80, 0
s_lshl_b32 s82, s21, 20
L_a_slow3_0:
BL4 v[16:19],v2,s[8:11],s82 offen offset:0
BL4 v[20:23],v2,s[8:11],s82 offen offset:1024
BL4 v[24:27],v2,s[8:11],s82 offen offset:2048
BL4 v[28:31],v2,s[8:11],s82 offen offset:3072
s_add_u32 s82, s82, 4096
BL4 v[32:35],v2,s[8:11],s82 offen offset:0
BL4 v[36:39],v2,s[8:11],s82 offen offset:1024
BL4 v[40:43],v2,s[8:11],s82 offen offset:2048
BL4 v[44:47],v2,s[8:11],s82 offen offset:3072
s_add_u32 s82, s82, 4096
BL4 v[48:51],v2,s[8:11],s82 offen offset:0
BL4 v[52:55],v2,s[8:11],s82 offen offset:1024
BL4 v[56:59],v2,s[8:11],s82 offen offset:2048
BL4 v[60:63],v2,s[8:11],s82 offen offset:3072
s_add_u32 s82, s82, 4096
BL4 v[64:67],v2,s[8:11],s82 offen offset:0
BL4 v[68:71],v2,s[8:11],s82 offen offset:1024
BL4 v[72:75],v2,s[8:11],s82 offen offset:2048
BL4 v[76:79],v2,s[8:11],s82 offen offset:3072
s_add_u32 s82, s82, 4096
v_mov_b32 v240, v220
v_mov_b32 v241, v220
v_mov_b32 v242, v220
v_mov_b32 v243, v220
v_mov_b32 v244, v220
v_mov_b32 v245, v220
v_mov_b32 v246, v220
v_mov_b32 v247, v220
v_mov_b32 v248, v220
v_mov_b32 v249, v220
v_mov_b32 v250, v220
v_mov_b32 v251, v220
v_mov_b32 v252, v220
v_mov_b32 v253, v220
v_mov_b32 v254, v220
v_mov_b32 v255, v220
s_cmp_lg_u32 s80, s81
s_cbranch_scc1 L_a_slow3_0n
v_cndmask_b32 v240, v6, v220, s[32:33]
v_cndmask_b32 v241, v6, v220, s[34:35]
v_cndmask_b32 v242, v6, v220, s[36:37]
v_cndmask_b32 v243, v6, v220, s[38:39]
v_cndmask_b32 v244, v6, v220, s[40:41]
v_cndmask_b32 v245, v6, v220, s[42:43]
v_cndmask_b32 v246, v6, v220, s[44:45]
v_cndmask_b32 v247, v6, v220, s[46:47]
v_cndmask_b32 v248, v6, v220, s[48:49]
v_cndmask_b32 v249, v6, v220, s[50:51]
v_cndmask_b32 v250, v6, v220, s[52:53]
v_cndmask_b32 v251, v6, v220, s[54:55]
v_cndmask_b32 v252, v6, v220, s[56:57]
v_cndmask_b32 v253, v6, v220, s[58:59]
v_cndmask_b32 v254, v6, v220, s[60:61]
v_cndmask_b32 v255, v6, v220, s[62:63]
L_a_slow3_0n:
s_waitcnt vmcnt(0)
s_nop 1
M16 v[112:115],v[16:19],a[176:179],v[240:243]
M16 v[112:115],v[20:23],a[180:183],v[112:115]
M16 v[112:115],v[24:27],a[184:187],v[112:115]
M16 v[112:115],v[28:31],a[188:191],v[112:115]
M16 v[116:119],v[32:35],a[176:179],v[244:247]
M16 v[116:119],v[36:39],a[180:183],v[116:119]
M16 v[116:119],v[40:43],a[184:187],v[116:119]
M16 v[116:119],v[44:47],a[188:191],v[116:119]
M16 v[120:123],v[48:51],a[176:179],v[248:251]
M16 v[120:123],v[52:55],a[180:183],v[120:123]
M16 v[120:123],v[56:59],a[184:187],v[120:123]
M16 v[120:123],v[60:63],a[188:191],v[120:123]
M16 v[124:127],v[64:67],a[176:179],v[252:255]
M16 v[124:127],v[68:71],a[180:183],v[124:127]
M16 v[124:127],v[72:75],a[184:187],v[124:127]
M16 v[124:127],v[76:79],a[188:191],v[124:127]
s_nop 7
v_max3_f32 v136, v112, v113, v136
v_max3_f32 v136, v114, v115, v136
v_max3_f32 v136, v116, v117, v136
v_max3_f32 v136, v118, v119, v136
v_max3_f32 v136, v120, v121, v136
v_max3_f32 v136, v122, v123, v136
v_max3_f32 v136, v124, v125, v136
v_max3_f32 v136, v126, v127, v136
s_add_u32 s82, s82, 16384
s_add_u32 s80, s80, 1
s_cmp_le_u32 s80, s81
s_cbranch_scc1 L_a_slow3_0
v_mov_b32 v137, v136
s_nop 1
v_permlane16_swap_b32 v136, v137
s_nop 1
v_max_f32 v136, v136, v137
v_mov_b32 v137, v136
s_nop 1
v_permlane32_swap_b32 v136, v137
s_nop 1
v_max_f32 v136, v136, v137
v_sub_f32 v220, 0, v136
v_mov_b32 v236, 0
v_sub_f32 v221, 0, v136
v_mov_b32 v237, 0
v_sub_f32 v222, 0, v136
v_mov_b32 v238, 0
v_sub_f32 v223, 0, v136
v_mov_b32 v239, 0
AW a96,0
AW a97,0
AW a98,0
AW a99,0
AW a100,0
AW a101,0
AW a102,0
AW a103,0
AW a104,0
AW a105,0
AW a106,0
AW a107,0
AW a108,0
AW a109,0
AW a110,0
AW a111,0
AW a112,0
AW a113,0
AW a114,0
AW a115,0
AW a116,0
AW a117,0
AW a118,0
AW a119,0
AW a120,0
AW a121,0
AW a122,0
AW a123,0
AW a124,0
AW a125,0
AW a126,0
AW a127,0
s_mov_b32 s80, 0
s_lshl_b32 s82, s21, 20
L_a_slow3_1:
BL4 v[16:19],v2,s[8:11],s82 offen offset:0
BL4 v[20:23],v2,s[8:11],s82 offen offset:1024
BL4 v[24:27],v2,s[8:11],s82 offen offset:2048
BL4 v[28:31],v2,s[8:11],s82 offen offset:3072
s_add_u32 s82, s82, 4096
BL4 v[32:35],v2,s[8:11],s82 offen offset:0
BL4 v[36:39],v2,s[8:11],s82 offen offset:1024
BL4 v[40:43],v2,s[8:11],s82 offen offset:2048
BL4 v[44:47],v2,s[8:11],s82 offen offset:3072
s_add_u32 s82, s82, 4096
BL4 v[48:51],v2,s[8:11],s82 offen offset:0
BL4 v[52:55],v2,s[8:11],s82 offen offset:1024
BL4 v[56:59],v2,s[8:11],s82 offen offset:2048
BL4 v[60:63],v2,s[8:11],s82 offen offset:3072
s_add_u32 s82, s82, 4096
BL4 v[64:67],v2,s[8:11],s82 offen offset:0
BL4 v[68:71],v2,s[8:11],s82 offen offset:1024
BL4 v[72:75],v2,s[8:11],s82 offen offset:2048
BL4 v[76:79],v2,s[8:11],s82 offen offset:3072
s_add_u32 s82, s82, 4096
v_mov_b32 v240, v220
v_mov_b32 v241, v220
v_mov_b32 v242, v220
v_mov_b32 v243, v220
v_mov_b32 v244, v220
v_mov_b32 v245, v220
v_mov_b32 v246, v220
v_mov_b32 v247, v220
v_mov_b32 v248, v220
v_mov_b32 v249, v220
v_mov_b32 v250, v220
v_mov_b32 v251, v220
v_mov_b32 v252, v220
v_mov_b32 v253, v220
v_mov_b32 v254, v220
v_mov_b32 v255, v220
s_cmp_lg_u32 s80, s81
s_cbranch_scc1 L_a_slow3_1n
v_cndmask_b32 v240, v6, v220, s[32:33]
v_cndmask_b32 v241, v6, v220, s[34:35]
v_cndmask_b32 v242, v6, v220, s[36:37]
v_cndmask_b32 v243, v6, v220, s[38:39]
v_cndmask_b32 v244, v6, v220, s[40:41]
v_cndmask_b32 v245, v6, v220, s[42:43]
v_cndmask_b32 v246, v6, v220, s[44:45]
v_cndmask_b32 v247, v6, v220, s[46:47]
v_cndmask_b32 v248, v6, v220, s[48:49]
v_cndmask_b32 v249, v6, v220, s[50:51]
v_cndmask_b32 v250, v6, v220, s[52:53]
v_cndmask_b32 v251, v6, v220, s[54:55]
v_cndmask_b32 v252, v6, v220, s[56:57]
v_cndmask_b32 v253, v6, v220, s[58:59]
v_cndmask_b32 v254, v6, v220, s[60:61]
v_cndmask_b32 v255, v6, v220, s[62:63]
L_a_slow3_1n:
s_waitcnt vmcnt(0)
s_nop 1
M16 v[112:115],v[16:19],a[176:179],v[240:243]
M16 v[112:115],v[20:23],a[180:183],v[112:115]
M16 v[112:115],v[24:27],a[184:187],v[112:115]
M16 v[112:115],v[28:31],a[188:191],v[112:115]
M16 v[116:119],v[32:35],a[176:179],v[244:247]
M16 v[116:119],v[36:39],a[180:183],v[116:119]
M16 v[116:119],v[40:43],a[184:187],v[116:119]
M16 v[116:119],v[44:47],a[188:191],v[116:119]
M16 v[120:123],v[48:51],a[176:179],v[248:251]
M16 v[120:123],v[52:55],a[180:183],v[120:123]
M16 v[120:123],v[56:59],a[184:187],v[120:123]
M16 v[120:123],v[60:63],a[188:191],v[120:123]
M16 v[124:127],v[64:67],a[176:179],v[252:255]
M16 v[124:127],v[68:71],a[180:183],v[124:127]
M16 v[124:127],v[72:75],a[184:187],v[124:127]
M16 v[124:127],v[76:79],a[188:191],v[124:127]
BL4 v[16:19],v2,s[8:11],s82 offen offset:0
BL4 v[20:23],v2,s[8:11],s82 offen offset:1024
BL4 v[24:27],v2,s[8:11],s82 offen offset:2048
BL4 v[28:31],v2,s[8:11],s82 offen offset:3072
s_add_u32 s82, s82, 4096
BL4 v[32:35],v2,s[8:11],s82 offen offset:0
BL4 v[36:39],v2,s[8:11],s82 offen offset:1024
BL4 v[40:43],v2,s[8:11],s82 offen offset:2048
BL4 v[44:47],v2,s[8:11],s82 offen offset:3072
s_add_u32 s82, s82, 4096
BL4 v[48:51],v2,s[8:11],s82 offen offset:0
BL4 v[52:55],v2,s[8:11],s82 offen offset:1024
BL4 v[56:59],v2,s[8:11],s82 offen offset:2048
BL4 v[60:63],v2,s[8:11],s82 offen offset:3072
s_add_u32 s82, s82, 4096
BL4 v[64:67],v2,s[8:11],s82 offen offset:0
BL4 v[68:71],v2,s[8:11],s82 offen offset:1024
BL4 v[72:75],v2,s[8:11],s82 offen offset:2048
BL4 v[76:79],v2,s[8:11],s82 offen offset:3072
s_add_u32 s82, s82, 4096
EXP v112,v112
EXP v113,v113
EXP v114,v114
EXP v115,v115
EXP v116,v116
EXP v117,v117
EXP v118,v118
EXP v119,v119
EXP v120,v120
EXP v121,v121
EXP v122,v122
EXP v123,v123
EXP v124,v124
EXP v125,v125
EXP v126,v126
EXP v127,v127
s_nop 0
v_add_f32 v236, v112, v236
v_add_f32 v237, v113, v237
v_add_f32 v238, v114, v238
v_add_f32 v239, v115, v239
v_add_f32 v236, v116, v236
v_add_f32 v237, v117, v237
v_add_f32 v238, v118, v238
v_add_f32 v239, v119, v239
v_add_f32 v236, v120, v236
v_add_f32 v237, v121, v237
v_add_f32 v238, v122, v238
v_add_f32 v239, v123, v239
v_add_f32 v236, v124, v236
v_add_f32 v237, v125, v237
v_add_f32 v238, v126, v238
v_add_f32 v239, v127, v239
CVT v128,v112,v113
CVT v129,v114,v115
CVT v130,v116,v117
CVT v131,v118,v119
CVT v132,v120,v121
CVT v133,v122,v123
CVT v134,v124,v125
CVT v135,v126,v127
s_waitcnt vmcnt(0)
s_nop 1
M16 a[96:99],v[16:19],v[128:131],a[96:99]
M16 a[96:99],v[20:23],v[132:135],a[96:99]
M16 a[100:103],v[24:27],v[128:131],a[100:103]
M16 a[100:103],v[28:31],v[132:135],a[100:103]
M16 a[104:107],v[32:35],v[128:131],a[104:107]
M16 a[104:107],v[36:39],v[132:135],a[104:107]
M16 a[108:111],v[40:43],v[128:131],a[108:111]
M16 a[108:111],v[44:47],v[132:135],a[108:111]
M16 a[112:115],v[48:51],v[128:131],a[112:115]
M16 a[112:115],v[52:55],v[132:135],a[112:115]
M16 a[116:119],v[56:59],v[128:131],a[116:119]
M16 a[116:119],v[60:63],v[132:135],a[116:119]
M16 a[120:123],v[64:67],v[128:131],a[120:123]
M16 a[120:123],v[68:71],v[132:135],a[120:123]
M16 a[124:127],v[72:75],v[128:131],a[124:127]
M16 a[124:127],v[76:79],v[132:135],a[124:127]
s_nop 7
s_add_u32 s80, s80, 1
s_cmp_le_u32 s80, s81
s_cbranch_scc1 L_a_slow3_1
v_add_f32 v236, v236, v237
v_add_f32 v238, v238, v239
v_add_f32 v236, v236, v238
v_mov_b32 v237, v236
s_nop 1
v_permlane16_swap_b32 v236, v237
s_nop 1
v_add_f32 v236, v236, v237
v_mov_b32 v237, v236
s_nop 1
v_permlane32_swap_b32 v236, v237
s_nop 1
v_add_f32 v236, v236, v237
v_rcp_f32 v238, v236
s_nop 0
v_mov_b32 v239, v238
AR v48,a96
AR v49,a97
AR v50,a98
AR v51,a99
AR v52,a100
AR v53,a101
AR v54,a102
AR v55,a103
v_pk_mul_f32 v[48:49], v[48:49], v[238:239]
v_pk_mul_f32 v[50:51], v[50:51], v[238:239]
v_pk_mul_f32 v[52:53], v[52:53], v[238:239]
v_pk_mul_f32 v[54:55], v[54:55], v[238:239]
CVT v192,v48,v49
CVT v193,v50,v51
CVT v194,v52,v53
CVT v195,v54,v55
v_pk_add_f32 v[48:49], v[48:49], v[50:51]
v_pk_add_f32 v[52:53], v[52:53], v[54:55]
v_pk_add_f32 v[10:11], v[48:49], v[52:53]
AR v56,a104
AR v57,a105
AR v58,a106
AR v59,a107
AR v60,a108
AR v61,a109
AR v62,a110
AR v63,a111
v_pk_mul_f32 v[56:57], v[56:57], v[238:239]
v_pk_mul_f32 v[58:59], v[58:59], v[238:239]
v_pk_mul_f32 v[60:61], v[60:61], v[238:239]
v_pk_mul_f32 v[62:63], v[62:63], v[238:239]
CVT v196,v56,v57
CVT v197,v58,v59
CVT v198,v60,v61
CVT v199,v62,v63
v_pk_add_f32 v[56:57], v[56:57], v[58:59]
v_pk_add_f32 v[60:61], v[60:61], v[62:63]
v_pk_add_f32 v[10:11], v[10:11], v[56:57]
v_pk_add_f32 v[10:11], v[10:11], v[60:61]
AR v64,a112
AR v65,a113
AR v66,a114
AR v67,a115
AR v68,a116
AR v69,a117
AR v70,a118
AR v71,a119
v_pk_mul_f32 v[64:65], v[64:65], v[238:239]
v_pk_mul_f32 v[66:67], v[66:67], v[238:239]
v_pk_mul_f32 v[68:69], v[68:69], v[238:239]
v_pk_mul_f32 v[70:71], v[70:71], v[238:239]
CVT v200,v64,v65
CVT v201,v66,v67
CVT v202,v68,v69
CVT v203,v70,v71
v_pk_add_f32 v[64:65], v[64:65], v[66:67]
v_pk_add_f32 v[68:69], v[68:69], v[70:71]
v_pk_add_f32 v[10:11], v[10:11], v[64:65]
v_pk_add_f32 v[10:11], v[10:11], v[68:69]
AR v72,a120
AR v73,a121
AR v74,a122
AR v75,a123
AR v76,a124
AR v77,a125
AR v78,a126
AR v79,a127
v_pk_mul_f32 v[72:73], v[72:73], v[238:239]
v_pk_mul_f32 v[74:75], v[74:75], v[238:239]
v_pk_mul_f32 v[76:77], v[76:77], v[238:239]
v_pk_mul_f32 v[78:79], v[78:79], v[238:239]
CVT v204,v72,v73
CVT v205,v74,v75
CVT v206,v76,v77
CVT v207,v78,v79
v_pk_add_f32 v[72:73], v[72:73], v[74:75]
v_pk_add_f32 v[76:77], v[76:77], v[78:79]
v_pk_add_f32 v[10:11], v[10:11], v[72:73]
v_pk_add_f32 v[10:11], v[10:11], v[76:77]
s_branch L_a_ok3
L_a_done:
L_p2_end:
s_barrier
v_mov_b32 v138, v12
v_mov_b32 v95, v14
s_and_b32 s12, s2, 3
s_lshl_b32 s12, s12, 3
s_bfe_u32 s13, s2, 0x30003
s_add_u32 s32, s12, s13
s_bfe_u32 s12, s2, 0x10002
s_lshl_b32 s12, s12, 2
s_lshr_b32 s13, s2, 6
s_add_u32 s33, s12, s13
s_lshl_b32 s32, s32, 7
s_lshl_b32 s33, s33, 2
s_add_u32 s33, s33, s32
s_add_u32 s33, s33, 125894656
s_lshr_b32 s32, s2, 5
BS4 v[192:195],v8,s[8:11],s76 offen sc1
s_add_u32 s76, s76, 4096
s_lshl_b32 s32, s32, 3
s_and_b32 s12, s2, 7
s_add_u32 s32, s32, s12
s_lshl_b32 s32, s32, 7
s_bfe_u32 s12, s2, 0x20003
s_lshl_b32 s12, s12, 2
s_add_u32 s32, s32, s12
s_add_u32 s32, s32, 125829120
v_and_b32 v156, 31, v1
v_lshrrev_b32 v10, 5, v1
v_mul_u32_u24 v157, 5, v156
s_add_u32 s67, s67, 5120
s_mov_b32 s60, 0x5d800000
s_mov_b32 s61, 0x207
s_mov_b32 s34, 0
s_mov_b32 s35, -1
BS4 v[196:199],v8,s[8:11],s76 offen sc1
s_sub_u32 s76, s76, 4096
s_lshl_b32 s12, s20, 4
s_add_u32 s12, s12, 122880
v_add_u32 v11, 4, v157
v_lshrrev_b32 v141, 3, v11
v_lshl_add_u32 v141, v141, 9, s12
v_and_b32 v12, 3, v11
v_lshl_add_u32 v141, v12, 7, v141
v_bfe_u32 v12, v11, 2, 1
v_lshl_add_u32 v141, v12, 3, v141
v_add_u32 v11, v10, v157
v_lshrrev_b32 v139, 3, v11
v_lshl_add_u32 v139, v139, 9, s12
v_and_b32 v12, 3, v11
v_lshl_add_u32 v139, v12, 7, v139
v_bfe_u32 v12, v11, 2, 1
v_lshl_add_u32 v139, v12, 3, v139
BS4 v[200:203],v9,s[8:11],s76 offen sc1
s_add_u32 s76, s76, 4096
v_add_u32 v11, 2, v11
v_lshrrev_b32 v140, 3, v11
v_lshl_add_u32 v140, v140, 9, s12
v_and_b32 v12, 3, v11
v_lshl_add_u32 v140, v12, 7, v140
v_bfe_u32 v12, v11, 2, 1
v_lshl_add_u32 v140, v12, 3, v140
s_mul_i32 s12, s20, 3072
s_add_u32 s12, s12, 61440
v_add_u32 v142, s12, v2
s_mul_i32 s12, s20, 12288
s_add_u32 s12, s12, 61440
v_add_u32 v143, s12, v2
s_mul_i32 s12, s20, 1536
s_add_u32 s12, s12, 110592
v_add_u32 v144, s12, v2
BS4 v[204:207],v9,s[8:11],s76 offen sc1
s_add_u32 s76, s76, 602112
s_add_u32 s12, s12, 1024
v_add_u32 v145, s12, v95
v_add_u32 v146, 110592, v2
v_add_u32 v147, 111616, v95
s_mul_i32 s25, s64, 606208
s_add_u32 s26, s25, 83886080
s_lshr_b32 s12, s65, 1
s_lshl_b32 s12, s12, 10
s_and_b32 s13, s65, 1
s_lshl_b32 s13, s13, 7
s_add_u32 s12, s12, s13
s_add_u32 s25, s26, s12
s_add_u32 s25, s25, 524288
s_lshl_b32 s12, s20, 17
s_add_u32 s26, s26, s12
s_add_u32 s28, s26, 65536
s_mul_i32 s27, s20, 1310720
s_mul_i32 s12, s65, 5120
s_add_u32 s27, s27, s12
s_add_u32 s27, s27, 109051904
s_add_u32 s29, s27, 655360
s_mov_b32 s30, 15
s_mul_i32 s31, s20, 15360
s_waitcnt vmcnt(24)
M32 v[108:123],a[0:3],v[96:99],0
M8 v[108:123],a[32:33],v[100:101],v[108:123]
v_add_u32 v148, 4096, v2
v_add_u32 v153, s31, v2
v_lshlrev_b32 v149, 2, v1
global_load_dword v150, v149, s[88:89] sc1
s_nop 7
v_max3_f32 v102, v108, v109, v110
v_max3_f32 v102, v111, v112, v102
v_max3_f32 v102, v113, v114, v102
v_max3_f32 v102, v115, v116, v102
v_max3_f32 v102, v117, v118, v102
v_max3_f32 v102, v119, v120, v102
v_max3_f32 v102, v121, v122, v102
v_max_f32 v102, v123, v102
v_mov_b32 v103, v102
s_nop 1
v_permlane32_swap_b32 v102, v103
s_nop 1
v_max_f32 v102, v102, v103
v_sub_f32 v102, 0, v102
v_and_b32 v103, 0xffff0000, v102
v_sub_f32 v102, v102, v103
v_and_b32 v104, 0xffff0000, v102
v_sub_f32 v102, v102, v104
v_lshrrev_b32 v103, 16, v103
v_or_b32 v103, v103, v104
v_lshrrev_b32 v102, 16, v102
v_cndmask_b32 v104, v100, v103, s[34:35]
v_cndmask_b32 v105, v101, v102, s[34:35]
ds_write_b128 v144, v[96:99] offset:0
ds_write_b64 v145, v[104:105] offset:0
s_sub_u32 s12, 31, s64
s_min_u32 s12, s12, s64
s_lshr_b32 s12, s12, 1
s_lshl_b32 s36, s12, 3
s_lshl_b32 s12, s20, 1
s_add_u32 s36, s36, s12
s_lshl_b32 s36, s36, 7
s_add_u32 s36, s36, 125829120
v_min_u32 v155, 7, v1
v_lshrrev_b32 v11, 2, v155
v_and_b32 v155, 3, v155
v_lshlrev_b32 v155, 2, v155
v_lshl_add_u32 v155, v11, 7, v155
s_waitcnt lgkmcnt(0)
s_waitcnt vmcnt(1)
s_barrier
s_cmp_lg_u32 s20, 0
s_cbranch_scc1 L_c_nf0
v_mov_b32 v87, 0
v_mov_b32 v94, 1
s_mov_b64 exec, 1
buffer_store_dword v94, v87, s[8:11], s32 offen sc1
s_mov_b64 exec, -1
L_c_nf0:
buffer_load_dword v86, v155, s[8:11], s36 offen sc1
DR v[80:83],v146 offset:0
ds_read_b64 v[84:85], v147 offset:0
BL4 v[96:99],v138,s[8:11],s67 offen
s_mov_b32 exec_hi, 0
buffer_load_dwordx2 v[100:101], v138, s[8:11], s67 offen offset:32
s_mov_b32 exec_hi, -1
s_waitcnt lgkmcnt(0)
M32 v[16:31],a[0:3],v[80:83],0
M8 v[16:31],a[32:33],v[84:85],v[16:31]
s_nop 7
s_nop 3
M32 v[32:47],a[4:7],v[80:83],0
BL4 a[64:67],v2,s[8:11],s68 offen offset:0
EXP v16,v16
EXP v17,v17
EXP v18,v18
EXP v19,v19
M8 v[32:47],a[34:35],v[84:85],v[32:47]
BL4 a[96:99],v2,s[8:11],s70 offen offset:0
BL4 a[100:103],v2,s[8:11],s70 offen offset:1024
EXP v20,v20
CVT v48,v16,v17
EXP v21,v21
CVT v49,v18,v19
EXP v22,v22
EXP v23,v23
CVT v50,v20,v21
EXP v24,v24
M32 v[64:79],a[152:155],v[56:59],v[64:79]
BL4 a[68:71],v2,s[8:11],s68 offen offset:1024
EXP v25,v25
CVT v51,v22,v23
EXP v26,v26
EXP v27,v27
CVT v52,v24,v25
EXP v28,v28
M32 v[64:79],a[156:159],v[60:63],v[64:79]
BL4 a[104:107],v2,s[8:11],s70 offen offset:2048
BL4 a[108:111],v2,s[8:11],s70 offen offset:3072
s_add_u32 s70, s70, 4096
EXP v29,v29
CVT v53,v26,v27
EXP v30,v30
EXP v31,v31
CVT v54,v28,v29
CVT v55,v30,v31
M32 v[16:31],a[8:11],v[80:83],0
BL4 a[72:75],v2,s[8:11],s68 offen offset:2048
EXP v32,v32
EXP v33,v33
EXP v34,v34
EXP v35,v35
M8 v[16:31],a[36:37],v[84:85],v[16:31]
BL4 a[112:115],v2,s[8:11],s70 offen offset:0
BL4 a[116:119],v2,s[8:11],s70 offen offset:1024
EXP v36,v36
CVT v56,v32,v33
EXP v37,v37
CVT v57,v34,v35
EXP v38,v38
EXP v39,v39
CVT v58,v36,v37
EXP v40,v40
M32 v[64:79],a[192:195],v[48:51],0
BL4 a[76:79],v2,s[8:11],s68 offen offset:3072
s_add_u32 s68, s68, 4096
EXP v41,v41
CVT v59,v38,v39
EXP v42,v42
EXP v43,v43
CVT v60,v40,v41
EXP v44,v44
M32 v[64:79],a[196:199],v[52:55],v[64:79]
BL4 a[120:123],v2,s[8:11],s70 offen offset:2048
BL4 a[124:127],v2,s[8:11],s70 offen offset:3072
s_add_u32 s70, s70, 4096
EXP v45,v45
CVT v61,v42,v43
EXP v46,v46
EXP v47,v47
CVT v62,v44,v45
CVT v63,v46,v47
M32 v[32:47],a[12:15],v[80:83],0
BL4 a[80:83],v2,s[8:11],s68 offen offset:0
EXP v16,v16
EXP v17,v17
EXP v18,v18
EXP v19,v19
M8 v[32:47],a[38:39],v[84:85],v[32:47]
BL4 a[128:131],v2,s[8:11],s70 offen offset:0
BL4 a[132:135],v2,s[8:11],s70 offen offset:1024
EXP v20,v20
CVT v48,v16,v17
EXP v21,v21
CVT v49,v18,v19
EXP v22,v22
EXP v23,v23
CVT v50,v20,v21
EXP v24,v24
M32 v[64:79],a[200:203],v[56:59],v[64:79]
BL4 a[84:87],v2,s[8:11],s68 offen offset:1024
EXP v25,v25
CVT v51,v22,v23
EXP v26,v26
EXP v27,v27
CVT v52,v24,v25
EXP v28,v28
M32 v[64:79],a[204:207],v[60:63],v[64:79]
BL4 a[136:139],v2,s[8:11],s70 offen offset:2048
BL4 a[140:143],v2,s[8:11],s70 offen offset:3072
s_add_u32 s70, s70, 4096
EXP v29,v29
CVT v53,v26,v27
EXP v30,v30
EXP v31,v31
CVT v54,v28,v29
CVT v55,v30,v31
M32 v[16:31],a[16:19],v[80:83],0
BL4 a[88:91],v2,s[8:11],s68 offen offset:2048
EXP v32,v32
EXP v33,v33
EXP v34,v34
EXP v35,v35
M8 v[16:31],a[40:41],v[84:85],v[16:31]
BL4 a[144:147],v2,s[8:11],s70 offen offset:0
BL4 a[148:151],v2,s[8:11],s70 offen offset:1024
EXP v36,v36
CVT v56,v32,v33
EXP v37,v37
CVT v57,v34,v35
EXP v38,v38
EXP v39,v39
CVT v58,v36,v37
EXP v40,v40
M32 v[64:79],a[208:211],v[48:51],v[64:79]
BL4 a[92:95],v2,s[8:11],s68 offen offset:3072
s_add_u32 s68, s68, 4096
EXP v41,v41
CVT v59,v38,v39
EXP v42,v42
EXP v43,v43
CVT v60,v40,v41
EXP v44,v44
M32 v[64:79],a[212:215],v[52:55],v[64:79]
BL4 a[152:155],v2,s[8:11],s70 offen offset:2048
BL4 a[156:159],v2,s[8:11],s70 offen offset:3072
s_add_u32 s70, s70, 4096
EXP v45,v45
CVT v61,v42,v43
EXP v46,v46
EXP v47,v47
CVT v62,v44,v45
CVT v63,v46,v47
s_waitcnt vmcnt(26)
L_c_f0:
v_cmp_ne_u32 vcc, 0, v86
s_nop 3
s_and_b32 s56, vcc_lo, 0xf0
s_cmp_lg_u32 s56, 0xf0
s_cbranch_scc1 L_c_g0
s_and_b32 s56, vcc_lo, 15
s_cmp_eq_u32 s56, 15
s_cbranch_scc1 L_c_g0
s_mov_b32 s56, s26
s_mov_b32 s26, s28
s_mov_b32 s28, s56
s_mov_b32 s56, s27
s_mov_b32 s27, s29
s_mov_b32 s29, s56
s_mov_b32 s30, 0xf0
L_c_g0:
L_pl5:
v_readlane_b32 s56, v150, 16
s_nop 3
s_cmp_ge_u32 s56, 224
s_cbranch_scc1 L_pk5
s_cmp_eq_u32 s3, 0
s_cbranch_scc1 L_pk5
s_sub_u32 s3, s3, 1
s_sleep 8
global_load_dword v150, v149, s[88:89] sc1
s_waitcnt vmcnt(0)
s_branch L_pl5
L_pk5:
M32 v[32:47],a[20:23],v[80:83],0
s_add_u32 m0, s31, 0
s_nop 0
BL4 v2,s[8:11],s27 offen lds
EXP v16,v16
EXP v17,v17
EXP v18,v18
EXP v19,v19
M8 v[32:47],a[42:43],v[84:85],v[32:47]
EXP v20,v20
CVT v48,v16,v17
EXP v21,v21
CVT v49,v18,v19
EXP v22,v22
EXP v23,v23
CVT v50,v20,v21
EXP v24,v24
M32 v[64:79],a[216:219],v[56:59],v[64:79]
BL4 v2,s[8:11],s27 offen offset:1024 lds
EXP v25,v25
CVT v51,v22,v23
EXP v26,v26
EXP v27,v27
CVT v52,v24,v25
EXP v28,v28
M32 v[64:79],a[220:223],v[60:63],v[64:79]
EXP v29,v29
CVT v53,v26,v27
EXP v30,v30
EXP v31,v31
CVT v54,v28,v29
CVT v55,v30,v31
M32 v[16:31],a[24:27],v[80:83],0
BL4 v2,s[8:11],s27 offen offset:2048 lds
EXP v32,v32
EXP v33,v33
EXP v34,v34
EXP v35,v35
M8 v[16:31],a[44:45],v[84:85],v[16:31]
EXP v36,v36
CVT v56,v32,v33
EXP v37,v37
CVT v57,v34,v35
DR v[88:91],v146 offset:1536
ds_read_b64 v[92:93], v147 offset:1536
EXP v38,v38
EXP v39,v39
CVT v58,v36,v37
EXP v40,v40
M32 v[64:79],a[224:227],v[48:51],v[64:79]
BL4 v2,s[8:11],s27 offen offset:3072 lds
EXP v41,v41
CVT v59,v38,v39
EXP v42,v42
EXP v43,v43
CVT v60,v40,v41
EXP v44,v44
M32 v[64:79],a[228:231],v[52:55],v[64:79]
EXP v45,v45
CVT v61,v42,v43
EXP v46,v46
EXP v47,v47
CVT v62,v44,v45
CVT v63,v46,v47
M32 v[32:47],a[28:31],v[80:83],0
s_add_u32 m0, s31, 4096
s_nop 0
BL4 v148,s[8:11],s27 offen lds
s_add_u32 s27, s27, 40960
EXP v16,v16
EXP v17,v17
EXP v18,v18
EXP v19,v19
M8 v[32:47],a[46:47],v[84:85],v[32:47]
EXP v20,v20
CVT v48,v16,v17
EXP v21,v21
CVT v49,v18,v19
EXP v22,v22
EXP v23,v23
CVT v50,v20,v21
EXP v24,v24
M32 v[64:79],a[232:235],v[56:59],v[64:79]
s_add_u32 m0, s31, 5120
s_nop 0
BL4 v2,s[8:11],s27 offen lds
EXP v25,v25
CVT v51,v22,v23
EXP v26,v26
EXP v27,v27
CVT v52,v24,v25
EXP v28,v28
M32 v[64:79],a[236:239],v[60:63],v[64:79]
s_waitcnt vmcnt(27)
EXP v29,v29
CVT v53,v26,v27
EXP v30,v30
EXP v31,v31
CVT v54,v28,v29
CVT v55,v30,v31
M32 v[16:31],a[64:67],v[80:83],0
BL4 v2,s[8:11],s27 offen offset:1024 lds
EXP v32,v32
EXP v33,v33
EXP v34,v34
EXP v35,v35
M8 v[16:31],a[48:49],v[84:85],v[16:31]
EXP v36,v36
CVT v56,v32,v33
EXP v37,v37
CVT v57,v34,v35
EXP v38,v38
EXP v39,v39
CVT v58,v36,v37
EXP v40,v40
M32 v[64:79],a[240:243],v[48:51],v[64:79]
BL4 v2,s[8:11],s27 offen offset:2048 lds
EXP v41,v41
CVT v59,v38,v39
EXP v42,v42
EXP v43,v43
CVT v60,v40,v41
EXP v44,v44
M32 v[64:79],a[244:247],v[52:55],v[64:79]
s_waitcnt vmcnt(26)
EXP v45,v45
CVT v61,v42,v43
EXP v46,v46
EXP v47,v47
CVT v62,v44,v45
CVT v63,v46,v47
M32 v[32:47],a[68:71],v[80:83],0
BL4 v2,s[8:11],s27 offen offset:3072 lds
EXP v16,v16
EXP v17,v17
EXP v18,v18
EXP v19,v19
M8 v[32:47],a[50:51],v[84:85],v[32:47]
EXP v20,v20
CVT v48,v16,v17
EXP v21,v21
CVT v49,v18,v19
EXP v22,v22
EXP v23,v23
CVT v50,v20,v21
EXP v24,v24
M32 v[64:79],a[248:251],v[56:59],v[64:79]
s_add_u32 m0, s31, 9216
s_nop 0
BL4 v148,s[8:11],s27 offen lds
s_add_u32 s27, s27, 40960
EXP v25,v25
CVT v51,v22,v23
EXP v26,v26
EXP v27,v27
CVT v52,v24,v25
EXP v28,v28
M32 v[64:79],a[252:255],v[60:63],v[64:79]
s_waitcnt vmcnt(25)
EXP v29,v29
CVT v53,v26,v27
EXP v30,v30
EXP v31,v31
CVT v54,v28,v29
CVT v55,v30,v31
M32 v[16:31],a[72:75],v[80:83],0
s_add_u32 m0, s31, 10240
s_nop 0
BL4 v2,s[8:11],s27 offen lds
EXP v32,v32
EXP v33,v33
EXP v34,v34
EXP v35,v35
M8 v[16:31],a[52:53],v[84:85],v[16:31]
EXP v36,v36
CVT v56,v32,v33
EXP v37,v37
CVT v57,v34,v35
EXP v38,v38
EXP v39,v39
CVT v58,v36,v37
EXP v40,v40
M32 v[64:79],a[96:99],v[48:51],v[64:79]
BL4 v2,s[8:11],s27 offen offset:1024 lds
EXP v41,v41
CVT v59,v38,v39
EXP v42,v42
EXP v43,v43
CVT v60,v40,v41
EXP v44,v44
M32 v[64:79],a[100:103],v[52:55],v[64:79]
s_waitcnt vmcnt(24)
EXP v45,v45
CVT v61,v42,v43
EXP v46,v46
EXP v47,v47
CVT v62,v44,v45
CVT v63,v46,v47
buffer_load_dword v86, v155, s[8:11], s36 offen sc1
M32 v[32:47],a[76:79],v[80:83],0
BL4 v2,s[8:11],s27 offen offset:2048 lds
EXP v16,v16
EXP v17,v17
EXP v18,v18
EXP v19,v19
M8 v[32:47],a[54:55],v[84:85],v[32:47]
EXP v20,v20
CVT v48,v16,v17
EXP v21,v21
CVT v49,v18,v19
EXP v22,v22
EXP v23,v23
CVT v50,v20,v21
EXP v24,v24
M32 v[64:79],a[104:107],v[56:59],v[64:79]
BL4 v2,s[8:11],s27 offen offset:3072 lds
EXP v25,v25
CVT v51,v22,v23
EXP v26,v26
EXP v27,v27
CVT v52,v24,v25
EXP v28,v28
M32 v[64:79],a[108:111],v[60:63],v[64:79]
s_waitcnt vmcnt(24)
EXP v29,v29
CVT v53,v26,v27
EXP v30,v30
EXP v31,v31
CVT v54,v28,v29
CVT v55,v30,v31
M32 v[16:31],a[80:83],v[80:83],0
s_add_u32 m0, s31, 14336
s_nop 0
BL4 v148,s[8:11],s27 offen lds
s_add_u32 s27, s27, 40960
EXP v32,v32
EXP v33,v33
EXP v34,v34
EXP v35,v35
M8 v[16:31],a[56:57],v[84:85],v[16:31]
EXP v36,v36
CVT v56,v32,v33
EXP v37,v37
CVT v57,v34,v35
EXP v38,v38
EXP v39,v39
CVT v58,v36,v37
EXP v40,v40
M32 v[64:79],a[112:115],v[48:51],v[64:79]
EXP v41,v41
CVT v59,v38,v39
EXP v42,v42
EXP v43,v43
CVT v60,v40,v41
EXP v44,v44
M32 v[64:79],a[116:119],v[52:55],v[64:79]
s_waitcnt vmcnt(22)
EXP v45,v45
CVT v61,v42,v43
EXP v46,v46
EXP v47,v47
CVT v62,v44,v45
CVT v63,v46,v47
s_waitcnt vmcnt(3)
L_c_f1:
v_cmp_ne_u32 vcc, 0, v86
s_nop 3
s_and_b32 s56, vcc_lo, s30
s_cmp_eq_u32 s56, s30
s_cbranch_scc1 L_c_g1
s_cmp_eq_u32 s3, 0
s_cbranch_scc1 L_c_g1
s_sub_u32 s3, s3, 1
s_sleep 4
buffer_load_dword v86, v155, s[8:11], s36 offen sc1
s_waitcnt vmcnt(0)
s_branch L_c_f1
L_c_g1:
s_xor_b32 s30, s30, 0xff
M32 v[32:47],a[84:87],v[80:83],0
BL4 a[160:163],v2,s[8:11],s26 offen offset:0
EXP v16,v16
EXP v17,v17
EXP v18,v18
EXP v19,v19
M8 v[32:47],a[58:59],v[84:85],v[32:47]
EXP v20,v20
CVT v48,v16,v17
EXP v21,v21
CVT v49,v18,v19
EXP v22,v22
EXP v23,v23
CVT v50,v20,v21
EXP v24,v24
M32 v[64:79],a[120:123],v[56:59],v[64:79]
BL4 a[164:167],v2,s[8:11],s26 offen offset:1024
EXP v25,v25
CVT v51,v22,v23
EXP v26,v26
EXP v27,v27
CVT v52,v24,v25
EXP v28,v28
M32 v[64:79],a[124:127],v[60:63],v[64:79]
EXP v29,v29
CVT v53,v26,v27
EXP v30,v30
EXP v31,v31
CVT v54,v28,v29
CVT v55,v30,v31
M32 v[16:31],a[88:91],v[80:83],0
BL4 a[168:171],v2,s[8:11],s26 offen offset:2048
EXP v32,v32
EXP v33,v33
EXP v34,v34
EXP v35,v35
M8 v[16:31],a[60:61],v[84:85],v[16:31]
EXP v36,v36
CVT v56,v32,v33
EXP v37,v37
CVT v57,v34,v35
s_waitcnt lgkmcnt(0)
EXP v38,v38
EXP v39,v39
CVT v58,v36,v37
EXP v40,v40
M32 v[64:79],a[128:131],v[48:51],v[64:79]
BL4 a[172:175],v2,s[8:11],s26 offen offset:3072
s_add_u32 s26, s26, 4096
EXP v41,v41
CVT v59,v38,v39
EXP v42,v42
EXP v43,v43
CVT v60,v40,v41
EXP v44,v44
M32 v[64:79],a[132:135],v[52:55],v[64:79]
EXP v45,v45
CVT v61,v42,v43
EXP v46,v46
EXP v47,v47
CVT v62,v44,v45
CVT v63,v46,v47
M32 v[32:47],a[92:95],v[80:83],0
BL4 a[176:179],v2,s[8:11],s26 offen offset:0
EXP v16,v16
EXP v17,v17
EXP v18,v18
EXP v19,v19
M8 v[32:47],a[62:63],v[84:85],v[32:47]
EXP v20,v20
CVT v48,v16,v17
EXP v21,v21
CVT v49,v18,v19
EXP v22,v22
EXP v23,v23
CVT v50,v20,v21
EXP v24,v24
M32 v[64:79],a[136:139],v[56:59],v[64:79]
BL4 a[180:183],v2,s[8:11],s26 offen offset:1024
EXP v25,v25
CVT v51,v22,v23
EXP v26,v26
EXP v27,v27
CVT v52,v24,v25
EXP v28,v28
M32 v[64:79],a[140:143],v[60:63],v[64:79]
EXP v29,v29
CVT v53,v26,v27
EXP v30,v30
EXP v31,v31
CVT v54,v28,v29
CVT v55,v30,v31
M32 v[16:31],a[0:3],v[88:91],0
BL4 a[184:187],v2,s[8:11],s26 offen offset:2048
EXP v32,v32
EXP v33,v33
EXP v34,v34
EXP v35,v35
M8 v[16:31],a[32:33],v[92:93],v[16:31]
EXP v36,v36
CVT v56,v32,v33
EXP v37,v37
CVT v57,v34,v35
EXP v38,v38
EXP v39,v39
CVT v58,v36,v37
EXP v40,v40
M32 v[64:79],a[144:147],v[48:51],v[64:79]
BL4 a[188:191],v2,s[8:11],s26 offen offset:3072
s_add_u32 s26, s26, 4096
EXP v41,v41
CVT v59,v38,v39
EXP v42,v42
EXP v43,v43
CVT v60,v40,v41
EXP v44,v44
M32 v[64:79],a[148:151],v[52:55],v[64:79]
EXP v45,v45
CVT v61,v42,v43
EXP v46,v46
EXP v47,v47
CVT v62,v44,v45
CVT v63,v46,v47
DR v[156:159],v153 offset:0
DR v[160:163],v153 offset:1024
DR v[164:167],v153 offset:2048
DR v[168:171],v153 offset:3072
DR v[172:175],v153 offset:4096
s_waitcnt vmcnt(7)
M32 v[32:47],a[4:7],v[88:91],0
s_waitcnt lgkmcnt(1)
EXP v16,v16
EXP v17,v17
EXP v18,v18
M16 v[176:179],v[156:159],a[160:163],0
EXP v19,v19
M8 v[32:47],a[34:35],v[92:93],v[32:47]
EXP v20,v20
EXP v21,v21
CVT v48,v16,v17
CVT v49,v18,v19
EXP v22,v22
M16 v[192:195],v[160:163],a[160:163],0
EXP v23,v23
M32 v[64:79],a[152:155],v[56:59],v[64:79]
EXP v24,v24
EXP v25,v25
CVT v50,v20,v21
CVT v51,v22,v23
M16 v[208:211],v[164:167],a[160:163],0
s_add_u32 m0, s31, 0
EXP v26,v26
M32 v[64:79],a[156:159],v[60:63],v[64:79]
s_waitcnt lgkmcnt(0)
EXP v27,v27
EXP v28,v28
EXP v29,v29
M16 v[224:227],v[168:171],a[160:163],0
BL4 v2,s[8:11],s27 offen lds
CVT v52,v24,v25
CVT v53,v26,v27
M16 v[240:243],v[172:175],a[160:163],0
BL4 a[160:163],v2,s[8:11],s26 offen offset:0
EXP v30,v30
EXP v31,v31
CVT v54,v28,v29
CVT v55,v30,v31
M32 v[16:31],a[8:11],v[88:91],0
s_waitcnt vmcnt(8)
EXP v32,v32
EXP v33,v33
EXP v34,v34
M16 v[180:183],v[156:159],a[164:167],0
EXP v35,v35
M8 v[16:31],a[36:37],v[92:93],v[16:31]
ds_write_b128 v142, v[64:67] offset:0
EXP v36,v36
EXP v37,v37
CVT v56,v32,v33
CVT v57,v34,v35
ds_write_b128 v142, v[68:71] offset:1024
EXP v38,v38
M16 v[196:199],v[160:163],a[164:167],0
BL4 v2,s[8:11],s27 offen offset:1024 lds
EXP v39,v39
ds_write_b128 v142, v[72:75] offset:2048
M32 v[64:79],a[192:195],v[48:51],0
EXP v40,v40
EXP v41,v41
CVT v58,v36,v37
CVT v59,v38,v39
M16 v[212:215],v[164:167],a[164:167],0
EXP v42,v42
M32 v[64:79],a[196:199],v[52:55],v[64:79]
EXP v43,v43
EXP v44,v44
EXP v45,v45
M16 v[228:231],v[168:171],a[164:167],0
BL4 v2,s[8:11],s27 offen offset:2048 lds
CVT v60,v40,v41
CVT v61,v42,v43
M16 v[244:247],v[172:175],a[164:167],0
BL4 a[164:167],v2,s[8:11],s26 offen offset:1024
EXP v46,v46
EXP v47,v47
CVT v62,v44,v45
CVT v63,v46,v47
M32 v[32:47],a[12:15],v[88:91],0
s_waitcnt vmcnt(10)
EXP v16,v16
EXP v17,v17
EXP v18,v18
M16 v[184:187],v[156:159],a[168:171],0
EXP v19,v19
M8 v[32:47],a[38:39],v[92:93],v[32:47]
EXP v20,v20
EXP v21,v21
CVT v48,v16,v17
CVT v49,v18,v19
EXP v22,v22
M16 v[200:203],v[160:163],a[168:171],0
BL4 v2,s[8:11],s27 offen offset:3072 lds
EXP v23,v23
M32 v[64:79],a[200:203],v[56:59],v[64:79]
EXP v24,v24
EXP v25,v25
CVT v50,v20,v21
CVT v51,v22,v23
M16 v[216:219],v[164:167],a[168:171],0
s_add_u32 m0, s31, 4096
EXP v26,v26
M32 v[64:79],a[204:207],v[60:63],v[64:79]
EXP v27,v27
EXP v28,v28
EXP v29,v29
M16 v[232:235],v[168:171],a[168:171],0
BL4 v148,s[8:11],s27 offen lds
CVT v52,v24,v25
CVT v53,v26,v27
M16 v[248:251],v[172:175],a[168:171],0
BL4 a[168:171],v2,s[8:11],s26 offen offset:2048
EXP v30,v30
EXP v31,v31
CVT v54,v28,v29
CVT v55,v30,v31
M32 v[16:31],a[16:19],v[88:91],0
s_waitcnt vmcnt(11)
EXP v32,v32
EXP v33,v33
EXP v34,v34
M16 v[188:191],v[156:159],a[172:175],0
DR v[156:159],v153 offset:5120
EXP v35,v35
M8 v[16:31],a[40:41],v[92:93],v[16:31]
EXP v36,v36
EXP v37,v37
CVT v56,v32,v33
CVT v57,v34,v35
EXP v38,v38
M16 v[204:207],v[160:163],a[172:175],0
DR v[160:163],v153 offset:6144
EXP v39,v39
M32 v[64:79],a[208:211],v[48:51],v[64:79]
EXP v40,v40
EXP v41,v41
CVT v58,v36,v37
CVT v59,v38,v39
M16 v[220:223],v[164:167],a[172:175],0
DR v[164:167],v153 offset:7168
EXP v42,v42
M32 v[64:79],a[212:215],v[52:55],v[64:79]
EXP v43,v43
EXP v44,v44
EXP v45,v45
M16 v[236:239],v[168:171],a[172:175],0
DR v[168:171],v153 offset:8192
CVT v60,v40,v41
CVT v61,v42,v43
M16 v[252:255],v[172:175],a[172:175],0
BL4 a[172:175],v2,s[8:11],s26 offen offset:3072
EXP v46,v46
EXP v47,v47
CVT v62,v44,v45
CVT v63,v46,v47
M32 v[32:47],a[20:23],v[88:91],0
s_waitcnt lgkmcnt(0)
EXP v16,v16
EXP v17,v17
EXP v18,v18
M16 v[176:179],v[156:159],a[176:179],v[176:179]
DR v[172:175],v153 offset:9216
EXP v19,v19
M8 v[32:47],a[42:43],v[92:93],v[32:47]
EXP v20,v20
EXP v21,v21
CVT v48,v16,v17
CVT v49,v18,v19
EXP v22,v22
M16 v[192:195],v[160:163],a[176:179],v[192:195]
EXP v23,v23
M32 v[64:79],a[216:219],v[56:59],v[64:79]
s_add_u32 s26, s26, 4096
EXP v24,v24
EXP v25,v25
CVT v50,v20,v21
CVT v51,v22,v23
M16 v[208:211],v[164:167],a[176:179],v[208:211]
s_add_u32 s27, s27, 40960
s_add_u32 m0, s31, 5120
EXP v26,v26
M32 v[64:79],a[220:223],v[60:63],v[64:79]
s_waitcnt lgkmcnt(0)
EXP v27,v27
EXP v28,v28
EXP v29,v29
M16 v[224:227],v[168:171],a[176:179],v[224:227]
BL4 v2,s[8:11],s27 offen lds
CVT v52,v24,v25
CVT v53,v26,v27
M16 v[240:243],v[172:175],a[176:179],v[240:243]
BL4 a[176:179],v2,s[8:11],s26 offen offset:0
EXP v30,v30
EXP v31,v31
CVT v54,v28,v29
CVT v55,v30,v31
M32 v[16:31],a[24:27],v[88:91],0
s_waitcnt vmcnt(13)
EXP v32,v32
EXP v33,v33
EXP v34,v34
M16 v[180:183],v[156:159],a[180:183],v[180:183]
DR v[80:83],v146 offset:3072
EXP v35,v35
M8 v[16:31],a[44:45],v[92:93],v[16:31]
ds_read_b64 v[84:85], v147 offset:3072
EXP v36,v36
EXP v37,v37
CVT v56,v32,v33
CVT v57,v34,v35
EXP v38,v38
M16 v[196:199],v[160:163],a[180:183],v[196:199]
BL4 v2,s[8:11],s27 offen offset:1024 lds
EXP v39,v39
M32 v[64:79],a[224:227],v[48:51],v[64:79]
EXP v40,v40
EXP v41,v41
CVT v58,v36,v37
CVT v59,v38,v39
M16 v[212:215],v[164:167],a[180:183],v[212:215]
EXP v42,v42
M32 v[64:79],a[228:231],v[52:55],v[64:79]
EXP v43,v43
EXP v44,v44
EXP v45,v45
M16 v[228:231],v[168:171],a[180:183],v[228:231]
BL4 v2,s[8:11],s27 offen offset:2048 lds
CVT v60,v40,v41
CVT v61,v42,v43
M16 v[244:247],v[172:175],a[180:183],v[244:247]
BL4 a[180:183],v2,s[8:11],s26 offen offset:1024
EXP v46,v46
EXP v47,v47
CVT v62,v44,v45
CVT v63,v46,v47
M32 v[32:47],a[28:31],v[88:91],0
s_waitcnt vmcnt(15)
EXP v16,v16
EXP v17,v17
EXP v18,v18
M16 v[184:187],v[156:159],a[184:187],v[184:187]
EXP v19,v19
M8 v[32:47],a[46:47],v[92:93],v[32:47]
EXP v20,v20
EXP v21,v21
CVT v48,v16,v17
CVT v49,v18,v19
EXP v22,v22
M16 v[200:203],v[160:163],a[184:187],v[200:203]
BL4 v2,s[8:11],s27 offen offset:3072 lds
EXP v23,v23
M32 v[64:79],a[232:235],v[56:59],v[64:79]
EXP v24,v24
EXP v25,v25
CVT v50,v20,v21
CVT v51,v22,v23
M16 v[216:219],v[164:167],a[184:187],v[216:219]
s_add_u32 m0, s31, 9216
EXP v26,v26
M32 v[64:79],a[236:239],v[60:63],v[64:79]
EXP v27,v27
EXP v28,v28
EXP v29,v29
M16 v[232:235],v[168:171],a[184:187],v[232:235]
BL4 v148,s[8:11],s27 offen lds
CVT v52,v24,v25
CVT v53,v26,v27
M16 v[248:251],v[172:175],a[184:187],v[248:251]
BL4 a[184:187],v2,s[8:11],s26 offen offset:2048
EXP v30,v30
EXP v31,v31
CVT v54,v28,v29
CVT v55,v30,v31
M32 v[16:31],a[64:67],v[88:91],0
s_waitcnt vmcnt(15)
EXP v32,v32
EXP v33,v33
EXP v34,v34
M16 v[188:191],v[156:159],a[188:191],v[188:191]
DR v[156:159],v153 offset:10240
EXP v35,v35
M8 v[16:31],a[48:49],v[92:93],v[16:31]
EXP v36,v36
EXP v37,v37
CVT v56,v32,v33
CVT v57,v34,v35
EXP v38,v38
M16 v[204:207],v[160:163],a[188:191],v[204:207]
DR v[160:163],v153 offset:11264
EXP v39,v39
M32 v[64:79],a[240:243],v[48:51],v[64:79]
EXP v40,v40
EXP v41,v41
CVT v58,v36,v37
CVT v59,v38,v39
M16 v[220:223],v[164:167],a[188:191],v[220:223]
DR v[164:167],v153 offset:12288
EXP v42,v42
M32 v[64:79],a[244:247],v[52:55],v[64:79]
EXP v43,v43
EXP v44,v44
EXP v45,v45
M16 v[236:239],v[168:171],a[188:191],v[236:239]
DR v[168:171],v153 offset:13312
CVT v60,v40,v41
CVT v61,v42,v43
M16 v[252:255],v[172:175],a[188:191],v[252:255]
BL4 a[188:191],v2,s[8:11],s26 offen offset:3072
EXP v46,v46
EXP v47,v47
CVT v62,v44,v45
CVT v63,v46,v47
M32 v[32:47],a[68:71],v[88:91],0
s_waitcnt lgkmcnt(0)
EXP v16,v16
EXP v17,v17
EXP v18,v18
M16 v[176:179],v[156:159],a[160:163],v[176:179]
DR v[172:175],v153 offset:14336
EXP v19,v19
M8 v[32:47],a[50:51],v[92:93],v[32:47]
EXP v20,v20
EXP v21,v21
CVT v48,v16,v17
CVT v49,v18,v19
M32 v[108:123],a[0:3],v[96:99],0
EXP v22,v22
M16 v[192:195],v[160:163],a[160:163],v[192:195]
EXP v23,v23
M32 v[64:79],a[248:251],v[56:59],v[64:79]
s_add_u32 s26, s26, 4096
EXP v24,v24
EXP v25,v25
CVT v50,v20,v21
CVT v51,v22,v23
M16 v[208:211],v[164:167],a[160:163],v[208:211]
s_add_u32 s27, s27, 40960
s_add_u32 m0, s31, 10240
EXP v26,v26
M32 v[64:79],a[252:255],v[60:63],v[64:79]
s_waitcnt lgkmcnt(0)
EXP v27,v27
EXP v28,v28
M8 v[108:123],a[32:33],v[100:101],v[108:123]
EXP v29,v29
M16 v[224:227],v[168:171],a[160:163],v[224:227]
BL4 v2,s[8:11],s27 offen lds
CVT v52,v24,v25
CVT v53,v26,v27
M16 v[240:243],v[172:175],a[160:163],v[240:243]
BL4 a[160:163],v2,s[8:11],s26 offen offset:0
EXP v30,v30
EXP v31,v31
CVT v54,v28,v29
CVT v55,v30,v31
M32 v[16:31],a[72:75],v[88:91],0
s_waitcnt vmcnt(15)
EXP v32,v32
EXP v33,v33
EXP v34,v34
M16 v[180:183],v[156:159],a[164:167],v[180:183]
EXP v35,v35
M8 v[16:31],a[52:53],v[92:93],v[16:31]
EXP v36,v36
EXP v37,v37
CVT v56,v32,v33
CVT v57,v34,v35
EXP v38,v38
M16 v[196:199],v[160:163],a[164:167],v[196:199]
BL4 v2,s[8:11],s27 offen offset:1024 lds
EXP v39,v39
M32 v[64:79],a[96:99],v[48:51],v[64:79]
EXP v40,v40
EXP v41,v41
CVT v58,v36,v37
CVT v59,v38,v39
M16 v[212:215],v[164:167],a[164:167],v[212:215]
EXP v42,v42
M32 v[64:79],a[100:103],v[52:55],v[64:79]
EXP v43,v43
EXP v44,v44
EXP v45,v45
M16 v[228:231],v[168:171],a[164:167],v[228:231]
BL4 v2,s[8:11],s27 offen offset:2048 lds
CVT v60,v40,v41
CVT v61,v42,v43
M16 v[244:247],v[172:175],a[164:167],v[244:247]
BL4 a[164:167],v2,s[8:11],s26 offen offset:1024
EXP v46,v46
EXP v47,v47
CVT v62,v44,v45
CVT v63,v46,v47
M32 v[32:47],a[76:79],v[88:91],0
s_waitcnt vmcnt(15)
EXP v16,v16
EXP v17,v17
EXP v18,v18
M16 v[184:187],v[156:159],a[168:171],v[184:187]
EXP v19,v19
M8 v[32:47],a[54:55],v[92:93],v[32:47]
EXP v20,v20
EXP v21,v21
CVT v48,v16,v17
CVT v49,v18,v19
v_max3_f32 v102, v108, v109, v110
v_max3_f32 v102, v111, v112, v102
v_max3_f32 v102, v113, v114, v102
v_max3_f32 v102, v115, v116, v102
v_max3_f32 v102, v117, v118, v102
v_max3_f32 v102, v119, v120, v102
v_max3_f32 v102, v121, v122, v102
v_max_f32 v102, v123, v102
v_mov_b32 v103, v102
EXP v22,v22
M16 v[200:203],v[160:163],a[168:171],v[200:203]
BL4 v2,s[8:11],s27 offen offset:3072 lds
EXP v23,v23
M32 v[64:79],a[104:107],v[56:59],v[64:79]
EXP v24,v24
EXP v25,v25
v_permlane32_swap_b32 v102, v103
CVT v50,v20,v21
CVT v51,v22,v23
M16 v[216:219],v[164:167],a[168:171],v[216:219]
s_add_u32 m0, s31, 14336
EXP v26,v26
M32 v[64:79],a[108:111],v[60:63],v[64:79]
EXP v27,v27
EXP v28,v28
v_max_f32 v102, v102, v103
v_sub_f32 v102, 0, v102
v_and_b32 v103, 0xffff0000, v102
v_sub_f32 v102, v102, v103
v_and_b32 v104, 0xffff0000, v102
v_sub_f32 v102, v102, v104
v_lshrrev_b32 v103, 16, v103
v_or_b32 v103, v103, v104
v_lshrrev_b32 v102, 16, v102
v_cndmask_b32 v104, v100, v103, s[34:35]
v_cndmask_b32 v105, v101, v102, s[34:35]
EXP v29,v29
M16 v[232:235],v[168:171],a[168:171],v[232:235]
BL4 v148,s[8:11],s27 offen lds
CVT v52,v24,v25
CVT v53,v26,v27
M16 v[248:251],v[172:175],a[168:171],v[248:251]
BL4 a[168:171],v2,s[8:11],s26 offen offset:2048
EXP v30,v30
EXP v31,v31
CVT v54,v28,v29
CVT v55,v30,v31
M32 v[16:31],a[80:83],v[88:91],0
s_waitcnt vmcnt(15)
EXP v32,v32
EXP v33,v33
EXP v34,v34
M16 v[188:191],v[156:159],a[172:175],v[188:191]
DR v[156:159],v153 offset:0
EXP v35,v35
M8 v[16:31],a[56:57],v[92:93],v[16:31]
EXP v36,v36
EXP v37,v37
CVT v56,v32,v33
CVT v57,v34,v35
EXP v38,v38
M16 v[204:207],v[160:163],a[172:175],v[204:207]
DR v[160:163],v153 offset:1024
EXP v39,v39
M32 v[64:79],a[112:115],v[48:51],v[64:79]
EXP v40,v40
EXP v41,v41
CVT v58,v36,v37
CVT v59,v38,v39
M16 v[220:223],v[164:167],a[172:175],v[220:223]
DR v[164:167],v153 offset:2048
EXP v42,v42
M32 v[64:79],a[116:119],v[52:55],v[64:79]
EXP v43,v43
EXP v44,v44
EXP v45,v45
M16 v[236:239],v[168:171],a[172:175],v[236:239]
DR v[168:171],v153 offset:3072
CVT v60,v40,v41
CVT v61,v42,v43
M16 v[252:255],v[172:175],a[172:175],v[252:255]
BL4 a[172:175],v2,s[8:11],s26 offen offset:3072
EXP v46,v46
EXP v47,v47
CVT v62,v44,v45
CVT v63,v46,v47
M32 v[32:47],a[84:87],v[88:91],0
s_waitcnt lgkmcnt(0)
EXP v16,v16
EXP v17,v17
EXP v18,v18
M16 v[176:179],v[156:159],a[176:179],v[176:179]
DR v[172:175],v153 offset:4096
EXP v19,v19
M8 v[32:47],a[58:59],v[92:93],v[32:47]
ds_write_b128 v144, v[96:99] offset:6144
EXP v20,v20
EXP v21,v21
CVT v48,v16,v17
CVT v49,v18,v19
EXP v22,v22
M16 v[192:195],v[160:163],a[176:179],v[192:195]
ds_write_b64 v145, v[104:105] offset:6144
EXP v23,v23
M32 v[64:79],a[120:123],v[56:59],v[64:79]
s_add_u32 s26, s26, 4096
EXP v24,v24
EXP v25,v25
CVT v50,v20,v21
CVT v51,v22,v23
M16 v[208:211],v[164:167],a[176:179],v[208:211]
s_add_u32 s27, s27, 40960
s_add_u32 m0, s31, 0
EXP v26,v26
M32 v[64:79],a[124:127],v[60:63],v[64:79]
s_waitcnt lgkmcnt(2)
EXP v27,v27
EXP v28,v28
EXP v29,v29
M16 v[224:227],v[168:171],a[176:179],v[224:227]
BL4 v2,s[8:11],s27 offen lds
CVT v52,v24,v25
CVT v53,v26,v27
M16 v[240:243],v[172:175],a[176:179],v[240:243]
BL4 a[176:179],v2,s[8:11],s26 offen offset:0
EXP v30,v30
EXP v31,v31
CVT v54,v28,v29
CVT v55,v30,v31
M32 v[16:31],a[88:91],v[88:91],0
s_waitcnt vmcnt(15)
EXP v32,v32
EXP v33,v33
EXP v34,v34
M16 v[180:183],v[156:159],a[180:183],v[180:183]
EXP v35,v35
M8 v[16:31],a[60:61],v[92:93],v[16:31]
EXP v36,v36
EXP v37,v37
CVT v56,v32,v33
CVT v57,v34,v35
EXP v38,v38
M16 v[196:199],v[160:163],a[180:183],v[196:199]
BL4 v2,s[8:11],s27 offen offset:1024 lds
EXP v39,v39
M32 v[64:79],a[128:131],v[48:51],v[64:79]
EXP v40,v40
EXP v41,v41
CVT v58,v36,v37
CVT v59,v38,v39
M16 v[212:215],v[164:167],a[180:183],v[212:215]
EXP v42,v42
M32 v[64:79],a[132:135],v[52:55],v[64:79]
EXP v43,v43
EXP v44,v44
EXP v45,v45
M16 v[228:231],v[168:171],a[180:183],v[228:231]
BL4 v2,s[8:11],s27 offen offset:2048 lds
CVT v60,v40,v41
CVT v61,v42,v43
M16 v[244:247],v[172:175],a[180:183],v[244:247]
BL4 a[180:183],v2,s[8:11],s26 offen offset:1024
EXP v46,v46
EXP v47,v47
CVT v62,v44,v45
CVT v63,v46,v47
M32 v[32:47],a[92:95],v[88:91],0
s_waitcnt vmcnt(15)
EXP v16,v16
EXP v17,v17
EXP v18,v18
M16 v[184:187],v[156:159],a[184:187],v[184:187]
EXP v19,v19
M8 v[32:47],a[62:63],v[92:93],v[32:47]
EXP v20,v20
EXP v21,v21
CVT v48,v16,v17
CVT v49,v18,v19
EXP v22,v22
M16 v[200:203],v[160:163],a[184:187],v[200:203]
BL4 v2,s[8:11],s27 offen offset:3072 lds
EXP v23,v23
M32 v[64:79],a[136:139],v[56:59],v[64:79]
EXP v24,v24
EXP v25,v25
CVT v50,v20,v21
CVT v51,v22,v23
M16 v[216:219],v[164:167],a[184:187],v[216:219]
s_add_u32 m0, s31, 4096
EXP v26,v26
M32 v[64:79],a[140:143],v[60:63],v[64:79]
EXP v27,v27
EXP v28,v28
EXP v29,v29
M16 v[232:235],v[168:171],a[184:187],v[232:235]
BL4 v148,s[8:11],s27 offen lds
s_add_u32 s27, s27, 40960
CVT v52,v24,v25
CVT v53,v26,v27
M16 v[248:251],v[172:175],a[184:187],v[248:251]
BL4 a[184:187],v2,s[8:11],s26 offen offset:2048
EXP v30,v30
EXP v31,v31
CVT v54,v28,v29
CVT v55,v30,v31
M32 v[16:31],a[0:3],v[80:83],0
s_waitcnt vmcnt(15)
EXP v32,v32
EXP v33,v33
EXP v34,v34
M16 v[188:191],v[156:159],a[188:191],v[188:191]
DR v[156:159],v153 offset:5120
EXP v35,v35
M8 v[16:31],a[32:33],v[84:85],v[16:31]
EXP v36,v36
EXP v37,v37
CVT v56,v32,v33
CVT v57,v34,v35
EXP v38,v38
M16 v[204:207],v[160:163],a[188:191],v[204:207]
DR v[160:163],v153 offset:6144
EXP v39,v39
M32 v[64:79],a[144:147],v[48:51],v[64:79]
EXP v40,v40
EXP v41,v41
CVT v58,v36,v37
CVT v59,v38,v39
M16 v[220:223],v[164:167],a[188:191],v[220:223]
DR v[164:167],v153 offset:7168
EXP v42,v42
M32 v[64:79],a[148:151],v[52:55],v[64:79]
EXP v43,v43
EXP v44,v44
EXP v45,v45
M16 v[236:239],v[168:171],a[188:191],v[236:239]
DR v[168:171],v153 offset:8192
CVT v60,v40,v41
CVT v61,v42,v43
M16 v[252:255],v[172:175],a[188:191],v[252:255]
BL4 a[188:191],v2,s[8:11],s26 offen offset:3072
s_add_u32 s26, s26, 4096
EXP v46,v46
EXP v47,v47
CVT v62,v44,v45
CVT v63,v46,v47
M32 v[32:47],a[4:7],v[80:83],0
s_waitcnt lgkmcnt(0)
EXP v16,v16
EXP v17,v17
EXP v18,v18
M16 v[176:179],v[156:159],a[160:163],v[176:179]
DR v[172:175],v153 offset:9216
EXP v19,v19
M8 v[32:47],a[34:35],v[84:85],v[32:47]
EXP v20,v20
EXP v21,v21
CVT v48,v16,v17
CVT v49,v18,v19
EXP v22,v22
M16 v[192:195],v[160:163],a[160:163],v[192:195]
EXP v23,v23
M32 v[64:79],a[152:155],v[56:59],v[64:79]
EXP v24,v24
EXP v25,v25
CVT v50,v20,v21
CVT v51,v22,v23
M16 v[208:211],v[164:167],a[160:163],v[208:211]
s_add_u32 m0, s31, 5120
EXP v26,v26
M32 v[64:79],a[156:159],v[60:63],v[64:79]
s_waitcnt lgkmcnt(0)
EXP v27,v27
EXP v28,v28
EXP v29,v29
M16 v[224:227],v[168:171],a[160:163],v[224:227]
BL4 v2,s[8:11],s27 offen lds
CVT v52,v24,v25
CVT v53,v26,v27
M16 v[240:243],v[172:175],a[160:163],v[240:243]
BL4 a[160:163],v2,s[8:11],s26 offen offset:0
EXP v30,v30
EXP v31,v31
CVT v54,v28,v29
CVT v55,v30,v31
M32 v[16:31],a[8:11],v[80:83],0
s_waitcnt vmcnt(15)
EXP v32,v32
EXP v33,v33
EXP v34,v34
M16 v[180:183],v[156:159],a[164:167],v[180:183]
EXP v35,v35
M8 v[16:31],a[36:37],v[84:85],v[16:31]
ds_write_b128 v142, v[64:67] offset:12288
EXP v36,v36
EXP v37,v37
CVT v56,v32,v33
CVT v57,v34,v35
ds_write_b128 v142, v[68:71] offset:13312
EXP v38,v38
M16 v[196:199],v[160:163],a[164:167],v[196:199]
BL4 v2,s[8:11],s27 offen offset:1024 lds
EXP v39,v39
ds_write_b128 v142, v[72:75] offset:14336
M32 v[64:79],a[192:195],v[48:51],0
EXP v40,v40
EXP v41,v41
CVT v58,v36,v37
CVT v59,v38,v39
M16 v[212:215],v[164:167],a[164:167],v[212:215]
EXP v42,v42
M32 v[64:79],a[196:199],v[52:55],v[64:79]
EXP v43,v43
EXP v44,v44
EXP v45,v45
M16 v[228:231],v[168:171],a[164:167],v[228:231]
BL4 v2,s[8:11],s27 offen offset:2048 lds
CVT v60,v40,v41
CVT v61,v42,v43
M16 v[244:247],v[172:175],a[164:167],v[244:247]
BL4 a[164:167],v2,s[8:11],s26 offen offset:1024
EXP v46,v46
EXP v47,v47
CVT v62,v44,v45
CVT v63,v46,v47
M32 v[32:47],a[12:15],v[80:83],0
s_waitcnt vmcnt(15)
EXP v16,v16
EXP v17,v17
EXP v18,v18
M16 v[184:187],v[156:159],a[168:171],v[184:187]
EXP v19,v19
M8 v[32:47],a[38:39],v[84:85],v[32:47]
EXP v20,v20
EXP v21,v21
CVT v48,v16,v17
CVT v49,v18,v19
EXP v22,v22
M16 v[200:203],v[160:163],a[168:171],v[200:203]
BL4 v2,s[8:11],s27 offen offset:3072 lds
EXP v23,v23
M32 v[64:79],a[200:203],v[56:59],v[64:79]
EXP v24,v24
EXP v25,v25
CVT v50,v20,v21
CVT v51,v22,v23
M16 v[216:219],v[164:167],a[168:171],v[216:219]
s_add_u32 m0, s31, 9216
EXP v26,v26
M32 v[64:79],a[204:207],v[60:63],v[64:79]
EXP v27,v27
EXP v28,v28
EXP v29,v29
M16 v[232:235],v[168:171],a[168:171],v[232:235]
BL4 v148,s[8:11],s27 offen lds
CVT v52,v24,v25
CVT v53,v26,v27
M16 v[248:251],v[172:175],a[168:171],v[248:251]
BL4 a[168:171],v2,s[8:11],s26 offen offset:2048
EXP v30,v30
EXP v31,v31
CVT v54,v28,v29
CVT v55,v30,v31
M32 v[16:31],a[16:19],v[80:83],0
s_waitcnt vmcnt(15)
EXP v32,v32
EXP v33,v33
EXP v34,v34
M16 v[188:191],v[156:159],a[172:175],v[188:191]
DR v[156:159],v153 offset:10240
EXP v35,v35
M8 v[16:31],a[40:41],v[84:85],v[16:31]
EXP v36,v36
EXP v37,v37
CVT v56,v32,v33
CVT v57,v34,v35
EXP v38,v38
M16 v[204:207],v[160:163],a[172:175],v[204:207]
DR v[160:163],v153 offset:11264
EXP v39,v39
M32 v[64:79],a[208:211],v[48:51],v[64:79]
EXP v40,v40
EXP v41,v41
CVT v58,v36,v37
CVT v59,v38,v39
M16 v[220:223],v[164:167],a[172:175],v[220:223]
DR v[164:167],v153 offset:12288
EXP v42,v42
M32 v[64:79],a[212:215],v[52:55],v[64:79]
EXP v43,v43
EXP v44,v44
EXP v45,v45
M16 v[236:239],v[168:171],a[172:175],v[236:239]
DR v[168:171],v153 offset:13312
CVT v60,v40,v41
CVT v61,v42,v43
M16 v[252:255],v[172:175],a[172:175],v[252:255]
BL4 a[172:175],v2,s[8:11],s26 offen offset:3072
EXP v46,v46
EXP v47,v47
CVT v62,v44,v45
CVT v63,v46,v47
M32 v[32:47],a[20:23],v[80:83],0
s_waitcnt lgkmcnt(0)
EXP v16,v16
EXP v17,v17
EXP v18,v18
M16 v[176:179],v[156:159],a[176:179],v[176:179]
DR v[172:175],v153 offset:14336
EXP v19,v19
M8 v[32:47],a[42:43],v[84:85],v[32:47]
EXP v20,v20
EXP v21,v21
CVT v48,v16,v17
CVT v49,v18,v19
EXP v22,v22
M16 v[192:195],v[160:163],a[176:179],v[192:195]
EXP v23,v23
M32 v[64:79],a[216:219],v[56:59],v[64:79]
s_add_u32 s26, s26, 4096
EXP v24,v24
EXP v25,v25
CVT v50,v20,v21
CVT v51,v22,v23
M16 v[208:211],v[164:167],a[176:179],v[208:211]
s_add_u32 s27, s27, 40960
s_add_u32 m0, s31, 10240
EXP v26,v26
M32 v[64:79],a[220:223],v[60:63],v[64:79]
s_waitcnt lgkmcnt(0)
EXP v27,v27
EXP v28,v28
EXP v29,v29
M16 v[224:227],v[168:171],a[176:179],v[224:227]
BL4 v2,s[8:11],s27 offen lds
CVT v52,v24,v25
CVT v53,v26,v27
M16 v[240:243],v[172:175],a[176:179],v[240:243]
BL4 a[176:179],v2,s[8:11],s26 offen offset:0
EXP v30,v30
EXP v31,v31
CVT v54,v28,v29
CVT v55,v30,v31
M32 v[16:31],a[24:27],v[80:83],0
s_waitcnt vmcnt(15)
EXP v32,v32
EXP v33,v33
EXP v34,v34
M16 v[180:183],v[156:159],a[180:183],v[180:183]
DR v[88:91],v146 offset:4608
EXP v35,v35
M8 v[16:31],a[44:45],v[84:85],v[16:31]
ds_read_b64 v[92:93], v147 offset:4608
EXP v36,v36
EXP v37,v37
CVT v56,v32,v33
CVT v57,v34,v35
EXP v38,v38
M16 v[196:199],v[160:163],a[180:183],v[196:199]
BL4 v2,s[8:11],s27 offen offset:1024 lds
EXP v39,v39
M32 v[64:79],a[224:227],v[48:51],v[64:79]
EXP v40,v40
EXP v41,v41
CVT v58,v36,v37
CVT v59,v38,v39
M16 v[212:215],v[164:167],a[180:183],v[212:215]
EXP v42,v42
M32 v[64:79],a[228:231],v[52:55],v[64:79]
EXP v43,v43
EXP v44,v44
EXP v45,v45
M16 v[228:231],v[168:171],a[180:183],v[228:231]
BL4 v2,s[8:11],s27 offen offset:2048 lds
CVT v60,v40,v41
CVT v61,v42,v43
M16 v[244:247],v[172:175],a[180:183],v[244:247]
BL4 a[180:183],v2,s[8:11],s26 offen offset:1024
EXP v46,v46
EXP v47,v47
CVT v62,v44,v45
CVT v63,v46,v47
M32 v[32:47],a[28:31],v[80:83],0
s_waitcnt vmcnt(15)
EXP v16,v16
EXP v17,v17
EXP v18,v18
M16 v[184:187],v[156:159],a[184:187],v[184:187]
EXP v19,v19
M8 v[32:47],a[46:47],v[84:85],v[32:47]
EXP v20,v20
EXP v21,v21
CVT v48,v16,v17
CVT v49,v18,v19
EXP v22,v22
M16 v[200:203],v[160:163],a[184:187],v[200:203]
BL4 v2,s[8:11],s27 offen offset:3072 lds
EXP v23,v23
M32 v[64:79],a[232:235],v[56:59],v[64:79]
EXP v24,v24
EXP v25,v25
CVT v50,v20,v21
CVT v51,v22,v23
M16 v[216:219],v[164:167],a[184:187],v[216:219]
s_add_u32 m0, s31, 14336
EXP v26,v26
M32 v[64:79],a[236:239],v[60:63],v[64:79]
EXP v27,v27
EXP v28,v28
EXP v29,v29
M16 v[232:235],v[168:171],a[184:187],v[232:235]
BL4 v148,s[8:11],s27 offen lds
CVT v52,v24,v25
CVT v53,v26,v27
M16 v[248:251],v[172:175],a[184:187],v[248:251]
BL4 a[184:187],v2,s[8:11],s26 offen offset:2048
EXP v30,v30
EXP v31,v31
CVT v54,v28,v29
CVT v55,v30,v31
M32 v[16:31],a[64:67],v[80:83],0
s_waitcnt vmcnt(15)
EXP v32,v32
EXP v33,v33
EXP v34,v34
M16 v[188:191],v[156:159],a[188:191],v[188:191]
DR v[156:159],v153 offset:0
EXP v35,v35
M8 v[16:31],a[48:49],v[84:85],v[16:31]
EXP v36,v36
EXP v37,v37
CVT v56,v32,v33
CVT v57,v34,v35
EXP v38,v38
M16 v[204:207],v[160:163],a[188:191],v[204:207]
DR v[160:163],v153 offset:1024
EXP v39,v39
M32 v[64:79],a[240:243],v[48:51],v[64:79]
EXP v40,v40
EXP v41,v41
CVT v58,v36,v37
CVT v59,v38,v39
M16 v[220:223],v[164:167],a[188:191],v[220:223]
DR v[164:167],v153 offset:2048
EXP v42,v42
M32 v[64:79],a[244:247],v[52:55],v[64:79]
EXP v43,v43
EXP v44,v44
EXP v45,v45
M16 v[236:239],v[168:171],a[188:191],v[236:239]
DR v[168:171],v153 offset:3072
CVT v60,v40,v41
CVT v61,v42,v43
M16 v[252:255],v[172:175],a[188:191],v[252:255]
BL4 a[188:191],v2,s[8:11],s26 offen offset:3072
EXP v46,v46
EXP v47,v47
CVT v62,v44,v45
CVT v63,v46,v47
M32 v[32:47],a[68:71],v[80:83],0
s_waitcnt lgkmcnt(0)
EXP v16,v16
EXP v17,v17
EXP v18,v18
M16 v[176:179],v[156:159],a[160:163],v[176:179]
DR v[172:175],v153 offset:4096
EXP v19,v19
M8 v[32:47],a[50:51],v[84:85],v[32:47]
EXP v20,v20
EXP v21,v21
CVT v48,v16,v17
CVT v49,v18,v19
EXP v22,v22
M16 v[192:195],v[160:163],a[160:163],v[192:195]
EXP v23,v23
M32 v[64:79],a[248:251],v[56:59],v[64:79]
s_add_u32 s26, s26, 4096
EXP v24,v24
EXP v25,v25
CVT v50,v20,v21
CVT v51,v22,v23
M16 v[208:211],v[164:167],a[160:163],v[208:211]
s_add_u32 s27, s27, 40960
s_add_u32 m0, s31, 0
EXP v26,v26
M32 v[64:79],a[252:255],v[60:63],v[64:79]
s_waitcnt lgkmcnt(0)
EXP v27,v27
EXP v28,v28
EXP v29,v29
M16 v[224:227],v[168:171],a[160:163],v[224:227]
BL4 v2,s[8:11],s27 offen lds
CVT v52,v24,v25
CVT v53,v26,v27
M16 v[240:243],v[172:175],a[160:163],v[240:243]
BL4 a[160:163],v2,s[8:11],s26 offen offset:0
EXP v30,v30
EXP v31,v31
CVT v54,v28,v29
CVT v55,v30,v31
M32 v[16:31],a[72:75],v[80:83],0
s_waitcnt vmcnt(15)
EXP v32,v32
EXP v33,v33
EXP v34,v34
M16 v[180:183],v[156:159],a[164:167],v[180:183]
EXP v35,v35
M8 v[16:31],a[52:53],v[84:85],v[16:31]
EXP v36,v36
EXP v37,v37
CVT v56,v32,v33
CVT v57,v34,v35
EXP v38,v38
M16 v[196:199],v[160:163],a[164:167],v[196:199]
BL4 v2,s[8:11],s27 offen offset:1024 lds
EXP v39,v39
M32 v[64:79],a[96:99],v[48:51],v[64:79]
EXP v40,v40
EXP v41,v41
CVT v58,v36,v37
CVT v59,v38,v39
M16 v[212:215],v[164:167],a[164:167],v[212:215]
EXP v42,v42
M32 v[64:79],a[100:103],v[52:55],v[64:79]
EXP v43,v43
EXP v44,v44
EXP v45,v45
M16 v[228:231],v[168:171],a[164:167],v[228:231]
BL4 v2,s[8:11],s27 offen offset:2048 lds
CVT v60,v40,v41
CVT v61,v42,v43
M16 v[244:247],v[172:175],a[164:167],v[244:247]
BL4 a[164:167],v2,s[8:11],s26 offen offset:1024
EXP v46,v46
EXP v47,v47
CVT v62,v44,v45
CVT v63,v46,v47
M32 v[32:47],a[76:79],v[80:83],0
s_waitcnt vmcnt(15)
EXP v16,v16
EXP v17,v17
EXP v18,v18
M16 v[184:187],v[156:159],a[168:171],v[184:187]
EXP v19,v19
M8 v[32:47],a[54:55],v[84:85],v[32:47]
EXP v20,v20
EXP v21,v21
CVT v48,v16,v17
CVT v49,v18,v19
EXP v22,v22
M16 v[200:203],v[160:163],a[168:171],v[200:203]
BL4 v2,s[8:11],s27 offen offset:3072 lds
EXP v23,v23
M32 v[64:79],a[104:107],v[56:59],v[64:79]
EXP v24,v24
EXP v25,v25
CVT v50,v20,v21
CVT v51,v22,v23
M16 v[216:219],v[164:167],a[168:171],v[216:219]
s_add_u32 m0, s31, 4096
EXP v26,v26
M32 v[64:79],a[108:111],v[60:63],v[64:79]
EXP v27,v27
EXP v28,v28
EXP v29,v29
M16 v[232:235],v[168:171],a[168:171],v[232:235]
BL4 v148,s[8:11],s27 offen lds
CVT v52,v24,v25
CVT v53,v26,v27
M16 v[248:251],v[172:175],a[168:171],v[248:251]
BL4 a[168:171],v2,s[8:11],s26 offen offset:2048
EXP v30,v30
EXP v31,v31
CVT v54,v28,v29
CVT v55,v30,v31
M32 v[16:31],a[80:83],v[80:83],0
s_waitcnt vmcnt(15)
EXP v32,v32
EXP v33,v33
EXP v34,v34
M16 v[188:191],v[156:159],a[172:175],v[188:191]
DR v[156:159],v153 offset:5120
EXP v35,v35
M8 v[16:31],a[56:57],v[84:85],v[16:31]
EXP v36,v36
EXP v37,v37
CVT v56,v32,v33
CVT v57,v34,v35
EXP v38,v38
M16 v[204:207],v[160:163],a[172:175],v[204:207]
DR v[160:163],v153 offset:6144
EXP v39,v39
M32 v[64:79],a[112:115],v[48:51],v[64:79]
EXP v40,v40
EXP v41,v41
CVT v58,v36,v37
CVT v59,v38,v39
M16 v[220:223],v[164:167],a[172:175],v[220:223]
DR v[164:167],v153 offset:7168
EXP v42,v42
M32 v[64:79],a[116:119],v[52:55],v[64:79]
EXP v43,v43
EXP v44,v44
EXP v45,v45
M16 v[236:239],v[168:171],a[172:175],v[236:239]
DR v[168:171],v153 offset:8192
CVT v60,v40,v41
CVT v61,v42,v43
M16 v[252:255],v[172:175],a[172:175],v[252:255]
BL4 a[172:175],v2,s[8:11],s26 offen offset:3072
EXP v46,v46
EXP v47,v47
CVT v62,v44,v45
CVT v63,v46,v47
M32 v[32:47],a[84:87],v[80:83],0
s_waitcnt lgkmcnt(0)
EXP v16,v16
EXP v17,v17
EXP v18,v18
M16 v[176:179],v[156:159],a[176:179],v[176:179]
DR v[172:175],v153 offset:9216
EXP v19,v19
M8 v[32:47],a[58:59],v[84:85],v[32:47]
EXP v20,v20
EXP v21,v21
CVT v48,v16,v17
CVT v49,v18,v19
EXP v22,v22
M16 v[192:195],v[160:163],a[176:179],v[192:195]
EXP v23,v23
M32 v[64:79],a[120:123],v[56:59],v[64:79]
s_add_u32 s26, s26, 4096
EXP v24,v24
EXP v25,v25
CVT v50,v20,v21
CVT v51,v22,v23
M16 v[208:211],v[164:167],a[176:179],v[208:211]
s_add_u32 s27, s27, 40960
s_add_u32 m0, s31, 5120
EXP v26,v26
M32 v[64:79],a[124:127],v[60:63],v[64:79]
s_waitcnt lgkmcnt(0)
EXP v27,v27
EXP v28,v28
EXP v29,v29
M16 v[224:227],v[168:171],a[176:179],v[224:227]
BL4 v2,s[8:11],s27 offen lds
CVT v52,v24,v25
CVT v53,v26,v27
M16 v[240:243],v[172:175],a[176:179],v[240:243]
BL4 a[176:179],v2,s[8:11],s26 offen offset:0
EXP v30,v30
EXP v31,v31
CVT v54,v28,v29
CVT v55,v30,v31
M32 v[16:31],a[88:91],v[80:83],0
s_waitcnt vmcnt(15)
EXP v32,v32
EXP v33,v33
EXP v34,v34
M16 v[180:183],v[156:159],a[180:183],v[180:183]
EXP v35,v35
M8 v[16:31],a[60:61],v[84:85],v[16:31]
EXP v36,v36
EXP v37,v37
CVT v56,v32,v33
CVT v57,v34,v35
EXP v38,v38
M16 v[196:199],v[160:163],a[180:183],v[196:199]
BL4 v2,s[8:11],s27 offen offset:1024 lds
EXP v39,v39
M32 v[64:79],a[128:131],v[48:51],v[64:79]
EXP v40,v40
EXP v41,v41
CVT v58,v36,v37
CVT v59,v38,v39
M16 v[212:215],v[164:167],a[180:183],v[212:215]
EXP v42,v42
M32 v[64:79],a[132:135],v[52:55],v[64:79]
EXP v43,v43
EXP v44,v44
EXP v45,v45
M16 v[228:231],v[168:171],a[180:183],v[228:231]
BL4 v2,s[8:11],s27 offen offset:2048 lds
CVT v60,v40,v41
CVT v61,v42,v43
M16 v[244:247],v[172:175],a[180:183],v[244:247]
BL4 a[180:183],v2,s[8:11],s26 offen offset:1024
EXP v46,v46
EXP v47,v47
CVT v62,v44,v45
CVT v63,v46,v47
M32 v[32:47],a[92:95],v[80:83],0
s_waitcnt vmcnt(15)
EXP v16,v16
EXP v17,v17
EXP v18,v18
M16 v[184:187],v[156:159],a[184:187],v[184:187]
EXP v19,v19
M8 v[32:47],a[62:63],v[84:85],v[32:47]
EXP v20,v20
EXP v21,v21
CVT v48,v16,v17
CVT v49,v18,v19
EXP v22,v22
M16 v[200:203],v[160:163],a[184:187],v[200:203]
BL4 v2,s[8:11],s27 offen offset:3072 lds
EXP v23,v23
M32 v[64:79],a[136:139],v[56:59],v[64:79]
EXP v24,v24
EXP v25,v25
CVT v50,v20,v21
CVT v51,v22,v23
M16 v[216:219],v[164:167],a[184:187],v[216:219]
s_add_u32 m0, s31, 9216
EXP v26,v26
M32 v[64:79],a[140:143],v[60:63],v[64:79]
EXP v27,v27
EXP v28,v28
EXP v29,v29
M16 v[232:235],v[168:171],a[184:187],v[232:235]
BL4 v148,s[8:11],s27 offen lds
s_add_u32 s27, s27, 40960
CVT v52,v24,v25
CVT v53,v26,v27
M16 v[248:251],v[172:175],a[184:187],v[248:251]
BL4 a[184:187],v2,s[8:11],s26 offen offset:2048
EXP v30,v30
EXP v31,v31
CVT v54,v28,v29
CVT v55,v30,v31
M32 v[16:31],a[0:3],v[88:91],0
s_waitcnt vmcnt(15)
EXP v32,v32
EXP v33,v33
EXP v34,v34
M16 v[188:191],v[156:159],a[188:191],v[188:191]
DR v[156:159],v153 offset:10240
EXP v35,v35
M8 v[16:31],a[32:33],v[92:93],v[16:31]
EXP v36,v36
EXP v37,v37
CVT v56,v32,v33
CVT v57,v34,v35
EXP v38,v38
M16 v[204:207],v[160:163],a[188:191],v[204:207]
DR v[160:163],v153 offset:11264
EXP v39,v39
M32 v[64:79],a[144:147],v[48:51],v[64:79]
EXP v40,v40
EXP v41,v41
CVT v58,v36,v37
CVT v59,v38,v39
M16 v[220:223],v[164:167],a[188:191],v[220:223]
DR v[164:167],v153 offset:12288
EXP v42,v42
M32 v[64:79],a[148:151],v[52:55],v[64:79]
EXP v43,v43
EXP v44,v44
EXP v45,v45
M16 v[236:239],v[168:171],a[188:191],v[236:239]
DR v[168:171],v153 offset:13312
CVT v60,v40,v41
CVT v61,v42,v43
M16 v[252:255],v[172:175],a[188:191],v[252:255]
BL4 a[188:191],v2,s[8:11],s26 offen offset:3072
s_add_u32 s26, s26, 4096
EXP v46,v46
EXP v47,v47
CVT v62,v44,v45
CVT v63,v46,v47
M32 v[32:47],a[4:7],v[88:91],0
s_waitcnt lgkmcnt(0)
EXP v16,v16
EXP v17,v17
EXP v18,v18
M16 v[176:179],v[156:159],a[160:163],v[176:179]
DR v[172:175],v153 offset:14336
EXP v19,v19
M8 v[32:47],a[34:35],v[92:93],v[32:47]
EXP v20,v20
EXP v21,v21
CVT v48,v16,v17
CVT v49,v18,v19
EXP v22,v22
M16 v[192:195],v[160:163],a[160:163],v[192:195]
EXP v23,v23
M32 v[64:79],a[152:155],v[56:59],v[64:79]
EXP v24,v24
EXP v25,v25
CVT v50,v20,v21
CVT v51,v22,v23
M16 v[208:211],v[164:167],a[160:163],v[208:211]
s_add_u32 m0, s31, 10240
EXP v26,v26
M32 v[64:79],a[156:159],v[60:63],v[64:79]
s_waitcnt lgkmcnt(0)
EXP v27,v27
EXP v28,v28
EXP v29,v29
M16 v[224:227],v[168:171],a[160:163],v[224:227]
BL4 v2,s[8:11],s27 offen lds
CVT v52,v24,v25
CVT v53,v26,v27
M16 v[240:243],v[172:175],a[160:163],v[240:243]
BL4 a[160:163],v2,s[8:11],s26 offen offset:0
EXP v30,v30
EXP v31,v31
CVT v54,v28,v29
CVT v55,v30,v31
M32 v[16:31],a[8:11],v[88:91],0
s_waitcnt vmcnt(15)
EXP v32,v32
EXP v33,v33
EXP v34,v34
M16 v[180:183],v[156:159],a[164:167],v[180:183]
EXP v35,v35
M8 v[16:31],a[36:37],v[92:93],v[16:31]
ds_write_b128 v142, v[64:67] offset:24576
EXP v36,v36
EXP v37,v37
CVT v56,v32,v33
CVT v57,v34,v35
ds_write_b128 v142, v[68:71] offset:25600
EXP v38,v38
M16 v[196:199],v[160:163],a[164:167],v[196:199]
BL4 v2,s[8:11],s27 offen offset:1024 lds
EXP v39,v39
ds_write_b128 v142, v[72:75] offset:26624
M32 v[64:79],a[192:195],v[48:51],0
EXP v40,v40
EXP v41,v41
CVT v58,v36,v37
CVT v59,v38,v39
M16 v[212:215],v[164:167],a[164:167],v[212:215]
EXP v42,v42
M32 v[64:79],a[196:199],v[52:55],v[64:79]
EXP v43,v43
EXP v44,v44
EXP v45,v45
M16 v[228:231],v[168:171],a[164:167],v[228:231]
BL4 v2,s[8:11],s27 offen offset:2048 lds
CVT v60,v40,v41
CVT v61,v42,v43
M16 v[244:247],v[172:175],a[164:167],v[244:247]
BL4 a[164:167],v2,s[8:11],s26 offen offset:1024
EXP v46,v46
EXP v47,v47
CVT v62,v44,v45
CVT v63,v46,v47
M32 v[32:47],a[12:15],v[88:91],0
s_waitcnt vmcnt(15)
EXP v16,v16
EXP v17,v17
EXP v18,v18
M16 v[184:187],v[156:159],a[168:171],v[184:187]
EXP v19,v19
M8 v[32:47],a[38:39],v[92:93],v[32:47]
s_barrier
EXP v20,v20
EXP v21,v21
CVT v48,v16,v17
CVT v49,v18,v19
EXP v22,v22
M16 v[200:203],v[160:163],a[168:171],v[200:203]
BL4 v2,s[8:11],s27 offen offset:3072 lds
EXP v23,v23
M32 v[64:79],a[200:203],v[56:59],v[64:79]
EXP v24,v24
EXP v25,v25
CVT v50,v20,v21
CVT v51,v22,v23
M16 v[216:219],v[164:167],a[168:171],v[216:219]
s_add_u32 m0, s31, 14336
EXP v26,v26
M32 v[64:79],a[204:207],v[60:63],v[64:79]
EXP v27,v27
EXP v28,v28
EXP v29,v29
M16 v[232:235],v[168:171],a[168:171],v[232:235]
BL4 v148,s[8:11],s27 offen lds
CVT v52,v24,v25
CVT v53,v26,v27
M16 v[248:251],v[172:175],a[168:171],v[248:251]
BL4 a[168:171],v2,s[8:11],s26 offen offset:2048
EXP v30,v30
EXP v31,v31
CVT v54,v28,v29
CVT v55,v30,v31
M32 v[16:31],a[16:19],v[88:91],0
s_waitcnt vmcnt(15)
EXP v32,v32
EXP v33,v33
EXP v34,v34
M16 v[188:191],v[156:159],a[172:175],v[188:191]
DR v[156:159],v153 offset:0
EXP v35,v35
M8 v[16:31],a[40:41],v[92:93],v[16:31]
EXP v36,v36
EXP v37,v37
CVT v56,v32,v33
CVT v57,v34,v35
EXP v38,v38
M16 v[204:207],v[160:163],a[172:175],v[204:207]
DR v[160:163],v153 offset:1024
EXP v39,v39
M32 v[64:79],a[208:211],v[48:51],v[64:79]
EXP v40,v40
EXP v41,v41
CVT v58,v36,v37
CVT v59,v38,v39
M16 v[220:223],v[164:167],a[172:175],v[220:223]
DR v[164:167],v153 offset:2048
EXP v42,v42
M32 v[64:79],a[212:215],v[52:55],v[64:79]
EXP v43,v43
EXP v44,v44
EXP v45,v45
M16 v[236:239],v[168:171],a[172:175],v[236:239]
DR v[168:171],v153 offset:3072
CVT v60,v40,v41
CVT v61,v42,v43
M16 v[252:255],v[172:175],a[172:175],v[252:255]
BL4 a[172:175],v2,s[8:11],s26 offen offset:3072
EXP v46,v46
EXP v47,v47
CVT v62,v44,v45
CVT v63,v46,v47
M32 v[32:47],a[20:23],v[88:91],0
s_waitcnt lgkmcnt(0)
EXP v16,v16
EXP v17,v17
EXP v18,v18
M16 v[176:179],v[156:159],a[176:179],v[176:179]
DR v[172:175],v153 offset:4096
EXP v19,v19
M8 v[32:47],a[42:43],v[92:93],v[32:47]
EXP v20,v20
EXP v21,v21
CVT v48,v16,v17
CVT v49,v18,v19
EXP v22,v22
M16 v[192:195],v[160:163],a[176:179],v[192:195]
EXP v23,v23
M32 v[64:79],a[216:219],v[56:59],v[64:79]
s_add_u32 s26, s26, 4096
EXP v24,v24
EXP v25,v25
CVT v50,v20,v21
CVT v51,v22,v23
M16 v[208:211],v[164:167],a[176:179],v[208:211]
s_add_u32 s27, s27, 40960
s_add_u32 m0, s31, 0
EXP v26,v26
M32 v[64:79],a[220:223],v[60:63],v[64:79]
s_waitcnt lgkmcnt(0)
EXP v27,v27
EXP v28,v28
EXP v29,v29
M16 v[224:227],v[168:171],a[176:179],v[224:227]
BL4 v2,s[8:11],s27 offen lds
CVT v52,v24,v25
CVT v53,v26,v27
M16 v[240:243],v[172:175],a[176:179],v[240:243]
BL4 a[176:179],v2,s[8:11],s26 offen offset:0
EXP v30,v30
EXP v31,v31
CVT v54,v28,v29
CVT v55,v30,v31
M32 v[16:31],a[24:27],v[88:91],0
s_waitcnt vmcnt(15)
EXP v32,v32
EXP v33,v33
EXP v34,v34
M16 v[180:183],v[156:159],a[180:183],v[180:183]
DR v[80:83],v146 offset:6144
EXP v35,v35
M8 v[16:31],a[44:45],v[92:93],v[16:31]
ds_read_b64 v[84:85], v147 offset:6144
EXP v36,v36
EXP v37,v37
CVT v56,v32,v33
CVT v57,v34,v35
EXP v38,v38
M16 v[196:199],v[160:163],a[180:183],v[196:199]
BL4 v2,s[8:11],s27 offen offset:1024 lds
EXP v39,v39
M32 v[64:79],a[224:227],v[48:51],v[64:79]
EXP v40,v40
EXP v41,v41
CVT v58,v36,v37
CVT v59,v38,v39
M16 v[212:215],v[164:167],a[180:183],v[212:215]
EXP v42,v42
M32 v[64:79],a[228:231],v[52:55],v[64:79]
EXP v43,v43
EXP v44,v44
EXP v45,v45
M16 v[228:231],v[168:171],a[180:183],v[228:231]
BL4 v2,s[8:11],s27 offen offset:2048 lds
CVT v60,v40,v41
CVT v61,v42,v43
M16 v[244:247],v[172:175],a[180:183],v[244:247]
BL4 a[180:183],v2,s[8:11],s26 offen offset:1024
EXP v46,v46
EXP v47,v47
CVT v62,v44,v45
CVT v63,v46,v47
M32 v[32:47],a[28:31],v[88:91],0
s_waitcnt vmcnt(15)
EXP v16,v16
EXP v17,v17
EXP v18,v18
M16 v[184:187],v[156:159],a[184:187],v[184:187]
EXP v19,v19
M8 v[32:47],a[46:47],v[92:93],v[32:47]
EXP v20,v20
EXP v21,v21
CVT v48,v16,v17
CVT v49,v18,v19
EXP v22,v22
M16 v[200:203],v[160:163],a[184:187],v[200:203]
BL4 v2,s[8:11],s27 offen offset:3072 lds
EXP v23,v23
M32 v[64:79],a[232:235],v[56:59],v[64:79]
EXP v24,v24
EXP v25,v25
CVT v50,v20,v21
CVT v51,v22,v23
M16 v[216:219],v[164:167],a[184:187],v[216:219]
s_add_u32 m0, s31, 4096
EXP v26,v26
M32 v[64:79],a[236:239],v[60:63],v[64:79]
EXP v27,v27
EXP v28,v28
EXP v29,v29
M16 v[232:235],v[168:171],a[184:187],v[232:235]
BL4 v148,s[8:11],s27 offen lds
CVT v52,v24,v25
CVT v53,v26,v27
M16 v[248:251],v[172:175],a[184:187],v[248:251]
BL4 a[184:187],v2,s[8:11],s26 offen offset:2048
EXP v30,v30
EXP v31,v31
CVT v54,v28,v29
CVT v55,v30,v31
M32 v[16:31],a[64:67],v[88:91],0
s_waitcnt vmcnt(15)
EXP v32,v32
EXP v33,v33
EXP v34,v34
M16 v[188:191],v[156:159],a[188:191],v[188:191]
DR v[156:159],v153 offset:5120
EXP v35,v35
M8 v[16:31],a[48:49],v[92:93],v[16:31]
EXP v36,v36
EXP v37,v37
CVT v56,v32,v33
CVT v57,v34,v35
EXP v38,v38
M16 v[204:207],v[160:163],a[188:191],v[204:207]
DR v[160:163],v153 offset:6144
EXP v39,v39
M32 v[64:79],a[240:243],v[48:51],v[64:79]
EXP v40,v40
EXP v41,v41
CVT v58,v36,v37
CVT v59,v38,v39
M16 v[220:223],v[164:167],a[188:191],v[220:223]
DR v[164:167],v153 offset:7168
EXP v42,v42
M32 v[64:79],a[244:247],v[52:55],v[64:79]
EXP v43,v43
EXP v44,v44
EXP v45,v45
M16 v[236:239],v[168:171],a[188:191],v[236:239]
DR v[168:171],v153 offset:8192
CVT v60,v40,v41
CVT v61,v42,v43
M16 v[252:255],v[172:175],a[188:191],v[252:255]
BL4 a[188:191],v2,s[8:11],s26 offen offset:3072
EXP v46,v46
EXP v47,v47
CVT v62,v44,v45
CVT v63,v46,v47
M32 v[32:47],a[68:71],v[88:91],0
s_waitcnt lgkmcnt(0)
EXP v16,v16
EXP v17,v17
EXP v18,v18
M16 v[176:179],v[156:159],a[160:163],v[176:179]
DR v[172:175],v153 offset:9216
EXP v19,v19
M8 v[32:47],a[50:51],v[92:93],v[32:47]
EXP v20,v20
EXP v21,v21
CVT v48,v16,v17
CVT v49,v18,v19
EXP v22,v22
M16 v[192:195],v[160:163],a[160:163],v[192:195]
EXP v23,v23
M32 v[64:79],a[248:251],v[56:59],v[64:79]
s_add_u32 s26, s26, 4096
EXP v24,v24
EXP v25,v25
CVT v50,v20,v21
CVT v51,v22,v23
M16 v[208:211],v[164:167],a[160:163],v[208:211]
s_add_u32 s27, s27, 40960
s_add_u32 m0, s31, 5120
EXP v26,v26
M32 v[64:79],a[252:255],v[60:63],v[64:79]
s_waitcnt lgkmcnt(0)
EXP v27,v27
EXP v28,v28
EXP v29,v29
M16 v[224:227],v[168:171],a[160:163],v[224:227]
BL4 v2,s[8:11],s27 offen lds
CVT v52,v24,v25
CVT v53,v26,v27
M16 v[240:243],v[172:175],a[160:163],v[240:243]
BL4 a[160:163],v2,s[8:11],s26 offen offset:0
EXP v30,v30
EXP v31,v31
CVT v54,v28,v29
CVT v55,v30,v31
M32 v[16:31],a[72:75],v[88:91],0
s_waitcnt vmcnt(15)
EXP v32,v32
EXP v33,v33
EXP v34,v34
M16 v[180:183],v[156:159],a[164:167],v[180:183]
EXP v35,v35
M8 v[16:31],a[52:53],v[92:93],v[16:31]
EXP v36,v36
EXP v37,v37
CVT v56,v32,v33
CVT v57,v34,v35
EXP v38,v38
M16 v[196:199],v[160:163],a[164:167],v[196:199]
BL4 v2,s[8:11],s27 offen offset:1024 lds
EXP v39,v39
M32 v[64:79],a[96:99],v[48:51],v[64:79]
EXP v40,v40
EXP v41,v41
CVT v58,v36,v37
CVT v59,v38,v39
M16 v[212:215],v[164:167],a[164:167],v[212:215]
EXP v42,v42
M32 v[64:79],a[100:103],v[52:55],v[64:79]
EXP v43,v43
EXP v44,v44
EXP v45,v45
M16 v[228:231],v[168:171],a[164:167],v[228:231]
BL4 v2,s[8:11],s27 offen offset:2048 lds
CVT v60,v40,v41
CVT v61,v42,v43
M16 v[244:247],v[172:175],a[164:167],v[244:247]
BL4 a[164:167],v2,s[8:11],s26 offen offset:1024
EXP v46,v46
EXP v47,v47
CVT v62,v44,v45
CVT v63,v46,v47
M32 v[32:47],a[76:79],v[88:91],0
s_waitcnt vmcnt(15)
EXP v16,v16
EXP v17,v17
EXP v18,v18
M16 v[184:187],v[156:159],a[168:171],v[184:187]
EXP v19,v19
M8 v[32:47],a[54:55],v[92:93],v[32:47]
EXP v20,v20
EXP v21,v21
CVT v48,v16,v17
CVT v49,v18,v19
EXP v22,v22
M16 v[200:203],v[160:163],a[168:171],v[200:203]
BL4 v2,s[8:11],s27 offen offset:3072 lds
EXP v23,v23
M32 v[64:79],a[104:107],v[56:59],v[64:79]
EXP v24,v24
EXP v25,v25
CVT v50,v20,v21
CVT v51,v22,v23
M16 v[216:219],v[164:167],a[168:171],v[216:219]
s_add_u32 m0, s31, 9216
EXP v26,v26
M32 v[64:79],a[108:111],v[60:63],v[64:79]
EXP v27,v27
EXP v28,v28
EXP v29,v29
M16 v[232:235],v[168:171],a[168:171],v[232:235]
BL4 v148,s[8:11],s27 offen lds
CVT v52,v24,v25
CVT v53,v26,v27
M16 v[248:251],v[172:175],a[168:171],v[248:251]
BL4 a[168:171],v2,s[8:11],s26 offen offset:2048
EXP v30,v30
EXP v31,v31
CVT v54,v28,v29
CVT v55,v30,v31
M32 v[16:31],a[80:83],v[88:91],0
s_waitcnt vmcnt(15)
EXP v32,v32
EXP v33,v33
EXP v34,v34
M16 v[188:191],v[156:159],a[172:175],v[188:191]
DR v[156:159],v153 offset:10240
EXP v35,v35
M8 v[16:31],a[56:57],v[92:93],v[16:31]
EXP v36,v36
EXP v37,v37
CVT v56,v32,v33
CVT v57,v34,v35
EXP v38,v38
M16 v[204:207],v[160:163],a[172:175],v[204:207]
DR v[160:163],v153 offset:11264
EXP v39,v39
M32 v[64:79],a[112:115],v[48:51],v[64:79]
EXP v40,v40
EXP v41,v41
CVT v58,v36,v37
CVT v59,v38,v39
M16 v[220:223],v[164:167],a[172:175],v[220:223]
DR v[164:167],v153 offset:12288
EXP v42,v42
M32 v[64:79],a[116:119],v[52:55],v[64:79]
EXP v43,v43
EXP v44,v44
EXP v45,v45
M16 v[236:239],v[168:171],a[172:175],v[236:239]
DR v[168:171],v153 offset:13312
CVT v60,v40,v41
CVT v61,v42,v43
M16 v[252:255],v[172:175],a[172:175],v[252:255]
BL4 a[172:175],v2,s[8:11],s26 offen offset:3072
EXP v46,v46
EXP v47,v47
CVT v62,v44,v45
CVT v63,v46,v47
M32 v[32:47],a[84:87],v[88:91],0
s_waitcnt lgkmcnt(0)
EXP v16,v16
EXP v17,v17
EXP v18,v18
M16 v[176:179],v[156:159],a[176:179],v[176:179]
DR v[172:175],v153 offset:14336
EXP v19,v19
M8 v[32:47],a[58:59],v[92:93],v[32:47]
EXP v20,v20
EXP v21,v21
CVT v48,v16,v17
CVT v49,v18,v19
EXP v22,v22
M16 v[192:195],v[160:163],a[176:179],v[192:195]
EXP v23,v23
M32 v[64:79],a[120:123],v[56:59],v[64:79]
s_add_u32 s26, s26, 4096
EXP v24,v24
EXP v25,v25
CVT v50,v20,v21
CVT v51,v22,v23
M16 v[208:211],v[164:167],a[176:179],v[208:211]
s_add_u32 s27, s27, 40960
s_add_u32 m0, s31, 10240
EXP v26,v26
M32 v[64:79],a[124:127],v[60:63],v[64:79]
s_waitcnt lgkmcnt(0)
EXP v27,v27
EXP v28,v28
EXP v29,v29
M16 v[224:227],v[168:171],a[176:179],v[224:227]
BL4 v2,s[8:11],s27 offen lds
CVT v52,v24,v25
CVT v53,v26,v27
M16 v[240:243],v[172:175],a[176:179],v[240:243]
BL4 a[176:179],v2,s[8:11],s26 offen offset:0
EXP v30,v30
EXP v31,v31
CVT v54,v28,v29
CVT v55,v30,v31
M32 v[16:31],a[88:91],v[88:91],0
s_waitcnt vmcnt(15)
EXP v32,v32
EXP v33,v33
EXP v34,v34
M16 v[180:183],v[156:159],a[180:183],v[180:183]
EXP v35,v35
M8 v[16:31],a[60:61],v[92:93],v[16:31]
EXP v36,v36
EXP v37,v37
CVT v56,v32,v33
CVT v57,v34,v35
EXP v38,v38
M16 v[196:199],v[160:163],a[180:183],v[196:199]
BL4 v2,s[8:11],s27 offen offset:1024 lds
EXP v39,v39
M32 v[64:79],a[128:131],v[48:51],v[64:79]
EXP v40,v40
EXP v41,v41
CVT v58,v36,v37
CVT v59,v38,v39
M16 v[212:215],v[164:167],a[180:183],v[212:215]
EXP v42,v42
M32 v[64:79],a[132:135],v[52:55],v[64:79]
EXP v43,v43
EXP v44,v44
EXP v45,v45
M16 v[228:231],v[168:171],a[180:183],v[228:231]
BL4 v2,s[8:11],s27 offen offset:2048 lds
CVT v60,v40,v41
CVT v61,v42,v43
M16 v[244:247],v[172:175],a[180:183],v[244:247]
BL4 a[180:183],v2,s[8:11],s26 offen offset:1024
EXP v46,v46
EXP v47,v47
CVT v62,v44,v45
CVT v63,v46,v47
M32 v[32:47],a[92:95],v[88:91],0
s_waitcnt vmcnt(15)
EXP v16,v16
EXP v17,v17
EXP v18,v18
M16 v[184:187],v[156:159],a[184:187],v[184:187]
EXP v19,v19
M8 v[32:47],a[62:63],v[92:93],v[32:47]
EXP v20,v20
EXP v21,v21
CVT v48,v16,v17
CVT v49,v18,v19
EXP v22,v22
M16 v[200:203],v[160:163],a[184:187],v[200:203]
BL4 v2,s[8:11],s27 offen offset:3072 lds
EXP v23,v23
M32 v[64:79],a[136:139],v[56:59],v[64:79]
EXP v24,v24
EXP v25,v25
CVT v50,v20,v21
CVT v51,v22,v23
M16 v[216:219],v[164:167],a[184:187],v[216:219]
s_add_u32 m0, s31, 14336
EXP v26,v26
M32 v[64:79],a[140:143],v[60:63],v[64:79]
EXP v27,v27
EXP v28,v28
EXP v29,v29
M16 v[232:235],v[168:171],a[184:187],v[232:235]
BL4 v148,s[8:11],s27 offen lds
s_add_u32 s27, s27, 40960
CVT v52,v24,v25
CVT v53,v26,v27
M16 v[248:251],v[172:175],a[184:187],v[248:251]
BL4 a[184:187],v2,s[8:11],s26 offen offset:2048
EXP v30,v30
EXP v31,v31
CVT v54,v28,v29
CVT v55,v30,v31
M32 v[16:31],a[0:3],v[80:83],0
s_waitcnt vmcnt(15)
EXP v32,v32
EXP v33,v33
EXP v34,v34
M16 v[188:191],v[156:159],a[188:191],v[188:191]
DR v[156:159],v153 offset:0
EXP v35,v35
M8 v[16:31],a[32:33],v[84:85],v[16:31]
EXP v36,v36
EXP v37,v37
CVT v56,v32,v33
CVT v57,v34,v35
EXP v38,v38
M16 v[204:207],v[160:163],a[188:191],v[204:207]
DR v[160:163],v153 offset:1024
EXP v39,v39
M32 v[64:79],a[144:147],v[48:51],v[64:79]
EXP v40,v40
EXP v41,v41
CVT v58,v36,v37
CVT v59,v38,v39
M16 v[220:223],v[164:167],a[188:191],v[220:223]
DR v[164:167],v153 offset:2048
EXP v42,v42
M32 v[64:79],a[148:151],v[52:55],v[64:79]
EXP v43,v43
EXP v44,v44
EXP v45,v45
M16 v[236:239],v[168:171],a[188:191],v[236:239]
DR v[168:171],v153 offset:3072
CVT v60,v40,v41
CVT v61,v42,v43
M16 v[252:255],v[172:175],a[188:191],v[252:255]
BL4 a[188:191],v2,s[8:11],s26 offen offset:3072
s_add_u32 s26, s26, 4096
EXP v46,v46
EXP v47,v47
CVT v62,v44,v45
CVT v63,v46,v47
M32 v[32:47],a[4:7],v[80:83],0
s_waitcnt lgkmcnt(0)
EXP v16,v16
EXP v17,v17
EXP v18,v18
M16 v[176:179],v[156:159],a[160:163],v[176:179]
DR v[172:175],v153 offset:4096
EXP v19,v19
M8 v[32:47],a[34:35],v[84:85],v[32:47]
EXP v20,v20
EXP v21,v21
CVT v48,v16,v17
CVT v49,v18,v19
EXP v22,v22
M16 v[192:195],v[160:163],a[160:163],v[192:195]
EXP v23,v23
M32 v[64:79],a[152:155],v[56:59],v[64:79]
EXP v24,v24
EXP v25,v25
CVT v50,v20,v21
CVT v51,v22,v23
M16 v[208:211],v[164:167],a[160:163],v[208:211]
s_add_u32 m0, s31, 0
EXP v26,v26
M32 v[64:79],a[156:159],v[60:63],v[64:79]
s_waitcnt lgkmcnt(0)
EXP v27,v27
EXP v28,v28
EXP v29,v29
M16 v[224:227],v[168:171],a[160:163],v[224:227]
BL4 v2,s[8:11],s27 offen lds
CVT v52,v24,v25
CVT v53,v26,v27
M16 v[240:243],v[172:175],a[160:163],v[240:243]
BL4 a[160:163],v2,s[8:11],s26 offen offset:0
EXP v30,v30
EXP v31,v31
CVT v54,v28,v29
CVT v55,v30,v31
M32 v[16:31],a[8:11],v[80:83],0
s_waitcnt vmcnt(15)
EXP v32,v32
EXP v33,v33
EXP v34,v34
M16 v[180:183],v[156:159],a[164:167],v[180:183]
EXP v35,v35
M8 v[16:31],a[36:37],v[84:85],v[16:31]
ds_write_b128 v142, v[64:67] offset:36864
EXP v36,v36
EXP v37,v37
CVT v56,v32,v33
CVT v57,v34,v35
ds_write_b128 v142, v[68:71] offset:37888
EXP v38,v38
M16 v[196:199],v[160:163],a[164:167],v[196:199]
BL4 v2,s[8:11],s27 offen offset:1024 lds
EXP v39,v39
ds_write_b128 v142, v[72:75] offset:38912
M32 v[64:79],a[192:195],v[48:51],0
buffer_load_dword v86, v155, s[8:11], s36 offen sc1
EXP v40,v40
EXP v41,v41
CVT v58,v36,v37
CVT v59,v38,v39
M16 v[212:215],v[164:167],a[164:167],v[212:215]
EXP v42,v42
M32 v[64:79],a[196:199],v[52:55],v[64:79]
EXP v43,v43
EXP v44,v44
EXP v45,v45
M16 v[228:231],v[168:171],a[164:167],v[228:231]
BL4 v2,s[8:11],s27 offen offset:2048 lds
CVT v60,v40,v41
CVT v61,v42,v43
M16 v[244:247],v[172:175],a[164:167],v[244:247]
BL4 a[164:167],v2,s[8:11],s26 offen offset:1024
EXP v46,v46
EXP v47,v47
CVT v62,v44,v45
CVT v63,v46,v47
M32 v[32:47],a[12:15],v[80:83],0
s_waitcnt vmcnt(16)
EXP v16,v16
EXP v17,v17
EXP v18,v18
M16 v[184:187],v[156:159],a[168:171],v[184:187]
s_waitcnt lgkmcnt(0)
EXP v19,v19
M8 v[32:47],a[38:39],v[84:85],v[32:47]
s_barrier
EXP v20,v20
EXP v21,v21
CVT v48,v16,v17
CVT v49,v18,v19
EXP v22,v22
M16 v[200:203],v[160:163],a[168:171],v[200:203]
BL4 v2,s[8:11],s27 offen offset:3072 lds
EXP v23,v23
M32 v[64:79],a[200:203],v[56:59],v[64:79]
EXP v24,v24
EXP v25,v25
CVT v50,v20,v21
CVT v51,v22,v23
M16 v[216:219],v[164:167],a[168:171],v[216:219]
s_add_u32 m0, s31, 4096
EXP v26,v26
M32 v[64:79],a[204:207],v[60:63],v[64:79]
EXP v27,v27
EXP v28,v28
EXP v29,v29
M16 v[232:235],v[168:171],a[168:171],v[232:235]
BL4 v148,s[8:11],s27 offen lds
CVT v52,v24,v25
CVT v53,v26,v27
M16 v[248:251],v[172:175],a[168:171],v[248:251]
BL4 a[168:171],v2,s[8:11],s26 offen offset:2048
EXP v30,v30
EXP v31,v31
CVT v54,v28,v29
CVT v55,v30,v31
M32 v[16:31],a[16:19],v[80:83],0
s_waitcnt vmcnt(16)
EXP v32,v32
EXP v33,v33
EXP v34,v34
M16 v[188:191],v[156:159],a[172:175],v[188:191]
DR v[156:159],v153 offset:5120
EXP v35,v35
M8 v[16:31],a[40:41],v[84:85],v[16:31]
EXP v36,v36
EXP v37,v37
CVT v56,v32,v33
CVT v57,v34,v35
EXP v38,v38
M16 v[204:207],v[160:163],a[172:175],v[204:207]
DR v[160:163],v153 offset:6144
EXP v39,v39
M32 v[64:79],a[208:211],v[48:51],v[64:79]
EXP v40,v40
EXP v41,v41
CVT v58,v36,v37
CVT v59,v38,v39
M16 v[220:223],v[164:167],a[172:175],v[220:223]
DR v[164:167],v153 offset:7168
EXP v42,v42
M32 v[64:79],a[212:215],v[52:55],v[64:79]
EXP v43,v43
EXP v44,v44
EXP v45,v45
M16 v[236:239],v[168:171],a[172:175],v[236:239]
DR v[168:171],v153 offset:8192
CVT v60,v40,v41
CVT v61,v42,v43
M16 v[252:255],v[172:175],a[172:175],v[252:255]
BL4 a[172:175],v2,s[8:11],s26 offen offset:3072
EXP v46,v46
EXP v47,v47
CVT v62,v44,v45
CVT v63,v46,v47
M32 v[32:47],a[20:23],v[80:83],0
s_waitcnt lgkmcnt(0)
EXP v16,v16
EXP v17,v17
EXP v18,v18
M16 v[176:179],v[156:159],a[176:179],v[176:179]
DR v[172:175],v153 offset:9216
EXP v19,v19
M8 v[32:47],a[42:43],v[84:85],v[32:47]
DR v[108:111],v143 offset:0
EXP v20,v20
EXP v21,v21
CVT v48,v16,v17
CVT v49,v18,v19
EXP v22,v22
M16 v[192:195],v[160:163],a[176:179],v[192:195]
DR v[112:115],v143 offset:1024
EXP v23,v23
M32 v[64:79],a[216:219],v[56:59],v[64:79]
s_add_u32 s26, s26, 4096
EXP v24,v24
EXP v25,v25
CVT v50,v20,v21
CVT v51,v22,v23
M16 v[208:211],v[164:167],a[176:179],v[208:211]
s_mov_b32 s27, s29
s_add_u32 m0, s31, 5120
EXP v26,v26
M32 v[64:79],a[220:223],v[60:63],v[64:79]
s_waitcnt lgkmcnt(2)
EXP v27,v27
EXP v28,v28
EXP v29,v29
M16 v[224:227],v[168:171],a[176:179],v[224:227]
BL4 v2,s[8:11],s27 offen lds
CVT v52,v24,v25
CVT v53,v26,v27
M16 v[240:243],v[172:175],a[176:179],v[240:243]
BL4 a[176:179],v2,s[8:11],s26 offen offset:0
EXP v30,v30
EXP v31,v31
CVT v54,v28,v29
CVT v55,v30,v31
M32 v[16:31],a[24:27],v[80:83],0
s_waitcnt vmcnt(16)
EXP v32,v32
EXP v33,v33
EXP v34,v34
M16 v[180:183],v[156:159],a[180:183],v[180:183]
DR v[88:91],v146 offset:7680
EXP v35,v35
M8 v[16:31],a[44:45],v[84:85],v[16:31]
ds_read_b64 v[92:93], v147 offset:7680
EXP v36,v36
EXP v37,v37
CVT v56,v32,v33
CVT v57,v34,v35
EXP v38,v38
M16 v[196:199],v[160:163],a[180:183],v[196:199]
BL4 v2,s[8:11],s27 offen offset:1024 lds
EXP v39,v39
M32 v[64:79],a[224:227],v[48:51],v[64:79]
DR v[116:119],v143 offset:2048
EXP v40,v40
EXP v41,v41
CVT v58,v36,v37
CVT v59,v38,v39
M16 v[212:215],v[164:167],a[180:183],v[212:215]
DR v[120:123],v143 offset:3072
EXP v42,v42
M32 v[64:79],a[228:231],v[52:55],v[64:79]
DR v[124:127],v143 offset:4096
EXP v43,v43
EXP v44,v44
EXP v45,v45
M16 v[228:231],v[168:171],a[180:183],v[228:231]
BL4 v2,s[8:11],s27 offen offset:2048 lds
CVT v60,v40,v41
CVT v61,v42,v43
M16 v[244:247],v[172:175],a[180:183],v[244:247]
BL4 a[180:183],v2,s[8:11],s26 offen offset:1024
EXP v46,v46
EXP v47,v47
CVT v62,v44,v45
CVT v63,v46,v47
M32 v[32:47],a[28:31],v[80:83],0
s_waitcnt vmcnt(16)
EXP v16,v16
EXP v17,v17
EXP v18,v18
M16 v[184:187],v[156:159],a[184:187],v[184:187]
DR v[128:131],v143 offset:5120
EXP v19,v19
M8 v[32:47],a[46:47],v[84:85],v[32:47]
EXP v20,v20
EXP v21,v21
CVT v48,v16,v17
CVT v49,v18,v19
EXP v22,v22
M16 v[200:203],v[160:163],a[184:187],v[200:203]
BL4 v2,s[8:11],s27 offen offset:3072 lds
EXP v23,v23
M32 v[64:79],a[232:235],v[56:59],v[64:79]
EXP v24,v24
EXP v25,v25
CVT v50,v20,v21
CVT v51,v22,v23
M16 v[216:219],v[164:167],a[184:187],v[216:219]
s_add_u32 m0, s31, 9216
EXP v26,v26
M32 v[64:79],a[236:239],v[60:63],v[64:79]
EXP v27,v27
EXP v28,v28
EXP v29,v29
M16 v[232:235],v[168:171],a[184:187],v[232:235]
BL4 v148,s[8:11],s27 offen lds
CVT v52,v24,v25
CVT v53,v26,v27
M16 v[248:251],v[172:175],a[184:187],v[248:251]
BL4 a[184:187],v2,s[8:11],s26 offen offset:2048
EXP v30,v30
EXP v31,v31
CVT v54,v28,v29
CVT v55,v30,v31
s_waitcnt lgkmcnt(0)
v_add_f32 v108, v108, v120
v_add_f32 v109, v109, v121
v_add_f32 v110, v110, v122
v_add_f32 v111, v111, v123
v_add_f32 v112, v112, v124
v_add_f32 v113, v113, v125
v_add_f32 v114, v114, v126
v_add_f32 v115, v115, v127
v_add_f32 v116, v116, v128
v_add_f32 v117, v117, v129
v_add_f32 v118, v118, v130
v_add_f32 v119, v119, v131
DR v[120:123],v143 offset:6144
DR v[124:127],v143 offset:7168
DR v[128:131],v143 offset:8192
M32 v[16:31],a[64:67],v[80:83],0
s_waitcnt vmcnt(16)
EXP v32,v32
EXP v33,v33
EXP v34,v34
M16 v[188:191],v[156:159],a[188:191],v[188:191]
DR v[156:159],v153 offset:10240
EXP v35,v35
M8 v[16:31],a[48:49],v[84:85],v[16:31]
EXP v36,v36
EXP v37,v37
CVT v56,v32,v33
CVT v57,v34,v35
EXP v38,v38
M16 v[204:207],v[160:163],a[188:191],v[204:207]
DR v[160:163],v153 offset:11264
EXP v39,v39
M32 v[64:79],a[240:243],v[48:51],v[64:79]
EXP v40,v40
EXP v41,v41
CVT v58,v36,v37
CVT v59,v38,v39
M16 v[220:223],v[164:167],a[188:191],v[220:223]
DR v[164:167],v153 offset:12288
EXP v42,v42
M32 v[64:79],a[244:247],v[52:55],v[64:79]
EXP v43,v43
EXP v44,v44
EXP v45,v45
M16 v[236:239],v[168:171],a[188:191],v[236:239]
DR v[168:171],v153 offset:13312
CVT v60,v40,v41
CVT v61,v42,v43
M16 v[252:255],v[172:175],a[188:191],v[252:255]
BL4 a[188:191],v2,s[8:11],s26 offen offset:3072
EXP v46,v46
EXP v47,v47
CVT v62,v44,v45
CVT v63,v46,v47
s_waitcnt vmcnt(15)
L_c_f2:
v_cmp_ne_u32 vcc, 0, v86
s_nop 3
s_and_b32 s56, vcc_lo, s30
s_cmp_eq_u32 s56, s30
s_cbranch_scc1 L_c_g2
s_cmp_eq_u32 s3, 0
s_cbranch_scc1 L_c_g2
s_sub_u32 s3, s3, 1
s_sleep 4
buffer_load_dword v86, v155, s[8:11], s36 offen sc1
s_waitcnt vmcnt(0)
s_branch L_c_f2
L_c_g2:
M32 v[32:47],a[68:71],v[80:83],0
s_waitcnt lgkmcnt(0)
EXP v16,v16
EXP v17,v17
EXP v18,v18
M16 v[176:179],v[156:159],a[160:163],v[176:179]
DR v[172:175],v153 offset:14336
EXP v19,v19
M8 v[32:47],a[50:51],v[84:85],v[32:47]
EXP v20,v20
EXP v21,v21
CVT v48,v16,v17
CVT v49,v18,v19
v_add_f32 v108, v108, v120
v_add_f32 v109, v109, v121
v_add_f32 v110, v110, v122
v_add_f32 v111, v111, v123
v_add_f32 v112, v112, v124
v_add_f32 v113, v113, v125
v_add_f32 v114, v114, v126
v_add_f32 v115, v115, v127
v_add_f32 v116, v116, v128
v_add_f32 v117, v117, v129
v_add_f32 v118, v118, v130
v_add_f32 v119, v119, v131
DR v[120:123],v143 offset:9216
DR v[124:127],v143 offset:10240
DR v[128:131],v143 offset:11264
EXP v22,v22
M16 v[192:195],v[160:163],a[160:163],v[192:195]
EXP v23,v23
M32 v[64:79],a[248:251],v[56:59],v[64:79]
s_mov_b32 s26, s28
EXP v24,v24
EXP v25,v25
CVT v50,v20,v21
CVT v51,v22,v23
M16 v[208:211],v[164:167],a[160:163],v[208:211]
s_add_u32 s27, s27, 40960
s_add_u32 m0, s31, 10240
EXP v26,v26
M32 v[64:79],a[252:255],v[60:63],v[64:79]
s_waitcnt lgkmcnt(3)
EXP v27,v27
EXP v28,v28
EXP v29,v29
M16 v[224:227],v[168:171],a[160:163],v[224:227]
BL4 v2,s[8:11],s27 offen lds
CVT v52,v24,v25
CVT v53,v26,v27
M16 v[240:243],v[172:175],a[160:163],v[240:243]
BL4 a[160:163],v2,s[8:11],s26 offen offset:0
EXP v30,v30
EXP v31,v31
CVT v54,v28,v29
CVT v55,v30,v31
M32 v[16:31],a[72:75],v[80:83],0
s_waitcnt vmcnt(15)
EXP v32,v32
EXP v33,v33
EXP v34,v34
M16 v[180:183],v[156:159],a[164:167],v[180:183]
EXP v35,v35
M8 v[16:31],a[52:53],v[84:85],v[16:31]
EXP v36,v36
EXP v37,v37
CVT v56,v32,v33
CVT v57,v34,v35
EXP v38,v38
M16 v[196:199],v[160:163],a[164:167],v[196:199]
BL4 v2,s[8:11],s27 offen offset:1024 lds
EXP v39,v39
M32 v[64:79],a[96:99],v[48:51],v[64:79]
EXP v40,v40
EXP v41,v41
CVT v58,v36,v37
CVT v59,v38,v39
M16 v[212:215],v[164:167],a[164:167],v[212:215]
EXP v42,v42
M32 v[64:79],a[100:103],v[52:55],v[64:79]
EXP v43,v43
EXP v44,v44
EXP v45,v45
M16 v[228:231],v[168:171],a[164:167],v[228:231]
BL4 v2,s[8:11],s27 offen offset:2048 lds
CVT v60,v40,v41
CVT v61,v42,v43
M16 v[244:247],v[172:175],a[164:167],v[244:247]
BL4 a[164:167],v2,s[8:11],s26 offen offset:1024
EXP v46,v46
EXP v47,v47
CVT v62,v44,v45
CVT v63,v46,v47
s_waitcnt lgkmcnt(0)
v_add_f32 v116, v116, v128
v_add_f32 v108, v108, v120
v_add_f32 v109, v109, v121
v_add_f32 v110, v110, v122
v_add_f32 v111, v111, v123
v_add_f32 v112, v112, v124
v_add_f32 v113, v113, v125
v_add_f32 v114, v114, v126
v_add_f32 v115, v115, v127
v_add_f32 v117, v117, v129
v_add_f32 v118, v118, v130
v_add_f32 v119, v119, v131
v_mov_b32 v120, v116
v_mov_b32 v121, v116
M32 v[32:47],a[76:79],v[80:83],0
s_waitcnt vmcnt(15)
EXP v16,v16
EXP v17,v17
EXP v18,v18
v_permlane32_swap_b32 v120, v121
M16 v[184:187],v[156:159],a[168:171],v[184:187]
EXP v19,v19
M8 v[32:47],a[54:55],v[84:85],v[32:47]
EXP v20,v20
EXP v21,v21
CVT v48,v16,v17
CVT v49,v18,v19
EXP v22,v22
M16 v[200:203],v[160:163],a[168:171],v[200:203]
BL4 v2,s[8:11],s27 offen offset:3072 lds
EXP v23,v23
M32 v[64:79],a[104:107],v[56:59],v[64:79]
EXP v24,v24
EXP v25,v25
v_rcp_f32 v120, v121
CVT v50,v20,v21
CVT v51,v22,v23
M16 v[216:219],v[164:167],a[168:171],v[216:219]
s_add_u32 m0, s31, 14336
EXP v26,v26
M32 v[64:79],a[108:111],v[60:63],v[64:79]
EXP v27,v27
EXP v28,v28
EXP v29,v29
M16 v[232:235],v[168:171],a[168:171],v[232:235]
BL4 v148,s[8:11],s27 offen lds
CVT v52,v24,v25
CVT v53,v26,v27
M16 v[248:251],v[172:175],a[168:171],v[248:251]
BL4 a[168:171],v2,s[8:11],s26 offen offset:2048
EXP v30,v30
EXP v31,v31
CVT v54,v28,v29
CVT v55,v30,v31
v_mul_f32 v108, v108, v120
v_mul_f32 v109, v109, v120
v_mul_f32 v110, v110, v120
v_mul_f32 v111, v111, v120
v_mul_f32 v112, v112, v120
v_mul_f32 v113, v113, v120
v_mul_f32 v114, v114, v120
v_mul_f32 v115, v115, v120
v_mul_f32 v116, v116, v120
v_mul_f32 v117, v117, v120
v_mul_f32 v118, v118, v120
v_mul_f32 v119, v119, v120
CVT v132,v108,v109
CVT v133,v110,v111
CVT v134,v112,v113
CVT v135,v114,v115
CVT v136,v116,v117
CVT v137,v118,v119
v_add_f32 v122, v108, v109
v_add_f32 v122, v110, v122
v_add_f32 v122, v111, v122
v_add_f32 v122, v112, v122
v_add_f32 v122, v113, v122
v_add_f32 v122, v114, v122
v_add_f32 v122, v115, v122
v_add_f32 v122, v116, v122
v_add_f32 v122, v117, v122
v_add_f32 v122, v118, v122
v_add_f32 v122, v119, v122
v_cmp_nge_f32 s[56:57], s60, v121
v_cmp_class_f32 s[58:59], v122, s61
s_nop 1
s_or_b64 vcc, s[56:57], s[58:59]
s_cbranch_vccz L_b_ck0
s_mov_b32 s62, 0
s_call_b64 s[48:49], L_b_slow
L_b_ck0:
M32 v[16:31],a[80:83],v[80:83],0
s_waitcnt vmcnt(15)
EXP v32,v32
EXP v33,v33
EXP v34,v34
M16 v[188:191],v[156:159],a[172:175],v[188:191]
DR v[156:159],v153 offset:0
EXP v35,v35
M8 v[16:31],a[56:57],v[84:85],v[16:31]
EXP v36,v36
EXP v37,v37
CVT v56,v32,v33
CVT v57,v34,v35
EXP v38,v38
M16 v[204:207],v[160:163],a[172:175],v[204:207]
DR v[160:163],v153 offset:1024
EXP v39,v39
M32 v[64:79],a[112:115],v[48:51],v[64:79]
EXP v40,v40
EXP v41,v41
CVT v58,v36,v37
CVT v59,v38,v39
M16 v[220:223],v[164:167],a[172:175],v[220:223]
DR v[164:167],v153 offset:2048
EXP v42,v42
M32 v[64:79],a[116:119],v[52:55],v[64:79]
EXP v43,v43
EXP v44,v44
EXP v45,v45
M16 v[236:239],v[168:171],a[172:175],v[236:239]
DR v[168:171],v153 offset:3072
CVT v60,v40,v41
CVT v61,v42,v43
M16 v[252:255],v[172:175],a[172:175],v[252:255]
BL4 a[172:175],v2,s[8:11],s26 offen offset:3072
EXP v46,v46
EXP v47,v47
CVT v62,v44,v45
CVT v63,v46,v47
M32 v[32:47],a[84:87],v[80:83],0
s_waitcnt lgkmcnt(0)
EXP v16,v16
EXP v17,v17
EXP v18,v18
M16 v[176:179],v[156:159],a[176:179],v[176:179]
DR v[172:175],v153 offset:4096
EXP v19,v19
M8 v[32:47],a[58:59],v[84:85],v[32:47]
ds_write_b64 v139, v[132:133] offset:0
EXP v20,v20
EXP v21,v21
CVT v48,v16,v17
CVT v49,v18,v19
EXP v22,v22
M16 v[192:195],v[160:163],a[176:179],v[192:195]
ds_write_b64 v140, v[134:135] offset:0
EXP v23,v23
M32 v[64:79],a[120:123],v[56:59],v[64:79]
s_add_u32 s26, s26, 4096
EXP v24,v24
EXP v25,v25
CVT v50,v20,v21
CVT v51,v22,v23
M16 v[208:211],v[164:167],a[176:179],v[208:211]
s_add_u32 s27, s27, 40960
s_add_u32 m0, s31, 0
EXP v26,v26
M32 v[64:79],a[124:127],v[60:63],v[64:79]
s_waitcnt lgkmcnt(2)
EXP v27,v27
EXP v28,v28
EXP v29,v29
M16 v[224:227],v[168:171],a[176:179],v[224:227]
BL4 v2,s[8:11],s27 offen lds
CVT v52,v24,v25
CVT v53,v26,v27
M16 v[240:243],v[172:175],a[176:179],v[240:243]
BL4 a[176:179],v2,s[8:11],s26 offen offset:0
EXP v30,v30
EXP v31,v31
CVT v54,v28,v29
CVT v55,v30,v31
M32 v[16:31],a[88:91],v[80:83],0
s_waitcnt vmcnt(15)
EXP v32,v32
EXP v33,v33
EXP v34,v34
M16 v[180:183],v[156:159],a[180:183],v[180:183]
EXP v35,v35
M8 v[16:31],a[60:61],v[84:85],v[16:31]
s_mov_b32 exec_hi, 0
ds_write_b64 v141, v[136:137] offset:0
s_mov_b32 exec_hi, -1
EXP v36,v36
EXP v37,v37
CVT v56,v32,v33
CVT v57,v34,v35
EXP v38,v38
M16 v[196:199],v[160:163],a[180:183],v[196:199]
BL4 v2,s[8:11],s27 offen offset:1024 lds
EXP v39,v39
M32 v[64:79],a[128:131],v[48:51],v[64:79]
EXP v40,v40
EXP v41,v41
CVT v58,v36,v37
CVT v59,v38,v39
M16 v[212:215],v[164:167],a[180:183],v[212:215]
EXP v42,v42
M32 v[64:79],a[132:135],v[52:55],v[64:79]
EXP v43,v43
EXP v44,v44
EXP v45,v45
M16 v[228:231],v[168:171],a[180:183],v[228:231]
BL4 v2,s[8:11],s27 offen offset:2048 lds
CVT v60,v40,v41
CVT v61,v42,v43
M16 v[244:247],v[172:175],a[180:183],v[244:247]
BL4 a[180:183],v2,s[8:11],s26 offen offset:1024
EXP v46,v46
EXP v47,v47
CVT v62,v44,v45
CVT v63,v46,v47
M32 v[32:47],a[92:95],v[80:83],0
s_waitcnt vmcnt(15)
EXP v16,v16
EXP v17,v17
EXP v18,v18
M16 v[184:187],v[156:159],a[184:187],v[184:187]
EXP v19,v19
M8 v[32:47],a[62:63],v[84:85],v[32:47]
EXP v20,v20
EXP v21,v21
CVT v48,v16,v17
CVT v49,v18,v19
EXP v22,v22
M16 v[200:203],v[160:163],a[184:187],v[200:203]
BL4 v2,s[8:11],s27 offen offset:3072 lds
EXP v23,v23
M32 v[64:79],a[136:139],v[56:59],v[64:79]
EXP v24,v24
EXP v25,v25
CVT v50,v20,v21
CVT v51,v22,v23
M16 v[216:219],v[164:167],a[184:187],v[216:219]
s_add_u32 m0, s31, 4096
EXP v26,v26
M32 v[64:79],a[140:143],v[60:63],v[64:79]
EXP v27,v27
EXP v28,v28
EXP v29,v29
M16 v[232:235],v[168:171],a[184:187],v[232:235]
BL4 v148,s[8:11],s27 offen lds
s_add_u32 s27, s27, 40960
CVT v52,v24,v25
CVT v53,v26,v27
M16 v[248:251],v[172:175],a[184:187],v[248:251]
BL4 a[184:187],v2,s[8:11],s26 offen offset:2048
EXP v30,v30
EXP v31,v31
CVT v54,v28,v29
CVT v55,v30,v31
M32 v[16:31],a[0:3],v[88:91],0
s_waitcnt vmcnt(15)
EXP v32,v32
EXP v33,v33
EXP v34,v34
M16 v[188:191],v[156:159],a[188:191],v[188:191]
DR v[156:159],v153 offset:5120
EXP v35,v35
M8 v[16:31],a[32:33],v[92:93],v[16:31]
EXP v36,v36
EXP v37,v37
CVT v56,v32,v33
CVT v57,v34,v35
EXP v38,v38
M16 v[204:207],v[160:163],a[188:191],v[204:207]
DR v[160:163],v153 offset:6144
EXP v39,v39
M32 v[64:79],a[144:147],v[48:51],v[64:79]
EXP v40,v40
EXP v41,v41
CVT v58,v36,v37
CVT v59,v38,v39
M16 v[220:223],v[164:167],a[188:191],v[220:223]
DR v[164:167],v153 offset:7168
EXP v42,v42
M32 v[64:79],a[148:151],v[52:55],v[64:79]
EXP v43,v43
EXP v44,v44
EXP v45,v45
M16 v[236:239],v[168:171],a[188:191],v[236:239]
DR v[168:171],v153 offset:8192
CVT v60,v40,v41
CVT v61,v42,v43
M16 v[252:255],v[172:175],a[188:191],v[252:255]
BL4 a[188:191],v2,s[8:11],s26 offen offset:3072
s_add_u32 s26, s26, 4096
EXP v46,v46
EXP v47,v47
CVT v62,v44,v45
CVT v63,v46,v47
M32 v[32:47],a[4:7],v[88:91],0
s_waitcnt lgkmcnt(0)
EXP v16,v16
EXP v17,v17
EXP v18,v18
M16 v[176:179],v[156:159],a[160:163],v[176:179]
DR v[172:175],v153 offset:9216
EXP v19,v19
M8 v[32:47],a[34:35],v[92:93],v[32:47]
EXP v20,v20
EXP v21,v21
CVT v48,v16,v17
CVT v49,v18,v19
EXP v22,v22
M16 v[192:195],v[160:163],a[160:163],v[192:195]
EXP v23,v23
M32 v[64:79],a[152:155],v[56:59],v[64:79]
EXP v24,v24
EXP v25,v25
CVT v50,v20,v21
CVT v51,v22,v23
M16 v[208:211],v[164:167],a[160:163],v[208:211]
s_add_u32 m0, s31, 5120
EXP v26,v26
M32 v[64:79],a[156:159],v[60:63],v[64:79]
s_waitcnt lgkmcnt(0)
EXP v27,v27
EXP v28,v28
EXP v29,v29
M16 v[224:227],v[168:171],a[160:163],v[224:227]
BL4 v2,s[8:11],s27 offen lds
CVT v52,v24,v25
CVT v53,v26,v27
M16 v[240:243],v[172:175],a[160:163],v[240:243]
BL4 a[160:163],v2,s[8:11],s26 offen offset:0
s_barrier
EXP v30,v30
EXP v31,v31
CVT v54,v28,v29
CVT v55,v30,v31
M32 v[16:31],a[8:11],v[88:91],0
s_waitcnt vmcnt(15)
EXP v32,v32
EXP v33,v33
EXP v34,v34
M16 v[180:183],v[156:159],a[164:167],v[180:183]
EXP v35,v35
M8 v[16:31],a[36:37],v[92:93],v[16:31]
ds_write_b128 v142, v[64:67] offset:0
EXP v36,v36
EXP v37,v37
CVT v56,v32,v33
CVT v57,v34,v35
ds_write_b128 v142, v[68:71] offset:1024
EXP v38,v38
M16 v[196:199],v[160:163],a[164:167],v[196:199]
BL4 v2,s[8:11],s27 offen offset:1024 lds
EXP v39,v39
ds_write_b128 v142, v[72:75] offset:2048
M32 v[64:79],a[192:195],v[48:51],0
EXP v40,v40
EXP v41,v41
CVT v58,v36,v37
CVT v59,v38,v39
M16 v[212:215],v[164:167],a[164:167],v[212:215]
EXP v42,v42
M32 v[64:79],a[196:199],v[52:55],v[64:79]
EXP v43,v43
EXP v44,v44
EXP v45,v45
M16 v[228:231],v[168:171],a[164:167],v[228:231]
BL4 v2,s[8:11],s27 offen offset:2048 lds
CVT v60,v40,v41
CVT v61,v42,v43
M16 v[244:247],v[172:175],a[164:167],v[244:247]
BL4 a[164:167],v2,s[8:11],s26 offen offset:1024
EXP v46,v46
EXP v47,v47
CVT v62,v44,v45
CVT v63,v46,v47
M32 v[32:47],a[12:15],v[88:91],0
s_waitcnt vmcnt(15)
EXP v16,v16
EXP v17,v17
EXP v18,v18
M16 v[184:187],v[156:159],a[168:171],v[184:187]
EXP v19,v19
M8 v[32:47],a[38:39],v[92:93],v[32:47]
EXP v20,v20
EXP v21,v21
CVT v48,v16,v17
CVT v49,v18,v19
EXP v22,v22
M16 v[200:203],v[160:163],a[168:171],v[200:203]
BL4 v2,s[8:11],s27 offen offset:3072 lds
EXP v23,v23
M32 v[64:79],a[200:203],v[56:59],v[64:79]
EXP v24,v24
EXP v25,v25
CVT v50,v20,v21
CVT v51,v22,v23
M16 v[216:219],v[164:167],a[168:171],v[216:219]
s_add_u32 m0, s31, 9216
EXP v26,v26
M32 v[64:79],a[204:207],v[60:63],v[64:79]
EXP v27,v27
EXP v28,v28
EXP v29,v29
M16 v[232:235],v[168:171],a[168:171],v[232:235]
BL4 v148,s[8:11],s27 offen lds
CVT v52,v24,v25
CVT v53,v26,v27
M16 v[248:251],v[172:175],a[168:171],v[248:251]
BL4 a[168:171],v2,s[8:11],s26 offen offset:2048
EXP v30,v30
EXP v31,v31
CVT v54,v28,v29
CVT v55,v30,v31
M32 v[16:31],a[16:19],v[88:91],0
s_waitcnt vmcnt(15)
EXP v32,v32
EXP v33,v33
EXP v34,v34
M16 v[188:191],v[156:159],a[172:175],v[188:191]
DR v[156:159],v153 offset:10240
EXP v35,v35
M8 v[16:31],a[40:41],v[92:93],v[16:31]
EXP v36,v36
EXP v37,v37
CVT v56,v32,v33
CVT v57,v34,v35
EXP v38,v38
M16 v[204:207],v[160:163],a[172:175],v[204:207]
DR v[160:163],v153 offset:11264
EXP v39,v39
M32 v[64:79],a[208:211],v[48:51],v[64:79]
EXP v40,v40
EXP v41,v41
CVT v58,v36,v37
CVT v59,v38,v39
M16 v[220:223],v[164:167],a[172:175],v[220:223]
DR v[164:167],v153 offset:12288
EXP v42,v42
M32 v[64:79],a[212:215],v[52:55],v[64:79]
EXP v43,v43
EXP v44,v44
EXP v45,v45
M16 v[236:239],v[168:171],a[172:175],v[236:239]
DR v[168:171],v153 offset:13312
CVT v60,v40,v41
CVT v61,v42,v43
M16 v[252:255],v[172:175],a[172:175],v[252:255]
BL4 a[172:175],v2,s[8:11],s26 offen offset:3072
EXP v46,v46
EXP v47,v47
CVT v62,v44,v45
CVT v63,v46,v47
M32 v[32:47],a[20:23],v[88:91],0
s_waitcnt lgkmcnt(0)
EXP v16,v16
EXP v17,v17
EXP v18,v18
M16 v[176:179],v[156:159],a[176:179],v[176:179]
DR v[172:175],v153 offset:14336
EXP v19,v19
M8 v[32:47],a[42:43],v[92:93],v[32:47]
EXP v20,v20
EXP v21,v21
CVT v48,v16,v17
CVT v49,v18,v19
EXP v22,v22
M16 v[192:195],v[160:163],a[176:179],v[192:195]
EXP v23,v23
M32 v[64:79],a[216:219],v[56:59],v[64:79]
s_add_u32 s26, s26, 4096
EXP v24,v24
EXP v25,v25
CVT v50,v20,v21
CVT v51,v22,v23
M16 v[208:211],v[164:167],a[176:179],v[208:211]
s_add_u32 s27, s27, 40960
s_add_u32 m0, s31, 10240
EXP v26,v26
M32 v[64:79],a[220:223],v[60:63],v[64:79]
s_waitcnt lgkmcnt(0)
EXP v27,v27
EXP v28,v28
EXP v29,v29
M16 v[224:227],v[168:171],a[176:179],v[224:227]
BL4 v2,s[8:11],s27 offen lds
CVT v52,v24,v25
CVT v53,v26,v27
M16 v[240:243],v[172:175],a[176:179],v[240:243]
BL4 a[176:179],v2,s[8:11],s26 offen offset:0
EXP v30,v30
EXP v31,v31
CVT v54,v28,v29
CVT v55,v30,v31
M32 v[16:31],a[24:27],v[88:91],0
s_waitcnt vmcnt(15)
EXP v32,v32
EXP v33,v33
EXP v34,v34
M16 v[180:183],v[156:159],a[180:183],v[180:183]
DR v[80:83],v146 offset:9216
EXP v35,v35
M8 v[16:31],a[44:45],v[92:93],v[16:31]
ds_read_b64 v[84:85], v147 offset:9216
EXP v36,v36
EXP v37,v37
CVT v56,v32,v33
CVT v57,v34,v35
EXP v38,v38
M16 v[196:199],v[160:163],a[180:183],v[196:199]
BL4 v2,s[8:11],s27 offen offset:1024 lds
EXP v39,v39
M32 v[64:79],a[224:227],v[48:51],v[64:79]
EXP v40,v40
EXP v41,v41
CVT v58,v36,v37
CVT v59,v38,v39
M16 v[212:215],v[164:167],a[180:183],v[212:215]
EXP v42,v42
M32 v[64:79],a[228:231],v[52:55],v[64:79]
EXP v43,v43
EXP v44,v44
EXP v45,v45
M16 v[228:231],v[168:171],a[180:183],v[228:231]
BL4 v2,s[8:11],s27 offen offset:2048 lds
CVT v60,v40,v41
CVT v61,v42,v43
M16 v[244:247],v[172:175],a[180:183],v[244:247]
BL4 a[180:183],v2,s[8:11],s26 offen offset:1024
EXP v46,v46
EXP v47,v47
CVT v62,v44,v45
CVT v63,v46,v47
M32 v[32:47],a[28:31],v[88:91],0
s_waitcnt vmcnt(15)
EXP v16,v16
EXP v17,v17
EXP v18,v18
M16 v[184:187],v[156:159],a[184:187],v[184:187]
EXP v19,v19
M8 v[32:47],a[46:47],v[92:93],v[32:47]
EXP v20,v20
EXP v21,v21
CVT v48,v16,v17
CVT v49,v18,v19
EXP v22,v22
M16 v[200:203],v[160:163],a[184:187],v[200:203]
BL4 v2,s[8:11],s27 offen offset:3072 lds
EXP v23,v23
M32 v[64:79],a[232:235],v[56:59],v[64:79]
EXP v24,v24
EXP v25,v25
CVT v50,v20,v21
CVT v51,v22,v23
M16 v[216:219],v[164:167],a[184:187],v[216:219]
s_add_u32 m0, s31, 14336
EXP v26,v26
M32 v[64:79],a[236:239],v[60:63],v[64:79]
EXP v27,v27
EXP v28,v28
EXP v29,v29
M16 v[232:235],v[168:171],a[184:187],v[232:235]
BL4 v148,s[8:11],s27 offen lds
CVT v52,v24,v25
CVT v53,v26,v27
M16 v[248:251],v[172:175],a[184:187],v[248:251]
BL4 a[184:187],v2,s[8:11],s26 offen offset:2048
EXP v30,v30
EXP v31,v31
CVT v54,v28,v29
CVT v55,v30,v31
M32 v[16:31],a[64:67],v[88:91],0
s_waitcnt vmcnt(15)
EXP v32,v32
EXP v33,v33
EXP v34,v34
M16 v[188:191],v[156:159],a[188:191],v[188:191]
DR v[156:159],v153 offset:0
EXP v35,v35
M8 v[16:31],a[48:49],v[92:93],v[16:31]
EXP v36,v36
EXP v37,v37
CVT v56,v32,v33
CVT v57,v34,v35
EXP v38,v38
M16 v[204:207],v[160:163],a[188:191],v[204:207]
DR v[160:163],v153 offset:1024
EXP v39,v39
M32 v[64:79],a[240:243],v[48:51],v[64:79]
EXP v40,v40
EXP v41,v41
CVT v58,v36,v37
CVT v59,v38,v39
M16 v[220:223],v[164:167],a[188:191],v[220:223]
DR v[164:167],v153 offset:2048
EXP v42,v42
M32 v[64:79],a[244:247],v[52:55],v[64:79]
EXP v43,v43
EXP v44,v44
EXP v45,v45
M16 v[236:239],v[168:171],a[188:191],v[236:239]
DR v[168:171],v153 offset:3072
CVT v60,v40,v41
CVT v61,v42,v43
M16 v[252:255],v[172:175],a[188:191],v[252:255]
BL4 a[188:191],v2,s[8:11],s26 offen offset:3072
EXP v46,v46
EXP v47,v47
CVT v62,v44,v45
CVT v63,v46,v47
M32 v[32:47],a[68:71],v[88:91],0
s_waitcnt lgkmcnt(0)
EXP v16,v16
EXP v17,v17
EXP v18,v18
M16 v[176:179],v[156:159],a[160:163],v[176:179]
DR v[172:175],v153 offset:4096
EXP v19,v19
M8 v[32:47],a[50:51],v[92:93],v[32:47]
EXP v20,v20
EXP v21,v21
CVT v48,v16,v17
CVT v49,v18,v19
EXP v22,v22
M16 v[192:195],v[160:163],a[160:163],v[192:195]
EXP v23,v23
M32 v[64:79],a[248:251],v[56:59],v[64:79]
s_add_u32 s26, s26, 4096
EXP v24,v24
EXP v25,v25
CVT v50,v20,v21
CVT v51,v22,v23
M16 v[208:211],v[164:167],a[160:163],v[208:211]
s_add_u32 s27, s27, 40960
s_add_u32 m0, s31, 0
EXP v26,v26
M32 v[64:79],a[252:255],v[60:63],v[64:79]
s_waitcnt lgkmcnt(0)
EXP v27,v27
EXP v28,v28
EXP v29,v29
M16 v[224:227],v[168:171],a[160:163],v[224:227]
BL4 v2,s[8:11],s27 offen lds
CVT v52,v24,v25
CVT v53,v26,v27
M16 v[240:243],v[172:175],a[160:163],v[240:243]
BL4 a[160:163],v2,s[8:11],s26 offen offset:0
EXP v30,v30
EXP v31,v31
CVT v54,v28,v29
CVT v55,v30,v31
M32 v[16:31],a[72:75],v[88:91],0
s_waitcnt vmcnt(15)
EXP v32,v32
EXP v33,v33
EXP v34,v34
M16 v[180:183],v[156:159],a[164:167],v[180:183]
EXP v35,v35
M8 v[16:31],a[52:53],v[92:93],v[16:31]
EXP v36,v36
EXP v37,v37
CVT v56,v32,v33
CVT v57,v34,v35
EXP v38,v38
M16 v[196:199],v[160:163],a[164:167],v[196:199]
BL4 v2,s[8:11],s27 offen offset:1024 lds
EXP v39,v39
M32 v[64:79],a[96:99],v[48:51],v[64:79]
EXP v40,v40
EXP v41,v41
CVT v58,v36,v37
CVT v59,v38,v39
M16 v[212:215],v[164:167],a[164:167],v[212:215]
EXP v42,v42
M32 v[64:79],a[100:103],v[52:55],v[64:79]
EXP v43,v43
EXP v44,v44
EXP v45,v45
M16 v[228:231],v[168:171],a[164:167],v[228:231]
BL4 v2,s[8:11],s27 offen offset:2048 lds
CVT v60,v40,v41
CVT v61,v42,v43
M16 v[244:247],v[172:175],a[164:167],v[244:247]
BL4 a[164:167],v2,s[8:11],s26 offen offset:1024
EXP v46,v46
EXP v47,v47
CVT v62,v44,v45
CVT v63,v46,v47
M32 v[32:47],a[76:79],v[88:91],0
s_waitcnt vmcnt(15)
EXP v16,v16
EXP v17,v17
EXP v18,v18
M16 v[184:187],v[156:159],a[168:171],v[184:187]
EXP v19,v19
M8 v[32:47],a[54:55],v[92:93],v[32:47]
EXP v20,v20
EXP v21,v21
CVT v48,v16,v17
CVT v49,v18,v19
EXP v22,v22
M16 v[200:203],v[160:163],a[168:171],v[200:203]
BL4 v2,s[8:11],s27 offen offset:3072 lds
EXP v23,v23
M32 v[64:79],a[104:107],v[56:59],v[64:79]
EXP v24,v24
EXP v25,v25
CVT v50,v20,v21
CVT v51,v22,v23
M16 v[216:219],v[164:167],a[168:171],v[216:219]
s_add_u32 m0, s31, 4096
EXP v26,v26
M32 v[64:79],a[108:111],v[60:63],v[64:79]
EXP v27,v27
EXP v28,v28
EXP v29,v29
M16 v[232:235],v[168:171],a[168:171],v[232:235]
BL4 v148,s[8:11],s27 offen lds
CVT v52,v24,v25
CVT v53,v26,v27
M16 v[248:251],v[172:175],a[168:171],v[248:251]
BL4 a[168:171],v2,s[8:11],s26 offen offset:2048
EXP v30,v30
EXP v31,v31
CVT v54,v28,v29
CVT v55,v30,v31
M32 v[16:31],a[80:83],v[88:91],0
s_waitcnt vmcnt(15)
EXP v32,v32
EXP v33,v33
EXP v34,v34
M16 v[188:191],v[156:159],a[172:175],v[188:191]
DR v[156:159],v153 offset:5120
EXP v35,v35
M8 v[16:31],a[56:57],v[92:93],v[16:31]
EXP v36,v36
EXP v37,v37
CVT v56,v32,v33
CVT v57,v34,v35
EXP v38,v38
M16 v[204:207],v[160:163],a[172:175],v[204:207]
DR v[160:163],v153 offset:6144
EXP v39,v39
M32 v[64:79],a[112:115],v[48:51],v[64:79]
EXP v40,v40
EXP v41,v41
CVT v58,v36,v37
CVT v59,v38,v39
M16 v[220:223],v[164:167],a[172:175],v[220:223]
DR v[164:167],v153 offset:7168
EXP v42,v42
M32 v[64:79],a[116:119],v[52:55],v[64:79]
EXP v43,v43
EXP v44,v44
EXP v45,v45
M16 v[236:239],v[168:171],a[172:175],v[236:239]
DR v[168:171],v153 offset:8192
CVT v60,v40,v41
CVT v61,v42,v43
M16 v[252:255],v[172:175],a[172:175],v[252:255]
BL4 a[172:175],v2,s[8:11],s26 offen offset:3072
EXP v46,v46
EXP v47,v47
CVT v62,v44,v45
CVT v63,v46,v47
M32 v[32:47],a[84:87],v[88:91],0
s_waitcnt lgkmcnt(0)
EXP v16,v16
EXP v17,v17
EXP v18,v18
M16 v[176:179],v[156:159],a[176:179],v[176:179]
DR v[172:175],v153 offset:9216
EXP v19,v19
M8 v[32:47],a[58:59],v[92:93],v[32:47]
EXP v20,v20
EXP v21,v21
CVT v48,v16,v17
CVT v49,v18,v19
EXP v22,v22
M16 v[192:195],v[160:163],a[176:179],v[192:195]
EXP v23,v23
M32 v[64:79],a[120:123],v[56:59],v[64:79]
s_add_u32 s26, s26, 4096
EXP v24,v24
EXP v25,v25
CVT v50,v20,v21
CVT v51,v22,v23
M16 v[208:211],v[164:167],a[176:179],v[208:211]
s_add_u32 s27, s27, 40960
s_add_u32 m0, s31, 5120
EXP v26,v26
M32 v[64:79],a[124:127],v[60:63],v[64:79]
s_waitcnt lgkmcnt(0)
EXP v27,v27
EXP v28,v28
EXP v29,v29
M16 v[224:227],v[168:171],a[176:179],v[224:227]
BL4 v2,s[8:11],s27 offen lds
CVT v52,v24,v25
CVT v53,v26,v27
M16 v[240:243],v[172:175],a[176:179],v[240:243]
BL4 a[176:179],v2,s[8:11],s26 offen offset:0
EXP v30,v30
EXP v31,v31
CVT v54,v28,v29
CVT v55,v30,v31
M32 v[16:31],a[88:91],v[88:91],0
s_waitcnt vmcnt(15)
EXP v32,v32
EXP v33,v33
EXP v34,v34
M16 v[180:183],v[156:159],a[180:183],v[180:183]
EXP v35,v35
M8 v[16:31],a[60:61],v[92:93],v[16:31]
EXP v36,v36
EXP v37,v37
CVT v56,v32,v33
CVT v57,v34,v35
EXP v38,v38
M16 v[196:199],v[160:163],a[180:183],v[196:199]
BL4 v2,s[8:11],s27 offen offset:1024 lds
EXP v39,v39
M32 v[64:79],a[128:131],v[48:51],v[64:79]
EXP v40,v40
EXP v41,v41
CVT v58,v36,v37
CVT v59,v38,v39
M16 v[212:215],v[164:167],a[180:183],v[212:215]
EXP v42,v42
M32 v[64:79],a[132:135],v[52:55],v[64:79]
EXP v43,v43
EXP v44,v44
EXP v45,v45
M16 v[228:231],v[168:171],a[180:183],v[228:231]
BL4 v2,s[8:11],s27 offen offset:2048 lds
CVT v60,v40,v41
CVT v61,v42,v43
M16 v[244:247],v[172:175],a[180:183],v[244:247]
BL4 a[180:183],v2,s[8:11],s26 offen offset:1024
EXP v46,v46
EXP v47,v47
CVT v62,v44,v45
CVT v63,v46,v47
M32 v[32:47],a[92:95],v[88:91],0
s_waitcnt vmcnt(15)
EXP v16,v16
EXP v17,v17
EXP v18,v18
M16 v[184:187],v[156:159],a[184:187],v[184:187]
EXP v19,v19
M8 v[32:47],a[62:63],v[92:93],v[32:47]
EXP v20,v20
EXP v21,v21
CVT v48,v16,v17
CVT v49,v18,v19
EXP v22,v22
M16 v[200:203],v[160:163],a[184:187],v[200:203]
BL4 v2,s[8:11],s27 offen offset:3072 lds
EXP v23,v23
M32 v[64:79],a[136:139],v[56:59],v[64:79]
EXP v24,v24
EXP v25,v25
CVT v50,v20,v21
CVT v51,v22,v23
M16 v[216:219],v[164:167],a[184:187],v[216:219]
s_add_u32 m0, s31, 9216
EXP v26,v26
M32 v[64:79],a[140:143],v[60:63],v[64:79]
EXP v27,v27
EXP v28,v28
EXP v29,v29
M16 v[232:235],v[168:171],a[184:187],v[232:235]
BL4 v148,s[8:11],s27 offen lds
s_add_u32 s27, s27, 40960
CVT v52,v24,v25
CVT v53,v26,v27
M16 v[248:251],v[172:175],a[184:187],v[248:251]
BL4 a[184:187],v2,s[8:11],s26 offen offset:2048
EXP v30,v30
EXP v31,v31
CVT v54,v28,v29
CVT v55,v30,v31
M32 v[16:31],a[0:3],v[80:83],0
s_waitcnt vmcnt(15)
EXP v32,v32
EXP v33,v33
EXP v34,v34
M16 v[188:191],v[156:159],a[188:191],v[188:191]
DR v[156:159],v153 offset:10240
EXP v35,v35
M8 v[16:31],a[32:33],v[84:85],v[16:31]
EXP v36,v36
EXP v37,v37
CVT v56,v32,v33
CVT v57,v34,v35
EXP v38,v38
M16 v[204:207],v[160:163],a[188:191],v[204:207]
DR v[160:163],v153 offset:11264
EXP v39,v39
M32 v[64:79],a[144:147],v[48:51],v[64:79]
EXP v40,v40
EXP v41,v41
CVT v58,v36,v37
CVT v59,v38,v39
M16 v[220:223],v[164:167],a[188:191],v[220:223]
DR v[164:167],v153 offset:12288
EXP v42,v42
M32 v[64:79],a[148:151],v[52:55],v[64:79]
EXP v43,v43
EXP v44,v44
EXP v45,v45
M16 v[236:239],v[168:171],a[188:191],v[236:239]
DR v[168:171],v153 offset:13312
CVT v60,v40,v41
CVT v61,v42,v43
M16 v[252:255],v[172:175],a[188:191],v[252:255]
BL4 a[188:191],v2,s[8:11],s26 offen offset:3072
s_add_u32 s26, s26, 4096
EXP v46,v46
EXP v47,v47
CVT v62,v44,v45
CVT v63,v46,v47
M32 v[32:47],a[4:7],v[80:83],0
s_waitcnt lgkmcnt(0)
EXP v16,v16
EXP v17,v17
EXP v18,v18
M16 v[176:179],v[156:159],a[160:163],v[176:179]
DR v[172:175],v153 offset:14336
EXP v19,v19
M8 v[32:47],a[34:35],v[84:85],v[32:47]
EXP v20,v20
EXP v21,v21
CVT v48,v16,v17
CVT v49,v18,v19
EXP v22,v22
M16 v[192:195],v[160:163],a[160:163],v[192:195]
EXP v23,v23
M32 v[64:79],a[152:155],v[56:59],v[64:79]
EXP v24,v24
EXP v25,v25
CVT v50,v20,v21
CVT v51,v22,v23
M16 v[208:211],v[164:167],a[160:163],v[208:211]
s_add_u32 m0, s31, 10240
EXP v26,v26
M32 v[64:79],a[156:159],v[60:63],v[64:79]
s_waitcnt lgkmcnt(0)
EXP v27,v27
EXP v28,v28
EXP v29,v29
M16 v[224:227],v[168:171],a[160:163],v[224:227]
BL4 v2,s[8:11],s27 offen lds
CVT v52,v24,v25
CVT v53,v26,v27
M16 v[240:243],v[172:175],a[160:163],v[240:243]
BL4 a[160:163],v2,s[8:11],s26 offen offset:0
EXP v30,v30
EXP v31,v31
CVT v54,v28,v29
CVT v55,v30,v31
M32 v[16:31],a[8:11],v[80:83],0
s_waitcnt vmcnt(15)
EXP v32,v32
EXP v33,v33
EXP v34,v34
M16 v[180:183],v[156:159],a[164:167],v[180:183]
EXP v35,v35
M8 v[16:31],a[36:37],v[84:85],v[16:31]
ds_write_b128 v142, v[64:67] offset:12288
EXP v36,v36
EXP v37,v37
CVT v56,v32,v33
CVT v57,v34,v35
ds_write_b128 v142, v[68:71] offset:13312
EXP v38,v38
M16 v[196:199],v[160:163],a[164:167],v[196:199]
BL4 v2,s[8:11],s27 offen offset:1024 lds
EXP v39,v39
ds_write_b128 v142, v[72:75] offset:14336
M32 v[64:79],a[192:195],v[48:51],0
EXP v40,v40
EXP v41,v41
CVT v58,v36,v37
CVT v59,v38,v39
M16 v[212:215],v[164:167],a[164:167],v[212:215]
EXP v42,v42
M32 v[64:79],a[196:199],v[52:55],v[64:79]
EXP v43,v43
EXP v44,v44
EXP v45,v45
M16 v[228:231],v[168:171],a[164:167],v[228:231]
BL4 v2,s[8:11],s27 offen offset:2048 lds
CVT v60,v40,v41
CVT v61,v42,v43
M16 v[244:247],v[172:175],a[164:167],v[244:247]
BL4 a[164:167],v2,s[8:11],s26 offen offset:1024
EXP v46,v46
EXP v47,v47
CVT v62,v44,v45
CVT v63,v46,v47
M32 v[32:47],a[12:15],v[80:83],0
s_waitcnt vmcnt(15)
EXP v16,v16
EXP v17,v17
EXP v18,v18
M16 v[184:187],v[156:159],a[168:171],v[184:187]
EXP v19,v19
M8 v[32:47],a[38:39],v[84:85],v[32:47]
EXP v20,v20
EXP v21,v21
CVT v48,v16,v17
CVT v49,v18,v19
EXP v22,v22
M16 v[200:203],v[160:163],a[168:171],v[200:203]
BL4 v2,s[8:11],s27 offen offset:3072 lds
EXP v23,v23
M32 v[64:79],a[200:203],v[56:59],v[64:79]
EXP v24,v24
EXP v25,v25
CVT v50,v20,v21
CVT v51,v22,v23
M16 v[216:219],v[164:167],a[168:171],v[216:219]
s_add_u32 m0, s31, 14336
EXP v26,v26
M32 v[64:79],a[204:207],v[60:63],v[64:79]
EXP v27,v27
EXP v28,v28
EXP v29,v29
M16 v[232:235],v[168:171],a[168:171],v[232:235]
BL4 v148,s[8:11],s27 offen lds
CVT v52,v24,v25
CVT v53,v26,v27
M16 v[248:251],v[172:175],a[168:171],v[248:251]
BL4 a[168:171],v2,s[8:11],s26 offen offset:2048
EXP v30,v30
EXP v31,v31
CVT v54,v28,v29
CVT v55,v30,v31
M32 v[16:31],a[16:19],v[80:83],0
s_waitcnt vmcnt(15)
EXP v32,v32
EXP v33,v33
EXP v34,v34
M16 v[188:191],v[156:159],a[172:175],v[188:191]
DR v[156:159],v153 offset:0
EXP v35,v35
M8 v[16:31],a[40:41],v[84:85],v[16:31]
EXP v36,v36
EXP v37,v37
CVT v56,v32,v33
CVT v57,v34,v35
EXP v38,v38
M16 v[204:207],v[160:163],a[172:175],v[204:207]
DR v[160:163],v153 offset:1024
EXP v39,v39
M32 v[64:79],a[208:211],v[48:51],v[64:79]
EXP v40,v40
EXP v41,v41
CVT v58,v36,v37
CVT v59,v38,v39
M16 v[220:223],v[164:167],a[172:175],v[220:223]
DR v[164:167],v153 offset:2048
EXP v42,v42
M32 v[64:79],a[212:215],v[52:55],v[64:79]
EXP v43,v43
EXP v44,v44
EXP v45,v45
M16 v[236:239],v[168:171],a[172:175],v[236:239]
DR v[168:171],v153 offset:3072
CVT v60,v40,v41
CVT v61,v42,v43
M16 v[252:255],v[172:175],a[172:175],v[252:255]
BL4 a[172:175],v2,s[8:11],s26 offen offset:3072
EXP v46,v46
EXP v47,v47
CVT v62,v44,v45
CVT v63,v46,v47
M32 v[32:47],a[20:23],v[80:83],0
s_waitcnt lgkmcnt(0)
EXP v16,v16
EXP v17,v17
EXP v18,v18
M16 v[176:179],v[156:159],a[176:179],v[176:179]
DR v[172:175],v153 offset:4096
EXP v19,v19
M8 v[32:47],a[42:43],v[84:85],v[32:47]
EXP v20,v20
EXP v21,v21
CVT v48,v16,v17
CVT v49,v18,v19
EXP v22,v22
M16 v[192:195],v[160:163],a[176:179],v[192:195]
EXP v23,v23
M32 v[64:79],a[216:219],v[56:59],v[64:79]
s_add_u32 s26, s26, 4096
EXP v24,v24
EXP v25,v25
CVT v50,v20,v21
CVT v51,v22,v23
M16 v[208:211],v[164:167],a[176:179],v[208:211]
s_add_u32 s27, s27, 40960
s_add_u32 m0, s31, 0
EXP v26,v26
M32 v[64:79],a[220:223],v[60:63],v[64:79]
s_waitcnt lgkmcnt(0)
EXP v27,v27
EXP v28,v28
EXP v29,v29
M16 v[224:227],v[168:171],a[176:179],v[224:227]
BL4 v2,s[8:11],s27 offen lds
CVT v52,v24,v25
CVT v53,v26,v27
M16 v[240:243],v[172:175],a[176:179],v[240:243]
BL4 a[176:179],v2,s[8:11],s26 offen offset:0
EXP v30,v30
EXP v31,v31
CVT v54,v28,v29
CVT v55,v30,v31
M32 v[16:31],a[24:27],v[80:83],0
s_waitcnt vmcnt(15)
EXP v32,v32
EXP v33,v33
EXP v34,v34
M16 v[180:183],v[156:159],a[180:183],v[180:183]
DR v[88:91],v146 offset:10752
EXP v35,v35
M8 v[16:31],a[44:45],v[84:85],v[16:31]
ds_read_b64 v[92:93], v147 offset:10752
EXP v36,v36
EXP v37,v37
CVT v56,v32,v33
CVT v57,v34,v35
EXP v38,v38
M16 v[196:199],v[160:163],a[180:183],v[196:199]
BL4 v2,s[8:11],s27 offen offset:1024 lds
EXP v39,v39
M32 v[64:79],a[224:227],v[48:51],v[64:79]
EXP v40,v40
EXP v41,v41
CVT v58,v36,v37
CVT v59,v38,v39
M16 v[212:215],v[164:167],a[180:183],v[212:215]
EXP v42,v42
M32 v[64:79],a[228:231],v[52:55],v[64:79]
EXP v43,v43
EXP v44,v44
EXP v45,v45
M16 v[228:231],v[168:171],a[180:183],v[228:231]
BL4 v2,s[8:11],s27 offen offset:2048 lds
CVT v60,v40,v41
CVT v61,v42,v43
M16 v[244:247],v[172:175],a[180:183],v[244:247]
BL4 a[180:183],v2,s[8:11],s26 offen offset:1024
EXP v46,v46
EXP v47,v47
CVT v62,v44,v45
CVT v63,v46,v47
M32 v[32:47],a[28:31],v[80:83],0
s_waitcnt vmcnt(15)
EXP v16,v16
EXP v17,v17
EXP v18,v18
M16 v[184:187],v[156:159],a[184:187],v[184:187]
EXP v19,v19
M8 v[32:47],a[46:47],v[84:85],v[32:47]
EXP v20,v20
EXP v21,v21
CVT v48,v16,v17
CVT v49,v18,v19
EXP v22,v22
M16 v[200:203],v[160:163],a[184:187],v[200:203]
BL4 v2,s[8:11],s27 offen offset:3072 lds
EXP v23,v23
M32 v[64:79],a[232:235],v[56:59],v[64:79]
EXP v24,v24
EXP v25,v25
CVT v50,v20,v21
CVT v51,v22,v23
M16 v[216:219],v[164:167],a[184:187],v[216:219]
s_add_u32 m0, s31, 4096
EXP v26,v26
M32 v[64:79],a[236:239],v[60:63],v[64:79]
EXP v27,v27
EXP v28,v28
EXP v29,v29
M16 v[232:235],v[168:171],a[184:187],v[232:235]
BL4 v148,s[8:11],s27 offen lds
CVT v52,v24,v25
CVT v53,v26,v27
M16 v[248:251],v[172:175],a[184:187],v[248:251]
BL4 a[184:187],v2,s[8:11],s26 offen offset:2048
EXP v30,v30
EXP v31,v31
CVT v54,v28,v29
CVT v55,v30,v31
M32 v[16:31],a[64:67],v[80:83],0
s_waitcnt vmcnt(15)
EXP v32,v32
EXP v33,v33
EXP v34,v34
M16 v[188:191],v[156:159],a[188:191],v[188:191]
DR v[156:159],v153 offset:5120
EXP v35,v35
M8 v[16:31],a[48:49],v[84:85],v[16:31]
EXP v36,v36
EXP v37,v37
CVT v56,v32,v33
CVT v57,v34,v35
EXP v38,v38
M16 v[204:207],v[160:163],a[188:191],v[204:207]
DR v[160:163],v153 offset:6144
EXP v39,v39
M32 v[64:79],a[240:243],v[48:51],v[64:79]
EXP v40,v40
EXP v41,v41
CVT v58,v36,v37
CVT v59,v38,v39
M16 v[220:223],v[164:167],a[188:191],v[220:223]
DR v[164:167],v153 offset:7168
EXP v42,v42
M32 v[64:79],a[244:247],v[52:55],v[64:79]
EXP v43,v43
EXP v44,v44
EXP v45,v45
M16 v[236:239],v[168:171],a[188:191],v[236:239]
DR v[168:171],v153 offset:8192
CVT v60,v40,v41
CVT v61,v42,v43
M16 v[252:255],v[172:175],a[188:191],v[252:255]
BL4 a[188:191],v2,s[8:11],s26 offen offset:3072
EXP v46,v46
EXP v47,v47
CVT v62,v44,v45
CVT v63,v46,v47
M32 v[32:47],a[68:71],v[80:83],0
s_waitcnt lgkmcnt(0)
EXP v16,v16
EXP v17,v17
EXP v18,v18
M16 v[176:179],v[156:159],a[160:163],v[176:179]
DR v[172:175],v153 offset:9216
EXP v19,v19
M8 v[32:47],a[50:51],v[84:85],v[32:47]
EXP v20,v20
EXP v21,v21
CVT v48,v16,v17
CVT v49,v18,v19
EXP v22,v22
M16 v[192:195],v[160:163],a[160:163],v[192:195]
EXP v23,v23
M32 v[64:79],a[248:251],v[56:59],v[64:79]
s_add_u32 s26, s26, 4096
EXP v24,v24
EXP v25,v25
CVT v50,v20,v21
CVT v51,v22,v23
M16 v[208:211],v[164:167],a[160:163],v[208:211]
s_add_u32 s27, s27, 40960
s_add_u32 m0, s31, 5120
EXP v26,v26
M32 v[64:79],a[252:255],v[60:63],v[64:79]
s_waitcnt lgkmcnt(0)
EXP v27,v27
EXP v28,v28
EXP v29,v29
M16 v[224:227],v[168:171],a[160:163],v[224:227]
BL4 v2,s[8:11],s27 offen lds
CVT v52,v24,v25
CVT v53,v26,v27
M16 v[240:243],v[172:175],a[160:163],v[240:243]
BL4 a[160:163],v2,s[8:11],s26 offen offset:0
EXP v30,v30
EXP v31,v31
CVT v54,v28,v29
CVT v55,v30,v31
M32 v[16:31],a[72:75],v[80:83],0
s_waitcnt vmcnt(15)
EXP v32,v32
EXP v33,v33
EXP v34,v34
M16 v[180:183],v[156:159],a[164:167],v[180:183]
EXP v35,v35
M8 v[16:31],a[52:53],v[84:85],v[16:31]
EXP v36,v36
EXP v37,v37
CVT v56,v32,v33
CVT v57,v34,v35
EXP v38,v38
M16 v[196:199],v[160:163],a[164:167],v[196:199]
BL4 v2,s[8:11],s27 offen offset:1024 lds
EXP v39,v39
M32 v[64:79],a[96:99],v[48:51],v[64:79]
EXP v40,v40
EXP v41,v41
CVT v58,v36,v37
CVT v59,v38,v39
M16 v[212:215],v[164:167],a[164:167],v[212:215]
EXP v42,v42
M32 v[64:79],a[100:103],v[52:55],v[64:79]
EXP v43,v43
EXP v44,v44
EXP v45,v45
M16 v[228:231],v[168:171],a[164:167],v[228:231]
BL4 v2,s[8:11],s27 offen offset:2048 lds
CVT v60,v40,v41
CVT v61,v42,v43
M16 v[244:247],v[172:175],a[164:167],v[244:247]
BL4 a[164:167],v2,s[8:11],s26 offen offset:1024
EXP v46,v46
EXP v47,v47
CVT v62,v44,v45
CVT v63,v46,v47
M32 v[32:47],a[76:79],v[80:83],0
s_waitcnt vmcnt(15)
EXP v16,v16
EXP v17,v17
EXP v18,v18
M16 v[184:187],v[156:159],a[168:171],v[184:187]
EXP v19,v19
M8 v[32:47],a[54:55],v[84:85],v[32:47]
EXP v20,v20
EXP v21,v21
CVT v48,v16,v17
CVT v49,v18,v19
EXP v22,v22
M16 v[200:203],v[160:163],a[168:171],v[200:203]
BL4 v2,s[8:11],s27 offen offset:3072 lds
EXP v23,v23
M32 v[64:79],a[104:107],v[56:59],v[64:79]
EXP v24,v24
EXP v25,v25
CVT v50,v20,v21
CVT v51,v22,v23
M16 v[216:219],v[164:167],a[168:171],v[216:219]
s_add_u32 m0, s31, 9216
EXP v26,v26
M32 v[64:79],a[108:111],v[60:63],v[64:79]
EXP v27,v27
EXP v28,v28
EXP v29,v29
M16 v[232:235],v[168:171],a[168:171],v[232:235]
BL4 v148,s[8:11],s27 offen lds
CVT v52,v24,v25
CVT v53,v26,v27
M16 v[248:251],v[172:175],a[168:171],v[248:251]
BL4 a[168:171],v2,s[8:11],s26 offen offset:2048
EXP v30,v30
EXP v31,v31
CVT v54,v28,v29
CVT v55,v30,v31
M32 v[16:31],a[80:83],v[80:83],0
s_waitcnt vmcnt(15)
EXP v32,v32
EXP v33,v33
EXP v34,v34
M16 v[188:191],v[156:159],a[172:175],v[188:191]
DR v[156:159],v153 offset:10240
EXP v35,v35
M8 v[16:31],a[56:57],v[84:85],v[16:31]
EXP v36,v36
EXP v37,v37
CVT v56,v32,v33
CVT v57,v34,v35
EXP v38,v38
M16 v[204:207],v[160:163],a[172:175],v[204:207]
DR v[160:163],v153 offset:11264
EXP v39,v39
M32 v[64:79],a[112:115],v[48:51],v[64:79]
EXP v40,v40
EXP v41,v41
CVT v58,v36,v37
CVT v59,v38,v39
M16 v[220:223],v[164:167],a[172:175],v[220:223]
DR v[164:167],v153 offset:12288
EXP v42,v42
M32 v[64:79],a[116:119],v[52:55],v[64:79]
EXP v43,v43
EXP v44,v44
EXP v45,v45
M16 v[236:239],v[168:171],a[172:175],v[236:239]
DR v[168:171],v153 offset:13312
CVT v60,v40,v41
CVT v61,v42,v43
M16 v[252:255],v[172:175],a[172:175],v[252:255]
BL4 a[172:175],v2,s[8:11],s26 offen offset:3072
EXP v46,v46
EXP v47,v47
CVT v62,v44,v45
CVT v63,v46,v47
M32 v[32:47],a[84:87],v[80:83],0
s_waitcnt lgkmcnt(0)
EXP v16,v16
EXP v17,v17
EXP v18,v18
M16 v[176:179],v[156:159],a[176:179],v[176:179]
DR v[172:175],v153 offset:14336
EXP v19,v19
M8 v[32:47],a[58:59],v[84:85],v[32:47]
EXP v20,v20
EXP v21,v21
CVT v48,v16,v17
CVT v49,v18,v19
EXP v22,v22
M16 v[192:195],v[160:163],a[176:179],v[192:195]
EXP v23,v23
M32 v[64:79],a[120:123],v[56:59],v[64:79]
s_add_u32 s26, s26, 4096
EXP v24,v24
EXP v25,v25
CVT v50,v20,v21
CVT v51,v22,v23
M16 v[208:211],v[164:167],a[176:179],v[208:211]
s_add_u32 s27, s27, 40960
s_add_u32 m0, s31, 10240
EXP v26,v26
M32 v[64:79],a[124:127],v[60:63],v[64:79]
s_waitcnt lgkmcnt(0)
EXP v27,v27
EXP v28,v28
EXP v29,v29
M16 v[224:227],v[168:171],a[176:179],v[224:227]
BL4 v2,s[8:11],s27 offen lds
CVT v52,v24,v25
CVT v53,v26,v27
M16 v[240:243],v[172:175],a[176:179],v[240:243]
BL4 a[176:179],v2,s[8:11],s26 offen offset:0
EXP v30,v30
EXP v31,v31
CVT v54,v28,v29
CVT v55,v30,v31
M32 v[16:31],a[88:91],v[80:83],0
s_waitcnt vmcnt(15)
EXP v32,v32
EXP v33,v33
EXP v34,v34
M16 v[180:183],v[156:159],a[180:183],v[180:183]
EXP v35,v35
M8 v[16:31],a[60:61],v[84:85],v[16:31]
EXP v36,v36
EXP v37,v37
CVT v56,v32,v33
CVT v57,v34,v35
EXP v38,v38
M16 v[196:199],v[160:163],a[180:183],v[196:199]
BL4 v2,s[8:11],s27 offen offset:1024 lds
EXP v39,v39
M32 v[64:79],a[128:131],v[48:51],v[64:79]
EXP v40,v40
EXP v41,v41
CVT v58,v36,v37
CVT v59,v38,v39
M16 v[212:215],v[164:167],a[180:183],v[212:215]
EXP v42,v42
M32 v[64:79],a[132:135],v[52:55],v[64:79]
EXP v43,v43
EXP v44,v44
EXP v45,v45
M16 v[228:231],v[168:171],a[180:183],v[228:231]
BL4 v2,s[8:11],s27 offen offset:2048 lds
CVT v60,v40,v41
CVT v61,v42,v43
M16 v[244:247],v[172:175],a[180:183],v[244:247]
BL4 a[180:183],v2,s[8:11],s26 offen offset:1024
EXP v46,v46
EXP v47,v47
CVT v62,v44,v45
CVT v63,v46,v47
M32 v[32:47],a[92:95],v[80:83],0
s_waitcnt vmcnt(15)
EXP v16,v16
EXP v17,v17
EXP v18,v18
M16 v[184:187],v[156:159],a[184:187],v[184:187]
EXP v19,v19
M8 v[32:47],a[62:63],v[84:85],v[32:47]
EXP v20,v20
EXP v21,v21
CVT v48,v16,v17
CVT v49,v18,v19
EXP v22,v22
M16 v[200:203],v[160:163],a[184:187],v[200:203]
BL4 v2,s[8:11],s27 offen offset:3072 lds
EXP v23,v23
M32 v[64:79],a[136:139],v[56:59],v[64:79]
EXP v24,v24
EXP v25,v25
CVT v50,v20,v21
CVT v51,v22,v23
M16 v[216:219],v[164:167],a[184:187],v[216:219]
s_add_u32 m0, s31, 14336
EXP v26,v26
M32 v[64:79],a[140:143],v[60:63],v[64:79]
EXP v27,v27
EXP v28,v28
EXP v29,v29
M16 v[232:235],v[168:171],a[184:187],v[232:235]
BL4 v148,s[8:11],s27 offen lds
s_add_u32 s27, s27, 40960
CVT v52,v24,v25
CVT v53,v26,v27
M16 v[248:251],v[172:175],a[184:187],v[248:251]
BL4 a[184:187],v2,s[8:11],s26 offen offset:2048
EXP v30,v30
EXP v31,v31
CVT v54,v28,v29
CVT v55,v30,v31
M32 v[16:31],a[0:3],v[88:91],0
s_waitcnt vmcnt(15)
EXP v32,v32
EXP v33,v33
EXP v34,v34
M16 v[188:191],v[156:159],a[188:191],v[188:191]
DR v[156:159],v153 offset:0
EXP v35,v35
M8 v[16:31],a[32:33],v[92:93],v[16:31]
EXP v36,v36
EXP v37,v37
CVT v56,v32,v33
CVT v57,v34,v35
EXP v38,v38
M16 v[204:207],v[160:163],a[188:191],v[204:207]
DR v[160:163],v153 offset:1024
EXP v39,v39
M32 v[64:79],a[144:147],v[48:51],v[64:79]
EXP v40,v40
EXP v41,v41
CVT v58,v36,v37
CVT v59,v38,v39
M16 v[220:223],v[164:167],a[188:191],v[220:223]
DR v[164:167],v153 offset:2048
EXP v42,v42
M32 v[64:79],a[148:151],v[52:55],v[64:79]
EXP v43,v43
EXP v44,v44
EXP v45,v45
M16 v[236:239],v[168:171],a[188:191],v[236:239]
DR v[168:171],v153 offset:3072
CVT v60,v40,v41
CVT v61,v42,v43
M16 v[252:255],v[172:175],a[188:191],v[252:255]
BL4 a[188:191],v2,s[8:11],s26 offen offset:3072
s_add_u32 s26, s26, 4096
EXP v46,v46
EXP v47,v47
CVT v62,v44,v45
CVT v63,v46,v47
s_mul_i32 s39, s65, 5120
s_add_u32 s39, s39, 114294784
s_add_u32 s12, s20, 16
s_mul_i32 s45, s12, 5120
s_add_u32 s45, s45, 61440
s_mul_i32 s12, s12, 40960
s_add_u32 s39, s39, s12
s_mul_i32 s63, s20, 5120
s_cmp_lt_u32 s20, 2
s_mov_b32 s12, 122880
s_cselect_b32 s12, 110592, s12
s_add_u32 s63, s63, s12
s_sub_u32 s12, s63, s31
v_add_u32 v154, s12, v153
M32 v[32:47],a[4:7],v[88:91],0
s_waitcnt lgkmcnt(0)
EXP v16,v16
EXP v17,v17
EXP v18,v18
M16 v[176:179],v[156:159],a[160:163],v[176:179]
DR v[172:175],v153 offset:4096
EXP v19,v19
M8 v[32:47],a[34:35],v[92:93],v[32:47]
EXP v20,v20
EXP v21,v21
CVT v48,v16,v17
CVT v49,v18,v19
EXP v22,v22
M16 v[192:195],v[160:163],a[160:163],v[192:195]
EXP v23,v23
M32 v[64:79],a[152:155],v[56:59],v[64:79]
EXP v24,v24
EXP v25,v25
CVT v50,v20,v21
CVT v51,v22,v23
M16 v[208:211],v[164:167],a[160:163],v[208:211]
s_add_u32 m0, s31, 0
EXP v26,v26
M32 v[64:79],a[156:159],v[60:63],v[64:79]
s_waitcnt lgkmcnt(0)
EXP v27,v27
EXP v28,v28
EXP v29,v29
M16 v[224:227],v[168:171],a[160:163],v[224:227]
BL4 v2,s[8:11],s27 offen lds
CVT v52,v24,v25
CVT v53,v26,v27
M16 v[240:243],v[172:175],a[160:163],v[240:243]
BL4 a[160:163],v2,s[8:11],s26 offen offset:0
EXP v30,v30
EXP v31,v31
CVT v54,v28,v29
CVT v55,v30,v31
M32 v[16:31],a[8:11],v[88:91],0
s_waitcnt vmcnt(15)
EXP v32,v32
EXP v33,v33
EXP v34,v34
M16 v[180:183],v[156:159],a[164:167],v[180:183]
s_add_u32 m0, s31, 0
EXP v35,v35
M8 v[16:31],a[36:37],v[92:93],v[16:31]
ds_write_b128 v142, v[64:67] offset:24576
EXP v36,v36
EXP v37,v37
CVT v56,v32,v33
CVT v57,v34,v35
ds_write_b128 v142, v[68:71] offset:25600
EXP v38,v38
M16 v[196:199],v[160:163],a[164:167],v[196:199]
BL4 v2,s[8:11],s27 offen offset:1024 lds
EXP v39,v39
ds_write_b128 v142, v[72:75] offset:26624
M32 v[64:79],a[192:195],v[48:51],0
s_add_u32 s38, s39, 0
s_add_u32 m0, s45, 0
s_nop 0
BL4 v2,s[8:11],s38 offen lds
EXP v40,v40
EXP v41,v41
CVT v58,v36,v37
CVT v59,v38,v39
M16 v[212:215],v[164:167],a[164:167],v[212:215]
s_add_u32 m0, s31, 0
EXP v42,v42
M32 v[64:79],a[196:199],v[52:55],v[64:79]
EXP v43,v43
EXP v44,v44
EXP v45,v45
M16 v[228:231],v[168:171],a[164:167],v[228:231]
BL4 v2,s[8:11],s27 offen offset:2048 lds
CVT v60,v40,v41
CVT v61,v42,v43
M16 v[244:247],v[172:175],a[164:167],v[244:247]
BL4 a[164:167],v2,s[8:11],s26 offen offset:1024
EXP v46,v46
EXP v47,v47
CVT v62,v44,v45
CVT v63,v46,v47
M32 v[32:47],a[12:15],v[88:91],0
s_waitcnt vmcnt(16)
EXP v16,v16
EXP v17,v17
EXP v18,v18
M16 v[184:187],v[156:159],a[168:171],v[184:187]
s_add_u32 m0, s31, 0
EXP v19,v19
M8 v[32:47],a[38:39],v[92:93],v[32:47]
s_barrier
EXP v20,v20
EXP v21,v21
CVT v48,v16,v17
CVT v49,v18,v19
EXP v22,v22
M16 v[200:203],v[160:163],a[168:171],v[200:203]
BL4 v2,s[8:11],s27 offen offset:3072 lds
EXP v23,v23
M32 v[64:79],a[200:203],v[56:59],v[64:79]
s_add_u32 m0, s45, 0
s_nop 0
BL4 v2,s[8:11],s38 offen offset:1024 lds
EXP v24,v24
EXP v25,v25
CVT v50,v20,v21
CVT v51,v22,v23
M16 v[216:219],v[164:167],a[168:171],v[216:219]
s_add_u32 m0, s31, 4096
EXP v26,v26
M32 v[64:79],a[204:207],v[60:63],v[64:79]
EXP v27,v27
EXP v28,v28
EXP v29,v29
M16 v[232:235],v[168:171],a[168:171],v[232:235]
BL4 v148,s[8:11],s27 offen lds
CVT v52,v24,v25
CVT v53,v26,v27
M16 v[248:251],v[172:175],a[168:171],v[248:251]
BL4 a[168:171],v2,s[8:11],s26 offen offset:2048
EXP v30,v30
EXP v31,v31
CVT v54,v28,v29
CVT v55,v30,v31
M32 v[16:31],a[16:19],v[88:91],0
s_waitcnt vmcnt(17)
EXP v32,v32
EXP v33,v33
EXP v34,v34
M16 v[188:191],v[156:159],a[172:175],v[188:191]
DR v[156:159],v153 offset:5120
EXP v35,v35
M8 v[16:31],a[40:41],v[92:93],v[16:31]
EXP v36,v36
EXP v37,v37
CVT v56,v32,v33
CVT v57,v34,v35
EXP v38,v38
M16 v[204:207],v[160:163],a[172:175],v[204:207]
DR v[160:163],v153 offset:6144
EXP v39,v39
M32 v[64:79],a[208:211],v[48:51],v[64:79]
EXP v40,v40
EXP v41,v41
CVT v58,v36,v37
CVT v59,v38,v39
M16 v[220:223],v[164:167],a[172:175],v[220:223]
DR v[164:167],v153 offset:7168
EXP v42,v42
M32 v[64:79],a[212:215],v[52:55],v[64:79]
EXP v43,v43
EXP v44,v44
EXP v45,v45
M16 v[236:239],v[168:171],a[172:175],v[236:239]
DR v[168:171],v153 offset:8192
CVT v60,v40,v41
CVT v61,v42,v43
M16 v[252:255],v[172:175],a[172:175],v[252:255]
BL4 a[172:175],v2,s[8:11],s26 offen offset:3072
EXP v46,v46
EXP v47,v47
CVT v62,v44,v45
CVT v63,v46,v47
M32 v[32:47],a[20:23],v[88:91],0
s_waitcnt lgkmcnt(0)
EXP v16,v16
EXP v17,v17
EXP v18,v18
M16 v[176:179],v[156:159],a[176:179],v[176:179]
DR v[172:175],v153 offset:9216
EXP v19,v19
M8 v[32:47],a[42:43],v[92:93],v[32:47]
EXP v20,v20
EXP v21,v21
CVT v48,v16,v17
CVT v49,v18,v19
EXP v22,v22
M16 v[192:195],v[160:163],a[176:179],v[192:195]
EXP v23,v23
M32 v[64:79],a[216:219],v[56:59],v[64:79]
s_add_u32 s26, s26, 4096
EXP v24,v24
EXP v25,v25
CVT v50,v20,v21
CVT v51,v22,v23
M16 v[208:211],v[164:167],a[176:179],v[208:211]
s_add_u32 s27, s27, 40960
s_add_u32 m0, s31, 5120
EXP v26,v26
M32 v[64:79],a[220:223],v[60:63],v[64:79]
s_waitcnt lgkmcnt(0)
EXP v27,v27
EXP v28,v28
EXP v29,v29
M16 v[224:227],v[168:171],a[176:179],v[224:227]
BL4 v2,s[8:11],s27 offen lds
CVT v52,v24,v25
CVT v53,v26,v27
M16 v[240:243],v[172:175],a[176:179],v[240:243]
BL4 a[176:179],v2,s[8:11],s26 offen offset:0
EXP v30,v30
EXP v31,v31
CVT v54,v28,v29
CVT v55,v30,v31
M32 v[16:31],a[24:27],v[88:91],0
s_waitcnt vmcnt(17)
EXP v32,v32
EXP v33,v33
EXP v34,v34
M16 v[180:183],v[156:159],a[180:183],v[180:183]
s_add_u32 m0, s31, 5120
EXP v35,v35
M8 v[16:31],a[44:45],v[92:93],v[16:31]
EXP v36,v36
EXP v37,v37
CVT v56,v32,v33
CVT v57,v34,v35
EXP v38,v38
M16 v[196:199],v[160:163],a[180:183],v[196:199]
BL4 v2,s[8:11],s27 offen offset:1024 lds
EXP v39,v39
M32 v[64:79],a[224:227],v[48:51],v[64:79]
s_add_u32 m0, s45, 0
s_nop 0
BL4 v2,s[8:11],s38 offen offset:2048 lds
EXP v40,v40
EXP v41,v41
CVT v58,v36,v37
CVT v59,v38,v39
M16 v[212:215],v[164:167],a[180:183],v[212:215]
s_add_u32 m0, s31, 5120
EXP v42,v42
M32 v[64:79],a[228:231],v[52:55],v[64:79]
EXP v43,v43
EXP v44,v44
EXP v45,v45
M16 v[228:231],v[168:171],a[180:183],v[228:231]
BL4 v2,s[8:11],s27 offen offset:2048 lds
CVT v60,v40,v41
CVT v61,v42,v43
M16 v[244:247],v[172:175],a[180:183],v[244:247]
BL4 a[180:183],v2,s[8:11],s26 offen offset:1024
EXP v46,v46
EXP v47,v47
CVT v62,v44,v45
CVT v63,v46,v47
M32 v[32:47],a[28:31],v[88:91],0
s_waitcnt vmcnt(18)
EXP v16,v16
EXP v17,v17
EXP v18,v18
M16 v[184:187],v[156:159],a[184:187],v[184:187]
s_add_u32 m0, s31, 5120
EXP v19,v19
M8 v[32:47],a[46:47],v[92:93],v[32:47]
EXP v20,v20
EXP v21,v21
CVT v48,v16,v17
CVT v49,v18,v19
EXP v22,v22
M16 v[200:203],v[160:163],a[184:187],v[200:203]
BL4 v2,s[8:11],s27 offen offset:3072 lds
EXP v23,v23
M32 v[64:79],a[232:235],v[56:59],v[64:79]
s_add_u32 m0, s45, 0
s_nop 0
BL4 v2,s[8:11],s38 offen offset:3072 lds
EXP v24,v24
EXP v25,v25
CVT v50,v20,v21
CVT v51,v22,v23
M16 v[216:219],v[164:167],a[184:187],v[216:219]
s_add_u32 m0, s31, 9216
EXP v26,v26
M32 v[64:79],a[236:239],v[60:63],v[64:79]
EXP v27,v27
EXP v28,v28
EXP v29,v29
M16 v[232:235],v[168:171],a[184:187],v[232:235]
BL4 v148,s[8:11],s27 offen lds
CVT v52,v24,v25
CVT v53,v26,v27
M16 v[248:251],v[172:175],a[184:187],v[248:251]
BL4 a[184:187],v2,s[8:11],s26 offen offset:2048
EXP v30,v30
EXP v31,v31
CVT v54,v28,v29
CVT v55,v30,v31
M32 v[16:31],a[64:67],v[88:91],0
s_waitcnt vmcnt(19)
EXP v32,v32
EXP v33,v33
EXP v34,v34
M16 v[188:191],v[156:159],a[188:191],v[188:191]
DR v[156:159],v153 offset:10240
EXP v35,v35
M8 v[16:31],a[48:49],v[92:93],v[16:31]
EXP v36,v36
EXP v37,v37
CVT v56,v32,v33
CVT v57,v34,v35
EXP v38,v38
M16 v[204:207],v[160:163],a[188:191],v[204:207]
DR v[160:163],v153 offset:11264
EXP v39,v39
M32 v[64:79],a[240:243],v[48:51],v[64:79]
EXP v40,v40
EXP v41,v41
CVT v58,v36,v37
CVT v59,v38,v39
M16 v[220:223],v[164:167],a[188:191],v[220:223]
DR v[164:167],v153 offset:12288
EXP v42,v42
M32 v[64:79],a[244:247],v[52:55],v[64:79]
EXP v43,v43
EXP v44,v44
EXP v45,v45
M16 v[236:239],v[168:171],a[188:191],v[236:239]
DR v[168:171],v153 offset:13312
CVT v60,v40,v41
CVT v61,v42,v43
M16 v[252:255],v[172:175],a[188:191],v[252:255]
BL4 a[188:191],v2,s[8:11],s26 offen offset:3072
EXP v46,v46
EXP v47,v47
CVT v62,v44,v45
CVT v63,v46,v47
M32 v[32:47],a[68:71],v[88:91],0
s_waitcnt lgkmcnt(0)
EXP v16,v16
EXP v17,v17
EXP v18,v18
M16 v[176:179],v[156:159],a[160:163],v[176:179]
DR v[172:175],v153 offset:14336
EXP v19,v19
M8 v[32:47],a[50:51],v[92:93],v[32:47]
EXP v20,v20
EXP v21,v21
CVT v48,v16,v17
CVT v49,v18,v19
EXP v22,v22
M16 v[192:195],v[160:163],a[160:163],v[192:195]
EXP v23,v23
M32 v[64:79],a[248:251],v[56:59],v[64:79]
s_add_u32 s26, s26, 4096
EXP v24,v24
EXP v25,v25
CVT v50,v20,v21
CVT v51,v22,v23
M16 v[208:211],v[164:167],a[160:163],v[208:211]
s_add_u32 s27, s27, 40960
s_add_u32 m0, s31, 10240
EXP v26,v26
M32 v[64:79],a[252:255],v[60:63],v[64:79]
s_waitcnt lgkmcnt(0)
EXP v27,v27
EXP v28,v28
EXP v29,v29
M16 v[224:227],v[168:171],a[160:163],v[224:227]
BL4 v2,s[8:11],s27 offen lds
CVT v52,v24,v25
CVT v53,v26,v27
M16 v[240:243],v[172:175],a[160:163],v[240:243]
BL4 a[160:163],v2,s[8:11],s26 offen offset:0
EXP v30,v30
EXP v31,v31
CVT v54,v28,v29
CVT v55,v30,v31
M32 v[16:31],a[72:75],v[88:91],0
s_waitcnt vmcnt(18)
EXP v32,v32
EXP v33,v33
EXP v34,v34
M16 v[180:183],v[156:159],a[164:167],v[180:183]
s_add_u32 m0, s31, 10240
EXP v35,v35
M8 v[16:31],a[52:53],v[92:93],v[16:31]
s_add_u32 s50, s26, 8192
EXP v36,v36
EXP v37,v37
CVT v56,v32,v33
CVT v57,v34,v35
BL4 a[0:3],v2,s[8:11],s50 offen offset:0
EXP v38,v38
M16 v[196:199],v[160:163],a[164:167],v[196:199]
BL4 v2,s[8:11],s27 offen offset:1024 lds
EXP v39,v39
M32 v[64:79],a[96:99],v[48:51],v[64:79]
s_add_u32 m0, s45, 4096
s_nop 0
BL4 v148,s[8:11],s38 offen lds
EXP v40,v40
EXP v41,v41
CVT v58,v36,v37
CVT v59,v38,v39
BL4 a[4:7],v2,s[8:11],s50 offen offset:1024
M16 v[212:215],v[164:167],a[164:167],v[212:215]
s_add_u32 m0, s31, 10240
EXP v42,v42
M32 v[64:79],a[100:103],v[52:55],v[64:79]
EXP v43,v43
EXP v44,v44
EXP v45,v45
M16 v[228:231],v[168:171],a[164:167],v[228:231]
BL4 v2,s[8:11],s27 offen offset:2048 lds
CVT v60,v40,v41
CVT v61,v42,v43
M16 v[244:247],v[172:175],a[164:167],v[244:247]
BL4 a[164:167],v2,s[8:11],s26 offen offset:1024
EXP v46,v46
EXP v47,v47
CVT v62,v44,v45
CVT v63,v46,v47
M32 v[32:47],a[76:79],v[88:91],0
s_waitcnt vmcnt(20)
EXP v16,v16
EXP v17,v17
EXP v18,v18
M16 v[184:187],v[156:159],a[168:171],v[184:187]
s_add_u32 m0, s31, 10240
EXP v19,v19
M8 v[32:47],a[54:55],v[92:93],v[32:47]
EXP v20,v20
EXP v21,v21
CVT v48,v16,v17
CVT v49,v18,v19
BL4 a[8:11],v2,s[8:11],s50 offen offset:2048
EXP v22,v22
M16 v[200:203],v[160:163],a[168:171],v[200:203]
BL4 v2,s[8:11],s27 offen offset:3072 lds
EXP v23,v23
M32 v[64:79],a[104:107],v[56:59],v[64:79]
EXP v24,v24
EXP v25,v25
CVT v50,v20,v21
CVT v51,v22,v23
BL4 a[12:15],v2,s[8:11],s50 offen offset:3072
s_add_u32 s50, s50, 4096
M16 v[216:219],v[164:167],a[168:171],v[216:219]
s_add_u32 m0, s31, 14336
EXP v26,v26
M32 v[64:79],a[108:111],v[60:63],v[64:79]
EXP v27,v27
EXP v28,v28
EXP v29,v29
M16 v[232:235],v[168:171],a[168:171],v[232:235]
BL4 v148,s[8:11],s27 offen lds
CVT v52,v24,v25
CVT v53,v26,v27
M16 v[248:251],v[172:175],a[168:171],v[248:251]
BL4 a[168:171],v2,s[8:11],s26 offen offset:2048
EXP v30,v30
EXP v31,v31
CVT v54,v28,v29
CVT v55,v30,v31
M32 v[16:31],a[80:83],v[88:91],0
s_waitcnt vmcnt(22)
EXP v32,v32
EXP v33,v33
EXP v34,v34
M16 v[188:191],v[156:159],a[172:175],v[188:191]
DR v[156:159],v153 offset:0
EXP v35,v35
M8 v[16:31],a[56:57],v[92:93],v[16:31]
EXP v36,v36
EXP v37,v37
CVT v56,v32,v33
CVT v57,v34,v35
EXP v38,v38
M16 v[204:207],v[160:163],a[172:175],v[204:207]
DR v[160:163],v153 offset:1024
EXP v39,v39
M32 v[64:79],a[112:115],v[48:51],v[64:79]
EXP v40,v40
EXP v41,v41
CVT v58,v36,v37
CVT v59,v38,v39
M16 v[220:223],v[164:167],a[172:175],v[220:223]
DR v[164:167],v153 offset:2048
EXP v42,v42
M32 v[64:79],a[116:119],v[52:55],v[64:79]
EXP v43,v43
EXP v44,v44
EXP v45,v45
M16 v[236:239],v[168:171],a[172:175],v[236:239]
DR v[168:171],v153 offset:3072
CVT v60,v40,v41
CVT v61,v42,v43
M16 v[252:255],v[172:175],a[172:175],v[252:255]
BL4 a[172:175],v2,s[8:11],s26 offen offset:3072
EXP v46,v46
EXP v47,v47
CVT v62,v44,v45
CVT v63,v46,v47
M32 v[32:47],a[84:87],v[88:91],0
s_waitcnt lgkmcnt(0)
EXP v16,v16
EXP v17,v17
EXP v18,v18
M16 v[176:179],v[156:159],a[176:179],v[176:179]
DR v[172:175],v153 offset:4096
EXP v19,v19
M8 v[32:47],a[58:59],v[92:93],v[32:47]
EXP v20,v20
EXP v21,v21
CVT v48,v16,v17
CVT v49,v18,v19
BL4 a[16:19],v2,s[8:11],s50 offen offset:0
EXP v22,v22
M16 v[192:195],v[160:163],a[176:179],v[192:195]
EXP v23,v23
M32 v[64:79],a[120:123],v[56:59],v[64:79]
s_add_u32 s26, s26, 4096
EXP v24,v24
EXP v25,v25
CVT v50,v20,v21
CVT v51,v22,v23
BL4 a[20:23],v2,s[8:11],s50 offen offset:1024
M16 v[208:211],v[164:167],a[176:179],v[208:211]
s_add_u32 s27, s27, 40960
s_add_u32 m0, s31, 0
EXP v26,v26
M32 v[64:79],a[124:127],v[60:63],v[64:79]
s_waitcnt lgkmcnt(0)
EXP v27,v27
EXP v28,v28
EXP v29,v29
M16 v[224:227],v[168:171],a[176:179],v[224:227]
BL4 v2,s[8:11],s27 offen lds
CVT v52,v24,v25
CVT v53,v26,v27
M16 v[240:243],v[172:175],a[176:179],v[240:243]
BL4 a[176:179],v2,s[8:11],s26 offen offset:0
EXP v30,v30
EXP v31,v31
CVT v54,v28,v29
CVT v55,v30,v31
M32 v[16:31],a[88:91],v[88:91],0
s_waitcnt vmcnt(23)
EXP v32,v32
EXP v33,v33
EXP v34,v34
M16 v[180:183],v[156:159],a[180:183],v[180:183]
s_add_u32 m0, s31, 0
EXP v35,v35
M8 v[16:31],a[60:61],v[92:93],v[16:31]
EXP v36,v36
EXP v37,v37
CVT v56,v32,v33
CVT v57,v34,v35
BL4 a[24:27],v2,s[8:11],s50 offen offset:2048
EXP v38,v38
M16 v[196:199],v[160:163],a[180:183],v[196:199]
BL4 v2,s[8:11],s27 offen offset:1024 lds
EXP v39,v39
M32 v[64:79],a[128:131],v[48:51],v[64:79]
EXP v40,v40
EXP v41,v41
CVT v58,v36,v37
CVT v59,v38,v39
BL4 a[28:31],v2,s[8:11],s50 offen offset:3072
s_add_u32 s50, s50, 4096
M16 v[212:215],v[164:167],a[180:183],v[212:215]
s_add_u32 m0, s31, 0
EXP v42,v42
M32 v[64:79],a[132:135],v[52:55],v[64:79]
EXP v43,v43
EXP v44,v44
EXP v45,v45
M16 v[228:231],v[168:171],a[180:183],v[228:231]
BL4 v2,s[8:11],s27 offen offset:2048 lds
CVT v60,v40,v41
CVT v61,v42,v43
M16 v[244:247],v[172:175],a[180:183],v[244:247]
BL4 a[180:183],v2,s[8:11],s26 offen offset:1024
EXP v46,v46
EXP v47,v47
CVT v62,v44,v45
CVT v63,v46,v47
M32 v[32:47],a[92:95],v[88:91],0
s_waitcnt vmcnt(24)
EXP v16,v16
EXP v17,v17
EXP v18,v18
M16 v[184:187],v[156:159],a[184:187],v[184:187]
s_add_u32 m0, s31, 0
EXP v19,v19
M8 v[32:47],a[62:63],v[92:93],v[32:47]
EXP v20,v20
EXP v21,v21
CVT v48,v16,v17
CVT v49,v18,v19
EXP v22,v22
M16 v[200:203],v[160:163],a[184:187],v[200:203]
BL4 v2,s[8:11],s27 offen offset:3072 lds
EXP v23,v23
M32 v[64:79],a[136:139],v[56:59],v[64:79]
EXP v24,v24
EXP v25,v25
CVT v50,v20,v21
CVT v51,v22,v23
M16 v[216:219],v[164:167],a[184:187],v[216:219]
s_add_u32 m0, s31, 4096
EXP v26,v26
M32 v[64:79],a[140:143],v[60:63],v[64:79]
EXP v27,v27
EXP v28,v28
EXP v29,v29
M16 v[232:235],v[168:171],a[184:187],v[232:235]
BL4 v148,s[8:11],s27 offen lds
s_add_u32 s27, s27, 40960
CVT v52,v24,v25
CVT v53,v26,v27
M16 v[248:251],v[172:175],a[184:187],v[248:251]
BL4 a[184:187],v2,s[8:11],s26 offen offset:2048
EXP v30,v30
EXP v31,v31
CVT v54,v28,v29
CVT v55,v30,v31
s_waitcnt vmcnt(24)
EXP v32,v32
EXP v33,v33
s_add_u32 m0, s63, 0
s_nop 0
BL4 v2,s[8:11],s27 offen lds
EXP v34,v34
M16 v[188:191],v[156:159],a[188:191],v[188:191]
DR v[156:159],v153 offset:5120
EXP v35,v35
EXP v36,v36
EXP v37,v37
s_add_u32 m0, s63, 0
s_nop 0
BL4 v2,s[8:11],s27 offen offset:1024 lds
CVT v56,v32,v33
CVT v57,v34,v35
EXP v38,v38
M16 v[204:207],v[160:163],a[188:191],v[204:207]
DR v[160:163],v153 offset:6144
EXP v39,v39
M32 v[64:79],a[144:147],v[48:51],v[64:79]
EXP v40,v40
EXP v41,v41
s_add_u32 m0, s63, 0
s_nop 0
BL4 v2,s[8:11],s27 offen offset:2048 lds
CVT v58,v36,v37
CVT v59,v38,v39
M16 v[220:223],v[164:167],a[188:191],v[220:223]
DR v[164:167],v153 offset:7168
EXP v42,v42
M32 v[64:79],a[148:151],v[52:55],v[64:79]
EXP v43,v43
EXP v44,v44
s_add_u32 m0, s63, 0
s_nop 0
BL4 v2,s[8:11],s27 offen offset:3072 lds
EXP v45,v45
M16 v[236:239],v[168:171],a[188:191],v[236:239]
DR v[168:171],v153 offset:8192
CVT v60,v40,v41
CVT v61,v42,v43
M16 v[252:255],v[172:175],a[188:191],v[252:255]
BL4 a[188:191],v2,s[8:11],s26 offen offset:3072
s_add_u32 s26, s26, 4096
EXP v46,v46
DR v[172:175],v153 offset:9216
EXP v47,v47
s_add_u32 m0, s63, 4096
s_nop 0
BL4 v148,s[8:11],s27 offen lds
s_add_u32 s27, s27, 40960
CVT v62,v44,v45
CVT v63,v46,v47
s_mul_i32 s39, s65, 5120
s_add_u32 s39, s39, 114294784
s_mul_i32 s12, s20, 81920
s_add_u32 s39, s39, s12
s_mul_i32 s45, s20, 10240
s_add_u32 s45, s45, 61440
s_nop 1
M32 v[64:79],a[152:155],v[56:59],v[64:79]
M32 v[64:79],a[156:159],v[60:63],v[64:79]
s_lshl_b32 s12, s20, 10
s_add_u32 s12, s12, 122880
v_add_u32 v84, s12, v2
v_lshrrev_b32 v85, 5, v1
v_lshlrev_b32 v85, 12, v85
v_bfe_u32 v10, v1, 3, 2
v_lshl_add_u32 v85, v10, 8, v85
v_and_b32 v10, 7, v1
v_lshl_add_u32 v85, v10, 4, v85
s_lshl_b32 s12, s20, 13
s_add_u32 s25, s25, s12
s_add_u32 s40, s25, 32768
ds_write_b128 v142, v[64:67] offset:36864
ds_write_b128 v142, v[68:71] offset:37888
ds_write_b128 v142, v[72:75] offset:38912
s_add_u32 s41, s25, 65536
s_lshl_b32 s36, s64, 7
s_add_u32 s36, s36, 125894656
v_min_u32 v155, 7, v1
v_lshlrev_b32 v155, 2, v155
s_lshl_b32 s30, 1, s65
s_xor_b32 s30, s30, 0xff
s_cmp_lt_u32 s20, 2
s_cselect_b32 s41, s41, 1073741824
s_waitcnt lgkmcnt(0)
s_barrier
DR v[108:111],v143 offset:0
DR v[112:115],v143 offset:1024
DR v[116:119],v143 offset:2048
DR v[120:123],v143 offset:3072
DR v[124:127],v143 offset:4096
DR v[128:131],v143 offset:5120
DR v[28:31],v143 offset:6144
DR v[32:35],v143 offset:7168
DR v[36:39],v143 offset:8192
DR v[40:43],v143 offset:9216
DR v[44:47],v143 offset:10240
DR v[48:51],v143 offset:11264
s_waitcnt lgkmcnt(6)
v_add_f32 v108, v108, v120
v_add_f32 v109, v109, v121
v_add_f32 v110, v110, v122
v_add_f32 v111, v111, v123
v_add_f32 v112, v112, v124
v_add_f32 v113, v113, v125
v_add_f32 v114, v114, v126
v_add_f32 v115, v115, v127
v_add_f32 v116, v116, v128
v_add_f32 v117, v117, v129
v_add_f32 v118, v118, v130
v_add_f32 v119, v119, v131
s_waitcnt lgkmcnt(0)
v_add_f32 v28, v28, v40
v_add_f32 v29, v29, v41
v_add_f32 v30, v30, v42
v_add_f32 v31, v31, v43
v_add_f32 v32, v32, v44
v_add_f32 v33, v33, v45
v_add_f32 v34, v34, v46
v_add_f32 v35, v35, v47
v_add_f32 v36, v36, v48
v_add_f32 v37, v37, v49
v_add_f32 v38, v38, v50
v_add_f32 v39, v39, v51
v_add_f32 v116, v116, v36
v_add_f32 v108, v108, v28
v_add_f32 v109, v109, v29
v_add_f32 v110, v110, v30
v_add_f32 v111, v111, v31
v_add_f32 v112, v112, v32
v_add_f32 v113, v113, v33
v_add_f32 v114, v114, v34
v_add_f32 v115, v115, v35
v_add_f32 v117, v117, v37
v_add_f32 v118, v118, v38
v_add_f32 v119, v119, v39
v_mov_b32 v120, v116
v_mov_b32 v121, v116
s_nop 1
v_permlane32_swap_b32 v120, v121
s_nop 1
v_rcp_f32 v120, v121
s_nop 0
v_mul_f32 v108, v108, v120
v_mul_f32 v109, v109, v120
v_mul_f32 v110, v110, v120
v_mul_f32 v111, v111, v120
v_mul_f32 v112, v112, v120
v_mul_f32 v113, v113, v120
v_mul_f32 v114, v114, v120
v_mul_f32 v115, v115, v120
v_mul_f32 v116, v116, v120
v_mul_f32 v117, v117, v120
v_mul_f32 v118, v118, v120
v_mul_f32 v119, v119, v120
CVT v132,v108,v109
CVT v133,v110,v111
CVT v134,v112,v113
CVT v135,v114,v115
CVT v136,v116,v117
CVT v137,v118,v119
v_add_f32 v122, v108, v109
v_add_f32 v122, v110, v122
v_add_f32 v122, v111, v122
v_add_f32 v122, v112, v122
v_add_f32 v122, v113, v122
v_add_f32 v122, v114, v122
v_add_f32 v122, v115, v122
v_add_f32 v122, v116, v122
v_add_f32 v122, v117, v122
v_add_f32 v122, v118, v122
v_add_f32 v122, v119, v122
v_cmp_nge_f32 s[56:57], s60, v121
v_cmp_class_f32 s[58:59], v122, s61
s_nop 1
s_or_b64 vcc, s[56:57], s[58:59]
s_cbranch_vccz L_b_ck1
s_mov_b32 s62, 4
s_call_b64 s[48:49], L_b_slow
L_b_ck1:
ds_write_b64 v139, v[132:133] offset:64
ds_write_b64 v140, v[134:135] offset:64
s_mov_b32 exec_hi, 0
ds_write_b64 v141, v[136:137] offset:64
s_mov_b32 exec_hi, -1
s_waitcnt lgkmcnt(0)
s_barrier
DR v[108:111],v84 offset:0
DR v[112:115],v84 offset:4096
DR v[116:119],v84 offset:8192
s_waitcnt lgkmcnt(0)
BS4 v[108:111],v85,s[8:11],s25 offen sc1
BS4 v[112:115],v85,s[8:11],s40 offen sc1
BS4 v[116:119],v85,s[8:11],s41 offen sc1
M16 v[176:179],v[156:159],a[160:163],v[176:179]
s_add_u32 s38, s39, 0
s_add_u32 m0, s45, 0
s_nop 0
BL4 v2,s[8:11],s38 offen lds
M16 v[192:195],v[160:163],a[160:163],v[192:195]
BL4 v2,s[8:11],s38 offen offset:1024 lds
M16 v[208:211],v[164:167],a[160:163],v[208:211]
BL4 v2,s[8:11],s38 offen offset:2048 lds
M16 v[224:227],v[168:171],a[160:163],v[224:227]
BL4 v2,s[8:11],s38 offen offset:3072 lds
M16 v[240:243],v[172:175],a[160:163],v[240:243]
s_waitcnt vmcnt(31)
M16 v[180:183],v[156:159],a[164:167],v[180:183]
s_add_u32 m0, s45, 4096
s_nop 0
BL4 v148,s[8:11],s38 offen lds
M16 v[196:199],v[160:163],a[164:167],v[196:199]
s_add_u32 s38, s39, 40960
s_add_u32 m0, s45, 5120
s_nop 0
BL4 v2,s[8:11],s38 offen lds
M16 v[212:215],v[164:167],a[164:167],v[212:215]
BL4 v2,s[8:11],s38 offen offset:1024 lds
M16 v[228:231],v[168:171],a[164:167],v[228:231]
BL4 v2,s[8:11],s38 offen offset:2048 lds
M16 v[244:247],v[172:175],a[164:167],v[244:247]
s_waitcnt vmcnt(30)
M16 v[184:187],v[156:159],a[168:171],v[184:187]
BL4 v2,s[8:11],s38 offen offset:3072 lds
M16 v[200:203],v[160:163],a[168:171],v[200:203]
s_add_u32 m0, s45, 9216
s_nop 0
BL4 v148,s[8:11],s38 offen lds
M16 v[216:219],v[164:167],a[168:171],v[216:219]
s_mov_b32 s92, s86
s_mov_b32 s93, s87
s_mov_b32 s94, 5242880
M16 v[232:235],v[168:171],a[168:171],v[232:235]
s_mov_b32 s95, 0x00020000
s_add_u32 s12, s20, 1
s_and_b32 s12, s12, 3
M16 v[248:251],v[172:175],a[168:171],v[248:251]
s_waitcnt vmcnt(31)
s_mul_i32 s12, s12, 15360
s_add_u32 s12, s12, 10240
M16 v[188:191],v[156:159],a[172:175],v[188:191]
DR v[156:159],v153 offset:10240
v_add_u32 v16, s12, v2
M16 v[204:207],v[160:163],a[172:175],v[204:207]
DR v[160:163],v153 offset:11264
s_add_u32 s12, s20, 2
M16 v[220:223],v[164:167],a[172:175],v[220:223]
DR v[164:167],v153 offset:12288
s_and_b32 s12, s12, 3
M16 v[236:239],v[168:171],a[172:175],v[236:239]
DR v[168:171],v153 offset:13312
s_mul_i32 s12, s12, 15360
M16 v[252:255],v[172:175],a[172:175],v[252:255]
DR v[172:175],v153 offset:14336
s_waitcnt lgkmcnt(4)
s_waitcnt vmcnt(27)
M16 v[176:179],v[156:159],a[176:179],v[176:179]
s_waitcnt lgkmcnt(3)
s_add_u32 s12, s12, 5120
v_add_u32 v17, s12, v2
M16 v[192:195],v[160:163],a[176:179],v[192:195]
s_waitcnt lgkmcnt(2)
s_add_u32 s12, s20, 3
s_and_b32 s12, s12, 3
M16 v[208:211],v[164:167],a[176:179],v[208:211]
s_waitcnt lgkmcnt(1)
s_mul_i32 s12, s12, 15360
s_add_u32 s12, s12, 0
M16 v[224:227],v[168:171],a[176:179],v[224:227]
s_waitcnt lgkmcnt(0)
v_add_u32 v18, s12, v2
v_add_u32 v19, s31, v2
M16 v[240:243],v[172:175],a[176:179],v[240:243]
s_waitcnt vmcnt(22)
v_and_b32 v10, 15, v1
v_mul_u32_u24 v10, 176, v10
M16 v[180:183],v[156:159],a[180:183],v[180:183]
v_lshrrev_b32 v11, 4, v1
v_lshl_add_u32 v10, v11, 3, v10
M16 v[196:199],v[160:163],a[180:183],v[196:199]
v_add_u32 v20, s31, v10
s_mov_b32 s15, 6554
M16 v[212:215],v[164:167],a[180:183],v[212:215]
v_add_u32 v10, 0, v1
v_min_u32 v10, 159, v10
M16 v[228:231],v[168:171],a[180:183],v[228:231]
v_mul_u32_u24 v11, s15, v10
v_lshrrev_b32 v11, 16, v11
M16 v[244:247],v[172:175],a[180:183],v[244:247]
s_waitcnt vmcnt(19)
v_mul_u32_u24 v12, 10, v11
v_sub_u32 v12, v10, v12
M16 v[184:187],v[156:159],a[184:187],v[184:187]
v_mul_u32_u24 v21, 176, v11
v_lshl_add_u32 v21, v12, 4, v21
M16 v[200:203],v[160:163],a[184:187],v[200:203]
v_add_u32 v21, s31, v21
v_mul_u32_u24 v24, 2560, v11
M16 v[216:219],v[164:167],a[184:187],v[216:219]
v_lshl_add_u32 v24, v12, 4, v24
v_add_u32 v10, 64, v1
M16 v[232:235],v[168:171],a[184:187],v[232:235]
v_min_u32 v10, 159, v10
v_mul_u32_u24 v11, s15, v10
M16 v[248:251],v[172:175],a[184:187],v[248:251]
s_waitcnt vmcnt(14)
v_lshrrev_b32 v11, 16, v11
v_mul_u32_u24 v12, 10, v11
M16 v[188:191],v[156:159],a[188:191],v[188:191]
DR v[156:159],v153 offset:0
v_sub_u32 v12, v10, v12
M16 v[204:207],v[160:163],a[188:191],v[204:207]
DR v[160:163],v153 offset:1024
v_mul_u32_u24 v22, 176, v11
M16 v[220:223],v[164:167],a[188:191],v[220:223]
DR v[164:167],v153 offset:2048
v_lshl_add_u32 v22, v12, 4, v22
M16 v[236:239],v[168:171],a[188:191],v[236:239]
DR v[168:171],v153 offset:3072
v_add_u32 v22, s31, v22
M16 v[252:255],v[172:175],a[188:191],v[252:255]
DR v[172:175],v153 offset:4096
s_waitcnt lgkmcnt(4)
M16 v[176:179],v[156:159],a[0:3],v[176:179]
s_waitcnt lgkmcnt(3)
v_mul_u32_u24 v25, 2560, v11
v_lshl_add_u32 v25, v12, 4, v25
M16 v[192:195],v[160:163],a[0:3],v[192:195]
s_waitcnt lgkmcnt(2)
v_add_u32 v10, 128, v1
v_min_u32 v10, 159, v10
M16 v[208:211],v[164:167],a[0:3],v[208:211]
s_waitcnt lgkmcnt(1)
v_mul_u32_u24 v11, s15, v10
v_lshrrev_b32 v11, 16, v11
M16 v[224:227],v[168:171],a[0:3],v[224:227]
s_waitcnt lgkmcnt(0)
v_mul_u32_u24 v12, 10, v11
v_sub_u32 v12, v10, v12
M16 v[240:243],v[172:175],a[0:3],v[240:243]
v_mul_u32_u24 v23, 176, v11
v_lshl_add_u32 v23, v12, 4, v23
M16 v[180:183],v[156:159],a[4:7],v[180:183]
v_add_u32 v23, s31, v23
v_mul_u32_u24 v26, 2560, v11
M16 v[196:199],v[160:163],a[4:7],v[196:199]
v_lshl_add_u32 v26, v12, 4, v26
s_lshl_b32 s13, s64, 6
M16 v[212:215],v[164:167],a[4:7],v[212:215]
s_lshl_b32 s14, s20, 4
s_add_u32 s13, s13, s14
s_mul_i32 s13, s13, 2560
M16 v[228:231],v[168:171],a[4:7],v[228:231]
s_mul_i32 s14, s65, 160
s_add_u32 s37, s13, s14
M16 v[244:247],v[172:175],a[4:7],v[244:247]
M16 v[184:187],v[156:159],a[8:11],v[184:187]
s_barrier
M16 v[200:203],v[160:163],a[8:11],v[200:203]
M16 v[216:219],v[164:167],a[8:11],v[216:219]
M16 v[232:235],v[168:171],a[8:11],v[232:235]
M16 v[248:251],v[172:175],a[8:11],v[248:251]
s_waitcnt vmcnt(13)
M16 v[188:191],v[156:159],a[12:15],v[188:191]
DR v[156:159],v154 offset:0
M16 v[204:207],v[160:163],a[12:15],v[204:207]
DR v[160:163],v154 offset:1024
M16 v[220:223],v[164:167],a[12:15],v[220:223]
DR v[164:167],v154 offset:2048
M16 v[236:239],v[168:171],a[12:15],v[236:239]
DR v[168:171],v154 offset:3072
M16 v[252:255],v[172:175],a[12:15],v[252:255]
DR v[172:175],v154 offset:4096
s_waitcnt lgkmcnt(4)
s_cmp_lg_u32 s20, 0
s_cbranch_scc1 L_c_w1
M16 v[176:179],v[156:159],a[16:19],v[176:179]
s_waitcnt lgkmcnt(3)
M16 v[192:195],v[160:163],a[16:19],v[192:195]
s_waitcnt lgkmcnt(2)
M16 v[208:211],v[164:167],a[16:19],v[208:211]
s_waitcnt lgkmcnt(1)
M16 v[224:227],v[168:171],a[16:19],v[224:227]
s_waitcnt lgkmcnt(0)
M16 v[240:243],v[172:175],a[16:19],v[240:243]
M16 v[180:183],v[156:159],a[20:23],v[180:183]
buffer_load_dword v27, v155, s[8:11], s36 offen sc1
M16 v[196:199],v[160:163],a[20:23],v[196:199]
M16 v[212:215],v[164:167],a[20:23],v[212:215]
M16 v[228:231],v[168:171],a[20:23],v[228:231]
M16 v[244:247],v[172:175],a[20:23],v[244:247]
M16 v[184:187],v[156:159],a[24:27],v[184:187]
M16 v[200:203],v[160:163],a[24:27],v[200:203]
M16 v[216:219],v[164:167],a[24:27],v[216:219]
v_mov_b32 v28, v176
v_mov_b32 v29, v177
M16 v[232:235],v[168:171],a[24:27],v[232:235]
v_mov_b32 v30, v178
v_mov_b32 v31, v179
M16 v[248:251],v[172:175],a[24:27],v[248:251]
v_mov_b32 v32, v192
v_mov_b32 v33, v193
M16 v[188:191],v[156:159],a[28:31],v[188:191]
v_mov_b32 v34, v194
v_mov_b32 v35, v195
M16 v[204:207],v[160:163],a[28:31],v[204:207]
v_mov_b32 v36, v208
v_mov_b32 v37, v209
M16 v[220:223],v[164:167],a[28:31],v[220:223]
v_mov_b32 v38, v210
v_mov_b32 v39, v211
ds_write_b128 v16, v[180:183] offset:0
M16 v[236:239],v[168:171],a[28:31],v[236:239]
v_mov_b32 v40, v224
v_mov_b32 v41, v225
ds_write_b128 v16, v[196:199] offset:1024
M16 v[252:255],v[172:175],a[28:31],v[252:255]
v_mov_b32 v42, v226
v_mov_b32 v43, v227
ds_write_b128 v16, v[212:215] offset:2048
s_nop 3
v_mov_b32 v44, v240
v_mov_b32 v45, v241
v_mov_b32 v46, v242
v_mov_b32 v47, v243
ds_write_b128 v16, v[228:231] offset:3072
ds_write_b128 v16, v[244:247] offset:4096
ds_write_b128 v17, v[184:187] offset:0
ds_write_b128 v17, v[200:203] offset:1024
ds_write_b128 v17, v[216:219] offset:2048
ds_write_b128 v17, v[232:235] offset:3072
ds_write_b128 v17, v[248:251] offset:4096
ds_write_b128 v18, v[188:191] offset:0
ds_write_b128 v18, v[204:207] offset:1024
ds_write_b128 v18, v[220:223] offset:2048
ds_write_b128 v18, v[236:239] offset:3072
ds_write_b128 v18, v[252:255] offset:4096
s_branch L_c_wd
L_c_w1:
s_cmp_lg_u32 s20, 1
s_cbranch_scc1 L_c_w2
M16 v[176:179],v[156:159],a[16:19],v[176:179]
s_waitcnt lgkmcnt(3)
M16 v[192:195],v[160:163],a[16:19],v[192:195]
s_waitcnt lgkmcnt(2)
M16 v[208:211],v[164:167],a[16:19],v[208:211]
s_waitcnt lgkmcnt(1)
M16 v[224:227],v[168:171],a[16:19],v[224:227]
s_waitcnt lgkmcnt(0)
M16 v[240:243],v[172:175],a[16:19],v[240:243]
M16 v[180:183],v[156:159],a[20:23],v[180:183]
buffer_load_dword v27, v155, s[8:11], s36 offen sc1
M16 v[196:199],v[160:163],a[20:23],v[196:199]
M16 v[212:215],v[164:167],a[20:23],v[212:215]
M16 v[228:231],v[168:171],a[20:23],v[228:231]
M16 v[244:247],v[172:175],a[20:23],v[244:247]
M16 v[184:187],v[156:159],a[24:27],v[184:187]
M16 v[200:203],v[160:163],a[24:27],v[200:203]
M16 v[216:219],v[164:167],a[24:27],v[216:219]
ds_write_b128 v18, v[176:179] offset:0
M16 v[232:235],v[168:171],a[24:27],v[232:235]
ds_write_b128 v18, v[192:195] offset:1024
M16 v[248:251],v[172:175],a[24:27],v[248:251]
ds_write_b128 v18, v[208:211] offset:2048
M16 v[188:191],v[156:159],a[28:31],v[188:191]
ds_write_b128 v18, v[224:227] offset:3072
M16 v[204:207],v[160:163],a[28:31],v[204:207]
ds_write_b128 v18, v[240:243] offset:4096
M16 v[220:223],v[164:167],a[28:31],v[220:223]
v_mov_b32 v28, v180
v_mov_b32 v29, v181
M16 v[236:239],v[168:171],a[28:31],v[236:239]
v_mov_b32 v30, v182
v_mov_b32 v31, v183
M16 v[252:255],v[172:175],a[28:31],v[252:255]
v_mov_b32 v32, v196
v_mov_b32 v33, v197
s_nop 3
v_mov_b32 v34, v198
v_mov_b32 v35, v199
v_mov_b32 v36, v212
v_mov_b32 v37, v213
v_mov_b32 v38, v214
v_mov_b32 v39, v215
v_mov_b32 v40, v228
v_mov_b32 v41, v229
v_mov_b32 v42, v230
v_mov_b32 v43, v231
v_mov_b32 v44, v244
v_mov_b32 v45, v245
v_mov_b32 v46, v246
v_mov_b32 v47, v247
ds_write_b128 v16, v[184:187] offset:0
ds_write_b128 v16, v[200:203] offset:1024
ds_write_b128 v16, v[216:219] offset:2048
ds_write_b128 v16, v[232:235] offset:3072
ds_write_b128 v16, v[248:251] offset:4096
ds_write_b128 v17, v[188:191] offset:0
ds_write_b128 v17, v[204:207] offset:1024
ds_write_b128 v17, v[220:223] offset:2048
ds_write_b128 v17, v[236:239] offset:3072
ds_write_b128 v17, v[252:255] offset:4096
s_branch L_c_wd
L_c_w2:
s_cmp_lg_u32 s20, 2
s_cbranch_scc1 L_c_w3
M16 v[176:179],v[156:159],a[16:19],v[176:179]
s_waitcnt lgkmcnt(3)
M16 v[192:195],v[160:163],a[16:19],v[192:195]
s_waitcnt lgkmcnt(2)
M16 v[208:211],v[164:167],a[16:19],v[208:211]
s_waitcnt lgkmcnt(1)
M16 v[224:227],v[168:171],a[16:19],v[224:227]
s_waitcnt lgkmcnt(0)
M16 v[240:243],v[172:175],a[16:19],v[240:243]
M16 v[180:183],v[156:159],a[20:23],v[180:183]
buffer_load_dword v27, v155, s[8:11], s36 offen sc1
M16 v[196:199],v[160:163],a[20:23],v[196:199]
M16 v[212:215],v[164:167],a[20:23],v[212:215]
M16 v[228:231],v[168:171],a[20:23],v[228:231]
M16 v[244:247],v[172:175],a[20:23],v[244:247]
M16 v[184:187],v[156:159],a[24:27],v[184:187]
M16 v[200:203],v[160:163],a[24:27],v[200:203]
M16 v[216:219],v[164:167],a[24:27],v[216:219]
ds_write_b128 v17, v[176:179] offset:0
M16 v[232:235],v[168:171],a[24:27],v[232:235]
ds_write_b128 v17, v[192:195] offset:1024
M16 v[248:251],v[172:175],a[24:27],v[248:251]
ds_write_b128 v17, v[208:211] offset:2048
M16 v[188:191],v[156:159],a[28:31],v[188:191]
ds_write_b128 v17, v[224:227] offset:3072
M16 v[204:207],v[160:163],a[28:31],v[204:207]
ds_write_b128 v17, v[240:243] offset:4096
M16 v[220:223],v[164:167],a[28:31],v[220:223]
ds_write_b128 v18, v[180:183] offset:0
M16 v[236:239],v[168:171],a[28:31],v[236:239]
ds_write_b128 v18, v[196:199] offset:1024
M16 v[252:255],v[172:175],a[28:31],v[252:255]
ds_write_b128 v18, v[212:215] offset:2048
s_nop 3
ds_write_b128 v18, v[228:231] offset:3072
ds_write_b128 v18, v[244:247] offset:4096
v_mov_b32 v28, v184
v_mov_b32 v29, v185
v_mov_b32 v30, v186
v_mov_b32 v31, v187
v_mov_b32 v32, v200
v_mov_b32 v33, v201
v_mov_b32 v34, v202
v_mov_b32 v35, v203
v_mov_b32 v36, v216
v_mov_b32 v37, v217
v_mov_b32 v38, v218
v_mov_b32 v39, v219
v_mov_b32 v40, v232
v_mov_b32 v41, v233
v_mov_b32 v42, v234
v_mov_b32 v43, v235
v_mov_b32 v44, v248
v_mov_b32 v45, v249
v_mov_b32 v46, v250
v_mov_b32 v47, v251
ds_write_b128 v16, v[188:191] offset:0
ds_write_b128 v16, v[204:207] offset:1024
ds_write_b128 v16, v[220:223] offset:2048
ds_write_b128 v16, v[236:239] offset:3072
ds_write_b128 v16, v[252:255] offset:4096
s_branch L_c_wd
L_c_w3:
M16 v[176:179],v[156:159],a[16:19],v[176:179]
s_waitcnt lgkmcnt(3)
M16 v[192:195],v[160:163],a[16:19],v[192:195]
s_waitcnt lgkmcnt(2)
M16 v[208:211],v[164:167],a[16:19],v[208:211]
s_waitcnt lgkmcnt(1)
M16 v[224:227],v[168:171],a[16:19],v[224:227]
s_waitcnt lgkmcnt(0)
M16 v[240:243],v[172:175],a[16:19],v[240:243]
M16 v[180:183],v[156:159],a[20:23],v[180:183]
buffer_load_dword v27, v155, s[8:11], s36 offen sc1
M16 v[196:199],v[160:163],a[20:23],v[196:199]
M16 v[212:215],v[164:167],a[20:23],v[212:215]
M16 v[228:231],v[168:171],a[20:23],v[228:231]
M16 v[244:247],v[172:175],a[20:23],v[244:247]
M16 v[184:187],v[156:159],a[24:27],v[184:187]
M16 v[200:203],v[160:163],a[24:27],v[200:203]
M16 v[216:219],v[164:167],a[24:27],v[216:219]
ds_write_b128 v16, v[176:179] offset:0
M16 v[232:235],v[168:171],a[24:27],v[232:235]
ds_write_b128 v16, v[192:195] offset:1024
M16 v[248:251],v[172:175],a[24:27],v[248:251]
ds_write_b128 v16, v[208:211] offset:2048
M16 v[188:191],v[156:159],a[28:31],v[188:191]
ds_write_b128 v16, v[224:227] offset:3072
M16 v[204:207],v[160:163],a[28:31],v[204:207]
ds_write_b128 v16, v[240:243] offset:4096
M16 v[220:223],v[164:167],a[28:31],v[220:223]
ds_write_b128 v17, v[180:183] offset:0
M16 v[236:239],v[168:171],a[28:31],v[236:239]
ds_write_b128 v17, v[196:199] offset:1024
M16 v[252:255],v[172:175],a[28:31],v[252:255]
ds_write_b128 v17, v[212:215] offset:2048
s_nop 3
ds_write_b128 v17, v[228:231] offset:3072
ds_write_b128 v17, v[244:247] offset:4096
ds_write_b128 v18, v[184:187] offset:0
ds_write_b128 v18, v[200:203] offset:1024
ds_write_b128 v18, v[216:219] offset:2048
ds_write_b128 v18, v[232:235] offset:3072
ds_write_b128 v18, v[248:251] offset:4096
v_mov_b32 v28, v188
v_mov_b32 v29, v189
v_mov_b32 v30, v190
v_mov_b32 v31, v191
v_mov_b32 v32, v204
v_mov_b32 v33, v205
v_mov_b32 v34, v206
v_mov_b32 v35, v207
v_mov_b32 v36, v220
v_mov_b32 v37, v221
v_mov_b32 v38, v222
v_mov_b32 v39, v223
v_mov_b32 v40, v236
v_mov_b32 v41, v237
v_mov_b32 v42, v238
v_mov_b32 v43, v239
v_mov_b32 v44, v252
v_mov_b32 v45, v253
v_mov_b32 v46, v254
v_mov_b32 v47, v255
L_c_wd:
s_mul_i32 s26, s64, 606208
s_lshl_b32 s12, s20, 10
s_add_u32 s26, s26, s12
s_add_u32 s26, s26, 84410368
s_waitcnt lgkmcnt(0)
s_waitcnt vmcnt(0)
s_barrier
s_cmp_lg_u32 s20, 0
s_cbranch_scc1 L_c_nf1
v_mov_b32 v87, 0
v_mov_b32 v94, 1
s_mov_b64 exec, 1
buffer_store_dword v94, v87, s[8:11], s33 offen sc1
s_mov_b64 exec, -1
L_c_nf1:
DR v[48:51],v19 offset:0
DR v[52:55],v19 offset:1024
DR v[56:59],v19 offset:2048
DR v[60:63],v19 offset:3072
DR v[64:67],v19 offset:4096
DR v[68:71],v19 offset:5120
DR v[72:75],v19 offset:6144
DR v[76:79],v19 offset:7168
DR v[80:83],v19 offset:8192
DR v[84:87],v19 offset:9216
DR v[88:91],v19 offset:10240
DR v[92:95],v19 offset:11264
DR v[96:99],v19 offset:12288
DR v[100:103],v19 offset:13312
DR v[104:107],v19 offset:14336
L_c_f3:
v_cmp_ne_u32 vcc, 0, v27
s_nop 3
s_and_b32 s56, vcc_lo, s30
s_cmp_eq_u32 s56, s30
s_cbranch_scc1 L_c_g3
s_cmp_eq_u32 s3, 0
s_cbranch_scc1 L_c_g3
s_sub_u32 s3, s3, 1
s_sleep 4
buffer_load_dword v27, v155, s[8:11], s36 offen sc1
s_waitcnt vmcnt(0)
s_branch L_c_f3
L_c_g3:
v_add_u32 v153, 61440, v2
v_add_u32 v155, 51200, v153
BL4 a[0:3],v2,s[8:11],s26 offen
s_add_u32 s26, s26, 4096
BL4 a[4:7],v2,s[8:11],s26 offen
s_add_u32 s26, s26, 4096
BL4 a[8:11],v2,s[8:11],s26 offen
s_add_u32 s26, s26, 4096
BL4 a[12:15],v2,s[8:11],s26 offen
s_add_u32 s26, s26, 4096
BL4 a[16:19],v2,s[8:11],s26 offen
s_add_u32 s26, s26, 4096
BL4 a[20:23],v2,s[8:11],s26 offen
s_add_u32 s26, s26, 4096
BL4 a[24:27],v2,s[8:11],s26 offen
s_add_u32 s26, s26, 4096
BL4 a[28:31],v2,s[8:11],s26 offen
s_add_u32 s26, s26, 4096
s_waitcnt lgkmcnt(0)
DR v[176:179],v153 offset:0
DR v[180:183],v153 offset:1024
DR v[184:187],v153 offset:2048
DR v[188:191],v153 offset:3072
DR v[192:195],v153 offset:4096
DR v[196:199],v153 offset:5120
DR v[200:203],v153 offset:6144
DR v[204:207],v153 offset:7168
DR v[208:211],v153 offset:8192
DR v[212:215],v153 offset:9216
s_add_u32 s38, s39, 327680
s_add_u32 m0, s45, 40960
s_nop 0
BL4 v2,s[8:11],s38 offen lds
v_add_f32 v48, v48, v68
v_add_f32 v49, v49, v69
v_add_f32 v50, v50, v70
BL4 v2,s[8:11],s38 offen offset:1024 lds
v_add_f32 v51, v51, v71
v_add_f32 v52, v52, v72
v_add_f32 v53, v53, v73
BL4 v2,s[8:11],s38 offen offset:2048 lds
v_add_f32 v54, v54, v74
v_add_f32 v55, v55, v75
v_add_f32 v56, v56, v76
BL4 v2,s[8:11],s38 offen offset:3072 lds
v_add_f32 v57, v57, v77
v_add_f32 v58, v58, v78
v_add_f32 v59, v59, v79
s_add_u32 m0, s45, 45056
s_nop 0
BL4 v148,s[8:11],s38 offen lds
v_add_f32 v60, v60, v80
v_add_f32 v61, v61, v81
v_add_f32 v62, v62, v82
s_add_u32 s38, s39, 368640
s_add_u32 m0, s45, 46080
s_nop 0
BL4 v2,s[8:11],s38 offen lds
v_add_f32 v63, v63, v83
v_add_f32 v64, v64, v84
v_add_f32 v65, v65, v85
BL4 v2,s[8:11],s38 offen offset:1024 lds
v_add_f32 v66, v66, v86
v_add_f32 v67, v67, v87
v_add_f32 v28, v28, v88
BL4 v2,s[8:11],s38 offen offset:2048 lds
v_add_f32 v29, v29, v89
v_add_f32 v30, v30, v90
v_add_f32 v31, v31, v91
BL4 v2,s[8:11],s38 offen offset:3072 lds
v_add_f32 v32, v32, v92
v_add_f32 v33, v33, v93
v_add_f32 v34, v34, v94
s_add_u32 m0, s45, 50176
s_nop 0
BL4 v148,s[8:11],s38 offen lds
v_add_f32 v35, v35, v95
v_add_f32 v36, v36, v96
v_add_f32 v37, v37, v97
BL4 a[32:35],v2,s[8:11],s26 offen
s_add_u32 s26, s26, 4096
v_add_f32 v38, v38, v98
v_add_f32 v39, v39, v99
v_add_f32 v40, v40, v100
BL4 a[36:39],v2,s[8:11],s26 offen
s_add_u32 s26, s26, 4096
v_add_f32 v41, v41, v101
v_add_f32 v42, v42, v102
v_add_f32 v43, v43, v103
BL4 a[40:43],v2,s[8:11],s26 offen
s_add_u32 s26, s26, 4096
v_add_f32 v44, v44, v104
v_add_f32 v45, v45, v105
v_add_f32 v46, v46, v106
BL4 a[44:47],v2,s[8:11],s26 offen
s_add_u32 s26, s26, 4096
v_add_f32 v47, v47, v107
v_add_f32 v28, v28, v48
v_add_f32 v29, v29, v49
BL4 a[48:51],v2,s[8:11],s26 offen
s_add_u32 s26, s26, 4096
v_add_f32 v30, v30, v50
v_add_f32 v31, v31, v51
v_add_f32 v32, v32, v52
BL4 a[52:55],v2,s[8:11],s26 offen
s_add_u32 s26, s26, 4096
v_add_f32 v33, v33, v53
v_add_f32 v34, v34, v54
v_add_f32 v35, v35, v55
BL4 a[56:59],v2,s[8:11],s26 offen
s_add_u32 s26, s26, 4096
v_add_f32 v36, v36, v56
v_add_f32 v37, v37, v57
v_add_f32 v38, v38, v58
BL4 a[60:63],v2,s[8:11],s26 offen
s_add_u32 s26, s26, 4096
v_add_f32 v39, v39, v59
v_add_f32 v40, v40, v60
v_add_f32 v41, v41, v61
BL4 a[64:67],v2,s[8:11],s26 offen
s_add_u32 s26, s26, 4096
v_add_f32 v42, v42, v62
v_add_f32 v43, v43, v63
v_add_f32 v44, v44, v64
BL4 a[68:71],v2,s[8:11],s26 offen
s_add_u32 s26, s26, 4096
v_add_f32 v45, v45, v65
v_add_f32 v46, v46, v66
v_add_f32 v47, v47, v67
BL4 a[72:75],v2,s[8:11],s26 offen
s_add_u32 s26, s26, 4096
BL4 a[76:79],v2,s[8:11],s26 offen
s_add_u32 s26, s26, 4096
s_waitcnt vmcnt(29)
s_waitcnt lgkmcnt(5)
M16 v[108:111],v[176:179],a[0:3],0
DR v[216:219],v153 offset:10240
CVT v28,v28,v29
M16 v[112:115],v[180:183],a[0:3],0
DR v[220:223],v153 offset:11264
M16 v[116:119],v[184:187],a[0:3],0
DR v[224:227],v153 offset:12288
CVT v29,v30,v31
M16 v[120:123],v[188:191],a[0:3],0
DR v[228:231],v153 offset:13312
M16 v[124:127],v[192:195],a[0:3],0
DR v[232:235],v153 offset:14336
CVT v30,v32,v33
s_waitcnt vmcnt(28)
s_waitcnt lgkmcnt(5)
M16 v[108:111],v[196:199],a[4:7],v[108:111]
DR v[176:179],v153 offset:15360
CVT v31,v34,v35
M16 v[112:115],v[200:203],a[4:7],v[112:115]
DR v[180:183],v153 offset:16384
M16 v[116:119],v[204:207],a[4:7],v[116:119]
DR v[184:187],v153 offset:17408
CVT v32,v36,v37
M16 v[120:123],v[208:211],a[4:7],v[120:123]
DR v[188:191],v153 offset:18432
M16 v[124:127],v[212:215],a[4:7],v[124:127]
DR v[192:195],v153 offset:19456
CVT v33,v38,v39
s_waitcnt vmcnt(27)
s_waitcnt lgkmcnt(5)
M16 v[108:111],v[216:219],a[8:11],v[108:111]
DR v[196:199],v153 offset:20480
CVT v34,v40,v41
M16 v[112:115],v[220:223],a[8:11],v[112:115]
DR v[200:203],v153 offset:21504
M16 v[116:119],v[224:227],a[8:11],v[116:119]
DR v[204:207],v153 offset:22528
CVT v35,v42,v43
M16 v[120:123],v[228:231],a[8:11],v[120:123]
DR v[208:211],v153 offset:23552
M16 v[124:127],v[232:235],a[8:11],v[124:127]
DR v[212:215],v153 offset:24576
CVT v36,v44,v45
s_waitcnt vmcnt(26)
s_waitcnt lgkmcnt(5)
M16 v[108:111],v[176:179],a[12:15],v[108:111]
DR v[216:219],v153 offset:25600
CVT v37,v46,v47
M16 v[112:115],v[180:183],a[12:15],v[112:115]
DR v[220:223],v153 offset:26624
M16 v[116:119],v[184:187],a[12:15],v[116:119]
DR v[224:227],v153 offset:27648
ds_write_b64 v20, v[28:29] offset:0
M16 v[120:123],v[188:191],a[12:15],v[120:123]
DR v[228:231],v153 offset:28672
M16 v[124:127],v[192:195],a[12:15],v[124:127]
DR v[232:235],v153 offset:29696
ds_write_b64 v20, v[30:31] offset:32
s_waitcnt vmcnt(25)
s_waitcnt lgkmcnt(7)
M16 v[108:111],v[196:199],a[16:19],v[108:111]
DR v[176:179],v153 offset:30720
ds_write_b64 v20, v[32:33] offset:64
M16 v[112:115],v[200:203],a[16:19],v[112:115]
DR v[180:183],v153 offset:31744
M16 v[116:119],v[204:207],a[16:19],v[116:119]
DR v[184:187],v153 offset:32768
ds_write_b64 v20, v[34:35] offset:96
M16 v[120:123],v[208:211],a[16:19],v[120:123]
DR v[188:191],v153 offset:33792
M16 v[124:127],v[212:215],a[16:19],v[124:127]
DR v[192:195],v153 offset:34816
ds_write_b64 v20, v[36:37] offset:128
s_waitcnt vmcnt(24)
s_waitcnt lgkmcnt(9)
M16 v[108:111],v[216:219],a[20:23],v[108:111]
DR v[196:199],v153 offset:35840
s_waitcnt lgkmcnt(1)
M16 v[112:115],v[220:223],a[20:23],v[112:115]
DR v[200:203],v153 offset:36864
M16 v[116:119],v[224:227],a[20:23],v[116:119]
DR v[204:207],v153 offset:37888
DR v[48:51],v21
M16 v[120:123],v[228:231],a[20:23],v[120:123]
DR v[208:211],v153 offset:38912
M16 v[124:127],v[232:235],a[20:23],v[124:127]
DR v[212:215],v153 offset:39936
DR v[52:55],v22
s_waitcnt vmcnt(23)
s_waitcnt vmcnt(12)
s_barrier
M16 v[108:111],v[176:179],a[24:27],v[108:111]
DR v[216:219],v153 offset:40960
M16 v[112:115],v[180:183],a[24:27],v[112:115]
DR v[220:223],v153 offset:41984
M16 v[116:119],v[184:187],a[24:27],v[116:119]
DR v[224:227],v153 offset:43008
M16 v[120:123],v[188:191],a[24:27],v[120:123]
DR v[228:231],v153 offset:44032
M16 v[124:127],v[192:195],a[24:27],v[124:127]
DR v[232:235],v153 offset:45056
s_waitcnt lgkmcnt(6)
M16 v[108:111],v[196:199],a[28:31],v[108:111]
DR v[176:179],v153 offset:46080
M16 v[112:115],v[200:203],a[28:31],v[112:115]
DR v[180:183],v153 offset:47104
M16 v[116:119],v[204:207],a[28:31],v[116:119]
DR v[184:187],v153 offset:48128
M16 v[120:123],v[208:211],a[28:31],v[120:123]
DR v[188:191],v153 offset:49152
M16 v[124:127],v[212:215],a[28:31],v[124:127]
DR v[192:195],v153 offset:50176
s_waitcnt vmcnt(11)
s_waitcnt lgkmcnt(5)
M16 v[108:111],v[216:219],a[32:35],v[108:111]
DR v[196:199],v155 offset:0
DR v[56:59],v23
M16 v[112:115],v[220:223],a[32:35],v[112:115]
DR v[200:203],v155 offset:1024
M16 v[116:119],v[224:227],a[32:35],v[116:119]
DR v[204:207],v155 offset:2048
s_waitcnt lgkmcnt(2)
M16 v[120:123],v[228:231],a[32:35],v[120:123]
DR v[208:211],v155 offset:3072
M16 v[124:127],v[232:235],a[32:35],v[124:127]
DR v[212:215],v155 offset:4096
BS4 v[48:51],v24,s[92:95],s37 offen offset:0
s_waitcnt vmcnt(11)
M16 v[108:111],v[176:179],a[36:39],v[108:111]
DR v[216:219],v155 offset:5120
BS4 v[52:55],v25,s[92:95],s37 offen offset:0
M16 v[112:115],v[180:183],a[36:39],v[112:115]
DR v[220:223],v155 offset:6144
M16 v[116:119],v[184:187],a[36:39],v[116:119]
DR v[224:227],v155 offset:7168
BS4 v[56:59],v26,s[92:95],s37 offen offset:0
M16 v[120:123],v[188:191],a[36:39],v[120:123]
DR v[228:231],v155 offset:8192
M16 v[124:127],v[192:195],a[36:39],v[124:127]
DR v[232:235],v155 offset:9216
s_waitcnt vmcnt(12)
s_waitcnt lgkmcnt(5)
M16 v[108:111],v[196:199],a[40:43],v[108:111]
DR v[176:179],v155 offset:10240
M16 v[112:115],v[200:203],a[40:43],v[112:115]
DR v[180:183],v155 offset:11264
M16 v[116:119],v[204:207],a[40:43],v[116:119]
DR v[184:187],v155 offset:12288
M16 v[120:123],v[208:211],a[40:43],v[120:123]
DR v[188:191],v155 offset:13312
M16 v[124:127],v[212:215],a[40:43],v[124:127]
DR v[192:195],v155 offset:14336
s_waitcnt vmcnt(11)
s_waitcnt lgkmcnt(5)
M16 v[108:111],v[216:219],a[44:47],v[108:111]
DR v[196:199],v155 offset:15360
M16 v[112:115],v[220:223],a[44:47],v[112:115]
DR v[200:203],v155 offset:16384
M16 v[116:119],v[224:227],a[44:47],v[116:119]
DR v[204:207],v155 offset:17408
M16 v[120:123],v[228:231],a[44:47],v[120:123]
DR v[208:211],v155 offset:18432
M16 v[124:127],v[232:235],a[44:47],v[124:127]
DR v[212:215],v155 offset:19456
s_waitcnt vmcnt(10)
s_waitcnt lgkmcnt(5)
M16 v[108:111],v[176:179],a[48:51],v[108:111]
DR v[216:219],v155 offset:20480
M16 v[112:115],v[180:183],a[48:51],v[112:115]
DR v[220:223],v155 offset:21504
M16 v[116:119],v[184:187],a[48:51],v[116:119]
DR v[224:227],v155 offset:22528
M16 v[120:123],v[188:191],a[48:51],v[120:123]
DR v[228:231],v155 offset:23552
M16 v[124:127],v[192:195],a[48:51],v[124:127]
DR v[232:235],v155 offset:24576
s_waitcnt vmcnt(9)
s_waitcnt lgkmcnt(5)
M16 v[108:111],v[196:199],a[52:55],v[108:111]
DR v[176:179],v155 offset:25600
M16 v[112:115],v[200:203],a[52:55],v[112:115]
DR v[180:183],v155 offset:26624
M16 v[116:119],v[204:207],a[52:55],v[116:119]
DR v[184:187],v155 offset:27648
M16 v[120:123],v[208:211],a[52:55],v[120:123]
DR v[188:191],v155 offset:28672
M16 v[124:127],v[212:215],a[52:55],v[124:127]
DR v[192:195],v155 offset:29696
s_waitcnt vmcnt(8)
s_waitcnt lgkmcnt(5)
M16 v[108:111],v[216:219],a[56:59],v[108:111]
DR v[196:199],v155 offset:30720
M16 v[112:115],v[220:223],a[56:59],v[112:115]
DR v[200:203],v155 offset:31744
M16 v[116:119],v[224:227],a[56:59],v[116:119]
DR v[204:207],v155 offset:32768
M16 v[120:123],v[228:231],a[56:59],v[120:123]
DR v[208:211],v155 offset:33792
M16 v[124:127],v[232:235],a[56:59],v[124:127]
DR v[212:215],v155 offset:34816
s_waitcnt vmcnt(7)
s_waitcnt lgkmcnt(5)
M16 v[108:111],v[176:179],a[60:63],v[108:111]
DR v[216:219],v155 offset:35840
M16 v[112:115],v[180:183],a[60:63],v[112:115]
DR v[220:223],v155 offset:36864
M16 v[116:119],v[184:187],a[60:63],v[116:119]
DR v[224:227],v155 offset:37888
M16 v[120:123],v[188:191],a[60:63],v[120:123]
DR v[228:231],v155 offset:38912
M16 v[124:127],v[192:195],a[60:63],v[124:127]
DR v[232:235],v155 offset:39936
s_waitcnt vmcnt(6)
s_waitcnt lgkmcnt(5)
M16 v[108:111],v[196:199],a[64:67],v[108:111]
DR v[176:179],v155 offset:40960
M16 v[112:115],v[200:203],a[64:67],v[112:115]
DR v[180:183],v155 offset:41984
M16 v[116:119],v[204:207],a[64:67],v[116:119]
DR v[184:187],v155 offset:43008
M16 v[120:123],v[208:211],a[64:67],v[120:123]
DR v[188:191],v155 offset:44032
M16 v[124:127],v[212:215],a[64:67],v[124:127]
DR v[192:195],v155 offset:45056
s_waitcnt vmcnt(5)
s_waitcnt lgkmcnt(5)
M16 v[108:111],v[216:219],a[68:71],v[108:111]
DR v[196:199],v155 offset:46080
M16 v[112:115],v[220:223],a[68:71],v[112:115]
DR v[200:203],v155 offset:47104
M16 v[116:119],v[224:227],a[68:71],v[116:119]
DR v[204:207],v155 offset:48128
M16 v[120:123],v[228:231],a[68:71],v[120:123]
DR v[208:211],v155 offset:49152
M16 v[124:127],v[232:235],a[68:71],v[124:127]
DR v[212:215],v155 offset:50176
s_waitcnt vmcnt(4)
s_waitcnt lgkmcnt(5)
M16 v[108:111],v[176:179],a[72:75],v[108:111]
M16 v[112:115],v[180:183],a[72:75],v[112:115]
M16 v[116:119],v[184:187],a[72:75],v[116:119]
M16 v[120:123],v[188:191],a[72:75],v[120:123]
M16 v[124:127],v[192:195],a[72:75],v[124:127]
s_waitcnt vmcnt(3)
s_waitcnt lgkmcnt(0)
M16 v[108:111],v[196:199],a[76:79],v[108:111]
M16 v[112:115],v[200:203],a[76:79],v[112:115]
M16 v[116:119],v[204:207],a[76:79],v[116:119]
M16 v[120:123],v[208:211],a[76:79],v[120:123]
M16 v[124:127],v[212:215],a[76:79],v[124:127]
s_nop 7
CVT v108,v108,v109
CVT v109,v110,v111
CVT v110,v112,v113
CVT v111,v114,v115
CVT v112,v116,v117
CVT v113,v118,v119
CVT v114,v120,v121
CVT v115,v122,v123
CVT v116,v124,v125
CVT v117,v126,v127
ds_write_b64 v20, v[108:109] offset:0
ds_write_b64 v20, v[110:111] offset:32
ds_write_b64 v20, v[112:113] offset:64
ds_write_b64 v20, v[114:115] offset:96
ds_write_b64 v20, v[116:117] offset:128
s_waitcnt lgkmcnt(0)
DR v[48:51],v21
DR v[52:55],v22
DR v[56:59],v23
s_waitcnt lgkmcnt(0)
BS4 v[48:51],v24,s[92:95],s37 offen offset:1280
BS4 v[52:55],v25,s[92:95],s37 offen offset:1280
BS4 v[56:59],v26,s[92:95],s37 offen offset:1280
s_endpgm
L_b_slow:
s_nop 7
s_lshl_b32 s14, s2, 2
s_add_u32 s14, s14, s20
s_mul_i32 s14, s14, 20480
s_add_u32 s14, s14, 134217728
BS4 v[176:179],v2,s[8:11],s14 offen offset:0
BS4 v[180:183],v2,s[8:11],s14 offen offset:1024
BS4 v[184:187],v2,s[8:11],s14 offen offset:2048
BS4 v[188:191],v2,s[8:11],s14 offen offset:3072
s_add_u32 s14, s14, 4096
BS4 v[192:195],v2,s[8:11],s14 offen offset:0
BS4 v[196:199],v2,s[8:11],s14 offen offset:1024
BS4 v[200:203],v2,s[8:11],s14 offen offset:2048
BS4 v[204:207],v2,s[8:11],s14 offen offset:3072
s_add_u32 s14, s14, 4096
BS4 v[208:211],v2,s[8:11],s14 offen offset:0
BS4 v[212:215],v2,s[8:11],s14 offen offset:1024
BS4 v[216:219],v2,s[8:11],s14 offen offset:2048
BS4 v[220:223],v2,s[8:11],s14 offen offset:3072
s_add_u32 s14, s14, 4096
BS4 v[224:227],v2,s[8:11],s14 offen offset:0
BS4 v[228:231],v2,s[8:11],s14 offen offset:1024
BS4 v[232:235],v2,s[8:11],s14 offen offset:2048
BS4 v[236:239],v2,s[8:11],s14 offen offset:3072
s_add_u32 s14, s14, 4096
BS4 v[240:243],v2,s[8:11],s14 offen offset:0
BS4 v[244:247],v2,s[8:11],s14 offen offset:1024
BS4 v[248:251],v2,s[8:11],s14 offen offset:2048
BS4 v[252:255],v2,s[8:11],s14 offen offset:3072
s_add_u32 s14, s14, 4096
s_waitcnt vmcnt(0)
s_add_u32 s12, s66, s62
s_mul_i32 s12, s12, 1280
s_add_u32 s12, s12, 67108864
v_mov_b32 v252, 0
v_mov_b32 v253, 0
v_mov_b32 v254, 0xff800000
BL4 v[248:251],v138,s[8:11],s12 offen
s_mov_b32 exec_hi, 0
buffer_load_dwordx2 v[252:253], v138, s[8:11], s12 offen offset:32
s_mov_b32 exec_hi, -1
v_mov_b32 v192, 0
v_mov_b32 v193, 0
v_mov_b32 v194, 0
v_mov_b32 v195, 0
v_mov_b32 v196, 0
v_mov_b32 v197, 0
v_mov_b32 v198, 0
v_mov_b32 v199, 0
v_mov_b32 v200, 0
v_mov_b32 v201, 0
v_mov_b32 v202, 0
v_mov_b32 v203, 0
v_mov_b32 v204, 0
v_mov_b32 v205, 0
v_mov_b32 v206, 0
v_mov_b32 v207, 0
s_mov_b32 s12, 0
L_b_slow0:
s_lshl_b32 s13, s12, 10
s_add_u32 s13, s13, 71303168
BL4 v[232:235],v2,s[8:11],s13 offen
s_lshl_b32 s13, s12, 9
s_add_u32 s13, s13, 71827456
buffer_load_dwordx2 v[236:237], v95, s[8:11], s13 offen
s_waitcnt vmcnt(0)
s_nop 1
M32 v[176:191],v[232:235],v[248:251],v[192:207]
M8 v[176:191],v[236:237],v[252:253],v[176:191]
s_nop 7
s_nop 3
v_max3_f32 v254, v176, v177, v254
v_max3_f32 v254, v178, v179, v254
v_max3_f32 v254, v180, v181, v254
v_max3_f32 v254, v182, v183, v254
v_max3_f32 v254, v184, v185, v254
v_max3_f32 v254, v186, v187, v254
v_max3_f32 v254, v188, v189, v254
v_max3_f32 v254, v190, v191, v254
s_add_u32 s12, s12, 1
s_cmp_lt_u32 s12, 64
s_cbranch_scc1 L_b_slow0
v_mov_b32 v192, v254
s_nop 1
v_permlane32_swap_b32 v254, v192
s_nop 1
v_max_f32 v254, v254, v192
v_sub_f32 v192, 0, v254
v_mov_b32 v208, 0
v_sub_f32 v193, 0, v254
v_mov_b32 v209, 0
v_sub_f32 v194, 0, v254
v_mov_b32 v210, 0
v_sub_f32 v195, 0, v254
v_mov_b32 v211, 0
v_sub_f32 v196, 0, v254
v_mov_b32 v212, 0
v_sub_f32 v197, 0, v254
v_mov_b32 v213, 0
v_sub_f32 v198, 0, v254
v_mov_b32 v214, 0
v_sub_f32 v199, 0, v254
v_mov_b32 v215, 0
v_sub_f32 v200, 0, v254
v_mov_b32 v216, 0
v_sub_f32 v201, 0, v254
v_mov_b32 v217, 0
v_sub_f32 v202, 0, v254
v_mov_b32 v218, 0
v_sub_f32 v203, 0, v254
v_mov_b32 v219, 0
v_sub_f32 v204, 0, v254
v_mov_b32 v220, 0
v_sub_f32 v205, 0, v254
v_mov_b32 v221, 0
v_sub_f32 v206, 0, v254
v_mov_b32 v222, 0
v_sub_f32 v207, 0, v254
v_mov_b32 v223, 0
s_mov_b32 s12, 0
L_b_slow1:
s_lshl_b32 s13, s12, 10
s_add_u32 s13, s13, 71303168
BL4 v[232:235],v2,s[8:11],s13 offen
s_lshl_b32 s13, s12, 9
s_add_u32 s13, s13, 71827456
buffer_load_dwordx2 v[236:237], v95, s[8:11], s13 offen
s_lshl_b32 s13, s12, 11
s_add_u32 s13, s13, 72351744
BL4 v[240:243],v2,s[8:11],s13 offen
BL4 v[244:247],v2,s[8:11],s13 offen offset:1024
s_waitcnt vmcnt(0)
s_nop 1
M32 v[176:191],v[232:235],v[248:251],v[192:207]
M8 v[176:191],v[236:237],v[252:253],v[176:191]
s_nop 7
s_nop 3
EXP v176,v176
EXP v177,v177
EXP v178,v178
EXP v179,v179
EXP v180,v180
EXP v181,v181
EXP v182,v182
EXP v183,v183
EXP v184,v184
EXP v185,v185
EXP v186,v186
EXP v187,v187
EXP v188,v188
EXP v189,v189
EXP v190,v190
EXP v191,v191
s_nop 0
CVT v224,v176,v177
CVT v225,v178,v179
CVT v226,v180,v181
CVT v227,v182,v183
CVT v228,v184,v185
CVT v229,v186,v187
CVT v230,v188,v189
CVT v231,v190,v191
s_nop 1
M32 v[208:223],v[240:243],v[224:227],v[208:223]
M32 v[208:223],v[244:247],v[228:231],v[208:223]
s_nop 7
s_nop 3
s_add_u32 s12, s12, 1
s_cmp_lt_u32 s12, 64
s_cbranch_scc1 L_b_slow1
v_mov_b32 v108, v208
v_mov_b32 v109, v209
v_mov_b32 v110, v210
v_mov_b32 v111, v211
v_mov_b32 v112, v212
v_mov_b32 v113, v213
v_mov_b32 v114, v214
v_mov_b32 v115, v215
v_mov_b32 v116, v216
v_mov_b32 v117, v217
v_mov_b32 v118, v218
v_mov_b32 v119, v219
s_sub_u32 s14, s14, 20480
BL4 v[176:179],v2,s[8:11],s14 offen sc1
BL4 v[180:183],v2,s[8:11],s14 offen offset:1024 sc1
BL4 v[184:187],v2,s[8:11],s14 offen offset:2048 sc1
BL4 v[188:191],v2,s[8:11],s14 offen offset:3072 sc1
s_add_u32 s14, s14, 4096
BL4 v[192:195],v2,s[8:11],s14 offen sc1
BL4 v[196:199],v2,s[8:11],s14 offen offset:1024 sc1
BL4 v[200:203],v2,s[8:11],s14 offen offset:2048 sc1
BL4 v[204:207],v2,s[8:11],s14 offen offset:3072 sc1
s_add_u32 s14, s14, 4096
BL4 v[208:211],v2,s[8:11],s14 offen sc1
BL4 v[212:215],v2,s[8:11],s14 offen offset:1024 sc1
BL4 v[216:219],v2,s[8:11],s14 offen offset:2048 sc1
BL4 v[220:223],v2,s[8:11],s14 offen offset:3072 sc1
s_add_u32 s14, s14, 4096
BL4 v[224:227],v2,s[8:11],s14 offen sc1
BL4 v[228:231],v2,s[8:11],s14 offen offset:1024 sc1
BL4 v[232:235],v2,s[8:11],s14 offen offset:2048 sc1
BL4 v[236:239],v2,s[8:11],s14 offen offset:3072 sc1
s_add_u32 s14, s14, 4096
BL4 v[240:243],v2,s[8:11],s14 offen sc1
BL4 v[244:247],v2,s[8:11],s14 offen offset:1024 sc1
BL4 v[248:251],v2,s[8:11],s14 offen offset:2048 sc1
BL4 v[252:255],v2,s[8:11],s14 offen offset:3072 sc1
s_add_u32 s14, s14, 4096
v_mov_b32 v120, v116
v_mov_b32 v121, v116
s_nop 1
v_permlane32_swap_b32 v120, v121
s_nop 1
v_rcp_f32 v120, v121
s_nop 0
v_mul_f32 v108, v108, v120
v_mul_f32 v109, v109, v120
v_mul_f32 v110, v110, v120
v_mul_f32 v111, v111, v120
v_mul_f32 v112, v112, v120
v_mul_f32 v113, v113, v120
v_mul_f32 v114, v114, v120
v_mul_f32 v115, v115, v120
v_mul_f32 v116, v116, v120
v_mul_f32 v117, v117, v120
v_mul_f32 v118, v118, v120
v_mul_f32 v119, v119, v120
CVT v132,v108,v109
CVT v133,v110,v111
CVT v134,v112,v113
CVT v135,v114,v115
CVT v136,v116,v117
CVT v137,v118,v119
s_waitcnt vmcnt(0)
s_setpc_b64 s[48:49]
L_p3_end:
s_endpgm
.section .rodata,"a"
.p2align 6
.amdhsa_kernel concat_heads__compressed_kv_cla__grouped_kv_mqa__prompt_kernel
  .amdhsa_next_free_vgpr 512
  .amdhsa_next_free_sgpr 102
  .amdhsa_accum_offset 256
  .amdhsa_group_segment_fixed_size 0
  .amdhsa_kernarg_size 112
  .amdhsa_user_sgpr_count 2
  .amdhsa_user_sgpr_kernarg_segment_ptr 1
  .amdhsa_system_sgpr_workgroup_id_x 1
  .amdhsa_float_denorm_mode_32 3
.end_amdhsa_kernel
.text
```
